```python
import torch

def _softmax(x, axis=-1):
    return torch.softmax(x, dim=axis)
def _gelu(x):
    return torch.nn.functional.gelu(x, approximate="tanh")
def _silu(x):
    return torch.nn.functional.silu(x)
def _sigmoid(x):
    return torch.sigmoid(x)
def _layernorm(x, axis=-1, eps=1e-5):
    m = x.mean(dim=axis, keepdim=True)
    v = x.var(dim=axis, keepdim=True, unbiased=False)
    return (x - m) / torch.sqrt(v + eps)
def _scatter_add(tgt, idx, src, axis=0):
    return tgt.clone().index_add_(axis, idx, src)
def _segment_sum(src, seg, n):
    out = torch.zeros((n,) + src.shape[1:], dtype=src.dtype)
    return out.index_add_(0, seg, src)
def _pad(x, pw):
    flat = tuple(v for pair in reversed(pw) for v in pair)
    return torch.nn.functional.pad(x, flat)

kernel_name = 'sequential_preLN__compressed_kv_cla__mixer_token_mlp__prompt'

def setup_inputs():

    _w = (lambda a: (lambda t: t.to(torch.bfloat16) if t.is_floating_point() else t)(torch.as_tensor(a)))
    def _A_setup():
        B, H, Sq, Sk, D, M = 1, 32, 2048, 2048, 128, 576
        Dc = 4 * D
        return {
            "x": _w((lambda *s: torch.randn(*s, dtype=torch.bfloat16) * 0.05)(B, Sq, M)),
            "c_kv": _w((lambda *s: torch.randn(*s, dtype=torch.bfloat16) * 0.2)(B, Sk, Dc)),
            "w_q": _w((lambda *s: torch.randn(*s, dtype=torch.bfloat16) * 3.2)(M, H, D) * (M ** -0.5)),
            "w_uk": _w((lambda *s: torch.randn(*s, dtype=torch.bfloat16) * 6.4)(Dc, H, D) * (Dc ** -0.5)),
            "w_uv": _w((lambda *s: torch.randn(*s, dtype=torch.bfloat16) * 0.2)(Dc, H, D) * (Dc ** -0.5)),
            "w_o": _w((lambda *s: torch.randn(*s, dtype=torch.bfloat16) * 0.2)(H, D, M) * ((H * D) ** -0.5)),
        }
    _A_in = _A_setup()

    def _B_setup():
        B, S, D, F = 1, 2048, 576, 4608
        return {
            "x": _w((lambda *s: torch.randn(*s, dtype=torch.bfloat16) * 0.05)(B, S, D)),
            "w1": _w((lambda *s: torch.randn(*s, dtype=torch.bfloat16) * 0.4)(S, F) * (S ** -0.5)),
            "b1": _w((lambda *s: torch.randn(*s, dtype=torch.bfloat16) * 3.2)(F) * 0.02),
            "w2": _w((lambda *s: torch.randn(*s, dtype=torch.bfloat16) * 0.2)(F, S) * (F ** -0.5)),
            "b2": _w((lambda *s: torch.randn(*s, dtype=torch.bfloat16) * 0.8)(S) * 0.02),
        }
    _B_in = _B_setup()

    return {
        "A_x": _A_in["x"],
        "A_c_kv": _A_in["c_kv"],
        "A_w_q": _A_in["w_q"],
        "A_w_uk": _A_in["w_uk"],
        "A_w_uv": _A_in["w_uv"],
        "A_w_o": _A_in["w_o"],
        "B_x": _B_in["x"],
        "B_w1": _B_in["w1"],
        "B_b1": _B_in["b1"],
        "B_w2": _B_in["w2"],
        "B_b2": _B_in["b2"],
    }

def reference(A_x, A_c_kv, A_w_q, A_w_uk, A_w_uv, A_w_o, B_x, B_w1, B_b1, B_w2, B_b2):
    def _A_ref(x, c_kv, w_q, w_uk, w_uv, w_o):
        B, Sq, M = x.shape[0], x.shape[1], x.shape[2]
        Sk = c_kv.shape[1]
        H, D = w_q.shape[1], w_q.shape[2]
        q = torch.einsum("bqm,mhd->bhqd", x, w_q)
        k = torch.einsum("bkc,chd->bhkd", c_kv, w_uk)
        v = torch.einsum("bkc,chd->bhkd", c_kv, w_uv)
        scores = torch.einsum("bhqd,bhkd->bhqk", q, k) * (D ** -0.5)
        off = Sk - Sq
        qi = torch.arange(Sq)[:, None]
        kj = torch.arange(Sk)[None, :]
        cmask = kj <= (qi + off)
        scores = torch.where(cmask[None, None], scores, -1e9)
        p = _softmax(scores, axis=-1)
        ctx = torch.einsum("bhqk,bhkd->bhqd", p, v)
        return torch.einsum("bhqd,hdm->bqm", ctx, w_o)

    def _B_ref(x, w1, b1, w2, b2):
        B, S, D = x.shape
        h = _layernorm(x, axis=-1)
        u = torch.einsum("bsd,sf->bdf", h, w1) + b1
        u = _gelu(u)
        y = torch.einsum("bdf,fs->bds", u, w2) + b2
        return (lambda x, *d: x.permute(*d))(y, 0, 2, 1)

    x = A_x
    h = x + _A_ref(_layernorm(x, axis=-1), A_c_kv, A_w_q, A_w_uk, A_w_uv, A_w_o)
    h2 = h + _B_ref(_layernorm(h, axis=-1), B_w1, B_b1, B_w2, B_b2)
    return h2
```

```asm
; @launch kernel=kv_kernel grid=(256,1,1) block=(256,1,1) lds=131072
; @launch kernel=at_kernel grid=(256,1,1) block=(256,1,1) lds=163840
; @launch kernel=op_kernel grid=(192,1,1) block=(256,1,1) lds=163840
; @launch kernel=ln_kernel grid=(256,1,1) block=(128,1,1) lds=0
; @launch kernel=w1_kernel grid=(216,1,1) block=(256,1,1) lds=147456
; @launch kernel=w2_kernel grid=(192,1,1) block=(256,1,1) lds=163840
.amdgcn_target "amdgcn-amd-amdhsa--gfx950"
.text
.globl kv_kernel
.p2align 8
.type kv_kernel,@function
kv_kernel:
s_cmp_ge_u32 s2, 256
s_cbranch_scc0 kv_kernel_go
s_endpgm
kv_kernel_go:
v_lshrrev_b32 v1, 6, v0
v_and_b32 v0, 63, v0
s_nop 0
v_readfirstlane_b32 s3, v1
s_load_dwordx2 s[8:9], s[0:1], 8
s_load_dwordx2 s[12:13], s[0:1], 24
s_load_dwordx2 s[16:17], s[0:1], 32
s_load_dwordx2 s[20:21], s[0:1], 104
s_load_dwordx2 s[24:25], s[0:1], 104
s_load_dwordx2 s[28:29], s[0:1], 0
s_load_dwordx2 s[32:33], s[0:1], 104
s_load_dwordx2 s[48:49], s[0:1], 40
s_load_dwordx2 s[52:53], s[0:1], 104
s_load_dwordx2 s[56:57], s[0:1], 16
s_and_b32 s5, s2, 7
s_lshr_b32 s6, s2, 3
s_and_b32 s36, s6, 7
s_lshr_b32 s6, s6, 3
s_and_b32 s7, s6, 1
s_lshl_b32 s5, s5, 1
s_add_u32 s37, s5, s7
s_lshr_b32 s38, s6, 1
s_lshr_b32 s39, s3, 1
s_and_b32 s40, s3, 1
s_lshl_b32 s41, s3, 2
s_lshl_b32 s42, s3, 12
s_lshl_b32 s43, s36, 18
s_lshl_b32 s44, s37, 9
s_lshl_b32 s47, s2, 3
s_lshl_b32 s5, s3, 2
s_add_u32 s47, s47, s5
s_waitcnt lgkmcnt(0)
s_mov_b32 s10, 0x200000
s_mov_b32 s11, 0x00020000
s_mov_b32 s14, 0x400000
s_mov_b32 s15, 0x00020000
s_mov_b32 s18, 0x400000
s_mov_b32 s19, 0x00020000
s_add_u32 s20, s20, 0x400000
s_addc_u32 s21, s21, 0
s_mov_b32 s22, 0x1000000
s_mov_b32 s23, 0x00020000
s_add_u32 s24, s24, 0x1400000
s_addc_u32 s25, s25, 0
s_mov_b32 s26, 0x1000000
s_mov_b32 s27, 0x00020000
s_mov_b32 s30, 0x240000
s_mov_b32 s31, 0x00020000
s_mov_b32 s34, 0x240000
s_mov_b32 s35, 0x00020000
s_mov_b32 s50, 0x480000
s_mov_b32 s51, 0x00020000
s_add_u32 s52, s52, 0x4400000
s_addc_u32 s53, s53, 0
s_mov_b32 s54, 0x480000
s_mov_b32 s55, 0x00020000
s_mov_b32 s58, 0x480000
s_mov_b32 s59, 0x00020000
s_cmp_eq_u32 s38, 1
s_cbranch_scc1 kv_v
v_add_u32 v1, 0, v0
v_lshl_add_u32 v1, s41, 6, v1
v_lshrrev_b32 v2, 5, v1
v_and_b32 v1, 31, v1
v_and_b32 v3, 3, v2
v_lshlrev_b32 v3, 2, v3
v_xor_b32 v1, v1, v3
v_mul_u32_u24 v2, 8192, v2
v_lshl_add_u32 v4, v1, 4, v2
v_add_u32 v1, 64, v0
v_lshl_add_u32 v1, s41, 6, v1
v_lshrrev_b32 v2, 5, v1
v_and_b32 v1, 31, v1
v_and_b32 v3, 3, v2
v_lshlrev_b32 v3, 2, v3
v_xor_b32 v1, v1, v3
v_mul_u32_u24 v2, 8192, v2
v_lshl_add_u32 v5, v1, 4, v2
v_subrev_u32 v5, 1024, v5
v_add_u32 v1, 128, v0
v_lshl_add_u32 v1, s41, 6, v1
v_lshrrev_b32 v2, 5, v1
v_and_b32 v1, 31, v1
v_and_b32 v3, 3, v2
v_lshlrev_b32 v3, 2, v3
v_xor_b32 v1, v1, v3
v_mul_u32_u24 v2, 8192, v2
v_lshl_add_u32 v6, v1, 4, v2
v_subrev_u32 v6, 2048, v6
v_add_u32 v1, 192, v0
v_lshl_add_u32 v1, s41, 6, v1
v_lshrrev_b32 v2, 5, v1
v_and_b32 v1, 31, v1
v_and_b32 v3, 3, v2
v_lshlrev_b32 v3, 2, v3
v_xor_b32 v1, v1, v3
v_mul_u32_u24 v2, 8192, v2
v_lshl_add_u32 v7, v1, 4, v2
v_subrev_u32 v7, 3072, v7
v_add_u32 v1, 0, v0
v_lshl_add_u32 v1, s41, 6, v1
v_lshrrev_b32 v2, 2, v1
v_and_b32 v1, 3, v1
v_bfe_u32 v3, v2, 2, 2
v_xor_b32 v1, v1, v3
v_mul_u32_u24 v2, 1024, v2
v_lshl_add_u32 v8, v1, 4, v2
v_add_u32 v1, 64, v0
v_lshl_add_u32 v1, s41, 6, v1
v_lshrrev_b32 v2, 2, v1
v_and_b32 v1, 3, v1
v_bfe_u32 v3, v2, 2, 2
v_xor_b32 v1, v1, v3
v_mul_u32_u24 v2, 1024, v2
v_lshl_add_u32 v9, v1, 4, v2
v_subrev_u32 v9, 1024, v9
v_add_u32 v1, 128, v0
v_lshl_add_u32 v1, s41, 6, v1
v_lshrrev_b32 v2, 2, v1
v_and_b32 v1, 3, v1
v_bfe_u32 v3, v2, 2, 2
v_xor_b32 v1, v1, v3
v_mul_u32_u24 v2, 1024, v2
v_lshl_add_u32 v10, v1, 4, v2
v_subrev_u32 v10, 2048, v10
v_add_u32 v1, 192, v0
v_lshl_add_u32 v1, s41, 6, v1
v_lshrrev_b32 v2, 2, v1
v_and_b32 v1, 3, v1
v_bfe_u32 v3, v2, 2, 2
v_xor_b32 v1, v1, v3
v_mul_u32_u24 v2, 1024, v2
v_lshl_add_u32 v11, v1, 4, v2
v_subrev_u32 v11, 3072, v11
s_lshl_b32 s45, s39, 8
v_bfe_u32 v1, v0, 2, 2
v_lshrrev_b32 v2, 5, v0
v_lshl_add_u32 v2, v2, 3, v1
v_mul_u32_u24 v2, 512, v2
v_bfe_u32 v3, v0, 4, 1
v_lshl_add_u32 v2, v3, 5, v2
v_and_b32 v3, 3, v0
v_lshl_add_u32 v2, v3, 3, v2
v_add_u32 v2, s45, v2
v_xor_b32 v3, 0, v1
v_lshl_add_u32 v12, v3, 6, v2
v_xor_b32 v3, 1, v1
v_lshl_add_u32 v13, v3, 6, v2
v_xor_b32 v3, 2, v1
v_lshl_add_u32 v14, v3, 6, v2
v_xor_b32 v3, 3, v1
v_lshl_add_u32 v15, v3, 6, v2
v_add_u32 v16, 65536, v12
v_add_u32 v17, 65536, v13
v_add_u32 v18, 65536, v14
v_add_u32 v19, 65536, v15
s_lshl_b32 s45, s40, 13
v_and_b32 v1, 31, v0
v_bfe_u32 v2, v0, 2, 2
v_lshrrev_b32 v3, 5, v0
v_xor_b32 v2, v2, v3
v_lshlrev_b32 v2, 4, v2
v_mul_u32_u24 v1, 64, v1
v_add_u32 v1, v1, v2
v_xor_b32 v20, 0, v1
v_add_u32 v20, s45, v20
v_xor_b32 v21, 32, v1
v_add_u32 v21, s45, v21
v_add_u32 v22, 65536, v20
v_add_u32 v23, 65536, v21
s_cmp_ge_u32 s3, 2
s_cbranch_scc1 L_1
v_lshrrev_b32 v110, 4, v0
v_add_u32 v110, s47, v110
v_mul_u32_u24 v110, 1152, v110
v_and_b32 v166, 15, v0
v_lshl_add_u32 v110, v166, 3, v110
buffer_load_dwordx2 v[112:113], v110, s[28:31], 0 offen offset:0
buffer_load_dwordx2 v[114:115], v110, s[28:31], 0 offen offset:128
buffer_load_dwordx2 v[116:117], v110, s[28:31], 0 offen offset:256
buffer_load_dwordx2 v[118:119], v110, s[28:31], 0 offen offset:384
buffer_load_dwordx2 v[120:121], v110, s[28:31], 0 offen offset:512
buffer_load_dwordx2 v[122:123], v110, s[28:31], 0 offen offset:640
buffer_load_dwordx2 v[124:125], v110, s[28:31], 0 offen offset:768
buffer_load_dwordx2 v[126:127], v110, s[28:31], 0 offen offset:896
buffer_load_dwordx2 v[128:129], v110, s[28:31], 0 offen offset:1024
s_branch L_2
L_1:
s_lshl_b32 s5, s2, 1
s_add_u32 s5, s5, s40
s_mul_i32 s6, s5, 1536
s_mul_i32 s5, s5, 9216
v_lshlrev_b32 v110, 4, v0
buffer_load_dwordx4 v[124:127], v110, s[48:51], s5 offen offset:0
buffer_load_dwordx4 v[128:131], v110, s[48:51], s5 offen offset:1024
buffer_load_dwordx4 v[132:135], v110, s[48:51], s5 offen offset:2048
buffer_load_dwordx4 v[136:139], v110, s[48:51], s5 offen offset:3072
s_add_u32 s5, s5, 4096
buffer_load_dwordx4 v[140:143], v110, s[48:51], s5 offen offset:0
buffer_load_dwordx4 v[144:147], v110, s[48:51], s5 offen offset:1024
buffer_load_dwordx4 v[148:151], v110, s[48:51], s5 offen offset:2048
buffer_load_dwordx4 v[152:155], v110, s[48:51], s5 offen offset:3072
s_add_u32 s5, s5, 4096
buffer_load_dwordx4 v[156:159], v110, s[48:51], s5 offen offset:0
L_2:
s_lshl_b32 s5, s2, 2
s_add_u32 s5, s5, s3
s_mul_i32 s5, s5, 4608
v_mul_u32_u24 v108, 72, v0
buffer_load_dword v109, v108, s[56:59], s5 offen
s_add_u32 m0, s42, 0
s_nop 0
buffer_load_dwordx4 v4, s[12:15], s44 offen offset:0 lds
buffer_load_dwordx4 v5, s[12:15], s44 offen offset:1024 lds
buffer_load_dwordx4 v6, s[12:15], s44 offen offset:2048 lds
buffer_load_dwordx4 v7, s[12:15], s44 offen offset:3072 lds
s_add_u32 m0, s42, 16384
s_nop 0
buffer_load_dwordx4 v8, s[8:11], s43 offen offset:0 lds
buffer_load_dwordx4 v9, s[8:11], s43 offen offset:1024 lds
buffer_load_dwordx4 v10, s[8:11], s43 offen offset:2048 lds
buffer_load_dwordx4 v11, s[8:11], s43 offen offset:3072 lds
s_add_u32 s44, s44, 262144
s_add_u32 s43, s43, 64
s_add_u32 m0, s42, 32768
s_nop 0
buffer_load_dwordx4 v4, s[12:15], s44 offen offset:0 lds
buffer_load_dwordx4 v5, s[12:15], s44 offen offset:1024 lds
buffer_load_dwordx4 v6, s[12:15], s44 offen offset:2048 lds
buffer_load_dwordx4 v7, s[12:15], s44 offen offset:3072 lds
s_add_u32 m0, s42, 49152
s_nop 0
buffer_load_dwordx4 v8, s[8:11], s43 offen offset:0 lds
buffer_load_dwordx4 v9, s[8:11], s43 offen offset:1024 lds
buffer_load_dwordx4 v10, s[8:11], s43 offen offset:2048 lds
buffer_load_dwordx4 v11, s[8:11], s43 offen offset:3072 lds
s_add_u32 s44, s44, 262144
s_add_u32 s43, s43, 64
s_add_u32 m0, s42, 65536
s_nop 0
buffer_load_dwordx4 v4, s[12:15], s44 offen offset:0 lds
buffer_load_dwordx4 v5, s[12:15], s44 offen offset:1024 lds
buffer_load_dwordx4 v6, s[12:15], s44 offen offset:2048 lds
buffer_load_dwordx4 v7, s[12:15], s44 offen offset:3072 lds
s_add_u32 m0, s42, 81920
s_nop 0
buffer_load_dwordx4 v8, s[8:11], s43 offen offset:0 lds
buffer_load_dwordx4 v9, s[8:11], s43 offen offset:1024 lds
buffer_load_dwordx4 v10, s[8:11], s43 offen offset:2048 lds
buffer_load_dwordx4 v11, s[8:11], s43 offen offset:3072 lds
s_add_u32 s44, s44, 262144
s_add_u32 s43, s43, 64
s_add_u32 m0, s42, 98304
s_nop 0
buffer_load_dwordx4 v4, s[12:15], s44 offen offset:0 lds
buffer_load_dwordx4 v5, s[12:15], s44 offen offset:1024 lds
buffer_load_dwordx4 v6, s[12:15], s44 offen offset:2048 lds
buffer_load_dwordx4 v7, s[12:15], s44 offen offset:3072 lds
v_accvgpr_write_b32 a0, 0
v_accvgpr_write_b32 a1, 0
v_accvgpr_write_b32 a2, 0
v_accvgpr_write_b32 a3, 0
v_accvgpr_write_b32 a4, 0
v_accvgpr_write_b32 a5, 0
v_accvgpr_write_b32 a6, 0
v_accvgpr_write_b32 a7, 0
v_accvgpr_write_b32 a8, 0
v_accvgpr_write_b32 a9, 0
v_accvgpr_write_b32 a10, 0
v_accvgpr_write_b32 a11, 0
v_accvgpr_write_b32 a12, 0
v_accvgpr_write_b32 a13, 0
v_accvgpr_write_b32 a14, 0
v_accvgpr_write_b32 a15, 0
v_accvgpr_write_b32 a16, 0
v_accvgpr_write_b32 a17, 0
v_accvgpr_write_b32 a18, 0
v_accvgpr_write_b32 a19, 0
v_accvgpr_write_b32 a20, 0
v_accvgpr_write_b32 a21, 0
v_accvgpr_write_b32 a22, 0
v_accvgpr_write_b32 a23, 0
v_accvgpr_write_b32 a24, 0
v_accvgpr_write_b32 a25, 0
v_accvgpr_write_b32 a26, 0
v_accvgpr_write_b32 a27, 0
v_accvgpr_write_b32 a28, 0
v_accvgpr_write_b32 a29, 0
v_accvgpr_write_b32 a30, 0
v_accvgpr_write_b32 a31, 0
v_accvgpr_write_b32 a32, 0
v_accvgpr_write_b32 a33, 0
v_accvgpr_write_b32 a34, 0
v_accvgpr_write_b32 a35, 0
v_accvgpr_write_b32 a36, 0
v_accvgpr_write_b32 a37, 0
v_accvgpr_write_b32 a38, 0
v_accvgpr_write_b32 a39, 0
v_accvgpr_write_b32 a40, 0
v_accvgpr_write_b32 a41, 0
v_accvgpr_write_b32 a42, 0
v_accvgpr_write_b32 a43, 0
v_accvgpr_write_b32 a44, 0
v_accvgpr_write_b32 a45, 0
v_accvgpr_write_b32 a46, 0
v_accvgpr_write_b32 a47, 0
v_accvgpr_write_b32 a48, 0
v_accvgpr_write_b32 a49, 0
v_accvgpr_write_b32 a50, 0
v_accvgpr_write_b32 a51, 0
v_accvgpr_write_b32 a52, 0
v_accvgpr_write_b32 a53, 0
v_accvgpr_write_b32 a54, 0
v_accvgpr_write_b32 a55, 0
v_accvgpr_write_b32 a56, 0
v_accvgpr_write_b32 a57, 0
v_accvgpr_write_b32 a58, 0
v_accvgpr_write_b32 a59, 0
v_accvgpr_write_b32 a60, 0
v_accvgpr_write_b32 a61, 0
v_accvgpr_write_b32 a62, 0
v_accvgpr_write_b32 a63, 0
v_accvgpr_write_b32 a64, 0
v_accvgpr_write_b32 a65, 0
v_accvgpr_write_b32 a66, 0
v_accvgpr_write_b32 a67, 0
v_accvgpr_write_b32 a68, 0
v_accvgpr_write_b32 a69, 0
v_accvgpr_write_b32 a70, 0
v_accvgpr_write_b32 a71, 0
v_accvgpr_write_b32 a72, 0
v_accvgpr_write_b32 a73, 0
v_accvgpr_write_b32 a74, 0
v_accvgpr_write_b32 a75, 0
v_accvgpr_write_b32 a76, 0
v_accvgpr_write_b32 a77, 0
v_accvgpr_write_b32 a78, 0
v_accvgpr_write_b32 a79, 0
v_accvgpr_write_b32 a80, 0
v_accvgpr_write_b32 a81, 0
v_accvgpr_write_b32 a82, 0
v_accvgpr_write_b32 a83, 0
v_accvgpr_write_b32 a84, 0
v_accvgpr_write_b32 a85, 0
v_accvgpr_write_b32 a86, 0
v_accvgpr_write_b32 a87, 0
v_accvgpr_write_b32 a88, 0
v_accvgpr_write_b32 a89, 0
v_accvgpr_write_b32 a90, 0
v_accvgpr_write_b32 a91, 0
v_accvgpr_write_b32 a92, 0
v_accvgpr_write_b32 a93, 0
v_accvgpr_write_b32 a94, 0
v_accvgpr_write_b32 a95, 0
v_accvgpr_write_b32 a96, 0
v_accvgpr_write_b32 a97, 0
v_accvgpr_write_b32 a98, 0
v_accvgpr_write_b32 a99, 0
v_accvgpr_write_b32 a100, 0
v_accvgpr_write_b32 a101, 0
v_accvgpr_write_b32 a102, 0
v_accvgpr_write_b32 a103, 0
v_accvgpr_write_b32 a104, 0
v_accvgpr_write_b32 a105, 0
v_accvgpr_write_b32 a106, 0
v_accvgpr_write_b32 a107, 0
v_accvgpr_write_b32 a108, 0
v_accvgpr_write_b32 a109, 0
v_accvgpr_write_b32 a110, 0
v_accvgpr_write_b32 a111, 0
v_accvgpr_write_b32 a112, 0
v_accvgpr_write_b32 a113, 0
v_accvgpr_write_b32 a114, 0
v_accvgpr_write_b32 a115, 0
v_accvgpr_write_b32 a116, 0
v_accvgpr_write_b32 a117, 0
v_accvgpr_write_b32 a118, 0
v_accvgpr_write_b32 a119, 0
v_accvgpr_write_b32 a120, 0
v_accvgpr_write_b32 a121, 0
v_accvgpr_write_b32 a122, 0
v_accvgpr_write_b32 a123, 0
v_accvgpr_write_b32 a124, 0
v_accvgpr_write_b32 a125, 0
v_accvgpr_write_b32 a126, 0
v_accvgpr_write_b32 a127, 0
v_accvgpr_write_b32 a128, 0
v_accvgpr_write_b32 a129, 0
v_accvgpr_write_b32 a130, 0
v_accvgpr_write_b32 a131, 0
v_accvgpr_write_b32 a132, 0
v_accvgpr_write_b32 a133, 0
v_accvgpr_write_b32 a134, 0
v_accvgpr_write_b32 a135, 0
v_accvgpr_write_b32 a136, 0
v_accvgpr_write_b32 a137, 0
v_accvgpr_write_b32 a138, 0
v_accvgpr_write_b32 a139, 0
v_accvgpr_write_b32 a140, 0
v_accvgpr_write_b32 a141, 0
v_accvgpr_write_b32 a142, 0
v_accvgpr_write_b32 a143, 0
v_accvgpr_write_b32 a144, 0
v_accvgpr_write_b32 a145, 0
v_accvgpr_write_b32 a146, 0
v_accvgpr_write_b32 a147, 0
v_accvgpr_write_b32 a148, 0
v_accvgpr_write_b32 a149, 0
v_accvgpr_write_b32 a150, 0
v_accvgpr_write_b32 a151, 0
v_accvgpr_write_b32 a152, 0
v_accvgpr_write_b32 a153, 0
v_accvgpr_write_b32 a154, 0
v_accvgpr_write_b32 a155, 0
v_accvgpr_write_b32 a156, 0
v_accvgpr_write_b32 a157, 0
v_accvgpr_write_b32 a158, 0
v_accvgpr_write_b32 a159, 0
v_accvgpr_write_b32 a160, 0
v_accvgpr_write_b32 a161, 0
v_accvgpr_write_b32 a162, 0
v_accvgpr_write_b32 a163, 0
v_accvgpr_write_b32 a164, 0
v_accvgpr_write_b32 a165, 0
v_accvgpr_write_b32 a166, 0
v_accvgpr_write_b32 a167, 0
v_accvgpr_write_b32 a168, 0
v_accvgpr_write_b32 a169, 0
v_accvgpr_write_b32 a170, 0
v_accvgpr_write_b32 a171, 0
v_accvgpr_write_b32 a172, 0
v_accvgpr_write_b32 a173, 0
v_accvgpr_write_b32 a174, 0
v_accvgpr_write_b32 a175, 0
v_accvgpr_write_b32 a176, 0
v_accvgpr_write_b32 a177, 0
v_accvgpr_write_b32 a178, 0
v_accvgpr_write_b32 a179, 0
v_accvgpr_write_b32 a180, 0
v_accvgpr_write_b32 a181, 0
v_accvgpr_write_b32 a182, 0
v_accvgpr_write_b32 a183, 0
v_accvgpr_write_b32 a184, 0
v_accvgpr_write_b32 a185, 0
v_accvgpr_write_b32 a186, 0
v_accvgpr_write_b32 a187, 0
v_accvgpr_write_b32 a188, 0
v_accvgpr_write_b32 a189, 0
v_accvgpr_write_b32 a190, 0
v_accvgpr_write_b32 a191, 0
v_accvgpr_write_b32 a192, 0
v_accvgpr_write_b32 a193, 0
v_accvgpr_write_b32 a194, 0
v_accvgpr_write_b32 a195, 0
v_accvgpr_write_b32 a196, 0
v_accvgpr_write_b32 a197, 0
v_accvgpr_write_b32 a198, 0
v_accvgpr_write_b32 a199, 0
v_accvgpr_write_b32 a200, 0
v_accvgpr_write_b32 a201, 0
v_accvgpr_write_b32 a202, 0
v_accvgpr_write_b32 a203, 0
v_accvgpr_write_b32 a204, 0
v_accvgpr_write_b32 a205, 0
v_accvgpr_write_b32 a206, 0
v_accvgpr_write_b32 a207, 0
v_accvgpr_write_b32 a208, 0
v_accvgpr_write_b32 a209, 0
v_accvgpr_write_b32 a210, 0
v_accvgpr_write_b32 a211, 0
v_accvgpr_write_b32 a212, 0
v_accvgpr_write_b32 a213, 0
v_accvgpr_write_b32 a214, 0
v_accvgpr_write_b32 a215, 0
v_accvgpr_write_b32 a216, 0
v_accvgpr_write_b32 a217, 0
v_accvgpr_write_b32 a218, 0
v_accvgpr_write_b32 a219, 0
v_accvgpr_write_b32 a220, 0
v_accvgpr_write_b32 a221, 0
v_accvgpr_write_b32 a222, 0
v_accvgpr_write_b32 a223, 0
v_accvgpr_write_b32 a224, 0
v_accvgpr_write_b32 a225, 0
v_accvgpr_write_b32 a226, 0
v_accvgpr_write_b32 a227, 0
v_accvgpr_write_b32 a228, 0
v_accvgpr_write_b32 a229, 0
v_accvgpr_write_b32 a230, 0
v_accvgpr_write_b32 a231, 0
v_accvgpr_write_b32 a232, 0
v_accvgpr_write_b32 a233, 0
v_accvgpr_write_b32 a234, 0
v_accvgpr_write_b32 a235, 0
v_accvgpr_write_b32 a236, 0
v_accvgpr_write_b32 a237, 0
v_accvgpr_write_b32 a238, 0
v_accvgpr_write_b32 a239, 0
v_accvgpr_write_b32 a240, 0
v_accvgpr_write_b32 a241, 0
v_accvgpr_write_b32 a242, 0
v_accvgpr_write_b32 a243, 0
v_accvgpr_write_b32 a244, 0
v_accvgpr_write_b32 a245, 0
v_accvgpr_write_b32 a246, 0
v_accvgpr_write_b32 a247, 0
v_accvgpr_write_b32 a248, 0
v_accvgpr_write_b32 a249, 0
v_accvgpr_write_b32 a250, 0
v_accvgpr_write_b32 a251, 0
v_accvgpr_write_b32 a252, 0
v_accvgpr_write_b32 a253, 0
v_accvgpr_write_b32 a254, 0
v_accvgpr_write_b32 a255, 0
s_waitcnt vmcnt(28)
s_cmp_ge_u32 s3, 2
s_cbranch_scc1 L_3
v_lshlrev_b32 v130, 16, v112
v_and_b32 v131, 0xffff0000, v112
v_lshlrev_b32 v132, 16, v113
v_and_b32 v133, 0xffff0000, v113
v_lshlrev_b32 v134, 16, v114
v_and_b32 v135, 0xffff0000, v114
v_lshlrev_b32 v136, 16, v115
v_and_b32 v137, 0xffff0000, v115
v_lshlrev_b32 v138, 16, v116
v_and_b32 v139, 0xffff0000, v116
v_lshlrev_b32 v140, 16, v117
v_and_b32 v141, 0xffff0000, v117
v_lshlrev_b32 v142, 16, v118
v_and_b32 v143, 0xffff0000, v118
v_lshlrev_b32 v144, 16, v119
v_and_b32 v145, 0xffff0000, v119
v_lshlrev_b32 v146, 16, v120
v_and_b32 v147, 0xffff0000, v120
v_lshlrev_b32 v148, 16, v121
v_and_b32 v149, 0xffff0000, v121
v_lshlrev_b32 v150, 16, v122
v_and_b32 v151, 0xffff0000, v122
v_lshlrev_b32 v152, 16, v123
v_and_b32 v153, 0xffff0000, v123
v_lshlrev_b32 v154, 16, v124
v_and_b32 v155, 0xffff0000, v124
v_lshlrev_b32 v156, 16, v125
v_and_b32 v157, 0xffff0000, v125
v_lshlrev_b32 v158, 16, v126
v_and_b32 v159, 0xffff0000, v126
v_lshlrev_b32 v160, 16, v127
v_and_b32 v161, 0xffff0000, v127
v_lshlrev_b32 v162, 16, v128
v_and_b32 v163, 0xffff0000, v128
v_lshlrev_b32 v164, 16, v129
v_and_b32 v165, 0xffff0000, v129
v_add_f32 v166, v130, v131
v_add_f32 v166, v166, v132
v_add_f32 v166, v166, v133
v_add_f32 v166, v166, v134
v_add_f32 v166, v166, v135
v_add_f32 v166, v166, v136
v_add_f32 v166, v166, v137
v_add_f32 v166, v166, v138
v_add_f32 v166, v166, v139
v_add_f32 v166, v166, v140
v_add_f32 v166, v166, v141
v_add_f32 v166, v166, v142
v_add_f32 v166, v166, v143
v_add_f32 v166, v166, v144
v_add_f32 v166, v166, v145
v_add_f32 v166, v166, v146
v_add_f32 v166, v166, v147
v_add_f32 v166, v166, v148
v_add_f32 v166, v166, v149
v_add_f32 v166, v166, v150
v_add_f32 v166, v166, v151
v_add_f32 v166, v166, v152
v_add_f32 v166, v166, v153
v_add_f32 v166, v166, v154
v_add_f32 v166, v166, v155
v_add_f32 v166, v166, v156
v_add_f32 v166, v166, v157
v_add_f32 v166, v166, v158
v_add_f32 v166, v166, v159
v_add_f32 v166, v166, v160
v_add_f32 v166, v166, v161
v_add_f32 v166, v166, v162
v_add_f32 v166, v166, v163
v_add_f32 v166, v166, v164
v_add_f32 v166, v166, v165
s_nop 1
v_add_f32_dpp v166, v166, v166 row_ror:8 row_mask:0xf bank_mask:0xf
s_nop 1
v_add_f32_dpp v166, v166, v166 row_ror:4 row_mask:0xf bank_mask:0xf
s_nop 1
v_add_f32_dpp v166, v166, v166 row_ror:2 row_mask:0xf bank_mask:0xf
s_nop 1
v_add_f32_dpp v166, v166, v166 row_ror:1 row_mask:0xf bank_mask:0xf
v_mul_f32 v166, 0x3ae38e39, v166
v_sub_f32 v130, v130, v166
v_sub_f32 v131, v131, v166
v_sub_f32 v132, v132, v166
v_sub_f32 v133, v133, v166
v_sub_f32 v134, v134, v166
v_sub_f32 v135, v135, v166
v_sub_f32 v136, v136, v166
v_sub_f32 v137, v137, v166
v_sub_f32 v138, v138, v166
v_sub_f32 v139, v139, v166
v_sub_f32 v140, v140, v166
v_sub_f32 v141, v141, v166
v_sub_f32 v142, v142, v166
v_sub_f32 v143, v143, v166
v_sub_f32 v144, v144, v166
v_sub_f32 v145, v145, v166
v_sub_f32 v146, v146, v166
v_sub_f32 v147, v147, v166
v_sub_f32 v148, v148, v166
v_sub_f32 v149, v149, v166
v_sub_f32 v150, v150, v166
v_sub_f32 v151, v151, v166
v_sub_f32 v152, v152, v166
v_sub_f32 v153, v153, v166
v_sub_f32 v154, v154, v166
v_sub_f32 v155, v155, v166
v_sub_f32 v156, v156, v166
v_sub_f32 v157, v157, v166
v_sub_f32 v158, v158, v166
v_sub_f32 v159, v159, v166
v_sub_f32 v160, v160, v166
v_sub_f32 v161, v161, v166
v_sub_f32 v162, v162, v166
v_sub_f32 v163, v163, v166
v_sub_f32 v164, v164, v166
v_sub_f32 v165, v165, v166
v_mul_f32 v166, v130, v130
v_fmac_f32 v166, v131, v131
v_fmac_f32 v166, v132, v132
v_fmac_f32 v166, v133, v133
v_fmac_f32 v166, v134, v134
v_fmac_f32 v166, v135, v135
v_fmac_f32 v166, v136, v136
v_fmac_f32 v166, v137, v137
v_fmac_f32 v166, v138, v138
v_fmac_f32 v166, v139, v139
v_fmac_f32 v166, v140, v140
v_fmac_f32 v166, v141, v141
v_fmac_f32 v166, v142, v142
v_fmac_f32 v166, v143, v143
v_fmac_f32 v166, v144, v144
v_fmac_f32 v166, v145, v145
v_fmac_f32 v166, v146, v146
v_fmac_f32 v166, v147, v147
v_fmac_f32 v166, v148, v148
v_fmac_f32 v166, v149, v149
v_fmac_f32 v166, v150, v150
v_fmac_f32 v166, v151, v151
v_fmac_f32 v166, v152, v152
v_fmac_f32 v166, v153, v153
v_fmac_f32 v166, v154, v154
v_fmac_f32 v166, v155, v155
v_fmac_f32 v166, v156, v156
v_fmac_f32 v166, v157, v157
v_fmac_f32 v166, v158, v158
v_fmac_f32 v166, v159, v159
v_fmac_f32 v166, v160, v160
v_fmac_f32 v166, v161, v161
v_fmac_f32 v166, v162, v162
v_fmac_f32 v166, v163, v163
v_fmac_f32 v166, v164, v164
v_fmac_f32 v166, v165, v165
s_nop 1
v_add_f32_dpp v166, v166, v166 row_ror:8 row_mask:0xf bank_mask:0xf
s_nop 1
v_add_f32_dpp v166, v166, v166 row_ror:4 row_mask:0xf bank_mask:0xf
s_nop 1
v_add_f32_dpp v166, v166, v166 row_ror:2 row_mask:0xf bank_mask:0xf
s_nop 1
v_add_f32_dpp v166, v166, v166 row_ror:1 row_mask:0xf bank_mask:0xf
v_mov_b32 v167, 0x3727c5ac
v_fmac_f32 v167, 0x3ae38e39, v166
v_rsq_f32 v166, v167
s_nop 0
v_mul_f32 v130, v130, v166
v_mul_f32 v131, v131, v166
v_mul_f32 v132, v132, v166
v_mul_f32 v133, v133, v166
v_mul_f32 v134, v134, v166
v_mul_f32 v135, v135, v166
v_mul_f32 v136, v136, v166
v_mul_f32 v137, v137, v166
v_mul_f32 v138, v138, v166
v_mul_f32 v139, v139, v166
v_mul_f32 v140, v140, v166
v_mul_f32 v141, v141, v166
v_mul_f32 v142, v142, v166
v_mul_f32 v143, v143, v166
v_mul_f32 v144, v144, v166
v_mul_f32 v145, v145, v166
v_mul_f32 v146, v146, v166
v_mul_f32 v147, v147, v166
v_mul_f32 v148, v148, v166
v_mul_f32 v149, v149, v166
v_mul_f32 v150, v150, v166
v_mul_f32 v151, v151, v166
v_mul_f32 v152, v152, v166
v_mul_f32 v153, v153, v166
v_mul_f32 v154, v154, v166
v_mul_f32 v155, v155, v166
v_mul_f32 v156, v156, v166
v_mul_f32 v157, v157, v166
v_mul_f32 v158, v158, v166
v_mul_f32 v159, v159, v166
v_mul_f32 v160, v160, v166
v_mul_f32 v161, v161, v166
v_mul_f32 v162, v162, v166
v_mul_f32 v163, v163, v166
v_mul_f32 v164, v164, v166
v_mul_f32 v165, v165, v166
v_cvt_pk_bf16_f32 v112, v130, v131
v_cvt_pk_bf16_f32 v113, v132, v133
v_cvt_pk_bf16_f32 v114, v134, v135
v_cvt_pk_bf16_f32 v115, v136, v137
v_cvt_pk_bf16_f32 v116, v138, v139
v_cvt_pk_bf16_f32 v117, v140, v141
v_cvt_pk_bf16_f32 v118, v142, v143
v_cvt_pk_bf16_f32 v119, v144, v145
v_cvt_pk_bf16_f32 v120, v146, v147
v_cvt_pk_bf16_f32 v121, v148, v149
v_cvt_pk_bf16_f32 v122, v150, v151
v_cvt_pk_bf16_f32 v123, v152, v153
v_cvt_pk_bf16_f32 v124, v154, v155
v_cvt_pk_bf16_f32 v125, v156, v157
v_cvt_pk_bf16_f32 v126, v158, v159
v_cvt_pk_bf16_f32 v127, v160, v161
v_cvt_pk_bf16_f32 v128, v162, v163
v_cvt_pk_bf16_f32 v129, v164, v165
buffer_store_dwordx2 v[112:113], v110, s[32:35], 0 offen offset:0
buffer_store_dwordx2 v[114:115], v110, s[32:35], 0 offen offset:128
buffer_store_dwordx2 v[116:117], v110, s[32:35], 0 offen offset:256
buffer_store_dwordx2 v[118:119], v110, s[32:35], 0 offen offset:384
buffer_store_dwordx2 v[120:121], v110, s[32:35], 0 offen offset:512
buffer_store_dwordx2 v[122:123], v110, s[32:35], 0 offen offset:640
buffer_store_dwordx2 v[124:125], v110, s[32:35], 0 offen offset:768
buffer_store_dwordx2 v[126:127], v110, s[32:35], 0 offen offset:896
buffer_store_dwordx2 v[128:129], v110, s[32:35], 0 offen offset:1024
s_branch L_4
L_3:
s_lshl_b32 s5, s2, 1
s_add_u32 s5, s5, s40
s_mul_i32 s6, s5, 1536
s_mul_i32 s5, s5, 9216
v_lshlrev_b32 v110, 4, v0
v_add_u32 v110, 0, v0
v_mul_u32_u24 v111, 911, v110
v_lshrrev_b32 v111, 16, v111
v_mul_u32_u24 v112, 72, v111
v_sub_u32 v110, v110, v112
v_mul_u32_u24 v112, 0x5556, v110
v_lshrrev_b32 v112, 18, v112
v_mul_u32_u24 v112, 786240, v112
v_mul_u32_u24 v111, 192, v111
v_lshl_add_u32 v110, v110, 4, v111
v_add_u32 v113, v110, v112
buffer_store_dwordx4 v[124:127], v113, s[52:55], s6 offen
v_add_u32 v110, 64, v0
v_mul_u32_u24 v111, 911, v110
v_lshrrev_b32 v111, 16, v111
v_mul_u32_u24 v112, 72, v111
v_sub_u32 v110, v110, v112
v_mul_u32_u24 v112, 0x5556, v110
v_lshrrev_b32 v112, 18, v112
v_mul_u32_u24 v112, 786240, v112
v_mul_u32_u24 v111, 192, v111
v_lshl_add_u32 v110, v110, 4, v111
v_add_u32 v114, v110, v112
buffer_store_dwordx4 v[128:131], v114, s[52:55], s6 offen
v_add_u32 v110, 128, v0
v_mul_u32_u24 v111, 911, v110
v_lshrrev_b32 v111, 16, v111
v_mul_u32_u24 v112, 72, v111
v_sub_u32 v110, v110, v112
v_mul_u32_u24 v112, 0x5556, v110
v_lshrrev_b32 v112, 18, v112
v_mul_u32_u24 v112, 786240, v112
v_mul_u32_u24 v111, 192, v111
v_lshl_add_u32 v110, v110, 4, v111
v_add_u32 v115, v110, v112
buffer_store_dwordx4 v[132:135], v115, s[52:55], s6 offen
v_add_u32 v110, 192, v0
v_mul_u32_u24 v111, 911, v110
v_lshrrev_b32 v111, 16, v111
v_mul_u32_u24 v112, 72, v111
v_sub_u32 v110, v110, v112
v_mul_u32_u24 v112, 0x5556, v110
v_lshrrev_b32 v112, 18, v112
v_mul_u32_u24 v112, 786240, v112
v_mul_u32_u24 v111, 192, v111
v_lshl_add_u32 v110, v110, 4, v111
v_add_u32 v116, v110, v112
buffer_store_dwordx4 v[136:139], v116, s[52:55], s6 offen
v_add_u32 v110, 256, v0
v_mul_u32_u24 v111, 911, v110
v_lshrrev_b32 v111, 16, v111
v_mul_u32_u24 v112, 72, v111
v_sub_u32 v110, v110, v112
v_mul_u32_u24 v112, 0x5556, v110
v_lshrrev_b32 v112, 18, v112
v_mul_u32_u24 v112, 786240, v112
v_mul_u32_u24 v111, 192, v111
v_lshl_add_u32 v110, v110, 4, v111
v_add_u32 v117, v110, v112
buffer_store_dwordx4 v[140:143], v117, s[52:55], s6 offen
v_add_u32 v110, 320, v0
v_mul_u32_u24 v111, 911, v110
v_lshrrev_b32 v111, 16, v111
v_mul_u32_u24 v112, 72, v111
v_sub_u32 v110, v110, v112
v_mul_u32_u24 v112, 0x5556, v110
v_lshrrev_b32 v112, 18, v112
v_mul_u32_u24 v112, 786240, v112
v_mul_u32_u24 v111, 192, v111
v_lshl_add_u32 v110, v110, 4, v111
v_add_u32 v118, v110, v112
buffer_store_dwordx4 v[144:147], v118, s[52:55], s6 offen
v_add_u32 v110, 384, v0
v_mul_u32_u24 v111, 911, v110
v_lshrrev_b32 v111, 16, v111
v_mul_u32_u24 v112, 72, v111
v_sub_u32 v110, v110, v112
v_mul_u32_u24 v112, 0x5556, v110
v_lshrrev_b32 v112, 18, v112
v_mul_u32_u24 v112, 786240, v112
v_mul_u32_u24 v111, 192, v111
v_lshl_add_u32 v110, v110, 4, v111
v_add_u32 v119, v110, v112
buffer_store_dwordx4 v[148:151], v119, s[52:55], s6 offen
v_add_u32 v110, 448, v0
v_mul_u32_u24 v111, 911, v110
v_lshrrev_b32 v111, 16, v111
v_mul_u32_u24 v112, 72, v111
v_sub_u32 v110, v110, v112
v_mul_u32_u24 v112, 0x5556, v110
v_lshrrev_b32 v112, 18, v112
v_mul_u32_u24 v112, 786240, v112
v_mul_u32_u24 v111, 192, v111
v_lshl_add_u32 v110, v110, 4, v111
v_add_u32 v120, v110, v112
buffer_store_dwordx4 v[152:155], v120, s[52:55], s6 offen
v_add_u32 v110, 512, v0
v_mul_u32_u24 v111, 911, v110
v_lshrrev_b32 v111, 16, v111
v_mul_u32_u24 v112, 72, v111
v_sub_u32 v110, v110, v112
v_mul_u32_u24 v112, 0x5556, v110
v_lshrrev_b32 v112, 18, v112
v_mul_u32_u24 v112, 786240, v112
v_mul_u32_u24 v111, 192, v111
v_lshl_add_u32 v110, v110, 4, v111
v_add_u32 v121, v110, v112
buffer_store_dwordx4 v[156:159], v121, s[52:55], s6 offen
L_4:
s_waitcnt vmcnt(29)
s_barrier
ds_read_b64_tr_b16 v[32:33], v12 offset:0
ds_read_b64_tr_b16 v[34:35], v12 offset:2048
ds_read_b64_tr_b16 v[36:37], v13 offset:0
ds_read_b64_tr_b16 v[38:39], v13 offset:2048
ds_read_b64_tr_b16 v[40:41], v14 offset:0
ds_read_b64_tr_b16 v[42:43], v14 offset:2048
ds_read_b64_tr_b16 v[44:45], v15 offset:0
ds_read_b64_tr_b16 v[46:47], v15 offset:2048
ds_read_b128 v[48:51], v20 offset:16384
ds_read_b128 v[52:55], v20 offset:18432
ds_read_b128 v[56:59], v20 offset:20480
ds_read_b128 v[60:63], v20 offset:22528
s_mov_b32 s4, 3
gl_5:
s_waitcnt lgkmcnt(0)
v_mfma_f32_32x32x16_bf16 a[0:15], v[32:35], v[48:51], a[0:15]
ds_read_b64_tr_b16 v[64:65], v12 offset:8192
ds_read_b64_tr_b16 v[66:67], v12 offset:10240
v_mfma_f32_32x32x16_bf16 a[16:31], v[32:35], v[52:55], a[16:31]
ds_read_b64_tr_b16 v[68:69], v13 offset:8192
v_mfma_f32_32x32x16_bf16 a[32:47], v[32:35], v[56:59], a[32:47]
ds_read_b64_tr_b16 v[70:71], v13 offset:10240
v_mfma_f32_32x32x16_bf16 a[48:63], v[32:35], v[60:63], a[48:63]
ds_read_b64_tr_b16 v[72:73], v14 offset:8192
v_mfma_f32_32x32x16_bf16 a[64:79], v[36:39], v[48:51], a[64:79]
ds_read_b64_tr_b16 v[74:75], v14 offset:10240
v_mfma_f32_32x32x16_bf16 a[80:95], v[36:39], v[52:55], a[80:95]
ds_read_b64_tr_b16 v[76:77], v15 offset:8192
ds_read_b64_tr_b16 v[78:79], v15 offset:10240
v_mfma_f32_32x32x16_bf16 a[96:111], v[36:39], v[56:59], a[96:111]
ds_read_b128 v[80:83], v21 offset:16384
v_mfma_f32_32x32x16_bf16 a[112:127], v[36:39], v[60:63], a[112:127]
ds_read_b128 v[84:87], v21 offset:18432
v_mfma_f32_32x32x16_bf16 a[128:143], v[40:43], v[48:51], a[128:143]
ds_read_b128 v[88:91], v21 offset:20480
v_mfma_f32_32x32x16_bf16 a[144:159], v[40:43], v[52:55], a[144:159]
ds_read_b128 v[92:95], v21 offset:22528
v_mfma_f32_32x32x16_bf16 a[160:175], v[40:43], v[56:59], a[160:175]
s_add_u32 m0, s42, 114688
s_nop 0
buffer_load_dwordx4 v8, s[8:11], s43 offen offset:0 lds
v_mfma_f32_32x32x16_bf16 a[176:191], v[40:43], v[60:63], a[176:191]
buffer_load_dwordx4 v9, s[8:11], s43 offen offset:1024 lds
v_mfma_f32_32x32x16_bf16 a[192:207], v[44:47], v[48:51], a[192:207]
buffer_load_dwordx4 v10, s[8:11], s43 offen offset:2048 lds
v_mfma_f32_32x32x16_bf16 a[208:223], v[44:47], v[52:55], a[208:223]
buffer_load_dwordx4 v11, s[8:11], s43 offen offset:3072 lds
v_mfma_f32_32x32x16_bf16 a[224:239], v[44:47], v[56:59], a[224:239]
s_add_u32 s44, s44, 262144
s_add_u32 s43, s43, 64
v_mfma_f32_32x32x16_bf16 a[240:255], v[44:47], v[60:63], a[240:255]
s_waitcnt lgkmcnt(0)
s_waitcnt vmcnt(16)
s_barrier
v_mfma_f32_32x32x16_bf16 a[0:15], v[64:67], v[80:83], a[0:15]
ds_read_b64_tr_b16 v[32:33], v12 offset:32768
ds_read_b64_tr_b16 v[34:35], v12 offset:34816
v_mfma_f32_32x32x16_bf16 a[16:31], v[64:67], v[84:87], a[16:31]
ds_read_b64_tr_b16 v[36:37], v13 offset:32768
v_mfma_f32_32x32x16_bf16 a[32:47], v[64:67], v[88:91], a[32:47]
ds_read_b64_tr_b16 v[38:39], v13 offset:34816
v_mfma_f32_32x32x16_bf16 a[48:63], v[64:67], v[92:95], a[48:63]
ds_read_b64_tr_b16 v[40:41], v14 offset:32768
v_mfma_f32_32x32x16_bf16 a[64:79], v[68:71], v[80:83], a[64:79]
ds_read_b64_tr_b16 v[42:43], v14 offset:34816
v_mfma_f32_32x32x16_bf16 a[80:95], v[68:71], v[84:87], a[80:95]
ds_read_b64_tr_b16 v[44:45], v15 offset:32768
ds_read_b64_tr_b16 v[46:47], v15 offset:34816
v_mfma_f32_32x32x16_bf16 a[96:111], v[68:71], v[88:91], a[96:111]
ds_read_b128 v[48:51], v20 offset:49152
v_mfma_f32_32x32x16_bf16 a[112:127], v[68:71], v[92:95], a[112:127]
ds_read_b128 v[52:55], v20 offset:51200
v_mfma_f32_32x32x16_bf16 a[128:143], v[72:75], v[80:83], a[128:143]
ds_read_b128 v[56:59], v20 offset:53248
v_mfma_f32_32x32x16_bf16 a[144:159], v[72:75], v[84:87], a[144:159]
ds_read_b128 v[60:63], v20 offset:55296
v_mfma_f32_32x32x16_bf16 a[160:175], v[72:75], v[88:91], a[160:175]
s_add_u32 m0, s42, 0
s_nop 0
buffer_load_dwordx4 v4, s[12:15], s44 offen offset:0 lds
v_mfma_f32_32x32x16_bf16 a[176:191], v[72:75], v[92:95], a[176:191]
buffer_load_dwordx4 v5, s[12:15], s44 offen offset:1024 lds
v_mfma_f32_32x32x16_bf16 a[192:207], v[76:79], v[80:83], a[192:207]
v_mfma_f32_32x32x16_bf16 a[208:223], v[76:79], v[84:87], a[208:223]
buffer_load_dwordx4 v6, s[12:15], s44 offen offset:2048 lds
v_mfma_f32_32x32x16_bf16 a[224:239], v[76:79], v[88:91], a[224:239]
buffer_load_dwordx4 v7, s[12:15], s44 offen offset:3072 lds
v_mfma_f32_32x32x16_bf16 a[240:255], v[76:79], v[92:95], a[240:255]
s_waitcnt lgkmcnt(0)
v_mfma_f32_32x32x16_bf16 a[0:15], v[32:35], v[48:51], a[0:15]
ds_read_b64_tr_b16 v[64:65], v12 offset:40960
ds_read_b64_tr_b16 v[66:67], v12 offset:43008
v_mfma_f32_32x32x16_bf16 a[16:31], v[32:35], v[52:55], a[16:31]
ds_read_b64_tr_b16 v[68:69], v13 offset:40960
v_mfma_f32_32x32x16_bf16 a[32:47], v[32:35], v[56:59], a[32:47]
ds_read_b64_tr_b16 v[70:71], v13 offset:43008
v_mfma_f32_32x32x16_bf16 a[48:63], v[32:35], v[60:63], a[48:63]
ds_read_b64_tr_b16 v[72:73], v14 offset:40960
v_mfma_f32_32x32x16_bf16 a[64:79], v[36:39], v[48:51], a[64:79]
ds_read_b64_tr_b16 v[74:75], v14 offset:43008
v_mfma_f32_32x32x16_bf16 a[80:95], v[36:39], v[52:55], a[80:95]
ds_read_b64_tr_b16 v[76:77], v15 offset:40960
ds_read_b64_tr_b16 v[78:79], v15 offset:43008
v_mfma_f32_32x32x16_bf16 a[96:111], v[36:39], v[56:59], a[96:111]
ds_read_b128 v[80:83], v21 offset:49152
v_mfma_f32_32x32x16_bf16 a[112:127], v[36:39], v[60:63], a[112:127]
ds_read_b128 v[84:87], v21 offset:51200
v_mfma_f32_32x32x16_bf16 a[128:143], v[40:43], v[48:51], a[128:143]
ds_read_b128 v[88:91], v21 offset:53248
v_mfma_f32_32x32x16_bf16 a[144:159], v[40:43], v[52:55], a[144:159]
ds_read_b128 v[92:95], v21 offset:55296
v_mfma_f32_32x32x16_bf16 a[160:175], v[40:43], v[56:59], a[160:175]
s_add_u32 m0, s42, 16384
s_nop 0
buffer_load_dwordx4 v8, s[8:11], s43 offen offset:0 lds
v_mfma_f32_32x32x16_bf16 a[176:191], v[40:43], v[60:63], a[176:191]
buffer_load_dwordx4 v9, s[8:11], s43 offen offset:1024 lds
v_mfma_f32_32x32x16_bf16 a[192:207], v[44:47], v[48:51], a[192:207]
buffer_load_dwordx4 v10, s[8:11], s43 offen offset:2048 lds
v_mfma_f32_32x32x16_bf16 a[208:223], v[44:47], v[52:55], a[208:223]
buffer_load_dwordx4 v11, s[8:11], s43 offen offset:3072 lds
v_mfma_f32_32x32x16_bf16 a[224:239], v[44:47], v[56:59], a[224:239]
s_add_u32 s44, s44, 262144
s_add_u32 s43, s43, 64
v_mfma_f32_32x32x16_bf16 a[240:255], v[44:47], v[60:63], a[240:255]
s_waitcnt lgkmcnt(0)
s_waitcnt vmcnt(16)
s_barrier
v_mfma_f32_32x32x16_bf16 a[0:15], v[64:67], v[80:83], a[0:15]
ds_read_b64_tr_b16 v[32:33], v16 offset:0
ds_read_b64_tr_b16 v[34:35], v16 offset:2048
v_mfma_f32_32x32x16_bf16 a[16:31], v[64:67], v[84:87], a[16:31]
ds_read_b64_tr_b16 v[36:37], v17 offset:0
v_mfma_f32_32x32x16_bf16 a[32:47], v[64:67], v[88:91], a[32:47]
ds_read_b64_tr_b16 v[38:39], v17 offset:2048
v_mfma_f32_32x32x16_bf16 a[48:63], v[64:67], v[92:95], a[48:63]
ds_read_b64_tr_b16 v[40:41], v18 offset:0
v_mfma_f32_32x32x16_bf16 a[64:79], v[68:71], v[80:83], a[64:79]
ds_read_b64_tr_b16 v[42:43], v18 offset:2048
v_mfma_f32_32x32x16_bf16 a[80:95], v[68:71], v[84:87], a[80:95]
ds_read_b64_tr_b16 v[44:45], v19 offset:0
ds_read_b64_tr_b16 v[46:47], v19 offset:2048
v_mfma_f32_32x32x16_bf16 a[96:111], v[68:71], v[88:91], a[96:111]
ds_read_b128 v[48:51], v22 offset:16384
v_mfma_f32_32x32x16_bf16 a[112:127], v[68:71], v[92:95], a[112:127]
ds_read_b128 v[52:55], v22 offset:18432
v_mfma_f32_32x32x16_bf16 a[128:143], v[72:75], v[80:83], a[128:143]
ds_read_b128 v[56:59], v22 offset:20480
v_mfma_f32_32x32x16_bf16 a[144:159], v[72:75], v[84:87], a[144:159]
ds_read_b128 v[60:63], v22 offset:22528
v_mfma_f32_32x32x16_bf16 a[160:175], v[72:75], v[88:91], a[160:175]
s_add_u32 m0, s42, 32768
s_nop 0
buffer_load_dwordx4 v4, s[12:15], s44 offen offset:0 lds
v_mfma_f32_32x32x16_bf16 a[176:191], v[72:75], v[92:95], a[176:191]
buffer_load_dwordx4 v5, s[12:15], s44 offen offset:1024 lds
v_mfma_f32_32x32x16_bf16 a[192:207], v[76:79], v[80:83], a[192:207]
v_mfma_f32_32x32x16_bf16 a[208:223], v[76:79], v[84:87], a[208:223]
buffer_load_dwordx4 v6, s[12:15], s44 offen offset:2048 lds
v_mfma_f32_32x32x16_bf16 a[224:239], v[76:79], v[88:91], a[224:239]
buffer_load_dwordx4 v7, s[12:15], s44 offen offset:3072 lds
v_mfma_f32_32x32x16_bf16 a[240:255], v[76:79], v[92:95], a[240:255]
s_waitcnt lgkmcnt(0)
v_mfma_f32_32x32x16_bf16 a[0:15], v[32:35], v[48:51], a[0:15]
ds_read_b64_tr_b16 v[64:65], v16 offset:8192
ds_read_b64_tr_b16 v[66:67], v16 offset:10240
v_mfma_f32_32x32x16_bf16 a[16:31], v[32:35], v[52:55], a[16:31]
ds_read_b64_tr_b16 v[68:69], v17 offset:8192
v_mfma_f32_32x32x16_bf16 a[32:47], v[32:35], v[56:59], a[32:47]
ds_read_b64_tr_b16 v[70:71], v17 offset:10240
v_mfma_f32_32x32x16_bf16 a[48:63], v[32:35], v[60:63], a[48:63]
ds_read_b64_tr_b16 v[72:73], v18 offset:8192
v_mfma_f32_32x32x16_bf16 a[64:79], v[36:39], v[48:51], a[64:79]
ds_read_b64_tr_b16 v[74:75], v18 offset:10240
v_mfma_f32_32x32x16_bf16 a[80:95], v[36:39], v[52:55], a[80:95]
ds_read_b64_tr_b16 v[76:77], v19 offset:8192
ds_read_b64_tr_b16 v[78:79], v19 offset:10240
v_mfma_f32_32x32x16_bf16 a[96:111], v[36:39], v[56:59], a[96:111]
ds_read_b128 v[80:83], v23 offset:16384
v_mfma_f32_32x32x16_bf16 a[112:127], v[36:39], v[60:63], a[112:127]
ds_read_b128 v[84:87], v23 offset:18432
v_mfma_f32_32x32x16_bf16 a[128:143], v[40:43], v[48:51], a[128:143]
ds_read_b128 v[88:91], v23 offset:20480
v_mfma_f32_32x32x16_bf16 a[144:159], v[40:43], v[52:55], a[144:159]
ds_read_b128 v[92:95], v23 offset:22528
v_mfma_f32_32x32x16_bf16 a[160:175], v[40:43], v[56:59], a[160:175]
s_add_u32 m0, s42, 49152
s_nop 0
buffer_load_dwordx4 v8, s[8:11], s43 offen offset:0 lds
v_mfma_f32_32x32x16_bf16 a[176:191], v[40:43], v[60:63], a[176:191]
buffer_load_dwordx4 v9, s[8:11], s43 offen offset:1024 lds
v_mfma_f32_32x32x16_bf16 a[192:207], v[44:47], v[48:51], a[192:207]
buffer_load_dwordx4 v10, s[8:11], s43 offen offset:2048 lds
v_mfma_f32_32x32x16_bf16 a[208:223], v[44:47], v[52:55], a[208:223]
buffer_load_dwordx4 v11, s[8:11], s43 offen offset:3072 lds
v_mfma_f32_32x32x16_bf16 a[224:239], v[44:47], v[56:59], a[224:239]
s_add_u32 s44, s44, 262144
s_add_u32 s43, s43, 64
v_mfma_f32_32x32x16_bf16 a[240:255], v[44:47], v[60:63], a[240:255]
s_waitcnt lgkmcnt(0)
s_waitcnt vmcnt(16)
s_barrier
v_mfma_f32_32x32x16_bf16 a[0:15], v[64:67], v[80:83], a[0:15]
ds_read_b64_tr_b16 v[32:33], v16 offset:32768
ds_read_b64_tr_b16 v[34:35], v16 offset:34816
v_mfma_f32_32x32x16_bf16 a[16:31], v[64:67], v[84:87], a[16:31]
ds_read_b64_tr_b16 v[36:37], v17 offset:32768
v_mfma_f32_32x32x16_bf16 a[32:47], v[64:67], v[88:91], a[32:47]
ds_read_b64_tr_b16 v[38:39], v17 offset:34816
v_mfma_f32_32x32x16_bf16 a[48:63], v[64:67], v[92:95], a[48:63]
ds_read_b64_tr_b16 v[40:41], v18 offset:32768
v_mfma_f32_32x32x16_bf16 a[64:79], v[68:71], v[80:83], a[64:79]
ds_read_b64_tr_b16 v[42:43], v18 offset:34816
v_mfma_f32_32x32x16_bf16 a[80:95], v[68:71], v[84:87], a[80:95]
ds_read_b64_tr_b16 v[44:45], v19 offset:32768
ds_read_b64_tr_b16 v[46:47], v19 offset:34816
v_mfma_f32_32x32x16_bf16 a[96:111], v[68:71], v[88:91], a[96:111]
ds_read_b128 v[48:51], v22 offset:49152
v_mfma_f32_32x32x16_bf16 a[112:127], v[68:71], v[92:95], a[112:127]
ds_read_b128 v[52:55], v22 offset:51200
v_mfma_f32_32x32x16_bf16 a[128:143], v[72:75], v[80:83], a[128:143]
ds_read_b128 v[56:59], v22 offset:53248
v_mfma_f32_32x32x16_bf16 a[144:159], v[72:75], v[84:87], a[144:159]
ds_read_b128 v[60:63], v22 offset:55296
v_mfma_f32_32x32x16_bf16 a[160:175], v[72:75], v[88:91], a[160:175]
s_add_u32 m0, s42, 65536
s_nop 0
buffer_load_dwordx4 v4, s[12:15], s44 offen offset:0 lds
v_mfma_f32_32x32x16_bf16 a[176:191], v[72:75], v[92:95], a[176:191]
buffer_load_dwordx4 v5, s[12:15], s44 offen offset:1024 lds
v_mfma_f32_32x32x16_bf16 a[192:207], v[76:79], v[80:83], a[192:207]
v_mfma_f32_32x32x16_bf16 a[208:223], v[76:79], v[84:87], a[208:223]
buffer_load_dwordx4 v6, s[12:15], s44 offen offset:2048 lds
v_mfma_f32_32x32x16_bf16 a[224:239], v[76:79], v[88:91], a[224:239]
buffer_load_dwordx4 v7, s[12:15], s44 offen offset:3072 lds
v_mfma_f32_32x32x16_bf16 a[240:255], v[76:79], v[92:95], a[240:255]
s_waitcnt lgkmcnt(0)
v_mfma_f32_32x32x16_bf16 a[0:15], v[32:35], v[48:51], a[0:15]
ds_read_b64_tr_b16 v[64:65], v16 offset:40960
ds_read_b64_tr_b16 v[66:67], v16 offset:43008
v_mfma_f32_32x32x16_bf16 a[16:31], v[32:35], v[52:55], a[16:31]
ds_read_b64_tr_b16 v[68:69], v17 offset:40960
v_mfma_f32_32x32x16_bf16 a[32:47], v[32:35], v[56:59], a[32:47]
ds_read_b64_tr_b16 v[70:71], v17 offset:43008
v_mfma_f32_32x32x16_bf16 a[48:63], v[32:35], v[60:63], a[48:63]
ds_read_b64_tr_b16 v[72:73], v18 offset:40960
v_mfma_f32_32x32x16_bf16 a[64:79], v[36:39], v[48:51], a[64:79]
ds_read_b64_tr_b16 v[74:75], v18 offset:43008
v_mfma_f32_32x32x16_bf16 a[80:95], v[36:39], v[52:55], a[80:95]
ds_read_b64_tr_b16 v[76:77], v19 offset:40960
ds_read_b64_tr_b16 v[78:79], v19 offset:43008
v_mfma_f32_32x32x16_bf16 a[96:111], v[36:39], v[56:59], a[96:111]
ds_read_b128 v[80:83], v23 offset:49152
v_mfma_f32_32x32x16_bf16 a[112:127], v[36:39], v[60:63], a[112:127]
ds_read_b128 v[84:87], v23 offset:51200
v_mfma_f32_32x32x16_bf16 a[128:143], v[40:43], v[48:51], a[128:143]
ds_read_b128 v[88:91], v23 offset:53248
v_mfma_f32_32x32x16_bf16 a[144:159], v[40:43], v[52:55], a[144:159]
ds_read_b128 v[92:95], v23 offset:55296
v_mfma_f32_32x32x16_bf16 a[160:175], v[40:43], v[56:59], a[160:175]
s_add_u32 m0, s42, 81920
s_nop 0
buffer_load_dwordx4 v8, s[8:11], s43 offen offset:0 lds
v_mfma_f32_32x32x16_bf16 a[176:191], v[40:43], v[60:63], a[176:191]
buffer_load_dwordx4 v9, s[8:11], s43 offen offset:1024 lds
v_mfma_f32_32x32x16_bf16 a[192:207], v[44:47], v[48:51], a[192:207]
buffer_load_dwordx4 v10, s[8:11], s43 offen offset:2048 lds
v_mfma_f32_32x32x16_bf16 a[208:223], v[44:47], v[52:55], a[208:223]
buffer_load_dwordx4 v11, s[8:11], s43 offen offset:3072 lds
v_mfma_f32_32x32x16_bf16 a[224:239], v[44:47], v[56:59], a[224:239]
s_add_u32 s44, s44, 262144
s_add_u32 s43, s43, 64
v_mfma_f32_32x32x16_bf16 a[240:255], v[44:47], v[60:63], a[240:255]
s_waitcnt lgkmcnt(0)
s_waitcnt vmcnt(16)
s_barrier
v_mfma_f32_32x32x16_bf16 a[0:15], v[64:67], v[80:83], a[0:15]
ds_read_b64_tr_b16 v[32:33], v12 offset:0
ds_read_b64_tr_b16 v[34:35], v12 offset:2048
v_mfma_f32_32x32x16_bf16 a[16:31], v[64:67], v[84:87], a[16:31]
ds_read_b64_tr_b16 v[36:37], v13 offset:0
v_mfma_f32_32x32x16_bf16 a[32:47], v[64:67], v[88:91], a[32:47]
ds_read_b64_tr_b16 v[38:39], v13 offset:2048
v_mfma_f32_32x32x16_bf16 a[48:63], v[64:67], v[92:95], a[48:63]
ds_read_b64_tr_b16 v[40:41], v14 offset:0
v_mfma_f32_32x32x16_bf16 a[64:79], v[68:71], v[80:83], a[64:79]
ds_read_b64_tr_b16 v[42:43], v14 offset:2048
v_mfma_f32_32x32x16_bf16 a[80:95], v[68:71], v[84:87], a[80:95]
ds_read_b64_tr_b16 v[44:45], v15 offset:0
ds_read_b64_tr_b16 v[46:47], v15 offset:2048
v_mfma_f32_32x32x16_bf16 a[96:111], v[68:71], v[88:91], a[96:111]
ds_read_b128 v[48:51], v20 offset:16384
v_mfma_f32_32x32x16_bf16 a[112:127], v[68:71], v[92:95], a[112:127]
ds_read_b128 v[52:55], v20 offset:18432
v_mfma_f32_32x32x16_bf16 a[128:143], v[72:75], v[80:83], a[128:143]
ds_read_b128 v[56:59], v20 offset:20480
v_mfma_f32_32x32x16_bf16 a[144:159], v[72:75], v[84:87], a[144:159]
ds_read_b128 v[60:63], v20 offset:22528
v_mfma_f32_32x32x16_bf16 a[160:175], v[72:75], v[88:91], a[160:175]
s_add_u32 m0, s42, 98304
s_nop 0
buffer_load_dwordx4 v4, s[12:15], s44 offen offset:0 lds
v_mfma_f32_32x32x16_bf16 a[176:191], v[72:75], v[92:95], a[176:191]
buffer_load_dwordx4 v5, s[12:15], s44 offen offset:1024 lds
v_mfma_f32_32x32x16_bf16 a[192:207], v[76:79], v[80:83], a[192:207]
v_mfma_f32_32x32x16_bf16 a[208:223], v[76:79], v[84:87], a[208:223]
buffer_load_dwordx4 v6, s[12:15], s44 offen offset:2048 lds
v_mfma_f32_32x32x16_bf16 a[224:239], v[76:79], v[88:91], a[224:239]
buffer_load_dwordx4 v7, s[12:15], s44 offen offset:3072 lds
v_mfma_f32_32x32x16_bf16 a[240:255], v[76:79], v[92:95], a[240:255]
s_sub_u32 s4, s4, 1
s_cmp_lg_u32 s4, 0
s_cbranch_scc1 gl_5
s_waitcnt lgkmcnt(0)
v_mfma_f32_32x32x16_bf16 a[0:15], v[32:35], v[48:51], a[0:15]
ds_read_b64_tr_b16 v[64:65], v12 offset:8192
ds_read_b64_tr_b16 v[66:67], v12 offset:10240
v_mfma_f32_32x32x16_bf16 a[16:31], v[32:35], v[52:55], a[16:31]
ds_read_b64_tr_b16 v[68:69], v13 offset:8192
v_mfma_f32_32x32x16_bf16 a[32:47], v[32:35], v[56:59], a[32:47]
ds_read_b64_tr_b16 v[70:71], v13 offset:10240
v_mfma_f32_32x32x16_bf16 a[48:63], v[32:35], v[60:63], a[48:63]
ds_read_b64_tr_b16 v[72:73], v14 offset:8192
v_mfma_f32_32x32x16_bf16 a[64:79], v[36:39], v[48:51], a[64:79]
ds_read_b64_tr_b16 v[74:75], v14 offset:10240
v_mfma_f32_32x32x16_bf16 a[80:95], v[36:39], v[52:55], a[80:95]
ds_read_b64_tr_b16 v[76:77], v15 offset:8192
ds_read_b64_tr_b16 v[78:79], v15 offset:10240
v_mfma_f32_32x32x16_bf16 a[96:111], v[36:39], v[56:59], a[96:111]
ds_read_b128 v[80:83], v21 offset:16384
v_mfma_f32_32x32x16_bf16 a[112:127], v[36:39], v[60:63], a[112:127]
ds_read_b128 v[84:87], v21 offset:18432
v_mfma_f32_32x32x16_bf16 a[128:143], v[40:43], v[48:51], a[128:143]
ds_read_b128 v[88:91], v21 offset:20480
v_mfma_f32_32x32x16_bf16 a[144:159], v[40:43], v[52:55], a[144:159]
ds_read_b128 v[92:95], v21 offset:22528
v_mfma_f32_32x32x16_bf16 a[160:175], v[40:43], v[56:59], a[160:175]
s_add_u32 m0, s42, 114688
s_nop 0
buffer_load_dwordx4 v8, s[8:11], s43 offen offset:0 lds
v_mfma_f32_32x32x16_bf16 a[176:191], v[40:43], v[60:63], a[176:191]
buffer_load_dwordx4 v9, s[8:11], s43 offen offset:1024 lds
v_mfma_f32_32x32x16_bf16 a[192:207], v[44:47], v[48:51], a[192:207]
buffer_load_dwordx4 v10, s[8:11], s43 offen offset:2048 lds
v_mfma_f32_32x32x16_bf16 a[208:223], v[44:47], v[52:55], a[208:223]
buffer_load_dwordx4 v11, s[8:11], s43 offen offset:3072 lds
v_mfma_f32_32x32x16_bf16 a[224:239], v[44:47], v[56:59], a[224:239]
s_add_u32 s44, s44, 262144
s_add_u32 s43, s43, 64
v_mfma_f32_32x32x16_bf16 a[240:255], v[44:47], v[60:63], a[240:255]
s_waitcnt lgkmcnt(0)
s_waitcnt vmcnt(16)
s_barrier
v_mfma_f32_32x32x16_bf16 a[0:15], v[64:67], v[80:83], a[0:15]
ds_read_b64_tr_b16 v[32:33], v12 offset:32768
v_mfma_f32_32x32x16_bf16 a[16:31], v[64:67], v[84:87], a[16:31]
ds_read_b64_tr_b16 v[34:35], v12 offset:34816
v_mfma_f32_32x32x16_bf16 a[32:47], v[64:67], v[88:91], a[32:47]
ds_read_b64_tr_b16 v[36:37], v13 offset:32768
v_mfma_f32_32x32x16_bf16 a[48:63], v[64:67], v[92:95], a[48:63]
ds_read_b64_tr_b16 v[38:39], v13 offset:34816
v_mfma_f32_32x32x16_bf16 a[64:79], v[68:71], v[80:83], a[64:79]
ds_read_b64_tr_b16 v[40:41], v14 offset:32768
v_mfma_f32_32x32x16_bf16 a[80:95], v[68:71], v[84:87], a[80:95]
ds_read_b64_tr_b16 v[42:43], v14 offset:34816
v_mfma_f32_32x32x16_bf16 a[96:111], v[68:71], v[88:91], a[96:111]
ds_read_b64_tr_b16 v[44:45], v15 offset:32768
v_mfma_f32_32x32x16_bf16 a[112:127], v[68:71], v[92:95], a[112:127]
ds_read_b64_tr_b16 v[46:47], v15 offset:34816
v_mfma_f32_32x32x16_bf16 a[128:143], v[72:75], v[80:83], a[128:143]
ds_read_b128 v[48:51], v20 offset:49152
v_mfma_f32_32x32x16_bf16 a[144:159], v[72:75], v[84:87], a[144:159]
ds_read_b128 v[52:55], v20 offset:51200
v_mfma_f32_32x32x16_bf16 a[160:175], v[72:75], v[88:91], a[160:175]
ds_read_b128 v[56:59], v20 offset:53248
v_mfma_f32_32x32x16_bf16 a[176:191], v[72:75], v[92:95], a[176:191]
ds_read_b128 v[60:63], v20 offset:55296
v_mfma_f32_32x32x16_bf16 a[192:207], v[76:79], v[80:83], a[192:207]
v_mfma_f32_32x32x16_bf16 a[208:223], v[76:79], v[84:87], a[208:223]
v_mfma_f32_32x32x16_bf16 a[224:239], v[76:79], v[88:91], a[224:239]
v_mfma_f32_32x32x16_bf16 a[240:255], v[76:79], v[92:95], a[240:255]
s_waitcnt lgkmcnt(0)
v_mfma_f32_32x32x16_bf16 a[0:15], v[32:35], v[48:51], a[0:15]
ds_read_b64_tr_b16 v[64:65], v12 offset:40960
v_mfma_f32_32x32x16_bf16 a[16:31], v[32:35], v[52:55], a[16:31]
ds_read_b64_tr_b16 v[66:67], v12 offset:43008
v_mfma_f32_32x32x16_bf16 a[32:47], v[32:35], v[56:59], a[32:47]
ds_read_b64_tr_b16 v[68:69], v13 offset:40960
v_mfma_f32_32x32x16_bf16 a[48:63], v[32:35], v[60:63], a[48:63]
ds_read_b64_tr_b16 v[70:71], v13 offset:43008
v_mfma_f32_32x32x16_bf16 a[64:79], v[36:39], v[48:51], a[64:79]
ds_read_b64_tr_b16 v[72:73], v14 offset:40960
v_mfma_f32_32x32x16_bf16 a[80:95], v[36:39], v[52:55], a[80:95]
ds_read_b64_tr_b16 v[74:75], v14 offset:43008
v_mfma_f32_32x32x16_bf16 a[96:111], v[36:39], v[56:59], a[96:111]
ds_read_b64_tr_b16 v[76:77], v15 offset:40960
v_mfma_f32_32x32x16_bf16 a[112:127], v[36:39], v[60:63], a[112:127]
ds_read_b64_tr_b16 v[78:79], v15 offset:43008
v_mfma_f32_32x32x16_bf16 a[128:143], v[40:43], v[48:51], a[128:143]
ds_read_b128 v[80:83], v21 offset:49152
v_mfma_f32_32x32x16_bf16 a[144:159], v[40:43], v[52:55], a[144:159]
ds_read_b128 v[84:87], v21 offset:51200
v_mfma_f32_32x32x16_bf16 a[160:175], v[40:43], v[56:59], a[160:175]
ds_read_b128 v[88:91], v21 offset:53248
v_mfma_f32_32x32x16_bf16 a[176:191], v[40:43], v[60:63], a[176:191]
ds_read_b128 v[92:95], v21 offset:55296
v_mfma_f32_32x32x16_bf16 a[192:207], v[44:47], v[48:51], a[192:207]
v_mfma_f32_32x32x16_bf16 a[208:223], v[44:47], v[52:55], a[208:223]
v_mfma_f32_32x32x16_bf16 a[224:239], v[44:47], v[56:59], a[224:239]
v_mfma_f32_32x32x16_bf16 a[240:255], v[44:47], v[60:63], a[240:255]
s_waitcnt lgkmcnt(0)
s_waitcnt vmcnt(8)
s_barrier
v_mfma_f32_32x32x16_bf16 a[0:15], v[64:67], v[80:83], a[0:15]
ds_read_b64_tr_b16 v[32:33], v16 offset:0
v_mfma_f32_32x32x16_bf16 a[16:31], v[64:67], v[84:87], a[16:31]
ds_read_b64_tr_b16 v[34:35], v16 offset:2048
v_mfma_f32_32x32x16_bf16 a[32:47], v[64:67], v[88:91], a[32:47]
ds_read_b64_tr_b16 v[36:37], v17 offset:0
v_mfma_f32_32x32x16_bf16 a[48:63], v[64:67], v[92:95], a[48:63]
ds_read_b64_tr_b16 v[38:39], v17 offset:2048
v_mfma_f32_32x32x16_bf16 a[64:79], v[68:71], v[80:83], a[64:79]
ds_read_b64_tr_b16 v[40:41], v18 offset:0
v_mfma_f32_32x32x16_bf16 a[80:95], v[68:71], v[84:87], a[80:95]
ds_read_b64_tr_b16 v[42:43], v18 offset:2048
v_mfma_f32_32x32x16_bf16 a[96:111], v[68:71], v[88:91], a[96:111]
ds_read_b64_tr_b16 v[44:45], v19 offset:0
v_mfma_f32_32x32x16_bf16 a[112:127], v[68:71], v[92:95], a[112:127]
ds_read_b64_tr_b16 v[46:47], v19 offset:2048
v_mfma_f32_32x32x16_bf16 a[128:143], v[72:75], v[80:83], a[128:143]
ds_read_b128 v[48:51], v22 offset:16384
v_mfma_f32_32x32x16_bf16 a[144:159], v[72:75], v[84:87], a[144:159]
ds_read_b128 v[52:55], v22 offset:18432
v_mfma_f32_32x32x16_bf16 a[160:175], v[72:75], v[88:91], a[160:175]
ds_read_b128 v[56:59], v22 offset:20480
v_mfma_f32_32x32x16_bf16 a[176:191], v[72:75], v[92:95], a[176:191]
ds_read_b128 v[60:63], v22 offset:22528
v_mfma_f32_32x32x16_bf16 a[192:207], v[76:79], v[80:83], a[192:207]
v_mfma_f32_32x32x16_bf16 a[208:223], v[76:79], v[84:87], a[208:223]
v_mfma_f32_32x32x16_bf16 a[224:239], v[76:79], v[88:91], a[224:239]
v_mfma_f32_32x32x16_bf16 a[240:255], v[76:79], v[92:95], a[240:255]
s_waitcnt lgkmcnt(0)
v_mfma_f32_32x32x16_bf16 a[0:15], v[32:35], v[48:51], a[0:15]
ds_read_b64_tr_b16 v[64:65], v16 offset:8192
v_mfma_f32_32x32x16_bf16 a[16:31], v[32:35], v[52:55], a[16:31]
ds_read_b64_tr_b16 v[66:67], v16 offset:10240
v_mfma_f32_32x32x16_bf16 a[32:47], v[32:35], v[56:59], a[32:47]
ds_read_b64_tr_b16 v[68:69], v17 offset:8192
v_mfma_f32_32x32x16_bf16 a[48:63], v[32:35], v[60:63], a[48:63]
ds_read_b64_tr_b16 v[70:71], v17 offset:10240
v_mfma_f32_32x32x16_bf16 a[64:79], v[36:39], v[48:51], a[64:79]
ds_read_b64_tr_b16 v[72:73], v18 offset:8192
v_mfma_f32_32x32x16_bf16 a[80:95], v[36:39], v[52:55], a[80:95]
ds_read_b64_tr_b16 v[74:75], v18 offset:10240
v_mfma_f32_32x32x16_bf16 a[96:111], v[36:39], v[56:59], a[96:111]
ds_read_b64_tr_b16 v[76:77], v19 offset:8192
v_mfma_f32_32x32x16_bf16 a[112:127], v[36:39], v[60:63], a[112:127]
ds_read_b64_tr_b16 v[78:79], v19 offset:10240
v_mfma_f32_32x32x16_bf16 a[128:143], v[40:43], v[48:51], a[128:143]
ds_read_b128 v[80:83], v23 offset:16384
v_mfma_f32_32x32x16_bf16 a[144:159], v[40:43], v[52:55], a[144:159]
ds_read_b128 v[84:87], v23 offset:18432
v_mfma_f32_32x32x16_bf16 a[160:175], v[40:43], v[56:59], a[160:175]
ds_read_b128 v[88:91], v23 offset:20480
v_mfma_f32_32x32x16_bf16 a[176:191], v[40:43], v[60:63], a[176:191]
ds_read_b128 v[92:95], v23 offset:22528
v_mfma_f32_32x32x16_bf16 a[192:207], v[44:47], v[48:51], a[192:207]
v_mfma_f32_32x32x16_bf16 a[208:223], v[44:47], v[52:55], a[208:223]
v_mfma_f32_32x32x16_bf16 a[224:239], v[44:47], v[56:59], a[224:239]
v_mfma_f32_32x32x16_bf16 a[240:255], v[44:47], v[60:63], a[240:255]
s_waitcnt lgkmcnt(0)
s_waitcnt vmcnt(0)
s_barrier
v_mfma_f32_32x32x16_bf16 a[0:15], v[64:67], v[80:83], a[0:15]
ds_read_b64_tr_b16 v[32:33], v16 offset:32768
v_mfma_f32_32x32x16_bf16 a[16:31], v[64:67], v[84:87], a[16:31]
ds_read_b64_tr_b16 v[34:35], v16 offset:34816
v_mfma_f32_32x32x16_bf16 a[32:47], v[64:67], v[88:91], a[32:47]
ds_read_b64_tr_b16 v[36:37], v17 offset:32768
v_mfma_f32_32x32x16_bf16 a[48:63], v[64:67], v[92:95], a[48:63]
ds_read_b64_tr_b16 v[38:39], v17 offset:34816
v_mfma_f32_32x32x16_bf16 a[64:79], v[68:71], v[80:83], a[64:79]
ds_read_b64_tr_b16 v[40:41], v18 offset:32768
v_mfma_f32_32x32x16_bf16 a[80:95], v[68:71], v[84:87], a[80:95]
ds_read_b64_tr_b16 v[42:43], v18 offset:34816
v_mfma_f32_32x32x16_bf16 a[96:111], v[68:71], v[88:91], a[96:111]
ds_read_b64_tr_b16 v[44:45], v19 offset:32768
v_mfma_f32_32x32x16_bf16 a[112:127], v[68:71], v[92:95], a[112:127]
ds_read_b64_tr_b16 v[46:47], v19 offset:34816
v_mfma_f32_32x32x16_bf16 a[128:143], v[72:75], v[80:83], a[128:143]
ds_read_b128 v[48:51], v22 offset:49152
v_mfma_f32_32x32x16_bf16 a[144:159], v[72:75], v[84:87], a[144:159]
ds_read_b128 v[52:55], v22 offset:51200
v_mfma_f32_32x32x16_bf16 a[160:175], v[72:75], v[88:91], a[160:175]
ds_read_b128 v[56:59], v22 offset:53248
v_mfma_f32_32x32x16_bf16 a[176:191], v[72:75], v[92:95], a[176:191]
ds_read_b128 v[60:63], v22 offset:55296
v_mfma_f32_32x32x16_bf16 a[192:207], v[76:79], v[80:83], a[192:207]
v_mfma_f32_32x32x16_bf16 a[208:223], v[76:79], v[84:87], a[208:223]
v_mfma_f32_32x32x16_bf16 a[224:239], v[76:79], v[88:91], a[224:239]
v_mfma_f32_32x32x16_bf16 a[240:255], v[76:79], v[92:95], a[240:255]
s_waitcnt lgkmcnt(0)
v_mfma_f32_32x32x16_bf16 a[0:15], v[32:35], v[48:51], a[0:15]
ds_read_b64_tr_b16 v[64:65], v16 offset:40960
v_mfma_f32_32x32x16_bf16 a[16:31], v[32:35], v[52:55], a[16:31]
ds_read_b64_tr_b16 v[66:67], v16 offset:43008
v_mfma_f32_32x32x16_bf16 a[32:47], v[32:35], v[56:59], a[32:47]
ds_read_b64_tr_b16 v[68:69], v17 offset:40960
v_mfma_f32_32x32x16_bf16 a[48:63], v[32:35], v[60:63], a[48:63]
ds_read_b64_tr_b16 v[70:71], v17 offset:43008
v_mfma_f32_32x32x16_bf16 a[64:79], v[36:39], v[48:51], a[64:79]
ds_read_b64_tr_b16 v[72:73], v18 offset:40960
v_mfma_f32_32x32x16_bf16 a[80:95], v[36:39], v[52:55], a[80:95]
ds_read_b64_tr_b16 v[74:75], v18 offset:43008
v_mfma_f32_32x32x16_bf16 a[96:111], v[36:39], v[56:59], a[96:111]
ds_read_b64_tr_b16 v[76:77], v19 offset:40960
v_mfma_f32_32x32x16_bf16 a[112:127], v[36:39], v[60:63], a[112:127]
ds_read_b64_tr_b16 v[78:79], v19 offset:43008
v_mfma_f32_32x32x16_bf16 a[128:143], v[40:43], v[48:51], a[128:143]
ds_read_b128 v[80:83], v23 offset:49152
v_mfma_f32_32x32x16_bf16 a[144:159], v[40:43], v[52:55], a[144:159]
ds_read_b128 v[84:87], v23 offset:51200
v_mfma_f32_32x32x16_bf16 a[160:175], v[40:43], v[56:59], a[160:175]
ds_read_b128 v[88:91], v23 offset:53248
v_mfma_f32_32x32x16_bf16 a[176:191], v[40:43], v[60:63], a[176:191]
ds_read_b128 v[92:95], v23 offset:55296
v_mfma_f32_32x32x16_bf16 a[192:207], v[44:47], v[48:51], a[192:207]
v_mfma_f32_32x32x16_bf16 a[208:223], v[44:47], v[52:55], a[208:223]
v_mfma_f32_32x32x16_bf16 a[224:239], v[44:47], v[56:59], a[224:239]
v_mfma_f32_32x32x16_bf16 a[240:255], v[44:47], v[60:63], a[240:255]
s_waitcnt lgkmcnt(0)
v_mfma_f32_32x32x16_bf16 a[0:15], v[64:67], v[80:83], a[0:15]
v_mfma_f32_32x32x16_bf16 a[16:31], v[64:67], v[84:87], a[16:31]
v_mfma_f32_32x32x16_bf16 a[32:47], v[64:67], v[88:91], a[32:47]
v_mfma_f32_32x32x16_bf16 a[48:63], v[64:67], v[92:95], a[48:63]
v_mfma_f32_32x32x16_bf16 a[64:79], v[68:71], v[80:83], a[64:79]
v_mfma_f32_32x32x16_bf16 a[80:95], v[68:71], v[84:87], a[80:95]
v_mfma_f32_32x32x16_bf16 a[96:111], v[68:71], v[88:91], a[96:111]
v_mfma_f32_32x32x16_bf16 a[112:127], v[68:71], v[92:95], a[112:127]
v_mfma_f32_32x32x16_bf16 a[128:143], v[72:75], v[80:83], a[128:143]
v_mfma_f32_32x32x16_bf16 a[144:159], v[72:75], v[84:87], a[144:159]
v_mfma_f32_32x32x16_bf16 a[160:175], v[72:75], v[88:91], a[160:175]
v_mfma_f32_32x32x16_bf16 a[176:191], v[72:75], v[92:95], a[176:191]
v_mfma_f32_32x32x16_bf16 a[192:207], v[76:79], v[80:83], a[192:207]
v_mfma_f32_32x32x16_bf16 a[208:223], v[76:79], v[84:87], a[208:223]
v_mfma_f32_32x32x16_bf16 a[224:239], v[76:79], v[88:91], a[224:239]
v_mfma_f32_32x32x16_bf16 a[240:255], v[76:79], v[92:95], a[240:255]
s_nop 7
s_nop 7
v_lshlrev_b32 v1, 4, v0
s_lshl_b32 s5, s37, 1
s_add_u32 s5, s5, s39
s_lshl_b32 s5, s5, 19
s_lshl_b32 s6, s36, 1
s_add_u32 s6, s6, s40
s_lshl_b32 s6, s6, 15
s_add_u32 s5, s5, s6
v_accvgpr_read_b32 v8, a0
v_accvgpr_read_b32 v9, a1
v_accvgpr_read_b32 v10, a2
v_accvgpr_read_b32 v11, a3
v_accvgpr_read_b32 v12, a4
v_accvgpr_read_b32 v13, a5
v_accvgpr_read_b32 v14, a6
v_accvgpr_read_b32 v15, a7
v_cvt_pk_bf16_f32 v16, v8, v9
v_cvt_pk_bf16_f32 v17, v10, v11
v_cvt_pk_bf16_f32 v18, v12, v13
v_cvt_pk_bf16_f32 v19, v14, v15
buffer_store_dwordx4 v[16:19], v1, s[20:23], s5 offen offset:0 sc0 sc1
v_accvgpr_read_b32 v20, a8
v_accvgpr_read_b32 v21, a9
v_accvgpr_read_b32 v22, a10
v_accvgpr_read_b32 v23, a11
v_accvgpr_read_b32 v24, a12
v_accvgpr_read_b32 v25, a13
v_accvgpr_read_b32 v26, a14
v_accvgpr_read_b32 v27, a15
v_cvt_pk_bf16_f32 v28, v20, v21
v_cvt_pk_bf16_f32 v29, v22, v23
v_cvt_pk_bf16_f32 v30, v24, v25
v_cvt_pk_bf16_f32 v31, v26, v27
buffer_store_dwordx4 v[28:31], v1, s[20:23], s5 offen offset:1024 sc0 sc1
v_accvgpr_read_b32 v32, a64
v_accvgpr_read_b32 v33, a65
v_accvgpr_read_b32 v34, a66
v_accvgpr_read_b32 v35, a67
v_accvgpr_read_b32 v36, a68
v_accvgpr_read_b32 v37, a69
v_accvgpr_read_b32 v38, a70
v_accvgpr_read_b32 v39, a71
v_cvt_pk_bf16_f32 v40, v32, v33
v_cvt_pk_bf16_f32 v41, v34, v35
v_cvt_pk_bf16_f32 v42, v36, v37
v_cvt_pk_bf16_f32 v43, v38, v39
buffer_store_dwordx4 v[40:43], v1, s[20:23], s5 offen offset:2048 sc0 sc1
v_accvgpr_read_b32 v44, a72
v_accvgpr_read_b32 v45, a73
v_accvgpr_read_b32 v46, a74
v_accvgpr_read_b32 v47, a75
v_accvgpr_read_b32 v48, a76
v_accvgpr_read_b32 v49, a77
v_accvgpr_read_b32 v50, a78
v_accvgpr_read_b32 v51, a79
v_cvt_pk_bf16_f32 v52, v44, v45
v_cvt_pk_bf16_f32 v53, v46, v47
v_cvt_pk_bf16_f32 v54, v48, v49
v_cvt_pk_bf16_f32 v55, v50, v51
buffer_store_dwordx4 v[52:55], v1, s[20:23], s5 offen offset:3072 sc0 sc1
s_add_u32 s5, s5, 4096
v_accvgpr_read_b32 v56, a128
v_accvgpr_read_b32 v57, a129
v_accvgpr_read_b32 v58, a130
v_accvgpr_read_b32 v59, a131
v_accvgpr_read_b32 v60, a132
v_accvgpr_read_b32 v61, a133
v_accvgpr_read_b32 v62, a134
v_accvgpr_read_b32 v63, a135
v_cvt_pk_bf16_f32 v64, v56, v57
v_cvt_pk_bf16_f32 v65, v58, v59
v_cvt_pk_bf16_f32 v66, v60, v61
v_cvt_pk_bf16_f32 v67, v62, v63
buffer_store_dwordx4 v[64:67], v1, s[20:23], s5 offen offset:0 sc0 sc1
v_accvgpr_read_b32 v68, a136
v_accvgpr_read_b32 v69, a137
v_accvgpr_read_b32 v70, a138
v_accvgpr_read_b32 v71, a139
v_accvgpr_read_b32 v72, a140
v_accvgpr_read_b32 v73, a141
v_accvgpr_read_b32 v74, a142
v_accvgpr_read_b32 v75, a143
v_cvt_pk_bf16_f32 v76, v68, v69
v_cvt_pk_bf16_f32 v77, v70, v71
v_cvt_pk_bf16_f32 v78, v72, v73
v_cvt_pk_bf16_f32 v79, v74, v75
buffer_store_dwordx4 v[76:79], v1, s[20:23], s5 offen offset:1024 sc0 sc1
v_accvgpr_read_b32 v80, a192
v_accvgpr_read_b32 v81, a193
v_accvgpr_read_b32 v82, a194
v_accvgpr_read_b32 v83, a195
v_accvgpr_read_b32 v84, a196
v_accvgpr_read_b32 v85, a197
v_accvgpr_read_b32 v86, a198
v_accvgpr_read_b32 v87, a199
v_cvt_pk_bf16_f32 v88, v80, v81
v_cvt_pk_bf16_f32 v89, v82, v83
v_cvt_pk_bf16_f32 v90, v84, v85
v_cvt_pk_bf16_f32 v91, v86, v87
buffer_store_dwordx4 v[88:91], v1, s[20:23], s5 offen offset:2048 sc0 sc1
v_accvgpr_read_b32 v92, a200
v_accvgpr_read_b32 v93, a201
v_accvgpr_read_b32 v94, a202
v_accvgpr_read_b32 v95, a203
v_accvgpr_read_b32 v96, a204
v_accvgpr_read_b32 v97, a205
v_accvgpr_read_b32 v98, a206
v_accvgpr_read_b32 v99, a207
v_cvt_pk_bf16_f32 v100, v92, v93
v_cvt_pk_bf16_f32 v101, v94, v95
v_cvt_pk_bf16_f32 v102, v96, v97
v_cvt_pk_bf16_f32 v103, v98, v99
buffer_store_dwordx4 v[100:103], v1, s[20:23], s5 offen offset:3072 sc0 sc1
s_add_u32 s5, s5, 4096
v_accvgpr_read_b32 v8, a16
v_accvgpr_read_b32 v9, a17
v_accvgpr_read_b32 v10, a18
v_accvgpr_read_b32 v11, a19
v_accvgpr_read_b32 v12, a20
v_accvgpr_read_b32 v13, a21
v_accvgpr_read_b32 v14, a22
v_accvgpr_read_b32 v15, a23
v_cvt_pk_bf16_f32 v16, v8, v9
v_cvt_pk_bf16_f32 v17, v10, v11
v_cvt_pk_bf16_f32 v18, v12, v13
v_cvt_pk_bf16_f32 v19, v14, v15
buffer_store_dwordx4 v[16:19], v1, s[20:23], s5 offen offset:0 sc0 sc1
v_accvgpr_read_b32 v20, a24
v_accvgpr_read_b32 v21, a25
v_accvgpr_read_b32 v22, a26
v_accvgpr_read_b32 v23, a27
v_accvgpr_read_b32 v24, a28
v_accvgpr_read_b32 v25, a29
v_accvgpr_read_b32 v26, a30
v_accvgpr_read_b32 v27, a31
v_cvt_pk_bf16_f32 v28, v20, v21
v_cvt_pk_bf16_f32 v29, v22, v23
v_cvt_pk_bf16_f32 v30, v24, v25
v_cvt_pk_bf16_f32 v31, v26, v27
buffer_store_dwordx4 v[28:31], v1, s[20:23], s5 offen offset:1024 sc0 sc1
v_accvgpr_read_b32 v32, a80
v_accvgpr_read_b32 v33, a81
v_accvgpr_read_b32 v34, a82
v_accvgpr_read_b32 v35, a83
v_accvgpr_read_b32 v36, a84
v_accvgpr_read_b32 v37, a85
v_accvgpr_read_b32 v38, a86
v_accvgpr_read_b32 v39, a87
v_cvt_pk_bf16_f32 v40, v32, v33
v_cvt_pk_bf16_f32 v41, v34, v35
v_cvt_pk_bf16_f32 v42, v36, v37
v_cvt_pk_bf16_f32 v43, v38, v39
buffer_store_dwordx4 v[40:43], v1, s[20:23], s5 offen offset:2048 sc0 sc1
v_accvgpr_read_b32 v44, a88
v_accvgpr_read_b32 v45, a89
v_accvgpr_read_b32 v46, a90
v_accvgpr_read_b32 v47, a91
v_accvgpr_read_b32 v48, a92
v_accvgpr_read_b32 v49, a93
v_accvgpr_read_b32 v50, a94
v_accvgpr_read_b32 v51, a95
v_cvt_pk_bf16_f32 v52, v44, v45
v_cvt_pk_bf16_f32 v53, v46, v47
v_cvt_pk_bf16_f32 v54, v48, v49
v_cvt_pk_bf16_f32 v55, v50, v51
buffer_store_dwordx4 v[52:55], v1, s[20:23], s5 offen offset:3072 sc0 sc1
s_add_u32 s5, s5, 4096
v_accvgpr_read_b32 v56, a144
v_accvgpr_read_b32 v57, a145
v_accvgpr_read_b32 v58, a146
v_accvgpr_read_b32 v59, a147
v_accvgpr_read_b32 v60, a148
v_accvgpr_read_b32 v61, a149
v_accvgpr_read_b32 v62, a150
v_accvgpr_read_b32 v63, a151
v_cvt_pk_bf16_f32 v64, v56, v57
v_cvt_pk_bf16_f32 v65, v58, v59
v_cvt_pk_bf16_f32 v66, v60, v61
v_cvt_pk_bf16_f32 v67, v62, v63
buffer_store_dwordx4 v[64:67], v1, s[20:23], s5 offen offset:0 sc0 sc1
v_accvgpr_read_b32 v68, a152
v_accvgpr_read_b32 v69, a153
v_accvgpr_read_b32 v70, a154
v_accvgpr_read_b32 v71, a155
v_accvgpr_read_b32 v72, a156
v_accvgpr_read_b32 v73, a157
v_accvgpr_read_b32 v74, a158
v_accvgpr_read_b32 v75, a159
v_cvt_pk_bf16_f32 v76, v68, v69
v_cvt_pk_bf16_f32 v77, v70, v71
v_cvt_pk_bf16_f32 v78, v72, v73
v_cvt_pk_bf16_f32 v79, v74, v75
buffer_store_dwordx4 v[76:79], v1, s[20:23], s5 offen offset:1024 sc0 sc1
v_accvgpr_read_b32 v80, a208
v_accvgpr_read_b32 v81, a209
v_accvgpr_read_b32 v82, a210
v_accvgpr_read_b32 v83, a211
v_accvgpr_read_b32 v84, a212
v_accvgpr_read_b32 v85, a213
v_accvgpr_read_b32 v86, a214
v_accvgpr_read_b32 v87, a215
v_cvt_pk_bf16_f32 v88, v80, v81
v_cvt_pk_bf16_f32 v89, v82, v83
v_cvt_pk_bf16_f32 v90, v84, v85
v_cvt_pk_bf16_f32 v91, v86, v87
buffer_store_dwordx4 v[88:91], v1, s[20:23], s5 offen offset:2048 sc0 sc1
v_accvgpr_read_b32 v92, a216
v_accvgpr_read_b32 v93, a217
v_accvgpr_read_b32 v94, a218
v_accvgpr_read_b32 v95, a219
v_accvgpr_read_b32 v96, a220
v_accvgpr_read_b32 v97, a221
v_accvgpr_read_b32 v98, a222
v_accvgpr_read_b32 v99, a223
v_cvt_pk_bf16_f32 v100, v92, v93
v_cvt_pk_bf16_f32 v101, v94, v95
v_cvt_pk_bf16_f32 v102, v96, v97
v_cvt_pk_bf16_f32 v103, v98, v99
buffer_store_dwordx4 v[100:103], v1, s[20:23], s5 offen offset:3072 sc0 sc1
s_add_u32 s5, s5, 4096
v_accvgpr_read_b32 v8, a32
v_accvgpr_read_b32 v9, a33
v_accvgpr_read_b32 v10, a34
v_accvgpr_read_b32 v11, a35
v_accvgpr_read_b32 v12, a36
v_accvgpr_read_b32 v13, a37
v_accvgpr_read_b32 v14, a38
v_accvgpr_read_b32 v15, a39
v_cvt_pk_bf16_f32 v16, v8, v9
v_cvt_pk_bf16_f32 v17, v10, v11
v_cvt_pk_bf16_f32 v18, v12, v13
v_cvt_pk_bf16_f32 v19, v14, v15
buffer_store_dwordx4 v[16:19], v1, s[20:23], s5 offen offset:0 sc0 sc1
v_accvgpr_read_b32 v20, a40
v_accvgpr_read_b32 v21, a41
v_accvgpr_read_b32 v22, a42
v_accvgpr_read_b32 v23, a43
v_accvgpr_read_b32 v24, a44
v_accvgpr_read_b32 v25, a45
v_accvgpr_read_b32 v26, a46
v_accvgpr_read_b32 v27, a47
v_cvt_pk_bf16_f32 v28, v20, v21
v_cvt_pk_bf16_f32 v29, v22, v23
v_cvt_pk_bf16_f32 v30, v24, v25
v_cvt_pk_bf16_f32 v31, v26, v27
buffer_store_dwordx4 v[28:31], v1, s[20:23], s5 offen offset:1024 sc0 sc1
v_accvgpr_read_b32 v32, a96
v_accvgpr_read_b32 v33, a97
v_accvgpr_read_b32 v34, a98
v_accvgpr_read_b32 v35, a99
v_accvgpr_read_b32 v36, a100
v_accvgpr_read_b32 v37, a101
v_accvgpr_read_b32 v38, a102
v_accvgpr_read_b32 v39, a103
v_cvt_pk_bf16_f32 v40, v32, v33
v_cvt_pk_bf16_f32 v41, v34, v35
v_cvt_pk_bf16_f32 v42, v36, v37
v_cvt_pk_bf16_f32 v43, v38, v39
buffer_store_dwordx4 v[40:43], v1, s[20:23], s5 offen offset:2048 sc0 sc1
v_accvgpr_read_b32 v44, a104
v_accvgpr_read_b32 v45, a105
v_accvgpr_read_b32 v46, a106
v_accvgpr_read_b32 v47, a107
v_accvgpr_read_b32 v48, a108
v_accvgpr_read_b32 v49, a109
v_accvgpr_read_b32 v50, a110
v_accvgpr_read_b32 v51, a111
v_cvt_pk_bf16_f32 v52, v44, v45
v_cvt_pk_bf16_f32 v53, v46, v47
v_cvt_pk_bf16_f32 v54, v48, v49
v_cvt_pk_bf16_f32 v55, v50, v51
buffer_store_dwordx4 v[52:55], v1, s[20:23], s5 offen offset:3072 sc0 sc1
s_add_u32 s5, s5, 4096
v_accvgpr_read_b32 v56, a160
v_accvgpr_read_b32 v57, a161
v_accvgpr_read_b32 v58, a162
v_accvgpr_read_b32 v59, a163
v_accvgpr_read_b32 v60, a164
v_accvgpr_read_b32 v61, a165
v_accvgpr_read_b32 v62, a166
v_accvgpr_read_b32 v63, a167
v_cvt_pk_bf16_f32 v64, v56, v57
v_cvt_pk_bf16_f32 v65, v58, v59
v_cvt_pk_bf16_f32 v66, v60, v61
v_cvt_pk_bf16_f32 v67, v62, v63
buffer_store_dwordx4 v[64:67], v1, s[20:23], s5 offen offset:0 sc0 sc1
v_accvgpr_read_b32 v68, a168
v_accvgpr_read_b32 v69, a169
v_accvgpr_read_b32 v70, a170
v_accvgpr_read_b32 v71, a171
v_accvgpr_read_b32 v72, a172
v_accvgpr_read_b32 v73, a173
v_accvgpr_read_b32 v74, a174
v_accvgpr_read_b32 v75, a175
v_cvt_pk_bf16_f32 v76, v68, v69
v_cvt_pk_bf16_f32 v77, v70, v71
v_cvt_pk_bf16_f32 v78, v72, v73
v_cvt_pk_bf16_f32 v79, v74, v75
buffer_store_dwordx4 v[76:79], v1, s[20:23], s5 offen offset:1024 sc0 sc1
v_accvgpr_read_b32 v80, a224
v_accvgpr_read_b32 v81, a225
v_accvgpr_read_b32 v82, a226
v_accvgpr_read_b32 v83, a227
v_accvgpr_read_b32 v84, a228
v_accvgpr_read_b32 v85, a229
v_accvgpr_read_b32 v86, a230
v_accvgpr_read_b32 v87, a231
v_cvt_pk_bf16_f32 v88, v80, v81
v_cvt_pk_bf16_f32 v89, v82, v83
v_cvt_pk_bf16_f32 v90, v84, v85
v_cvt_pk_bf16_f32 v91, v86, v87
buffer_store_dwordx4 v[88:91], v1, s[20:23], s5 offen offset:2048 sc0 sc1
v_accvgpr_read_b32 v92, a232
v_accvgpr_read_b32 v93, a233
v_accvgpr_read_b32 v94, a234
v_accvgpr_read_b32 v95, a235
v_accvgpr_read_b32 v96, a236
v_accvgpr_read_b32 v97, a237
v_accvgpr_read_b32 v98, a238
v_accvgpr_read_b32 v99, a239
v_cvt_pk_bf16_f32 v100, v92, v93
v_cvt_pk_bf16_f32 v101, v94, v95
v_cvt_pk_bf16_f32 v102, v96, v97
v_cvt_pk_bf16_f32 v103, v98, v99
buffer_store_dwordx4 v[100:103], v1, s[20:23], s5 offen offset:3072 sc0 sc1
s_add_u32 s5, s5, 4096
v_accvgpr_read_b32 v8, a48
v_accvgpr_read_b32 v9, a49
v_accvgpr_read_b32 v10, a50
v_accvgpr_read_b32 v11, a51
v_accvgpr_read_b32 v12, a52
v_accvgpr_read_b32 v13, a53
v_accvgpr_read_b32 v14, a54
v_accvgpr_read_b32 v15, a55
v_cvt_pk_bf16_f32 v16, v8, v9
v_cvt_pk_bf16_f32 v17, v10, v11
v_cvt_pk_bf16_f32 v18, v12, v13
v_cvt_pk_bf16_f32 v19, v14, v15
buffer_store_dwordx4 v[16:19], v1, s[20:23], s5 offen offset:0 sc0 sc1
v_accvgpr_read_b32 v20, a56
v_accvgpr_read_b32 v21, a57
v_accvgpr_read_b32 v22, a58
v_accvgpr_read_b32 v23, a59
v_accvgpr_read_b32 v24, a60
v_accvgpr_read_b32 v25, a61
v_accvgpr_read_b32 v26, a62
v_accvgpr_read_b32 v27, a63
v_cvt_pk_bf16_f32 v28, v20, v21
v_cvt_pk_bf16_f32 v29, v22, v23
v_cvt_pk_bf16_f32 v30, v24, v25
v_cvt_pk_bf16_f32 v31, v26, v27
buffer_store_dwordx4 v[28:31], v1, s[20:23], s5 offen offset:1024 sc0 sc1
v_accvgpr_read_b32 v32, a112
v_accvgpr_read_b32 v33, a113
v_accvgpr_read_b32 v34, a114
v_accvgpr_read_b32 v35, a115
v_accvgpr_read_b32 v36, a116
v_accvgpr_read_b32 v37, a117
v_accvgpr_read_b32 v38, a118
v_accvgpr_read_b32 v39, a119
v_cvt_pk_bf16_f32 v40, v32, v33
v_cvt_pk_bf16_f32 v41, v34, v35
v_cvt_pk_bf16_f32 v42, v36, v37
v_cvt_pk_bf16_f32 v43, v38, v39
buffer_store_dwordx4 v[40:43], v1, s[20:23], s5 offen offset:2048 sc0 sc1
v_accvgpr_read_b32 v44, a120
v_accvgpr_read_b32 v45, a121
v_accvgpr_read_b32 v46, a122
v_accvgpr_read_b32 v47, a123
v_accvgpr_read_b32 v48, a124
v_accvgpr_read_b32 v49, a125
v_accvgpr_read_b32 v50, a126
v_accvgpr_read_b32 v51, a127
v_cvt_pk_bf16_f32 v52, v44, v45
v_cvt_pk_bf16_f32 v53, v46, v47
v_cvt_pk_bf16_f32 v54, v48, v49
v_cvt_pk_bf16_f32 v55, v50, v51
buffer_store_dwordx4 v[52:55], v1, s[20:23], s5 offen offset:3072 sc0 sc1
s_add_u32 s5, s5, 4096
v_accvgpr_read_b32 v56, a176
v_accvgpr_read_b32 v57, a177
v_accvgpr_read_b32 v58, a178
v_accvgpr_read_b32 v59, a179
v_accvgpr_read_b32 v60, a180
v_accvgpr_read_b32 v61, a181
v_accvgpr_read_b32 v62, a182
v_accvgpr_read_b32 v63, a183
v_cvt_pk_bf16_f32 v64, v56, v57
v_cvt_pk_bf16_f32 v65, v58, v59
v_cvt_pk_bf16_f32 v66, v60, v61
v_cvt_pk_bf16_f32 v67, v62, v63
buffer_store_dwordx4 v[64:67], v1, s[20:23], s5 offen offset:0 sc0 sc1
v_accvgpr_read_b32 v68, a184
v_accvgpr_read_b32 v69, a185
v_accvgpr_read_b32 v70, a186
v_accvgpr_read_b32 v71, a187
v_accvgpr_read_b32 v72, a188
v_accvgpr_read_b32 v73, a189
v_accvgpr_read_b32 v74, a190
v_accvgpr_read_b32 v75, a191
v_cvt_pk_bf16_f32 v76, v68, v69
v_cvt_pk_bf16_f32 v77, v70, v71
v_cvt_pk_bf16_f32 v78, v72, v73
v_cvt_pk_bf16_f32 v79, v74, v75
buffer_store_dwordx4 v[76:79], v1, s[20:23], s5 offen offset:1024 sc0 sc1
v_accvgpr_read_b32 v80, a240
v_accvgpr_read_b32 v81, a241
v_accvgpr_read_b32 v82, a242
v_accvgpr_read_b32 v83, a243
v_accvgpr_read_b32 v84, a244
v_accvgpr_read_b32 v85, a245
v_accvgpr_read_b32 v86, a246
v_accvgpr_read_b32 v87, a247
v_cvt_pk_bf16_f32 v88, v80, v81
v_cvt_pk_bf16_f32 v89, v82, v83
v_cvt_pk_bf16_f32 v90, v84, v85
v_cvt_pk_bf16_f32 v91, v86, v87
buffer_store_dwordx4 v[88:91], v1, s[20:23], s5 offen offset:2048 sc0 sc1
v_accvgpr_read_b32 v92, a248
v_accvgpr_read_b32 v93, a249
v_accvgpr_read_b32 v94, a250
v_accvgpr_read_b32 v95, a251
v_accvgpr_read_b32 v96, a252
v_accvgpr_read_b32 v97, a253
v_accvgpr_read_b32 v98, a254
v_accvgpr_read_b32 v99, a255
v_cvt_pk_bf16_f32 v100, v92, v93
v_cvt_pk_bf16_f32 v101, v94, v95
v_cvt_pk_bf16_f32 v102, v96, v97
v_cvt_pk_bf16_f32 v103, v98, v99
buffer_store_dwordx4 v[100:103], v1, s[20:23], s5 offen offset:3072 sc0 sc1
s_add_u32 s5, s5, 4096
s_endpgm
kv_v:
v_add_u32 v1, 0, v0
v_lshl_add_u32 v1, s41, 6, v1
v_lshrrev_b32 v2, 2, v1
v_and_b32 v1, 3, v1
v_bfe_u32 v3, v2, 2, 2
v_xor_b32 v1, v1, v3
v_mul_u32_u24 v2, 1024, v2
v_lshl_add_u32 v4, v1, 4, v2
v_add_u32 v1, 64, v0
v_lshl_add_u32 v1, s41, 6, v1
v_lshrrev_b32 v2, 2, v1
v_and_b32 v1, 3, v1
v_bfe_u32 v3, v2, 2, 2
v_xor_b32 v1, v1, v3
v_mul_u32_u24 v2, 1024, v2
v_lshl_add_u32 v5, v1, 4, v2
v_subrev_u32 v5, 1024, v5
v_add_u32 v1, 128, v0
v_lshl_add_u32 v1, s41, 6, v1
v_lshrrev_b32 v2, 2, v1
v_and_b32 v1, 3, v1
v_bfe_u32 v3, v2, 2, 2
v_xor_b32 v1, v1, v3
v_mul_u32_u24 v2, 1024, v2
v_lshl_add_u32 v6, v1, 4, v2
v_subrev_u32 v6, 2048, v6
v_add_u32 v1, 192, v0
v_lshl_add_u32 v1, s41, 6, v1
v_lshrrev_b32 v2, 2, v1
v_and_b32 v1, 3, v1
v_bfe_u32 v3, v2, 2, 2
v_xor_b32 v1, v1, v3
v_mul_u32_u24 v2, 1024, v2
v_lshl_add_u32 v7, v1, 4, v2
v_subrev_u32 v7, 3072, v7
v_add_u32 v1, 0, v0
v_lshl_add_u32 v1, s41, 6, v1
v_lshrrev_b32 v2, 5, v1
v_and_b32 v1, 31, v1
v_and_b32 v3, 3, v2
v_lshlrev_b32 v3, 2, v3
v_xor_b32 v1, v1, v3
v_mul_u32_u24 v2, 8192, v2
v_lshl_add_u32 v8, v1, 4, v2
v_add_u32 v1, 64, v0
v_lshl_add_u32 v1, s41, 6, v1
v_lshrrev_b32 v2, 5, v1
v_and_b32 v1, 31, v1
v_and_b32 v3, 3, v2
v_lshlrev_b32 v3, 2, v3
v_xor_b32 v1, v1, v3
v_mul_u32_u24 v2, 8192, v2
v_lshl_add_u32 v9, v1, 4, v2
v_subrev_u32 v9, 1024, v9
v_add_u32 v1, 128, v0
v_lshl_add_u32 v1, s41, 6, v1
v_lshrrev_b32 v2, 5, v1
v_and_b32 v1, 31, v1
v_and_b32 v3, 3, v2
v_lshlrev_b32 v3, 2, v3
v_xor_b32 v1, v1, v3
v_mul_u32_u24 v2, 8192, v2
v_lshl_add_u32 v10, v1, 4, v2
v_subrev_u32 v10, 2048, v10
v_add_u32 v1, 192, v0
v_lshl_add_u32 v1, s41, 6, v1
v_lshrrev_b32 v2, 5, v1
v_and_b32 v1, 31, v1
v_and_b32 v3, 3, v2
v_lshlrev_b32 v3, 2, v3
v_xor_b32 v1, v1, v3
v_mul_u32_u24 v2, 8192, v2
v_lshl_add_u32 v11, v1, 4, v2
v_subrev_u32 v11, 3072, v11
s_lshl_b32 s45, s39, 13
v_and_b32 v1, 31, v0
v_bfe_u32 v2, v0, 2, 2
v_lshrrev_b32 v3, 5, v0
v_xor_b32 v2, v2, v3
v_lshlrev_b32 v2, 4, v2
v_mul_u32_u24 v1, 64, v1
v_add_u32 v1, v1, v2
v_xor_b32 v12, 0, v1
v_add_u32 v12, s45, v12
v_xor_b32 v13, 32, v1
v_add_u32 v13, s45, v13
v_add_u32 v14, 65536, v12
v_add_u32 v15, 65536, v13
s_lshl_b32 s45, s40, 8
v_bfe_u32 v1, v0, 2, 2
v_lshrrev_b32 v2, 5, v0
v_lshl_add_u32 v2, v2, 3, v1
v_mul_u32_u24 v2, 512, v2
v_bfe_u32 v3, v0, 4, 1
v_lshl_add_u32 v2, v3, 5, v2
v_and_b32 v3, 3, v0
v_lshl_add_u32 v2, v3, 3, v2
v_add_u32 v2, s45, v2
v_xor_b32 v3, 0, v1
v_lshl_add_u32 v16, v3, 6, v2
v_xor_b32 v3, 1, v1
v_lshl_add_u32 v17, v3, 6, v2
v_xor_b32 v3, 2, v1
v_lshl_add_u32 v18, v3, 6, v2
v_xor_b32 v3, 3, v1
v_lshl_add_u32 v19, v3, 6, v2
v_add_u32 v20, 65536, v16
v_add_u32 v21, 65536, v17
v_add_u32 v22, 65536, v18
v_add_u32 v23, 65536, v19
s_cmp_ge_u32 s3, 2
s_cbranch_scc1 L_6
v_lshrrev_b32 v110, 4, v0
v_add_u32 v110, s47, v110
v_mul_u32_u24 v110, 1152, v110
v_and_b32 v166, 15, v0
v_lshl_add_u32 v110, v166, 3, v110
buffer_load_dwordx2 v[112:113], v110, s[28:31], 0 offen offset:0
buffer_load_dwordx2 v[114:115], v110, s[28:31], 0 offen offset:128
buffer_load_dwordx2 v[116:117], v110, s[28:31], 0 offen offset:256
buffer_load_dwordx2 v[118:119], v110, s[28:31], 0 offen offset:384
buffer_load_dwordx2 v[120:121], v110, s[28:31], 0 offen offset:512
buffer_load_dwordx2 v[122:123], v110, s[28:31], 0 offen offset:640
buffer_load_dwordx2 v[124:125], v110, s[28:31], 0 offen offset:768
buffer_load_dwordx2 v[126:127], v110, s[28:31], 0 offen offset:896
buffer_load_dwordx2 v[128:129], v110, s[28:31], 0 offen offset:1024
s_branch L_7
L_6:
s_lshl_b32 s5, s2, 1
s_add_u32 s5, s5, s40
s_mul_i32 s6, s5, 1536
s_mul_i32 s5, s5, 9216
v_lshlrev_b32 v110, 4, v0
buffer_load_dwordx4 v[124:127], v110, s[48:51], s5 offen offset:0
buffer_load_dwordx4 v[128:131], v110, s[48:51], s5 offen offset:1024
buffer_load_dwordx4 v[132:135], v110, s[48:51], s5 offen offset:2048
buffer_load_dwordx4 v[136:139], v110, s[48:51], s5 offen offset:3072
s_add_u32 s5, s5, 4096
buffer_load_dwordx4 v[140:143], v110, s[48:51], s5 offen offset:0
buffer_load_dwordx4 v[144:147], v110, s[48:51], s5 offen offset:1024
buffer_load_dwordx4 v[148:151], v110, s[48:51], s5 offen offset:2048
buffer_load_dwordx4 v[152:155], v110, s[48:51], s5 offen offset:3072
s_add_u32 s5, s5, 4096
buffer_load_dwordx4 v[156:159], v110, s[48:51], s5 offen offset:0
L_7:
s_lshl_b32 s5, s2, 2
s_add_u32 s5, s5, s3
s_mul_i32 s5, s5, 4608
v_mul_u32_u24 v108, 72, v0
buffer_load_dword v109, v108, s[56:59], s5 offen
s_add_u32 m0, s42, 0
s_nop 0
buffer_load_dwordx4 v4, s[8:11], s43 offen offset:0 lds
buffer_load_dwordx4 v5, s[8:11], s43 offen offset:1024 lds
buffer_load_dwordx4 v6, s[8:11], s43 offen offset:2048 lds
buffer_load_dwordx4 v7, s[8:11], s43 offen offset:3072 lds
s_add_u32 m0, s42, 16384
s_nop 0
buffer_load_dwordx4 v8, s[16:19], s44 offen offset:0 lds
buffer_load_dwordx4 v9, s[16:19], s44 offen offset:1024 lds
buffer_load_dwordx4 v10, s[16:19], s44 offen offset:2048 lds
buffer_load_dwordx4 v11, s[16:19], s44 offen offset:3072 lds
s_add_u32 s43, s43, 64
s_add_u32 s44, s44, 262144
s_add_u32 m0, s42, 32768
s_nop 0
buffer_load_dwordx4 v4, s[8:11], s43 offen offset:0 lds
buffer_load_dwordx4 v5, s[8:11], s43 offen offset:1024 lds
buffer_load_dwordx4 v6, s[8:11], s43 offen offset:2048 lds
buffer_load_dwordx4 v7, s[8:11], s43 offen offset:3072 lds
s_add_u32 m0, s42, 49152
s_nop 0
buffer_load_dwordx4 v8, s[16:19], s44 offen offset:0 lds
buffer_load_dwordx4 v9, s[16:19], s44 offen offset:1024 lds
buffer_load_dwordx4 v10, s[16:19], s44 offen offset:2048 lds
buffer_load_dwordx4 v11, s[16:19], s44 offen offset:3072 lds
s_add_u32 s43, s43, 64
s_add_u32 s44, s44, 262144
s_add_u32 m0, s42, 65536
s_nop 0
buffer_load_dwordx4 v4, s[8:11], s43 offen offset:0 lds
buffer_load_dwordx4 v5, s[8:11], s43 offen offset:1024 lds
buffer_load_dwordx4 v6, s[8:11], s43 offen offset:2048 lds
buffer_load_dwordx4 v7, s[8:11], s43 offen offset:3072 lds
s_add_u32 m0, s42, 81920
s_nop 0
buffer_load_dwordx4 v8, s[16:19], s44 offen offset:0 lds
buffer_load_dwordx4 v9, s[16:19], s44 offen offset:1024 lds
buffer_load_dwordx4 v10, s[16:19], s44 offen offset:2048 lds
buffer_load_dwordx4 v11, s[16:19], s44 offen offset:3072 lds
s_add_u32 s43, s43, 64
s_add_u32 s44, s44, 262144
s_add_u32 m0, s42, 98304
s_nop 0
buffer_load_dwordx4 v4, s[8:11], s43 offen offset:0 lds
buffer_load_dwordx4 v5, s[8:11], s43 offen offset:1024 lds
buffer_load_dwordx4 v6, s[8:11], s43 offen offset:2048 lds
buffer_load_dwordx4 v7, s[8:11], s43 offen offset:3072 lds
v_accvgpr_write_b32 a0, 0
v_accvgpr_write_b32 a1, 0
v_accvgpr_write_b32 a2, 0
v_accvgpr_write_b32 a3, 0
v_accvgpr_write_b32 a4, 0
v_accvgpr_write_b32 a5, 0
v_accvgpr_write_b32 a6, 0
v_accvgpr_write_b32 a7, 0
v_accvgpr_write_b32 a8, 0
v_accvgpr_write_b32 a9, 0
v_accvgpr_write_b32 a10, 0
v_accvgpr_write_b32 a11, 0
v_accvgpr_write_b32 a12, 0
v_accvgpr_write_b32 a13, 0
v_accvgpr_write_b32 a14, 0
v_accvgpr_write_b32 a15, 0
v_accvgpr_write_b32 a16, 0
v_accvgpr_write_b32 a17, 0
v_accvgpr_write_b32 a18, 0
v_accvgpr_write_b32 a19, 0
v_accvgpr_write_b32 a20, 0
v_accvgpr_write_b32 a21, 0
v_accvgpr_write_b32 a22, 0
v_accvgpr_write_b32 a23, 0
v_accvgpr_write_b32 a24, 0
v_accvgpr_write_b32 a25, 0
v_accvgpr_write_b32 a26, 0
v_accvgpr_write_b32 a27, 0
v_accvgpr_write_b32 a28, 0
v_accvgpr_write_b32 a29, 0
v_accvgpr_write_b32 a30, 0
v_accvgpr_write_b32 a31, 0
v_accvgpr_write_b32 a32, 0
v_accvgpr_write_b32 a33, 0
v_accvgpr_write_b32 a34, 0
v_accvgpr_write_b32 a35, 0
v_accvgpr_write_b32 a36, 0
v_accvgpr_write_b32 a37, 0
v_accvgpr_write_b32 a38, 0
v_accvgpr_write_b32 a39, 0
v_accvgpr_write_b32 a40, 0
v_accvgpr_write_b32 a41, 0
v_accvgpr_write_b32 a42, 0
v_accvgpr_write_b32 a43, 0
v_accvgpr_write_b32 a44, 0
v_accvgpr_write_b32 a45, 0
v_accvgpr_write_b32 a46, 0
v_accvgpr_write_b32 a47, 0
v_accvgpr_write_b32 a48, 0
v_accvgpr_write_b32 a49, 0
v_accvgpr_write_b32 a50, 0
v_accvgpr_write_b32 a51, 0
v_accvgpr_write_b32 a52, 0
v_accvgpr_write_b32 a53, 0
v_accvgpr_write_b32 a54, 0
v_accvgpr_write_b32 a55, 0
v_accvgpr_write_b32 a56, 0
v_accvgpr_write_b32 a57, 0
v_accvgpr_write_b32 a58, 0
v_accvgpr_write_b32 a59, 0
v_accvgpr_write_b32 a60, 0
v_accvgpr_write_b32 a61, 0
v_accvgpr_write_b32 a62, 0
v_accvgpr_write_b32 a63, 0
v_accvgpr_write_b32 a64, 0
v_accvgpr_write_b32 a65, 0
v_accvgpr_write_b32 a66, 0
v_accvgpr_write_b32 a67, 0
v_accvgpr_write_b32 a68, 0
v_accvgpr_write_b32 a69, 0
v_accvgpr_write_b32 a70, 0
v_accvgpr_write_b32 a71, 0
v_accvgpr_write_b32 a72, 0
v_accvgpr_write_b32 a73, 0
v_accvgpr_write_b32 a74, 0
v_accvgpr_write_b32 a75, 0
v_accvgpr_write_b32 a76, 0
v_accvgpr_write_b32 a77, 0
v_accvgpr_write_b32 a78, 0
v_accvgpr_write_b32 a79, 0
v_accvgpr_write_b32 a80, 0
v_accvgpr_write_b32 a81, 0
v_accvgpr_write_b32 a82, 0
v_accvgpr_write_b32 a83, 0
v_accvgpr_write_b32 a84, 0
v_accvgpr_write_b32 a85, 0
v_accvgpr_write_b32 a86, 0
v_accvgpr_write_b32 a87, 0
v_accvgpr_write_b32 a88, 0
v_accvgpr_write_b32 a89, 0
v_accvgpr_write_b32 a90, 0
v_accvgpr_write_b32 a91, 0
v_accvgpr_write_b32 a92, 0
v_accvgpr_write_b32 a93, 0
v_accvgpr_write_b32 a94, 0
v_accvgpr_write_b32 a95, 0
v_accvgpr_write_b32 a96, 0
v_accvgpr_write_b32 a97, 0
v_accvgpr_write_b32 a98, 0
v_accvgpr_write_b32 a99, 0
v_accvgpr_write_b32 a100, 0
v_accvgpr_write_b32 a101, 0
v_accvgpr_write_b32 a102, 0
v_accvgpr_write_b32 a103, 0
v_accvgpr_write_b32 a104, 0
v_accvgpr_write_b32 a105, 0
v_accvgpr_write_b32 a106, 0
v_accvgpr_write_b32 a107, 0
v_accvgpr_write_b32 a108, 0
v_accvgpr_write_b32 a109, 0
v_accvgpr_write_b32 a110, 0
v_accvgpr_write_b32 a111, 0
v_accvgpr_write_b32 a112, 0
v_accvgpr_write_b32 a113, 0
v_accvgpr_write_b32 a114, 0
v_accvgpr_write_b32 a115, 0
v_accvgpr_write_b32 a116, 0
v_accvgpr_write_b32 a117, 0
v_accvgpr_write_b32 a118, 0
v_accvgpr_write_b32 a119, 0
v_accvgpr_write_b32 a120, 0
v_accvgpr_write_b32 a121, 0
v_accvgpr_write_b32 a122, 0
v_accvgpr_write_b32 a123, 0
v_accvgpr_write_b32 a124, 0
v_accvgpr_write_b32 a125, 0
v_accvgpr_write_b32 a126, 0
v_accvgpr_write_b32 a127, 0
v_accvgpr_write_b32 a128, 0
v_accvgpr_write_b32 a129, 0
v_accvgpr_write_b32 a130, 0
v_accvgpr_write_b32 a131, 0
v_accvgpr_write_b32 a132, 0
v_accvgpr_write_b32 a133, 0
v_accvgpr_write_b32 a134, 0
v_accvgpr_write_b32 a135, 0
v_accvgpr_write_b32 a136, 0
v_accvgpr_write_b32 a137, 0
v_accvgpr_write_b32 a138, 0
v_accvgpr_write_b32 a139, 0
v_accvgpr_write_b32 a140, 0
v_accvgpr_write_b32 a141, 0
v_accvgpr_write_b32 a142, 0
v_accvgpr_write_b32 a143, 0
v_accvgpr_write_b32 a144, 0
v_accvgpr_write_b32 a145, 0
v_accvgpr_write_b32 a146, 0
v_accvgpr_write_b32 a147, 0
v_accvgpr_write_b32 a148, 0
v_accvgpr_write_b32 a149, 0
v_accvgpr_write_b32 a150, 0
v_accvgpr_write_b32 a151, 0
v_accvgpr_write_b32 a152, 0
v_accvgpr_write_b32 a153, 0
v_accvgpr_write_b32 a154, 0
v_accvgpr_write_b32 a155, 0
v_accvgpr_write_b32 a156, 0
v_accvgpr_write_b32 a157, 0
v_accvgpr_write_b32 a158, 0
v_accvgpr_write_b32 a159, 0
v_accvgpr_write_b32 a160, 0
v_accvgpr_write_b32 a161, 0
v_accvgpr_write_b32 a162, 0
v_accvgpr_write_b32 a163, 0
v_accvgpr_write_b32 a164, 0
v_accvgpr_write_b32 a165, 0
v_accvgpr_write_b32 a166, 0
v_accvgpr_write_b32 a167, 0
v_accvgpr_write_b32 a168, 0
v_accvgpr_write_b32 a169, 0
v_accvgpr_write_b32 a170, 0
v_accvgpr_write_b32 a171, 0
v_accvgpr_write_b32 a172, 0
v_accvgpr_write_b32 a173, 0
v_accvgpr_write_b32 a174, 0
v_accvgpr_write_b32 a175, 0
v_accvgpr_write_b32 a176, 0
v_accvgpr_write_b32 a177, 0
v_accvgpr_write_b32 a178, 0
v_accvgpr_write_b32 a179, 0
v_accvgpr_write_b32 a180, 0
v_accvgpr_write_b32 a181, 0
v_accvgpr_write_b32 a182, 0
v_accvgpr_write_b32 a183, 0
v_accvgpr_write_b32 a184, 0
v_accvgpr_write_b32 a185, 0
v_accvgpr_write_b32 a186, 0
v_accvgpr_write_b32 a187, 0
v_accvgpr_write_b32 a188, 0
v_accvgpr_write_b32 a189, 0
v_accvgpr_write_b32 a190, 0
v_accvgpr_write_b32 a191, 0
v_accvgpr_write_b32 a192, 0
v_accvgpr_write_b32 a193, 0
v_accvgpr_write_b32 a194, 0
v_accvgpr_write_b32 a195, 0
v_accvgpr_write_b32 a196, 0
v_accvgpr_write_b32 a197, 0
v_accvgpr_write_b32 a198, 0
v_accvgpr_write_b32 a199, 0
v_accvgpr_write_b32 a200, 0
v_accvgpr_write_b32 a201, 0
v_accvgpr_write_b32 a202, 0
v_accvgpr_write_b32 a203, 0
v_accvgpr_write_b32 a204, 0
v_accvgpr_write_b32 a205, 0
v_accvgpr_write_b32 a206, 0
v_accvgpr_write_b32 a207, 0
v_accvgpr_write_b32 a208, 0
v_accvgpr_write_b32 a209, 0
v_accvgpr_write_b32 a210, 0
v_accvgpr_write_b32 a211, 0
v_accvgpr_write_b32 a212, 0
v_accvgpr_write_b32 a213, 0
v_accvgpr_write_b32 a214, 0
v_accvgpr_write_b32 a215, 0
v_accvgpr_write_b32 a216, 0
v_accvgpr_write_b32 a217, 0
v_accvgpr_write_b32 a218, 0
v_accvgpr_write_b32 a219, 0
v_accvgpr_write_b32 a220, 0
v_accvgpr_write_b32 a221, 0
v_accvgpr_write_b32 a222, 0
v_accvgpr_write_b32 a223, 0
v_accvgpr_write_b32 a224, 0
v_accvgpr_write_b32 a225, 0
v_accvgpr_write_b32 a226, 0
v_accvgpr_write_b32 a227, 0
v_accvgpr_write_b32 a228, 0
v_accvgpr_write_b32 a229, 0
v_accvgpr_write_b32 a230, 0
v_accvgpr_write_b32 a231, 0
v_accvgpr_write_b32 a232, 0
v_accvgpr_write_b32 a233, 0
v_accvgpr_write_b32 a234, 0
v_accvgpr_write_b32 a235, 0
v_accvgpr_write_b32 a236, 0
v_accvgpr_write_b32 a237, 0
v_accvgpr_write_b32 a238, 0
v_accvgpr_write_b32 a239, 0
v_accvgpr_write_b32 a240, 0
v_accvgpr_write_b32 a241, 0
v_accvgpr_write_b32 a242, 0
v_accvgpr_write_b32 a243, 0
v_accvgpr_write_b32 a244, 0
v_accvgpr_write_b32 a245, 0
v_accvgpr_write_b32 a246, 0
v_accvgpr_write_b32 a247, 0
v_accvgpr_write_b32 a248, 0
v_accvgpr_write_b32 a249, 0
v_accvgpr_write_b32 a250, 0
v_accvgpr_write_b32 a251, 0
v_accvgpr_write_b32 a252, 0
v_accvgpr_write_b32 a253, 0
v_accvgpr_write_b32 a254, 0
v_accvgpr_write_b32 a255, 0
s_waitcnt vmcnt(28)
s_cmp_ge_u32 s3, 2
s_cbranch_scc1 L_8
v_lshlrev_b32 v130, 16, v112
v_and_b32 v131, 0xffff0000, v112
v_lshlrev_b32 v132, 16, v113
v_and_b32 v133, 0xffff0000, v113
v_lshlrev_b32 v134, 16, v114
v_and_b32 v135, 0xffff0000, v114
v_lshlrev_b32 v136, 16, v115
v_and_b32 v137, 0xffff0000, v115
v_lshlrev_b32 v138, 16, v116
v_and_b32 v139, 0xffff0000, v116
v_lshlrev_b32 v140, 16, v117
v_and_b32 v141, 0xffff0000, v117
v_lshlrev_b32 v142, 16, v118
v_and_b32 v143, 0xffff0000, v118
v_lshlrev_b32 v144, 16, v119
v_and_b32 v145, 0xffff0000, v119
v_lshlrev_b32 v146, 16, v120
v_and_b32 v147, 0xffff0000, v120
v_lshlrev_b32 v148, 16, v121
v_and_b32 v149, 0xffff0000, v121
v_lshlrev_b32 v150, 16, v122
v_and_b32 v151, 0xffff0000, v122
v_lshlrev_b32 v152, 16, v123
v_and_b32 v153, 0xffff0000, v123
v_lshlrev_b32 v154, 16, v124
v_and_b32 v155, 0xffff0000, v124
v_lshlrev_b32 v156, 16, v125
v_and_b32 v157, 0xffff0000, v125
v_lshlrev_b32 v158, 16, v126
v_and_b32 v159, 0xffff0000, v126
v_lshlrev_b32 v160, 16, v127
v_and_b32 v161, 0xffff0000, v127
v_lshlrev_b32 v162, 16, v128
v_and_b32 v163, 0xffff0000, v128
v_lshlrev_b32 v164, 16, v129
v_and_b32 v165, 0xffff0000, v129
v_add_f32 v166, v130, v131
v_add_f32 v166, v166, v132
v_add_f32 v166, v166, v133
v_add_f32 v166, v166, v134
v_add_f32 v166, v166, v135
v_add_f32 v166, v166, v136
v_add_f32 v166, v166, v137
v_add_f32 v166, v166, v138
v_add_f32 v166, v166, v139
v_add_f32 v166, v166, v140
v_add_f32 v166, v166, v141
v_add_f32 v166, v166, v142
v_add_f32 v166, v166, v143
v_add_f32 v166, v166, v144
v_add_f32 v166, v166, v145
v_add_f32 v166, v166, v146
v_add_f32 v166, v166, v147
v_add_f32 v166, v166, v148
v_add_f32 v166, v166, v149
v_add_f32 v166, v166, v150
v_add_f32 v166, v166, v151
v_add_f32 v166, v166, v152
v_add_f32 v166, v166, v153
v_add_f32 v166, v166, v154
v_add_f32 v166, v166, v155
v_add_f32 v166, v166, v156
v_add_f32 v166, v166, v157
v_add_f32 v166, v166, v158
v_add_f32 v166, v166, v159
v_add_f32 v166, v166, v160
v_add_f32 v166, v166, v161
v_add_f32 v166, v166, v162
v_add_f32 v166, v166, v163
v_add_f32 v166, v166, v164
v_add_f32 v166, v166, v165
s_nop 1
v_add_f32_dpp v166, v166, v166 row_ror:8 row_mask:0xf bank_mask:0xf
s_nop 1
v_add_f32_dpp v166, v166, v166 row_ror:4 row_mask:0xf bank_mask:0xf
s_nop 1
v_add_f32_dpp v166, v166, v166 row_ror:2 row_mask:0xf bank_mask:0xf
s_nop 1
v_add_f32_dpp v166, v166, v166 row_ror:1 row_mask:0xf bank_mask:0xf
v_mul_f32 v166, 0x3ae38e39, v166
v_sub_f32 v130, v130, v166
v_sub_f32 v131, v131, v166
v_sub_f32 v132, v132, v166
v_sub_f32 v133, v133, v166
v_sub_f32 v134, v134, v166
v_sub_f32 v135, v135, v166
v_sub_f32 v136, v136, v166
v_sub_f32 v137, v137, v166
v_sub_f32 v138, v138, v166
v_sub_f32 v139, v139, v166
v_sub_f32 v140, v140, v166
v_sub_f32 v141, v141, v166
v_sub_f32 v142, v142, v166
v_sub_f32 v143, v143, v166
v_sub_f32 v144, v144, v166
v_sub_f32 v145, v145, v166
v_sub_f32 v146, v146, v166
v_sub_f32 v147, v147, v166
v_sub_f32 v148, v148, v166
v_sub_f32 v149, v149, v166
v_sub_f32 v150, v150, v166
v_sub_f32 v151, v151, v166
v_sub_f32 v152, v152, v166
v_sub_f32 v153, v153, v166
v_sub_f32 v154, v154, v166
v_sub_f32 v155, v155, v166
v_sub_f32 v156, v156, v166
v_sub_f32 v157, v157, v166
v_sub_f32 v158, v158, v166
v_sub_f32 v159, v159, v166
v_sub_f32 v160, v160, v166
v_sub_f32 v161, v161, v166
v_sub_f32 v162, v162, v166
v_sub_f32 v163, v163, v166
v_sub_f32 v164, v164, v166
v_sub_f32 v165, v165, v166
v_mul_f32 v166, v130, v130
v_fmac_f32 v166, v131, v131
v_fmac_f32 v166, v132, v132
v_fmac_f32 v166, v133, v133
v_fmac_f32 v166, v134, v134
v_fmac_f32 v166, v135, v135
v_fmac_f32 v166, v136, v136
v_fmac_f32 v166, v137, v137
v_fmac_f32 v166, v138, v138
v_fmac_f32 v166, v139, v139
v_fmac_f32 v166, v140, v140
v_fmac_f32 v166, v141, v141
v_fmac_f32 v166, v142, v142
v_fmac_f32 v166, v143, v143
v_fmac_f32 v166, v144, v144
v_fmac_f32 v166, v145, v145
v_fmac_f32 v166, v146, v146
v_fmac_f32 v166, v147, v147
v_fmac_f32 v166, v148, v148
v_fmac_f32 v166, v149, v149
v_fmac_f32 v166, v150, v150
v_fmac_f32 v166, v151, v151
v_fmac_f32 v166, v152, v152
v_fmac_f32 v166, v153, v153
v_fmac_f32 v166, v154, v154
v_fmac_f32 v166, v155, v155
v_fmac_f32 v166, v156, v156
v_fmac_f32 v166, v157, v157
v_fmac_f32 v166, v158, v158
v_fmac_f32 v166, v159, v159
v_fmac_f32 v166, v160, v160
v_fmac_f32 v166, v161, v161
v_fmac_f32 v166, v162, v162
v_fmac_f32 v166, v163, v163
v_fmac_f32 v166, v164, v164
v_fmac_f32 v166, v165, v165
s_nop 1
v_add_f32_dpp v166, v166, v166 row_ror:8 row_mask:0xf bank_mask:0xf
s_nop 1
v_add_f32_dpp v166, v166, v166 row_ror:4 row_mask:0xf bank_mask:0xf
s_nop 1
v_add_f32_dpp v166, v166, v166 row_ror:2 row_mask:0xf bank_mask:0xf
s_nop 1
v_add_f32_dpp v166, v166, v166 row_ror:1 row_mask:0xf bank_mask:0xf
v_mov_b32 v167, 0x3727c5ac
v_fmac_f32 v167, 0x3ae38e39, v166
v_rsq_f32 v166, v167
s_nop 0
v_mul_f32 v130, v130, v166
v_mul_f32 v131, v131, v166
v_mul_f32 v132, v132, v166
v_mul_f32 v133, v133, v166
v_mul_f32 v134, v134, v166
v_mul_f32 v135, v135, v166
v_mul_f32 v136, v136, v166
v_mul_f32 v137, v137, v166
v_mul_f32 v138, v138, v166
v_mul_f32 v139, v139, v166
v_mul_f32 v140, v140, v166
v_mul_f32 v141, v141, v166
v_mul_f32 v142, v142, v166
v_mul_f32 v143, v143, v166
v_mul_f32 v144, v144, v166
v_mul_f32 v145, v145, v166
v_mul_f32 v146, v146, v166
v_mul_f32 v147, v147, v166
v_mul_f32 v148, v148, v166
v_mul_f32 v149, v149, v166
v_mul_f32 v150, v150, v166
v_mul_f32 v151, v151, v166
v_mul_f32 v152, v152, v166
v_mul_f32 v153, v153, v166
v_mul_f32 v154, v154, v166
v_mul_f32 v155, v155, v166
v_mul_f32 v156, v156, v166
v_mul_f32 v157, v157, v166
v_mul_f32 v158, v158, v166
v_mul_f32 v159, v159, v166
v_mul_f32 v160, v160, v166
v_mul_f32 v161, v161, v166
v_mul_f32 v162, v162, v166
v_mul_f32 v163, v163, v166
v_mul_f32 v164, v164, v166
v_mul_f32 v165, v165, v166
v_cvt_pk_bf16_f32 v112, v130, v131
v_cvt_pk_bf16_f32 v113, v132, v133
v_cvt_pk_bf16_f32 v114, v134, v135
v_cvt_pk_bf16_f32 v115, v136, v137
v_cvt_pk_bf16_f32 v116, v138, v139
v_cvt_pk_bf16_f32 v117, v140, v141
v_cvt_pk_bf16_f32 v118, v142, v143
v_cvt_pk_bf16_f32 v119, v144, v145
v_cvt_pk_bf16_f32 v120, v146, v147
v_cvt_pk_bf16_f32 v121, v148, v149
v_cvt_pk_bf16_f32 v122, v150, v151
v_cvt_pk_bf16_f32 v123, v152, v153
v_cvt_pk_bf16_f32 v124, v154, v155
v_cvt_pk_bf16_f32 v125, v156, v157
v_cvt_pk_bf16_f32 v126, v158, v159
v_cvt_pk_bf16_f32 v127, v160, v161
v_cvt_pk_bf16_f32 v128, v162, v163
v_cvt_pk_bf16_f32 v129, v164, v165
buffer_store_dwordx2 v[112:113], v110, s[32:35], 0 offen offset:0
buffer_store_dwordx2 v[114:115], v110, s[32:35], 0 offen offset:128
buffer_store_dwordx2 v[116:117], v110, s[32:35], 0 offen offset:256
buffer_store_dwordx2 v[118:119], v110, s[32:35], 0 offen offset:384
buffer_store_dwordx2 v[120:121], v110, s[32:35], 0 offen offset:512
buffer_store_dwordx2 v[122:123], v110, s[32:35], 0 offen offset:640
buffer_store_dwordx2 v[124:125], v110, s[32:35], 0 offen offset:768
buffer_store_dwordx2 v[126:127], v110, s[32:35], 0 offen offset:896
buffer_store_dwordx2 v[128:129], v110, s[32:35], 0 offen offset:1024
s_branch L_9
L_8:
s_lshl_b32 s5, s2, 1
s_add_u32 s5, s5, s40
s_mul_i32 s6, s5, 1536
s_mul_i32 s5, s5, 9216
v_lshlrev_b32 v110, 4, v0
v_add_u32 v110, 0, v0
v_mul_u32_u24 v111, 911, v110
v_lshrrev_b32 v111, 16, v111
v_mul_u32_u24 v112, 72, v111
v_sub_u32 v110, v110, v112
v_mul_u32_u24 v112, 0x5556, v110
v_lshrrev_b32 v112, 18, v112
v_mul_u32_u24 v112, 786240, v112
v_mul_u32_u24 v111, 192, v111
v_lshl_add_u32 v110, v110, 4, v111
v_add_u32 v113, v110, v112
buffer_store_dwordx4 v[124:127], v113, s[52:55], s6 offen
v_add_u32 v110, 64, v0
v_mul_u32_u24 v111, 911, v110
v_lshrrev_b32 v111, 16, v111
v_mul_u32_u24 v112, 72, v111
v_sub_u32 v110, v110, v112
v_mul_u32_u24 v112, 0x5556, v110
v_lshrrev_b32 v112, 18, v112
v_mul_u32_u24 v112, 786240, v112
v_mul_u32_u24 v111, 192, v111
v_lshl_add_u32 v110, v110, 4, v111
v_add_u32 v114, v110, v112
buffer_store_dwordx4 v[128:131], v114, s[52:55], s6 offen
v_add_u32 v110, 128, v0
v_mul_u32_u24 v111, 911, v110
v_lshrrev_b32 v111, 16, v111
v_mul_u32_u24 v112, 72, v111
v_sub_u32 v110, v110, v112
v_mul_u32_u24 v112, 0x5556, v110
v_lshrrev_b32 v112, 18, v112
v_mul_u32_u24 v112, 786240, v112
v_mul_u32_u24 v111, 192, v111
v_lshl_add_u32 v110, v110, 4, v111
v_add_u32 v115, v110, v112
buffer_store_dwordx4 v[132:135], v115, s[52:55], s6 offen
v_add_u32 v110, 192, v0
v_mul_u32_u24 v111, 911, v110
v_lshrrev_b32 v111, 16, v111
v_mul_u32_u24 v112, 72, v111
v_sub_u32 v110, v110, v112
v_mul_u32_u24 v112, 0x5556, v110
v_lshrrev_b32 v112, 18, v112
v_mul_u32_u24 v112, 786240, v112
v_mul_u32_u24 v111, 192, v111
v_lshl_add_u32 v110, v110, 4, v111
v_add_u32 v116, v110, v112
buffer_store_dwordx4 v[136:139], v116, s[52:55], s6 offen
v_add_u32 v110, 256, v0
v_mul_u32_u24 v111, 911, v110
v_lshrrev_b32 v111, 16, v111
v_mul_u32_u24 v112, 72, v111
v_sub_u32 v110, v110, v112
v_mul_u32_u24 v112, 0x5556, v110
v_lshrrev_b32 v112, 18, v112
v_mul_u32_u24 v112, 786240, v112
v_mul_u32_u24 v111, 192, v111
v_lshl_add_u32 v110, v110, 4, v111
v_add_u32 v117, v110, v112
buffer_store_dwordx4 v[140:143], v117, s[52:55], s6 offen
v_add_u32 v110, 320, v0
v_mul_u32_u24 v111, 911, v110
v_lshrrev_b32 v111, 16, v111
v_mul_u32_u24 v112, 72, v111
v_sub_u32 v110, v110, v112
v_mul_u32_u24 v112, 0x5556, v110
v_lshrrev_b32 v112, 18, v112
v_mul_u32_u24 v112, 786240, v112
v_mul_u32_u24 v111, 192, v111
v_lshl_add_u32 v110, v110, 4, v111
v_add_u32 v118, v110, v112
buffer_store_dwordx4 v[144:147], v118, s[52:55], s6 offen
v_add_u32 v110, 384, v0
v_mul_u32_u24 v111, 911, v110
v_lshrrev_b32 v111, 16, v111
v_mul_u32_u24 v112, 72, v111
v_sub_u32 v110, v110, v112
v_mul_u32_u24 v112, 0x5556, v110
v_lshrrev_b32 v112, 18, v112
v_mul_u32_u24 v112, 786240, v112
v_mul_u32_u24 v111, 192, v111
v_lshl_add_u32 v110, v110, 4, v111
v_add_u32 v119, v110, v112
buffer_store_dwordx4 v[148:151], v119, s[52:55], s6 offen
v_add_u32 v110, 448, v0
v_mul_u32_u24 v111, 911, v110
v_lshrrev_b32 v111, 16, v111
v_mul_u32_u24 v112, 72, v111
v_sub_u32 v110, v110, v112
v_mul_u32_u24 v112, 0x5556, v110
v_lshrrev_b32 v112, 18, v112
v_mul_u32_u24 v112, 786240, v112
v_mul_u32_u24 v111, 192, v111
v_lshl_add_u32 v110, v110, 4, v111
v_add_u32 v120, v110, v112
buffer_store_dwordx4 v[152:155], v120, s[52:55], s6 offen
v_add_u32 v110, 512, v0
v_mul_u32_u24 v111, 911, v110
v_lshrrev_b32 v111, 16, v111
v_mul_u32_u24 v112, 72, v111
v_sub_u32 v110, v110, v112
v_mul_u32_u24 v112, 0x5556, v110
v_lshrrev_b32 v112, 18, v112
v_mul_u32_u24 v112, 786240, v112
v_mul_u32_u24 v111, 192, v111
v_lshl_add_u32 v110, v110, 4, v111
v_add_u32 v121, v110, v112
buffer_store_dwordx4 v[156:159], v121, s[52:55], s6 offen
L_9:
s_waitcnt vmcnt(29)
s_barrier
ds_read_b128 v[32:35], v12 offset:0
ds_read_b128 v[36:39], v12 offset:2048
ds_read_b128 v[40:43], v12 offset:4096
ds_read_b128 v[44:47], v12 offset:6144
ds_read_b64_tr_b16 v[48:49], v16 offset:16384
ds_read_b64_tr_b16 v[50:51], v16 offset:18432
ds_read_b64_tr_b16 v[52:53], v17 offset:16384
ds_read_b64_tr_b16 v[54:55], v17 offset:18432
ds_read_b64_tr_b16 v[56:57], v18 offset:16384
ds_read_b64_tr_b16 v[58:59], v18 offset:18432
ds_read_b64_tr_b16 v[60:61], v19 offset:16384
ds_read_b64_tr_b16 v[62:63], v19 offset:18432
s_mov_b32 s4, 3
gl_10:
s_waitcnt lgkmcnt(0)
v_mfma_f32_32x32x16_bf16 a[0:15], v[32:35], v[48:51], a[0:15]
ds_read_b128 v[64:67], v13 offset:0
ds_read_b128 v[68:71], v13 offset:2048
v_mfma_f32_32x32x16_bf16 a[16:31], v[32:35], v[52:55], a[16:31]
ds_read_b128 v[72:75], v13 offset:4096
v_mfma_f32_32x32x16_bf16 a[32:47], v[32:35], v[56:59], a[32:47]
ds_read_b128 v[76:79], v13 offset:6144
v_mfma_f32_32x32x16_bf16 a[48:63], v[32:35], v[60:63], a[48:63]
ds_read_b64_tr_b16 v[80:81], v16 offset:24576
v_mfma_f32_32x32x16_bf16 a[64:79], v[36:39], v[48:51], a[64:79]
ds_read_b64_tr_b16 v[82:83], v16 offset:26624
v_mfma_f32_32x32x16_bf16 a[80:95], v[36:39], v[52:55], a[80:95]
ds_read_b64_tr_b16 v[84:85], v17 offset:24576
ds_read_b64_tr_b16 v[86:87], v17 offset:26624
v_mfma_f32_32x32x16_bf16 a[96:111], v[36:39], v[56:59], a[96:111]
ds_read_b64_tr_b16 v[88:89], v18 offset:24576
v_mfma_f32_32x32x16_bf16 a[112:127], v[36:39], v[60:63], a[112:127]
ds_read_b64_tr_b16 v[90:91], v18 offset:26624
v_mfma_f32_32x32x16_bf16 a[128:143], v[40:43], v[48:51], a[128:143]
ds_read_b64_tr_b16 v[92:93], v19 offset:24576
v_mfma_f32_32x32x16_bf16 a[144:159], v[40:43], v[52:55], a[144:159]
ds_read_b64_tr_b16 v[94:95], v19 offset:26624
v_mfma_f32_32x32x16_bf16 a[160:175], v[40:43], v[56:59], a[160:175]
s_add_u32 m0, s42, 114688
s_nop 0
buffer_load_dwordx4 v8, s[16:19], s44 offen offset:0 lds
v_mfma_f32_32x32x16_bf16 a[176:191], v[40:43], v[60:63], a[176:191]
buffer_load_dwordx4 v9, s[16:19], s44 offen offset:1024 lds
v_mfma_f32_32x32x16_bf16 a[192:207], v[44:47], v[48:51], a[192:207]
buffer_load_dwordx4 v10, s[16:19], s44 offen offset:2048 lds
v_mfma_f32_32x32x16_bf16 a[208:223], v[44:47], v[52:55], a[208:223]
buffer_load_dwordx4 v11, s[16:19], s44 offen offset:3072 lds
v_mfma_f32_32x32x16_bf16 a[224:239], v[44:47], v[56:59], a[224:239]
s_add_u32 s43, s43, 64
s_add_u32 s44, s44, 262144
v_mfma_f32_32x32x16_bf16 a[240:255], v[44:47], v[60:63], a[240:255]
s_waitcnt lgkmcnt(0)
s_waitcnt vmcnt(16)
s_barrier
v_mfma_f32_32x32x16_bf16 a[0:15], v[64:67], v[80:83], a[0:15]
ds_read_b128 v[32:35], v12 offset:32768
ds_read_b128 v[36:39], v12 offset:34816
v_mfma_f32_32x32x16_bf16 a[16:31], v[64:67], v[84:87], a[16:31]
ds_read_b128 v[40:43], v12 offset:36864
v_mfma_f32_32x32x16_bf16 a[32:47], v[64:67], v[88:91], a[32:47]
ds_read_b128 v[44:47], v12 offset:38912
v_mfma_f32_32x32x16_bf16 a[48:63], v[64:67], v[92:95], a[48:63]
ds_read_b64_tr_b16 v[48:49], v16 offset:49152
v_mfma_f32_32x32x16_bf16 a[64:79], v[68:71], v[80:83], a[64:79]
ds_read_b64_tr_b16 v[50:51], v16 offset:51200
v_mfma_f32_32x32x16_bf16 a[80:95], v[68:71], v[84:87], a[80:95]
ds_read_b64_tr_b16 v[52:53], v17 offset:49152
ds_read_b64_tr_b16 v[54:55], v17 offset:51200
v_mfma_f32_32x32x16_bf16 a[96:111], v[68:71], v[88:91], a[96:111]
ds_read_b64_tr_b16 v[56:57], v18 offset:49152
v_mfma_f32_32x32x16_bf16 a[112:127], v[68:71], v[92:95], a[112:127]
ds_read_b64_tr_b16 v[58:59], v18 offset:51200
v_mfma_f32_32x32x16_bf16 a[128:143], v[72:75], v[80:83], a[128:143]
ds_read_b64_tr_b16 v[60:61], v19 offset:49152
v_mfma_f32_32x32x16_bf16 a[144:159], v[72:75], v[84:87], a[144:159]
ds_read_b64_tr_b16 v[62:63], v19 offset:51200
v_mfma_f32_32x32x16_bf16 a[160:175], v[72:75], v[88:91], a[160:175]
s_add_u32 m0, s42, 0
s_nop 0
buffer_load_dwordx4 v4, s[8:11], s43 offen offset:0 lds
v_mfma_f32_32x32x16_bf16 a[176:191], v[72:75], v[92:95], a[176:191]
buffer_load_dwordx4 v5, s[8:11], s43 offen offset:1024 lds
v_mfma_f32_32x32x16_bf16 a[192:207], v[76:79], v[80:83], a[192:207]
v_mfma_f32_32x32x16_bf16 a[208:223], v[76:79], v[84:87], a[208:223]
buffer_load_dwordx4 v6, s[8:11], s43 offen offset:2048 lds
v_mfma_f32_32x32x16_bf16 a[224:239], v[76:79], v[88:91], a[224:239]
buffer_load_dwordx4 v7, s[8:11], s43 offen offset:3072 lds
v_mfma_f32_32x32x16_bf16 a[240:255], v[76:79], v[92:95], a[240:255]
s_waitcnt lgkmcnt(0)
v_mfma_f32_32x32x16_bf16 a[0:15], v[32:35], v[48:51], a[0:15]
ds_read_b128 v[64:67], v13 offset:32768
ds_read_b128 v[68:71], v13 offset:34816
v_mfma_f32_32x32x16_bf16 a[16:31], v[32:35], v[52:55], a[16:31]
ds_read_b128 v[72:75], v13 offset:36864
v_mfma_f32_32x32x16_bf16 a[32:47], v[32:35], v[56:59], a[32:47]
ds_read_b128 v[76:79], v13 offset:38912
v_mfma_f32_32x32x16_bf16 a[48:63], v[32:35], v[60:63], a[48:63]
ds_read_b64_tr_b16 v[80:81], v16 offset:57344
v_mfma_f32_32x32x16_bf16 a[64:79], v[36:39], v[48:51], a[64:79]
ds_read_b64_tr_b16 v[82:83], v16 offset:59392
v_mfma_f32_32x32x16_bf16 a[80:95], v[36:39], v[52:55], a[80:95]
ds_read_b64_tr_b16 v[84:85], v17 offset:57344
ds_read_b64_tr_b16 v[86:87], v17 offset:59392
v_mfma_f32_32x32x16_bf16 a[96:111], v[36:39], v[56:59], a[96:111]
ds_read_b64_tr_b16 v[88:89], v18 offset:57344
v_mfma_f32_32x32x16_bf16 a[112:127], v[36:39], v[60:63], a[112:127]
ds_read_b64_tr_b16 v[90:91], v18 offset:59392
v_mfma_f32_32x32x16_bf16 a[128:143], v[40:43], v[48:51], a[128:143]
ds_read_b64_tr_b16 v[92:93], v19 offset:57344
v_mfma_f32_32x32x16_bf16 a[144:159], v[40:43], v[52:55], a[144:159]
ds_read_b64_tr_b16 v[94:95], v19 offset:59392
v_mfma_f32_32x32x16_bf16 a[160:175], v[40:43], v[56:59], a[160:175]
s_add_u32 m0, s42, 16384
s_nop 0
buffer_load_dwordx4 v8, s[16:19], s44 offen offset:0 lds
v_mfma_f32_32x32x16_bf16 a[176:191], v[40:43], v[60:63], a[176:191]
buffer_load_dwordx4 v9, s[16:19], s44 offen offset:1024 lds
v_mfma_f32_32x32x16_bf16 a[192:207], v[44:47], v[48:51], a[192:207]
buffer_load_dwordx4 v10, s[16:19], s44 offen offset:2048 lds
v_mfma_f32_32x32x16_bf16 a[208:223], v[44:47], v[52:55], a[208:223]
buffer_load_dwordx4 v11, s[16:19], s44 offen offset:3072 lds
v_mfma_f32_32x32x16_bf16 a[224:239], v[44:47], v[56:59], a[224:239]
s_add_u32 s43, s43, 64
s_add_u32 s44, s44, 262144
v_mfma_f32_32x32x16_bf16 a[240:255], v[44:47], v[60:63], a[240:255]
s_waitcnt lgkmcnt(0)
s_waitcnt vmcnt(16)
s_barrier
v_mfma_f32_32x32x16_bf16 a[0:15], v[64:67], v[80:83], a[0:15]
ds_read_b128 v[32:35], v14 offset:0
ds_read_b128 v[36:39], v14 offset:2048
v_mfma_f32_32x32x16_bf16 a[16:31], v[64:67], v[84:87], a[16:31]
ds_read_b128 v[40:43], v14 offset:4096
v_mfma_f32_32x32x16_bf16 a[32:47], v[64:67], v[88:91], a[32:47]
ds_read_b128 v[44:47], v14 offset:6144
v_mfma_f32_32x32x16_bf16 a[48:63], v[64:67], v[92:95], a[48:63]
ds_read_b64_tr_b16 v[48:49], v20 offset:16384
v_mfma_f32_32x32x16_bf16 a[64:79], v[68:71], v[80:83], a[64:79]
ds_read_b64_tr_b16 v[50:51], v20 offset:18432
v_mfma_f32_32x32x16_bf16 a[80:95], v[68:71], v[84:87], a[80:95]
ds_read_b64_tr_b16 v[52:53], v21 offset:16384
ds_read_b64_tr_b16 v[54:55], v21 offset:18432
v_mfma_f32_32x32x16_bf16 a[96:111], v[68:71], v[88:91], a[96:111]
ds_read_b64_tr_b16 v[56:57], v22 offset:16384
v_mfma_f32_32x32x16_bf16 a[112:127], v[68:71], v[92:95], a[112:127]
ds_read_b64_tr_b16 v[58:59], v22 offset:18432
v_mfma_f32_32x32x16_bf16 a[128:143], v[72:75], v[80:83], a[128:143]
ds_read_b64_tr_b16 v[60:61], v23 offset:16384
v_mfma_f32_32x32x16_bf16 a[144:159], v[72:75], v[84:87], a[144:159]
ds_read_b64_tr_b16 v[62:63], v23 offset:18432
v_mfma_f32_32x32x16_bf16 a[160:175], v[72:75], v[88:91], a[160:175]
s_add_u32 m0, s42, 32768
s_nop 0
buffer_load_dwordx4 v4, s[8:11], s43 offen offset:0 lds
v_mfma_f32_32x32x16_bf16 a[176:191], v[72:75], v[92:95], a[176:191]
buffer_load_dwordx4 v5, s[8:11], s43 offen offset:1024 lds
v_mfma_f32_32x32x16_bf16 a[192:207], v[76:79], v[80:83], a[192:207]
v_mfma_f32_32x32x16_bf16 a[208:223], v[76:79], v[84:87], a[208:223]
buffer_load_dwordx4 v6, s[8:11], s43 offen offset:2048 lds
v_mfma_f32_32x32x16_bf16 a[224:239], v[76:79], v[88:91], a[224:239]
buffer_load_dwordx4 v7, s[8:11], s43 offen offset:3072 lds
v_mfma_f32_32x32x16_bf16 a[240:255], v[76:79], v[92:95], a[240:255]
s_waitcnt lgkmcnt(0)
v_mfma_f32_32x32x16_bf16 a[0:15], v[32:35], v[48:51], a[0:15]
ds_read_b128 v[64:67], v15 offset:0
ds_read_b128 v[68:71], v15 offset:2048
v_mfma_f32_32x32x16_bf16 a[16:31], v[32:35], v[52:55], a[16:31]
ds_read_b128 v[72:75], v15 offset:4096
v_mfma_f32_32x32x16_bf16 a[32:47], v[32:35], v[56:59], a[32:47]
ds_read_b128 v[76:79], v15 offset:6144
v_mfma_f32_32x32x16_bf16 a[48:63], v[32:35], v[60:63], a[48:63]
ds_read_b64_tr_b16 v[80:81], v20 offset:24576
v_mfma_f32_32x32x16_bf16 a[64:79], v[36:39], v[48:51], a[64:79]
ds_read_b64_tr_b16 v[82:83], v20 offset:26624
v_mfma_f32_32x32x16_bf16 a[80:95], v[36:39], v[52:55], a[80:95]
ds_read_b64_tr_b16 v[84:85], v21 offset:24576
ds_read_b64_tr_b16 v[86:87], v21 offset:26624
v_mfma_f32_32x32x16_bf16 a[96:111], v[36:39], v[56:59], a[96:111]
ds_read_b64_tr_b16 v[88:89], v22 offset:24576
v_mfma_f32_32x32x16_bf16 a[112:127], v[36:39], v[60:63], a[112:127]
ds_read_b64_tr_b16 v[90:91], v22 offset:26624
v_mfma_f32_32x32x16_bf16 a[128:143], v[40:43], v[48:51], a[128:143]
ds_read_b64_tr_b16 v[92:93], v23 offset:24576
v_mfma_f32_32x32x16_bf16 a[144:159], v[40:43], v[52:55], a[144:159]
ds_read_b64_tr_b16 v[94:95], v23 offset:26624
v_mfma_f32_32x32x16_bf16 a[160:175], v[40:43], v[56:59], a[160:175]
s_add_u32 m0, s42, 49152
s_nop 0
buffer_load_dwordx4 v8, s[16:19], s44 offen offset:0 lds
v_mfma_f32_32x32x16_bf16 a[176:191], v[40:43], v[60:63], a[176:191]
buffer_load_dwordx4 v9, s[16:19], s44 offen offset:1024 lds
v_mfma_f32_32x32x16_bf16 a[192:207], v[44:47], v[48:51], a[192:207]
buffer_load_dwordx4 v10, s[16:19], s44 offen offset:2048 lds
v_mfma_f32_32x32x16_bf16 a[208:223], v[44:47], v[52:55], a[208:223]
buffer_load_dwordx4 v11, s[16:19], s44 offen offset:3072 lds
v_mfma_f32_32x32x16_bf16 a[224:239], v[44:47], v[56:59], a[224:239]
s_add_u32 s43, s43, 64
s_add_u32 s44, s44, 262144
v_mfma_f32_32x32x16_bf16 a[240:255], v[44:47], v[60:63], a[240:255]
s_waitcnt lgkmcnt(0)
s_waitcnt vmcnt(16)
s_barrier
v_mfma_f32_32x32x16_bf16 a[0:15], v[64:67], v[80:83], a[0:15]
ds_read_b128 v[32:35], v14 offset:32768
ds_read_b128 v[36:39], v14 offset:34816
v_mfma_f32_32x32x16_bf16 a[16:31], v[64:67], v[84:87], a[16:31]
ds_read_b128 v[40:43], v14 offset:36864
v_mfma_f32_32x32x16_bf16 a[32:47], v[64:67], v[88:91], a[32:47]
ds_read_b128 v[44:47], v14 offset:38912
v_mfma_f32_32x32x16_bf16 a[48:63], v[64:67], v[92:95], a[48:63]
ds_read_b64_tr_b16 v[48:49], v20 offset:49152
v_mfma_f32_32x32x16_bf16 a[64:79], v[68:71], v[80:83], a[64:79]
ds_read_b64_tr_b16 v[50:51], v20 offset:51200
v_mfma_f32_32x32x16_bf16 a[80:95], v[68:71], v[84:87], a[80:95]
ds_read_b64_tr_b16 v[52:53], v21 offset:49152
ds_read_b64_tr_b16 v[54:55], v21 offset:51200
v_mfma_f32_32x32x16_bf16 a[96:111], v[68:71], v[88:91], a[96:111]
ds_read_b64_tr_b16 v[56:57], v22 offset:49152
v_mfma_f32_32x32x16_bf16 a[112:127], v[68:71], v[92:95], a[112:127]
ds_read_b64_tr_b16 v[58:59], v22 offset:51200
v_mfma_f32_32x32x16_bf16 a[128:143], v[72:75], v[80:83], a[128:143]
ds_read_b64_tr_b16 v[60:61], v23 offset:49152
v_mfma_f32_32x32x16_bf16 a[144:159], v[72:75], v[84:87], a[144:159]
ds_read_b64_tr_b16 v[62:63], v23 offset:51200
v_mfma_f32_32x32x16_bf16 a[160:175], v[72:75], v[88:91], a[160:175]
s_add_u32 m0, s42, 65536
s_nop 0
buffer_load_dwordx4 v4, s[8:11], s43 offen offset:0 lds
v_mfma_f32_32x32x16_bf16 a[176:191], v[72:75], v[92:95], a[176:191]
buffer_load_dwordx4 v5, s[8:11], s43 offen offset:1024 lds
v_mfma_f32_32x32x16_bf16 a[192:207], v[76:79], v[80:83], a[192:207]
v_mfma_f32_32x32x16_bf16 a[208:223], v[76:79], v[84:87], a[208:223]
buffer_load_dwordx4 v6, s[8:11], s43 offen offset:2048 lds
v_mfma_f32_32x32x16_bf16 a[224:239], v[76:79], v[88:91], a[224:239]
buffer_load_dwordx4 v7, s[8:11], s43 offen offset:3072 lds
v_mfma_f32_32x32x16_bf16 a[240:255], v[76:79], v[92:95], a[240:255]
s_waitcnt lgkmcnt(0)
v_mfma_f32_32x32x16_bf16 a[0:15], v[32:35], v[48:51], a[0:15]
ds_read_b128 v[64:67], v15 offset:32768
ds_read_b128 v[68:71], v15 offset:34816
v_mfma_f32_32x32x16_bf16 a[16:31], v[32:35], v[52:55], a[16:31]
ds_read_b128 v[72:75], v15 offset:36864
v_mfma_f32_32x32x16_bf16 a[32:47], v[32:35], v[56:59], a[32:47]
ds_read_b128 v[76:79], v15 offset:38912
v_mfma_f32_32x32x16_bf16 a[48:63], v[32:35], v[60:63], a[48:63]
ds_read_b64_tr_b16 v[80:81], v20 offset:57344
v_mfma_f32_32x32x16_bf16 a[64:79], v[36:39], v[48:51], a[64:79]
ds_read_b64_tr_b16 v[82:83], v20 offset:59392
v_mfma_f32_32x32x16_bf16 a[80:95], v[36:39], v[52:55], a[80:95]
ds_read_b64_tr_b16 v[84:85], v21 offset:57344
ds_read_b64_tr_b16 v[86:87], v21 offset:59392
v_mfma_f32_32x32x16_bf16 a[96:111], v[36:39], v[56:59], a[96:111]
ds_read_b64_tr_b16 v[88:89], v22 offset:57344
v_mfma_f32_32x32x16_bf16 a[112:127], v[36:39], v[60:63], a[112:127]
ds_read_b64_tr_b16 v[90:91], v22 offset:59392
v_mfma_f32_32x32x16_bf16 a[128:143], v[40:43], v[48:51], a[128:143]
ds_read_b64_tr_b16 v[92:93], v23 offset:57344
v_mfma_f32_32x32x16_bf16 a[144:159], v[40:43], v[52:55], a[144:159]
ds_read_b64_tr_b16 v[94:95], v23 offset:59392
v_mfma_f32_32x32x16_bf16 a[160:175], v[40:43], v[56:59], a[160:175]
s_add_u32 m0, s42, 81920
s_nop 0
buffer_load_dwordx4 v8, s[16:19], s44 offen offset:0 lds
v_mfma_f32_32x32x16_bf16 a[176:191], v[40:43], v[60:63], a[176:191]
buffer_load_dwordx4 v9, s[16:19], s44 offen offset:1024 lds
v_mfma_f32_32x32x16_bf16 a[192:207], v[44:47], v[48:51], a[192:207]
buffer_load_dwordx4 v10, s[16:19], s44 offen offset:2048 lds
v_mfma_f32_32x32x16_bf16 a[208:223], v[44:47], v[52:55], a[208:223]
buffer_load_dwordx4 v11, s[16:19], s44 offen offset:3072 lds
v_mfma_f32_32x32x16_bf16 a[224:239], v[44:47], v[56:59], a[224:239]
s_add_u32 s43, s43, 64
s_add_u32 s44, s44, 262144
v_mfma_f32_32x32x16_bf16 a[240:255], v[44:47], v[60:63], a[240:255]
s_waitcnt lgkmcnt(0)
s_waitcnt vmcnt(16)
s_barrier
v_mfma_f32_32x32x16_bf16 a[0:15], v[64:67], v[80:83], a[0:15]
ds_read_b128 v[32:35], v12 offset:0
ds_read_b128 v[36:39], v12 offset:2048
v_mfma_f32_32x32x16_bf16 a[16:31], v[64:67], v[84:87], a[16:31]
ds_read_b128 v[40:43], v12 offset:4096
v_mfma_f32_32x32x16_bf16 a[32:47], v[64:67], v[88:91], a[32:47]
ds_read_b128 v[44:47], v12 offset:6144
v_mfma_f32_32x32x16_bf16 a[48:63], v[64:67], v[92:95], a[48:63]
ds_read_b64_tr_b16 v[48:49], v16 offset:16384
v_mfma_f32_32x32x16_bf16 a[64:79], v[68:71], v[80:83], a[64:79]
ds_read_b64_tr_b16 v[50:51], v16 offset:18432
v_mfma_f32_32x32x16_bf16 a[80:95], v[68:71], v[84:87], a[80:95]
ds_read_b64_tr_b16 v[52:53], v17 offset:16384
ds_read_b64_tr_b16 v[54:55], v17 offset:18432
v_mfma_f32_32x32x16_bf16 a[96:111], v[68:71], v[88:91], a[96:111]
ds_read_b64_tr_b16 v[56:57], v18 offset:16384
v_mfma_f32_32x32x16_bf16 a[112:127], v[68:71], v[92:95], a[112:127]
ds_read_b64_tr_b16 v[58:59], v18 offset:18432
v_mfma_f32_32x32x16_bf16 a[128:143], v[72:75], v[80:83], a[128:143]
ds_read_b64_tr_b16 v[60:61], v19 offset:16384
v_mfma_f32_32x32x16_bf16 a[144:159], v[72:75], v[84:87], a[144:159]
ds_read_b64_tr_b16 v[62:63], v19 offset:18432
v_mfma_f32_32x32x16_bf16 a[160:175], v[72:75], v[88:91], a[160:175]
s_add_u32 m0, s42, 98304
s_nop 0
buffer_load_dwordx4 v4, s[8:11], s43 offen offset:0 lds
v_mfma_f32_32x32x16_bf16 a[176:191], v[72:75], v[92:95], a[176:191]
buffer_load_dwordx4 v5, s[8:11], s43 offen offset:1024 lds
v_mfma_f32_32x32x16_bf16 a[192:207], v[76:79], v[80:83], a[192:207]
v_mfma_f32_32x32x16_bf16 a[208:223], v[76:79], v[84:87], a[208:223]
buffer_load_dwordx4 v6, s[8:11], s43 offen offset:2048 lds
v_mfma_f32_32x32x16_bf16 a[224:239], v[76:79], v[88:91], a[224:239]
buffer_load_dwordx4 v7, s[8:11], s43 offen offset:3072 lds
v_mfma_f32_32x32x16_bf16 a[240:255], v[76:79], v[92:95], a[240:255]
s_sub_u32 s4, s4, 1
s_cmp_lg_u32 s4, 0
s_cbranch_scc1 gl_10
s_waitcnt lgkmcnt(0)
v_mfma_f32_32x32x16_bf16 a[0:15], v[32:35], v[48:51], a[0:15]
ds_read_b128 v[64:67], v13 offset:0
ds_read_b128 v[68:71], v13 offset:2048
v_mfma_f32_32x32x16_bf16 a[16:31], v[32:35], v[52:55], a[16:31]
ds_read_b128 v[72:75], v13 offset:4096
v_mfma_f32_32x32x16_bf16 a[32:47], v[32:35], v[56:59], a[32:47]
ds_read_b128 v[76:79], v13 offset:6144
v_mfma_f32_32x32x16_bf16 a[48:63], v[32:35], v[60:63], a[48:63]
ds_read_b64_tr_b16 v[80:81], v16 offset:24576
v_mfma_f32_32x32x16_bf16 a[64:79], v[36:39], v[48:51], a[64:79]
ds_read_b64_tr_b16 v[82:83], v16 offset:26624
v_mfma_f32_32x32x16_bf16 a[80:95], v[36:39], v[52:55], a[80:95]
ds_read_b64_tr_b16 v[84:85], v17 offset:24576
ds_read_b64_tr_b16 v[86:87], v17 offset:26624
v_mfma_f32_32x32x16_bf16 a[96:111], v[36:39], v[56:59], a[96:111]
ds_read_b64_tr_b16 v[88:89], v18 offset:24576
v_mfma_f32_32x32x16_bf16 a[112:127], v[36:39], v[60:63], a[112:127]
ds_read_b64_tr_b16 v[90:91], v18 offset:26624
v_mfma_f32_32x32x16_bf16 a[128:143], v[40:43], v[48:51], a[128:143]
ds_read_b64_tr_b16 v[92:93], v19 offset:24576
v_mfma_f32_32x32x16_bf16 a[144:159], v[40:43], v[52:55], a[144:159]
ds_read_b64_tr_b16 v[94:95], v19 offset:26624
v_mfma_f32_32x32x16_bf16 a[160:175], v[40:43], v[56:59], a[160:175]
s_add_u32 m0, s42, 114688
s_nop 0
buffer_load_dwordx4 v8, s[16:19], s44 offen offset:0 lds
v_mfma_f32_32x32x16_bf16 a[176:191], v[40:43], v[60:63], a[176:191]
buffer_load_dwordx4 v9, s[16:19], s44 offen offset:1024 lds
v_mfma_f32_32x32x16_bf16 a[192:207], v[44:47], v[48:51], a[192:207]
buffer_load_dwordx4 v10, s[16:19], s44 offen offset:2048 lds
v_mfma_f32_32x32x16_bf16 a[208:223], v[44:47], v[52:55], a[208:223]
buffer_load_dwordx4 v11, s[16:19], s44 offen offset:3072 lds
v_mfma_f32_32x32x16_bf16 a[224:239], v[44:47], v[56:59], a[224:239]
s_add_u32 s43, s43, 64
s_add_u32 s44, s44, 262144
v_mfma_f32_32x32x16_bf16 a[240:255], v[44:47], v[60:63], a[240:255]
s_waitcnt lgkmcnt(0)
s_waitcnt vmcnt(16)
s_barrier
v_mfma_f32_32x32x16_bf16 a[0:15], v[64:67], v[80:83], a[0:15]
ds_read_b128 v[32:35], v12 offset:32768
v_mfma_f32_32x32x16_bf16 a[16:31], v[64:67], v[84:87], a[16:31]
ds_read_b128 v[36:39], v12 offset:34816
v_mfma_f32_32x32x16_bf16 a[32:47], v[64:67], v[88:91], a[32:47]
ds_read_b128 v[40:43], v12 offset:36864
v_mfma_f32_32x32x16_bf16 a[48:63], v[64:67], v[92:95], a[48:63]
ds_read_b128 v[44:47], v12 offset:38912
v_mfma_f32_32x32x16_bf16 a[64:79], v[68:71], v[80:83], a[64:79]
ds_read_b64_tr_b16 v[48:49], v16 offset:49152
v_mfma_f32_32x32x16_bf16 a[80:95], v[68:71], v[84:87], a[80:95]
ds_read_b64_tr_b16 v[50:51], v16 offset:51200
v_mfma_f32_32x32x16_bf16 a[96:111], v[68:71], v[88:91], a[96:111]
ds_read_b64_tr_b16 v[52:53], v17 offset:49152
v_mfma_f32_32x32x16_bf16 a[112:127], v[68:71], v[92:95], a[112:127]
ds_read_b64_tr_b16 v[54:55], v17 offset:51200
v_mfma_f32_32x32x16_bf16 a[128:143], v[72:75], v[80:83], a[128:143]
ds_read_b64_tr_b16 v[56:57], v18 offset:49152
v_mfma_f32_32x32x16_bf16 a[144:159], v[72:75], v[84:87], a[144:159]
ds_read_b64_tr_b16 v[58:59], v18 offset:51200
v_mfma_f32_32x32x16_bf16 a[160:175], v[72:75], v[88:91], a[160:175]
ds_read_b64_tr_b16 v[60:61], v19 offset:49152
v_mfma_f32_32x32x16_bf16 a[176:191], v[72:75], v[92:95], a[176:191]
ds_read_b64_tr_b16 v[62:63], v19 offset:51200
v_mfma_f32_32x32x16_bf16 a[192:207], v[76:79], v[80:83], a[192:207]
v_mfma_f32_32x32x16_bf16 a[208:223], v[76:79], v[84:87], a[208:223]
v_mfma_f32_32x32x16_bf16 a[224:239], v[76:79], v[88:91], a[224:239]
v_mfma_f32_32x32x16_bf16 a[240:255], v[76:79], v[92:95], a[240:255]
s_waitcnt lgkmcnt(0)
v_mfma_f32_32x32x16_bf16 a[0:15], v[32:35], v[48:51], a[0:15]
ds_read_b128 v[64:67], v13 offset:32768
v_mfma_f32_32x32x16_bf16 a[16:31], v[32:35], v[52:55], a[16:31]
ds_read_b128 v[68:71], v13 offset:34816
v_mfma_f32_32x32x16_bf16 a[32:47], v[32:35], v[56:59], a[32:47]
ds_read_b128 v[72:75], v13 offset:36864
v_mfma_f32_32x32x16_bf16 a[48:63], v[32:35], v[60:63], a[48:63]
ds_read_b128 v[76:79], v13 offset:38912
v_mfma_f32_32x32x16_bf16 a[64:79], v[36:39], v[48:51], a[64:79]
ds_read_b64_tr_b16 v[80:81], v16 offset:57344
v_mfma_f32_32x32x16_bf16 a[80:95], v[36:39], v[52:55], a[80:95]
ds_read_b64_tr_b16 v[82:83], v16 offset:59392
v_mfma_f32_32x32x16_bf16 a[96:111], v[36:39], v[56:59], a[96:111]
ds_read_b64_tr_b16 v[84:85], v17 offset:57344
v_mfma_f32_32x32x16_bf16 a[112:127], v[36:39], v[60:63], a[112:127]
ds_read_b64_tr_b16 v[86:87], v17 offset:59392
v_mfma_f32_32x32x16_bf16 a[128:143], v[40:43], v[48:51], a[128:143]
ds_read_b64_tr_b16 v[88:89], v18 offset:57344
v_mfma_f32_32x32x16_bf16 a[144:159], v[40:43], v[52:55], a[144:159]
ds_read_b64_tr_b16 v[90:91], v18 offset:59392
v_mfma_f32_32x32x16_bf16 a[160:175], v[40:43], v[56:59], a[160:175]
ds_read_b64_tr_b16 v[92:93], v19 offset:57344
v_mfma_f32_32x32x16_bf16 a[176:191], v[40:43], v[60:63], a[176:191]
ds_read_b64_tr_b16 v[94:95], v19 offset:59392
v_mfma_f32_32x32x16_bf16 a[192:207], v[44:47], v[48:51], a[192:207]
v_mfma_f32_32x32x16_bf16 a[208:223], v[44:47], v[52:55], a[208:223]
v_mfma_f32_32x32x16_bf16 a[224:239], v[44:47], v[56:59], a[224:239]
v_mfma_f32_32x32x16_bf16 a[240:255], v[44:47], v[60:63], a[240:255]
s_waitcnt lgkmcnt(0)
s_waitcnt vmcnt(8)
s_barrier
v_mfma_f32_32x32x16_bf16 a[0:15], v[64:67], v[80:83], a[0:15]
ds_read_b128 v[32:35], v14 offset:0
v_mfma_f32_32x32x16_bf16 a[16:31], v[64:67], v[84:87], a[16:31]
ds_read_b128 v[36:39], v14 offset:2048
v_mfma_f32_32x32x16_bf16 a[32:47], v[64:67], v[88:91], a[32:47]
ds_read_b128 v[40:43], v14 offset:4096
v_mfma_f32_32x32x16_bf16 a[48:63], v[64:67], v[92:95], a[48:63]
ds_read_b128 v[44:47], v14 offset:6144
v_mfma_f32_32x32x16_bf16 a[64:79], v[68:71], v[80:83], a[64:79]
ds_read_b64_tr_b16 v[48:49], v20 offset:16384
v_mfma_f32_32x32x16_bf16 a[80:95], v[68:71], v[84:87], a[80:95]
ds_read_b64_tr_b16 v[50:51], v20 offset:18432
v_mfma_f32_32x32x16_bf16 a[96:111], v[68:71], v[88:91], a[96:111]
ds_read_b64_tr_b16 v[52:53], v21 offset:16384
v_mfma_f32_32x32x16_bf16 a[112:127], v[68:71], v[92:95], a[112:127]
ds_read_b64_tr_b16 v[54:55], v21 offset:18432
v_mfma_f32_32x32x16_bf16 a[128:143], v[72:75], v[80:83], a[128:143]
ds_read_b64_tr_b16 v[56:57], v22 offset:16384
v_mfma_f32_32x32x16_bf16 a[144:159], v[72:75], v[84:87], a[144:159]
ds_read_b64_tr_b16 v[58:59], v22 offset:18432
v_mfma_f32_32x32x16_bf16 a[160:175], v[72:75], v[88:91], a[160:175]
ds_read_b64_tr_b16 v[60:61], v23 offset:16384
v_mfma_f32_32x32x16_bf16 a[176:191], v[72:75], v[92:95], a[176:191]
ds_read_b64_tr_b16 v[62:63], v23 offset:18432
v_mfma_f32_32x32x16_bf16 a[192:207], v[76:79], v[80:83], a[192:207]
v_mfma_f32_32x32x16_bf16 a[208:223], v[76:79], v[84:87], a[208:223]
v_mfma_f32_32x32x16_bf16 a[224:239], v[76:79], v[88:91], a[224:239]
v_mfma_f32_32x32x16_bf16 a[240:255], v[76:79], v[92:95], a[240:255]
s_waitcnt lgkmcnt(0)
v_mfma_f32_32x32x16_bf16 a[0:15], v[32:35], v[48:51], a[0:15]
ds_read_b128 v[64:67], v15 offset:0
v_mfma_f32_32x32x16_bf16 a[16:31], v[32:35], v[52:55], a[16:31]
ds_read_b128 v[68:71], v15 offset:2048
v_mfma_f32_32x32x16_bf16 a[32:47], v[32:35], v[56:59], a[32:47]
ds_read_b128 v[72:75], v15 offset:4096
v_mfma_f32_32x32x16_bf16 a[48:63], v[32:35], v[60:63], a[48:63]
ds_read_b128 v[76:79], v15 offset:6144
v_mfma_f32_32x32x16_bf16 a[64:79], v[36:39], v[48:51], a[64:79]
ds_read_b64_tr_b16 v[80:81], v20 offset:24576
v_mfma_f32_32x32x16_bf16 a[80:95], v[36:39], v[52:55], a[80:95]
ds_read_b64_tr_b16 v[82:83], v20 offset:26624
v_mfma_f32_32x32x16_bf16 a[96:111], v[36:39], v[56:59], a[96:111]
ds_read_b64_tr_b16 v[84:85], v21 offset:24576
v_mfma_f32_32x32x16_bf16 a[112:127], v[36:39], v[60:63], a[112:127]
ds_read_b64_tr_b16 v[86:87], v21 offset:26624
v_mfma_f32_32x32x16_bf16 a[128:143], v[40:43], v[48:51], a[128:143]
ds_read_b64_tr_b16 v[88:89], v22 offset:24576
v_mfma_f32_32x32x16_bf16 a[144:159], v[40:43], v[52:55], a[144:159]
ds_read_b64_tr_b16 v[90:91], v22 offset:26624
v_mfma_f32_32x32x16_bf16 a[160:175], v[40:43], v[56:59], a[160:175]
ds_read_b64_tr_b16 v[92:93], v23 offset:24576
v_mfma_f32_32x32x16_bf16 a[176:191], v[40:43], v[60:63], a[176:191]
ds_read_b64_tr_b16 v[94:95], v23 offset:26624
v_mfma_f32_32x32x16_bf16 a[192:207], v[44:47], v[48:51], a[192:207]
v_mfma_f32_32x32x16_bf16 a[208:223], v[44:47], v[52:55], a[208:223]
v_mfma_f32_32x32x16_bf16 a[224:239], v[44:47], v[56:59], a[224:239]
v_mfma_f32_32x32x16_bf16 a[240:255], v[44:47], v[60:63], a[240:255]
s_waitcnt lgkmcnt(0)
s_waitcnt vmcnt(0)
s_barrier
v_mfma_f32_32x32x16_bf16 a[0:15], v[64:67], v[80:83], a[0:15]
ds_read_b128 v[32:35], v14 offset:32768
v_mfma_f32_32x32x16_bf16 a[16:31], v[64:67], v[84:87], a[16:31]
ds_read_b128 v[36:39], v14 offset:34816
v_mfma_f32_32x32x16_bf16 a[32:47], v[64:67], v[88:91], a[32:47]
ds_read_b128 v[40:43], v14 offset:36864
v_mfma_f32_32x32x16_bf16 a[48:63], v[64:67], v[92:95], a[48:63]
ds_read_b128 v[44:47], v14 offset:38912
v_mfma_f32_32x32x16_bf16 a[64:79], v[68:71], v[80:83], a[64:79]
ds_read_b64_tr_b16 v[48:49], v20 offset:49152
v_mfma_f32_32x32x16_bf16 a[80:95], v[68:71], v[84:87], a[80:95]
ds_read_b64_tr_b16 v[50:51], v20 offset:51200
v_mfma_f32_32x32x16_bf16 a[96:111], v[68:71], v[88:91], a[96:111]
ds_read_b64_tr_b16 v[52:53], v21 offset:49152
v_mfma_f32_32x32x16_bf16 a[112:127], v[68:71], v[92:95], a[112:127]
ds_read_b64_tr_b16 v[54:55], v21 offset:51200
v_mfma_f32_32x32x16_bf16 a[128:143], v[72:75], v[80:83], a[128:143]
ds_read_b64_tr_b16 v[56:57], v22 offset:49152
v_mfma_f32_32x32x16_bf16 a[144:159], v[72:75], v[84:87], a[144:159]
ds_read_b64_tr_b16 v[58:59], v22 offset:51200
v_mfma_f32_32x32x16_bf16 a[160:175], v[72:75], v[88:91], a[160:175]
ds_read_b64_tr_b16 v[60:61], v23 offset:49152
v_mfma_f32_32x32x16_bf16 a[176:191], v[72:75], v[92:95], a[176:191]
ds_read_b64_tr_b16 v[62:63], v23 offset:51200
v_mfma_f32_32x32x16_bf16 a[192:207], v[76:79], v[80:83], a[192:207]
v_mfma_f32_32x32x16_bf16 a[208:223], v[76:79], v[84:87], a[208:223]
v_mfma_f32_32x32x16_bf16 a[224:239], v[76:79], v[88:91], a[224:239]
v_mfma_f32_32x32x16_bf16 a[240:255], v[76:79], v[92:95], a[240:255]
s_waitcnt lgkmcnt(0)
v_mfma_f32_32x32x16_bf16 a[0:15], v[32:35], v[48:51], a[0:15]
ds_read_b128 v[64:67], v15 offset:32768
v_mfma_f32_32x32x16_bf16 a[16:31], v[32:35], v[52:55], a[16:31]
ds_read_b128 v[68:71], v15 offset:34816
v_mfma_f32_32x32x16_bf16 a[32:47], v[32:35], v[56:59], a[32:47]
ds_read_b128 v[72:75], v15 offset:36864
v_mfma_f32_32x32x16_bf16 a[48:63], v[32:35], v[60:63], a[48:63]
ds_read_b128 v[76:79], v15 offset:38912
v_mfma_f32_32x32x16_bf16 a[64:79], v[36:39], v[48:51], a[64:79]
ds_read_b64_tr_b16 v[80:81], v20 offset:57344
v_mfma_f32_32x32x16_bf16 a[80:95], v[36:39], v[52:55], a[80:95]
ds_read_b64_tr_b16 v[82:83], v20 offset:59392
v_mfma_f32_32x32x16_bf16 a[96:111], v[36:39], v[56:59], a[96:111]
ds_read_b64_tr_b16 v[84:85], v21 offset:57344
v_mfma_f32_32x32x16_bf16 a[112:127], v[36:39], v[60:63], a[112:127]
ds_read_b64_tr_b16 v[86:87], v21 offset:59392
v_mfma_f32_32x32x16_bf16 a[128:143], v[40:43], v[48:51], a[128:143]
ds_read_b64_tr_b16 v[88:89], v22 offset:57344
v_mfma_f32_32x32x16_bf16 a[144:159], v[40:43], v[52:55], a[144:159]
ds_read_b64_tr_b16 v[90:91], v22 offset:59392
v_mfma_f32_32x32x16_bf16 a[160:175], v[40:43], v[56:59], a[160:175]
ds_read_b64_tr_b16 v[92:93], v23 offset:57344
v_mfma_f32_32x32x16_bf16 a[176:191], v[40:43], v[60:63], a[176:191]
ds_read_b64_tr_b16 v[94:95], v23 offset:59392
v_mfma_f32_32x32x16_bf16 a[192:207], v[44:47], v[48:51], a[192:207]
v_mfma_f32_32x32x16_bf16 a[208:223], v[44:47], v[52:55], a[208:223]
v_mfma_f32_32x32x16_bf16 a[224:239], v[44:47], v[56:59], a[224:239]
v_mfma_f32_32x32x16_bf16 a[240:255], v[44:47], v[60:63], a[240:255]
s_waitcnt lgkmcnt(0)
v_mfma_f32_32x32x16_bf16 a[0:15], v[64:67], v[80:83], a[0:15]
v_mfma_f32_32x32x16_bf16 a[16:31], v[64:67], v[84:87], a[16:31]
v_mfma_f32_32x32x16_bf16 a[32:47], v[64:67], v[88:91], a[32:47]
v_mfma_f32_32x32x16_bf16 a[48:63], v[64:67], v[92:95], a[48:63]
v_mfma_f32_32x32x16_bf16 a[64:79], v[68:71], v[80:83], a[64:79]
v_mfma_f32_32x32x16_bf16 a[80:95], v[68:71], v[84:87], a[80:95]
v_mfma_f32_32x32x16_bf16 a[96:111], v[68:71], v[88:91], a[96:111]
v_mfma_f32_32x32x16_bf16 a[112:127], v[68:71], v[92:95], a[112:127]
v_mfma_f32_32x32x16_bf16 a[128:143], v[72:75], v[80:83], a[128:143]
v_mfma_f32_32x32x16_bf16 a[144:159], v[72:75], v[84:87], a[144:159]
v_mfma_f32_32x32x16_bf16 a[160:175], v[72:75], v[88:91], a[160:175]
v_mfma_f32_32x32x16_bf16 a[176:191], v[72:75], v[92:95], a[176:191]
v_mfma_f32_32x32x16_bf16 a[192:207], v[76:79], v[80:83], a[192:207]
v_mfma_f32_32x32x16_bf16 a[208:223], v[76:79], v[84:87], a[208:223]
v_mfma_f32_32x32x16_bf16 a[224:239], v[76:79], v[88:91], a[224:239]
v_mfma_f32_32x32x16_bf16 a[240:255], v[76:79], v[92:95], a[240:255]
s_nop 7
s_nop 7
v_lshlrev_b32 v1, 4, v0
s_lshl_b32 s5, s37, 1
s_add_u32 s5, s5, s40
s_lshl_b32 s5, s5, 19
s_lshl_b32 s6, s36, 1
s_add_u32 s6, s6, s39
s_lshl_b32 s6, s6, 15
s_add_u32 s5, s5, s6
v_accvgpr_read_b32 v8, a0
v_accvgpr_read_b32 v9, a1
v_accvgpr_read_b32 v10, a2
v_accvgpr_read_b32 v11, a3
v_accvgpr_read_b32 v12, a4
v_accvgpr_read_b32 v13, a5
v_accvgpr_read_b32 v14, a6
v_accvgpr_read_b32 v15, a7
v_cvt_pk_bf16_f32 v16, v8, v9
v_cvt_pk_bf16_f32 v17, v10, v11
v_cvt_pk_bf16_f32 v18, v12, v13
v_cvt_pk_bf16_f32 v19, v14, v15
buffer_store_dwordx4 v[16:19], v1, s[24:27], s5 offen offset:0 sc0 sc1
v_accvgpr_read_b32 v20, a16
v_accvgpr_read_b32 v21, a17
v_accvgpr_read_b32 v22, a18
v_accvgpr_read_b32 v23, a19
v_accvgpr_read_b32 v24, a20
v_accvgpr_read_b32 v25, a21
v_accvgpr_read_b32 v26, a22
v_accvgpr_read_b32 v27, a23
v_cvt_pk_bf16_f32 v28, v20, v21
v_cvt_pk_bf16_f32 v29, v22, v23
v_cvt_pk_bf16_f32 v30, v24, v25
v_cvt_pk_bf16_f32 v31, v26, v27
buffer_store_dwordx4 v[28:31], v1, s[24:27], s5 offen offset:1024 sc0 sc1
v_accvgpr_read_b32 v32, a32
v_accvgpr_read_b32 v33, a33
v_accvgpr_read_b32 v34, a34
v_accvgpr_read_b32 v35, a35
v_accvgpr_read_b32 v36, a36
v_accvgpr_read_b32 v37, a37
v_accvgpr_read_b32 v38, a38
v_accvgpr_read_b32 v39, a39
v_cvt_pk_bf16_f32 v40, v32, v33
v_cvt_pk_bf16_f32 v41, v34, v35
v_cvt_pk_bf16_f32 v42, v36, v37
v_cvt_pk_bf16_f32 v43, v38, v39
buffer_store_dwordx4 v[40:43], v1, s[24:27], s5 offen offset:2048 sc0 sc1
v_accvgpr_read_b32 v44, a48
v_accvgpr_read_b32 v45, a49
v_accvgpr_read_b32 v46, a50
v_accvgpr_read_b32 v47, a51
v_accvgpr_read_b32 v48, a52
v_accvgpr_read_b32 v49, a53
v_accvgpr_read_b32 v50, a54
v_accvgpr_read_b32 v51, a55
v_cvt_pk_bf16_f32 v52, v44, v45
v_cvt_pk_bf16_f32 v53, v46, v47
v_cvt_pk_bf16_f32 v54, v48, v49
v_cvt_pk_bf16_f32 v55, v50, v51
buffer_store_dwordx4 v[52:55], v1, s[24:27], s5 offen offset:3072 sc0 sc1
s_add_u32 s5, s5, 4096
v_accvgpr_read_b32 v56, a8
v_accvgpr_read_b32 v57, a9
v_accvgpr_read_b32 v58, a10
v_accvgpr_read_b32 v59, a11
v_accvgpr_read_b32 v60, a12
v_accvgpr_read_b32 v61, a13
v_accvgpr_read_b32 v62, a14
v_accvgpr_read_b32 v63, a15
v_cvt_pk_bf16_f32 v64, v56, v57
v_cvt_pk_bf16_f32 v65, v58, v59
v_cvt_pk_bf16_f32 v66, v60, v61
v_cvt_pk_bf16_f32 v67, v62, v63
buffer_store_dwordx4 v[64:67], v1, s[24:27], s5 offen offset:0 sc0 sc1
v_accvgpr_read_b32 v68, a24
v_accvgpr_read_b32 v69, a25
v_accvgpr_read_b32 v70, a26
v_accvgpr_read_b32 v71, a27
v_accvgpr_read_b32 v72, a28
v_accvgpr_read_b32 v73, a29
v_accvgpr_read_b32 v74, a30
v_accvgpr_read_b32 v75, a31
v_cvt_pk_bf16_f32 v76, v68, v69
v_cvt_pk_bf16_f32 v77, v70, v71
v_cvt_pk_bf16_f32 v78, v72, v73
v_cvt_pk_bf16_f32 v79, v74, v75
buffer_store_dwordx4 v[76:79], v1, s[24:27], s5 offen offset:1024 sc0 sc1
v_accvgpr_read_b32 v80, a40
v_accvgpr_read_b32 v81, a41
v_accvgpr_read_b32 v82, a42
v_accvgpr_read_b32 v83, a43
v_accvgpr_read_b32 v84, a44
v_accvgpr_read_b32 v85, a45
v_accvgpr_read_b32 v86, a46
v_accvgpr_read_b32 v87, a47
v_cvt_pk_bf16_f32 v88, v80, v81
v_cvt_pk_bf16_f32 v89, v82, v83
v_cvt_pk_bf16_f32 v90, v84, v85
v_cvt_pk_bf16_f32 v91, v86, v87
buffer_store_dwordx4 v[88:91], v1, s[24:27], s5 offen offset:2048 sc0 sc1
v_accvgpr_read_b32 v92, a56
v_accvgpr_read_b32 v93, a57
v_accvgpr_read_b32 v94, a58
v_accvgpr_read_b32 v95, a59
v_accvgpr_read_b32 v96, a60
v_accvgpr_read_b32 v97, a61
v_accvgpr_read_b32 v98, a62
v_accvgpr_read_b32 v99, a63
v_cvt_pk_bf16_f32 v100, v92, v93
v_cvt_pk_bf16_f32 v101, v94, v95
v_cvt_pk_bf16_f32 v102, v96, v97
v_cvt_pk_bf16_f32 v103, v98, v99
buffer_store_dwordx4 v[100:103], v1, s[24:27], s5 offen offset:3072 sc0 sc1
s_add_u32 s5, s5, 4096
v_accvgpr_read_b32 v8, a64
v_accvgpr_read_b32 v9, a65
v_accvgpr_read_b32 v10, a66
v_accvgpr_read_b32 v11, a67
v_accvgpr_read_b32 v12, a68
v_accvgpr_read_b32 v13, a69
v_accvgpr_read_b32 v14, a70
v_accvgpr_read_b32 v15, a71
v_cvt_pk_bf16_f32 v16, v8, v9
v_cvt_pk_bf16_f32 v17, v10, v11
v_cvt_pk_bf16_f32 v18, v12, v13
v_cvt_pk_bf16_f32 v19, v14, v15
buffer_store_dwordx4 v[16:19], v1, s[24:27], s5 offen offset:0 sc0 sc1
v_accvgpr_read_b32 v20, a80
v_accvgpr_read_b32 v21, a81
v_accvgpr_read_b32 v22, a82
v_accvgpr_read_b32 v23, a83
v_accvgpr_read_b32 v24, a84
v_accvgpr_read_b32 v25, a85
v_accvgpr_read_b32 v26, a86
v_accvgpr_read_b32 v27, a87
v_cvt_pk_bf16_f32 v28, v20, v21
v_cvt_pk_bf16_f32 v29, v22, v23
v_cvt_pk_bf16_f32 v30, v24, v25
v_cvt_pk_bf16_f32 v31, v26, v27
buffer_store_dwordx4 v[28:31], v1, s[24:27], s5 offen offset:1024 sc0 sc1
v_accvgpr_read_b32 v32, a96
v_accvgpr_read_b32 v33, a97
v_accvgpr_read_b32 v34, a98
v_accvgpr_read_b32 v35, a99
v_accvgpr_read_b32 v36, a100
v_accvgpr_read_b32 v37, a101
v_accvgpr_read_b32 v38, a102
v_accvgpr_read_b32 v39, a103
v_cvt_pk_bf16_f32 v40, v32, v33
v_cvt_pk_bf16_f32 v41, v34, v35
v_cvt_pk_bf16_f32 v42, v36, v37
v_cvt_pk_bf16_f32 v43, v38, v39
buffer_store_dwordx4 v[40:43], v1, s[24:27], s5 offen offset:2048 sc0 sc1
v_accvgpr_read_b32 v44, a112
v_accvgpr_read_b32 v45, a113
v_accvgpr_read_b32 v46, a114
v_accvgpr_read_b32 v47, a115
v_accvgpr_read_b32 v48, a116
v_accvgpr_read_b32 v49, a117
v_accvgpr_read_b32 v50, a118
v_accvgpr_read_b32 v51, a119
v_cvt_pk_bf16_f32 v52, v44, v45
v_cvt_pk_bf16_f32 v53, v46, v47
v_cvt_pk_bf16_f32 v54, v48, v49
v_cvt_pk_bf16_f32 v55, v50, v51
buffer_store_dwordx4 v[52:55], v1, s[24:27], s5 offen offset:3072 sc0 sc1
s_add_u32 s5, s5, 4096
v_accvgpr_read_b32 v56, a72
v_accvgpr_read_b32 v57, a73
v_accvgpr_read_b32 v58, a74
v_accvgpr_read_b32 v59, a75
v_accvgpr_read_b32 v60, a76
v_accvgpr_read_b32 v61, a77
v_accvgpr_read_b32 v62, a78
v_accvgpr_read_b32 v63, a79
v_cvt_pk_bf16_f32 v64, v56, v57
v_cvt_pk_bf16_f32 v65, v58, v59
v_cvt_pk_bf16_f32 v66, v60, v61
v_cvt_pk_bf16_f32 v67, v62, v63
buffer_store_dwordx4 v[64:67], v1, s[24:27], s5 offen offset:0 sc0 sc1
v_accvgpr_read_b32 v68, a88
v_accvgpr_read_b32 v69, a89
v_accvgpr_read_b32 v70, a90
v_accvgpr_read_b32 v71, a91
v_accvgpr_read_b32 v72, a92
v_accvgpr_read_b32 v73, a93
v_accvgpr_read_b32 v74, a94
v_accvgpr_read_b32 v75, a95
v_cvt_pk_bf16_f32 v76, v68, v69
v_cvt_pk_bf16_f32 v77, v70, v71
v_cvt_pk_bf16_f32 v78, v72, v73
v_cvt_pk_bf16_f32 v79, v74, v75
buffer_store_dwordx4 v[76:79], v1, s[24:27], s5 offen offset:1024 sc0 sc1
v_accvgpr_read_b32 v80, a104
v_accvgpr_read_b32 v81, a105
v_accvgpr_read_b32 v82, a106
v_accvgpr_read_b32 v83, a107
v_accvgpr_read_b32 v84, a108
v_accvgpr_read_b32 v85, a109
v_accvgpr_read_b32 v86, a110
v_accvgpr_read_b32 v87, a111
v_cvt_pk_bf16_f32 v88, v80, v81
v_cvt_pk_bf16_f32 v89, v82, v83
v_cvt_pk_bf16_f32 v90, v84, v85
v_cvt_pk_bf16_f32 v91, v86, v87
buffer_store_dwordx4 v[88:91], v1, s[24:27], s5 offen offset:2048 sc0 sc1
v_accvgpr_read_b32 v92, a120
v_accvgpr_read_b32 v93, a121
v_accvgpr_read_b32 v94, a122
v_accvgpr_read_b32 v95, a123
v_accvgpr_read_b32 v96, a124
v_accvgpr_read_b32 v97, a125
v_accvgpr_read_b32 v98, a126
v_accvgpr_read_b32 v99, a127
v_cvt_pk_bf16_f32 v100, v92, v93
v_cvt_pk_bf16_f32 v101, v94, v95
v_cvt_pk_bf16_f32 v102, v96, v97
v_cvt_pk_bf16_f32 v103, v98, v99
buffer_store_dwordx4 v[100:103], v1, s[24:27], s5 offen offset:3072 sc0 sc1
s_add_u32 s5, s5, 4096
v_accvgpr_read_b32 v8, a128
v_accvgpr_read_b32 v9, a129
v_accvgpr_read_b32 v10, a130
v_accvgpr_read_b32 v11, a131
v_accvgpr_read_b32 v12, a132
v_accvgpr_read_b32 v13, a133
v_accvgpr_read_b32 v14, a134
v_accvgpr_read_b32 v15, a135
v_cvt_pk_bf16_f32 v16, v8, v9
v_cvt_pk_bf16_f32 v17, v10, v11
v_cvt_pk_bf16_f32 v18, v12, v13
v_cvt_pk_bf16_f32 v19, v14, v15
buffer_store_dwordx4 v[16:19], v1, s[24:27], s5 offen offset:0 sc0 sc1
v_accvgpr_read_b32 v20, a144
v_accvgpr_read_b32 v21, a145
v_accvgpr_read_b32 v22, a146
v_accvgpr_read_b32 v23, a147
v_accvgpr_read_b32 v24, a148
v_accvgpr_read_b32 v25, a149
v_accvgpr_read_b32 v26, a150
v_accvgpr_read_b32 v27, a151
v_cvt_pk_bf16_f32 v28, v20, v21
v_cvt_pk_bf16_f32 v29, v22, v23
v_cvt_pk_bf16_f32 v30, v24, v25
v_cvt_pk_bf16_f32 v31, v26, v27
buffer_store_dwordx4 v[28:31], v1, s[24:27], s5 offen offset:1024 sc0 sc1
v_accvgpr_read_b32 v32, a160
v_accvgpr_read_b32 v33, a161
v_accvgpr_read_b32 v34, a162
v_accvgpr_read_b32 v35, a163
v_accvgpr_read_b32 v36, a164
v_accvgpr_read_b32 v37, a165
v_accvgpr_read_b32 v38, a166
v_accvgpr_read_b32 v39, a167
v_cvt_pk_bf16_f32 v40, v32, v33
v_cvt_pk_bf16_f32 v41, v34, v35
v_cvt_pk_bf16_f32 v42, v36, v37
v_cvt_pk_bf16_f32 v43, v38, v39
buffer_store_dwordx4 v[40:43], v1, s[24:27], s5 offen offset:2048 sc0 sc1
v_accvgpr_read_b32 v44, a176
v_accvgpr_read_b32 v45, a177
v_accvgpr_read_b32 v46, a178
v_accvgpr_read_b32 v47, a179
v_accvgpr_read_b32 v48, a180
v_accvgpr_read_b32 v49, a181
v_accvgpr_read_b32 v50, a182
v_accvgpr_read_b32 v51, a183
v_cvt_pk_bf16_f32 v52, v44, v45
v_cvt_pk_bf16_f32 v53, v46, v47
v_cvt_pk_bf16_f32 v54, v48, v49
v_cvt_pk_bf16_f32 v55, v50, v51
buffer_store_dwordx4 v[52:55], v1, s[24:27], s5 offen offset:3072 sc0 sc1
s_add_u32 s5, s5, 4096
v_accvgpr_read_b32 v56, a136
v_accvgpr_read_b32 v57, a137
v_accvgpr_read_b32 v58, a138
v_accvgpr_read_b32 v59, a139
v_accvgpr_read_b32 v60, a140
v_accvgpr_read_b32 v61, a141
v_accvgpr_read_b32 v62, a142
v_accvgpr_read_b32 v63, a143
v_cvt_pk_bf16_f32 v64, v56, v57
v_cvt_pk_bf16_f32 v65, v58, v59
v_cvt_pk_bf16_f32 v66, v60, v61
v_cvt_pk_bf16_f32 v67, v62, v63
buffer_store_dwordx4 v[64:67], v1, s[24:27], s5 offen offset:0 sc0 sc1
v_accvgpr_read_b32 v68, a152
v_accvgpr_read_b32 v69, a153
v_accvgpr_read_b32 v70, a154
v_accvgpr_read_b32 v71, a155
v_accvgpr_read_b32 v72, a156
v_accvgpr_read_b32 v73, a157
v_accvgpr_read_b32 v74, a158
v_accvgpr_read_b32 v75, a159
v_cvt_pk_bf16_f32 v76, v68, v69
v_cvt_pk_bf16_f32 v77, v70, v71
v_cvt_pk_bf16_f32 v78, v72, v73
v_cvt_pk_bf16_f32 v79, v74, v75
buffer_store_dwordx4 v[76:79], v1, s[24:27], s5 offen offset:1024 sc0 sc1
v_accvgpr_read_b32 v80, a168
v_accvgpr_read_b32 v81, a169
v_accvgpr_read_b32 v82, a170
v_accvgpr_read_b32 v83, a171
v_accvgpr_read_b32 v84, a172
v_accvgpr_read_b32 v85, a173
v_accvgpr_read_b32 v86, a174
v_accvgpr_read_b32 v87, a175
v_cvt_pk_bf16_f32 v88, v80, v81
v_cvt_pk_bf16_f32 v89, v82, v83
v_cvt_pk_bf16_f32 v90, v84, v85
v_cvt_pk_bf16_f32 v91, v86, v87
buffer_store_dwordx4 v[88:91], v1, s[24:27], s5 offen offset:2048 sc0 sc1
v_accvgpr_read_b32 v92, a184
v_accvgpr_read_b32 v93, a185
v_accvgpr_read_b32 v94, a186
v_accvgpr_read_b32 v95, a187
v_accvgpr_read_b32 v96, a188
v_accvgpr_read_b32 v97, a189
v_accvgpr_read_b32 v98, a190
v_accvgpr_read_b32 v99, a191
v_cvt_pk_bf16_f32 v100, v92, v93
v_cvt_pk_bf16_f32 v101, v94, v95
v_cvt_pk_bf16_f32 v102, v96, v97
v_cvt_pk_bf16_f32 v103, v98, v99
buffer_store_dwordx4 v[100:103], v1, s[24:27], s5 offen offset:3072 sc0 sc1
s_add_u32 s5, s5, 4096
v_accvgpr_read_b32 v8, a192
v_accvgpr_read_b32 v9, a193
v_accvgpr_read_b32 v10, a194
v_accvgpr_read_b32 v11, a195
v_accvgpr_read_b32 v12, a196
v_accvgpr_read_b32 v13, a197
v_accvgpr_read_b32 v14, a198
v_accvgpr_read_b32 v15, a199
v_cvt_pk_bf16_f32 v16, v8, v9
v_cvt_pk_bf16_f32 v17, v10, v11
v_cvt_pk_bf16_f32 v18, v12, v13
v_cvt_pk_bf16_f32 v19, v14, v15
buffer_store_dwordx4 v[16:19], v1, s[24:27], s5 offen offset:0 sc0 sc1
v_accvgpr_read_b32 v20, a208
v_accvgpr_read_b32 v21, a209
v_accvgpr_read_b32 v22, a210
v_accvgpr_read_b32 v23, a211
v_accvgpr_read_b32 v24, a212
v_accvgpr_read_b32 v25, a213
v_accvgpr_read_b32 v26, a214
v_accvgpr_read_b32 v27, a215
v_cvt_pk_bf16_f32 v28, v20, v21
v_cvt_pk_bf16_f32 v29, v22, v23
v_cvt_pk_bf16_f32 v30, v24, v25
v_cvt_pk_bf16_f32 v31, v26, v27
buffer_store_dwordx4 v[28:31], v1, s[24:27], s5 offen offset:1024 sc0 sc1
v_accvgpr_read_b32 v32, a224
v_accvgpr_read_b32 v33, a225
v_accvgpr_read_b32 v34, a226
v_accvgpr_read_b32 v35, a227
v_accvgpr_read_b32 v36, a228
v_accvgpr_read_b32 v37, a229
v_accvgpr_read_b32 v38, a230
v_accvgpr_read_b32 v39, a231
v_cvt_pk_bf16_f32 v40, v32, v33
v_cvt_pk_bf16_f32 v41, v34, v35
v_cvt_pk_bf16_f32 v42, v36, v37
v_cvt_pk_bf16_f32 v43, v38, v39
buffer_store_dwordx4 v[40:43], v1, s[24:27], s5 offen offset:2048 sc0 sc1
v_accvgpr_read_b32 v44, a240
v_accvgpr_read_b32 v45, a241
v_accvgpr_read_b32 v46, a242
v_accvgpr_read_b32 v47, a243
v_accvgpr_read_b32 v48, a244
v_accvgpr_read_b32 v49, a245
v_accvgpr_read_b32 v50, a246
v_accvgpr_read_b32 v51, a247
v_cvt_pk_bf16_f32 v52, v44, v45
v_cvt_pk_bf16_f32 v53, v46, v47
v_cvt_pk_bf16_f32 v54, v48, v49
v_cvt_pk_bf16_f32 v55, v50, v51
buffer_store_dwordx4 v[52:55], v1, s[24:27], s5 offen offset:3072 sc0 sc1
s_add_u32 s5, s5, 4096
v_accvgpr_read_b32 v56, a200
v_accvgpr_read_b32 v57, a201
v_accvgpr_read_b32 v58, a202
v_accvgpr_read_b32 v59, a203
v_accvgpr_read_b32 v60, a204
v_accvgpr_read_b32 v61, a205
v_accvgpr_read_b32 v62, a206
v_accvgpr_read_b32 v63, a207
v_cvt_pk_bf16_f32 v64, v56, v57
v_cvt_pk_bf16_f32 v65, v58, v59
v_cvt_pk_bf16_f32 v66, v60, v61
v_cvt_pk_bf16_f32 v67, v62, v63
buffer_store_dwordx4 v[64:67], v1, s[24:27], s5 offen offset:0 sc0 sc1
v_accvgpr_read_b32 v68, a216
v_accvgpr_read_b32 v69, a217
v_accvgpr_read_b32 v70, a218
v_accvgpr_read_b32 v71, a219
v_accvgpr_read_b32 v72, a220
v_accvgpr_read_b32 v73, a221
v_accvgpr_read_b32 v74, a222
v_accvgpr_read_b32 v75, a223
v_cvt_pk_bf16_f32 v76, v68, v69
v_cvt_pk_bf16_f32 v77, v70, v71
v_cvt_pk_bf16_f32 v78, v72, v73
v_cvt_pk_bf16_f32 v79, v74, v75
buffer_store_dwordx4 v[76:79], v1, s[24:27], s5 offen offset:1024 sc0 sc1
v_accvgpr_read_b32 v80, a232
v_accvgpr_read_b32 v81, a233
v_accvgpr_read_b32 v82, a234
v_accvgpr_read_b32 v83, a235
v_accvgpr_read_b32 v84, a236
v_accvgpr_read_b32 v85, a237
v_accvgpr_read_b32 v86, a238
v_accvgpr_read_b32 v87, a239
v_cvt_pk_bf16_f32 v88, v80, v81
v_cvt_pk_bf16_f32 v89, v82, v83
v_cvt_pk_bf16_f32 v90, v84, v85
v_cvt_pk_bf16_f32 v91, v86, v87
buffer_store_dwordx4 v[88:91], v1, s[24:27], s5 offen offset:2048 sc0 sc1
v_accvgpr_read_b32 v92, a248
v_accvgpr_read_b32 v93, a249
v_accvgpr_read_b32 v94, a250
v_accvgpr_read_b32 v95, a251
v_accvgpr_read_b32 v96, a252
v_accvgpr_read_b32 v97, a253
v_accvgpr_read_b32 v98, a254
v_accvgpr_read_b32 v99, a255
v_cvt_pk_bf16_f32 v100, v92, v93
v_cvt_pk_bf16_f32 v101, v94, v95
v_cvt_pk_bf16_f32 v102, v96, v97
v_cvt_pk_bf16_f32 v103, v98, v99
buffer_store_dwordx4 v[100:103], v1, s[24:27], s5 offen offset:3072 sc0 sc1
s_add_u32 s5, s5, 4096
s_endpgm
.section .rodata,"a"
.p2align 6
.amdhsa_kernel kv_kernel
  .amdhsa_next_free_vgpr 512
  .amdhsa_next_free_sgpr 96
  .amdhsa_accum_offset 256
  .amdhsa_group_segment_fixed_size 0
  .amdhsa_kernarg_size 112
  .amdhsa_user_sgpr_count 2
  .amdhsa_user_sgpr_kernarg_segment_ptr 1
  .amdhsa_system_sgpr_workgroup_id_x 1
.end_amdhsa_kernel
.text
.globl at_kernel
.p2align 8
.type at_kernel,@function
at_kernel:
s_cmp_ge_u32 s2, 256
s_cbranch_scc0 at_kernel_go
s_endpgm
at_kernel_go:
v_lshrrev_b32 v1, 6, v0
v_and_b32 v0, 63, v0
s_nop 0
v_readfirstlane_b32 s3, v1
s_load_dwordx2 s[8:9], s[0:1], 104
s_load_dwordx2 s[12:13], s[0:1], 16
s_load_dwordx2 s[16:17], s[0:1], 104
s_load_dwordx2 s[20:21], s[0:1], 104
s_load_dwordx2 s[24:25], s[0:1], 104
s_and_b32 s5, s2, 7
s_lshr_b32 s6, s2, 6
s_lshl_b32 s5, s5, 2
s_add_u32 s36, s5, s6
s_bfe_u32 s51, s2, 0x30003
s_sub_u32 s37, 15, s51
s_mov_b32 s41, 2
s_lshr_b32 s38, s3, 1
s_and_b32 s39, s3, 1
s_lshl_b32 s5, s38, 16
s_lshl_b32 s6, s39, 13
s_add_u32 s49, s5, s6
s_lshl_b32 s50, s3, 12
s_lshl_b32 s60, s3, 2
s_lshl_b32 s61, s39, 3
s_lshl_b32 s62, s38, 1
s_mul_i32 s43, s51, 147456
s_lshl_b32 s44, s36, 8
s_sub_u32 s6, s37, s51
s_mul_i32 s7, s6, 147456
v_add_u32 v1, 0, v0
v_lshl_add_u32 v1, s60, 6, v1
v_lshrrev_b32 v2, 3, v1
v_and_b32 v1, 7, v1
v_bfe_u32 v3, v2, 1, 3
v_xor_b32 v1, v1, v3
v_mul_u32_u24 v2, 1152, v2
v_lshl_add_u32 v36, v1, 4, v2
v_add_u32 v1, 64, v0
v_lshl_add_u32 v1, s60, 6, v1
v_lshrrev_b32 v2, 3, v1
v_and_b32 v1, 7, v1
v_bfe_u32 v3, v2, 1, 3
v_xor_b32 v1, v1, v3
v_mul_u32_u24 v2, 1152, v2
v_lshl_add_u32 v37, v1, 4, v2
v_subrev_u32 v37, 1024, v37
v_add_u32 v1, 128, v0
v_lshl_add_u32 v1, s60, 6, v1
v_lshrrev_b32 v2, 3, v1
v_and_b32 v1, 7, v1
v_bfe_u32 v3, v2, 1, 3
v_xor_b32 v1, v1, v3
v_mul_u32_u24 v2, 1152, v2
v_lshl_add_u32 v38, v1, 4, v2
v_subrev_u32 v38, 2048, v38
v_add_u32 v1, 192, v0
v_lshl_add_u32 v1, s60, 6, v1
v_lshrrev_b32 v2, 3, v1
v_and_b32 v1, 7, v1
v_bfe_u32 v3, v2, 1, 3
v_xor_b32 v1, v1, v3
v_mul_u32_u24 v2, 1152, v2
v_lshl_add_u32 v39, v1, 4, v2
v_subrev_u32 v39, 3072, v39
v_add_u32 v1, 0, v0
v_lshl_add_u32 v1, s60, 6, v1
v_lshrrev_b32 v2, 4, v1
v_and_b32 v1, 15, v1
v_and_b32 v3, 3, v2
v_lshlrev_b32 v3, 2, v3
v_xor_b32 v1, v1, v3
v_mul_u32_u24 v2, 8192, v2
v_lshl_add_u32 v40, v1, 4, v2
v_add_u32 v1, 64, v0
v_lshl_add_u32 v1, s60, 6, v1
v_lshrrev_b32 v2, 4, v1
v_and_b32 v1, 15, v1
v_and_b32 v3, 3, v2
v_lshlrev_b32 v3, 2, v3
v_xor_b32 v1, v1, v3
v_mul_u32_u24 v2, 8192, v2
v_lshl_add_u32 v41, v1, 4, v2
v_subrev_u32 v41, 1024, v41
v_add_u32 v1, 128, v0
v_lshl_add_u32 v1, s60, 6, v1
v_lshrrev_b32 v2, 4, v1
v_and_b32 v1, 15, v1
v_and_b32 v3, 3, v2
v_lshlrev_b32 v3, 2, v3
v_xor_b32 v1, v1, v3
v_mul_u32_u24 v2, 8192, v2
v_lshl_add_u32 v42, v1, 4, v2
v_subrev_u32 v42, 2048, v42
v_add_u32 v1, 192, v0
v_lshl_add_u32 v1, s60, 6, v1
v_lshrrev_b32 v2, 4, v1
v_and_b32 v1, 15, v1
v_and_b32 v3, 3, v2
v_lshlrev_b32 v3, 2, v3
v_xor_b32 v1, v1, v3
v_mul_u32_u24 v2, 8192, v2
v_lshl_add_u32 v43, v1, 4, v2
v_subrev_u32 v43, 3072, v43
v_add_u32 v32, s7, v36
v_add_u32 v33, s7, v37
v_add_u32 v34, s7, v38
v_add_u32 v35, s7, v39
s_waitcnt lgkmcnt(0)
s_mov_b32 s10, 0x240000
s_mov_b32 s11, 0x00020000
s_mov_b32 s14, 0x480000
s_mov_b32 s15, 0x00020000
s_add_u32 s16, s16, 0x400000
s_addc_u32 s17, s17, 0
s_mov_b32 s18, 0x1000000
s_mov_b32 s19, 0x00020000
s_add_u32 s20, s20, 0x1400000
s_addc_u32 s21, s21, 0
s_mov_b32 s22, 0x1000000
s_mov_b32 s23, 0x00020000
s_add_u32 s24, s24, 0x2400000
s_addc_u32 s25, s25, 0
s_mov_b32 s26, 0x1000000
s_mov_b32 s27, 0x00020000
s_add_u32 m0, s50, 16384
s_nop 0
buffer_load_dwordx4 v32, s[8:11], s43 offen offset:0 lds
buffer_load_dwordx4 v33, s[8:11], s43 offen offset:1024 lds
buffer_load_dwordx4 v34, s[8:11], s43 offen offset:2048 lds
buffer_load_dwordx4 v35, s[8:11], s43 offen offset:3072 lds
s_add_u32 m0, s50, 81920
s_nop 0
buffer_load_dwordx4 v36, s[8:11], s43 offen offset:0 lds
buffer_load_dwordx4 v37, s[8:11], s43 offen offset:1024 lds
buffer_load_dwordx4 v38, s[8:11], s43 offen offset:2048 lds
buffer_load_dwordx4 v39, s[8:11], s43 offen offset:3072 lds
s_add_u32 m0, s50, 65536
s_nop 0
buffer_load_dwordx4 v40, s[12:15], s44 offen offset:0 lds
buffer_load_dwordx4 v41, s[12:15], s44 offen offset:1024 lds
buffer_load_dwordx4 v42, s[12:15], s44 offen offset:2048 lds
buffer_load_dwordx4 v43, s[12:15], s44 offen offset:3072 lds
s_add_u32 s43, s43, 128
s_add_u32 s44, s44, 524288
s_add_u32 m0, s50, 32768
s_nop 0
buffer_load_dwordx4 v32, s[8:11], s43 offen offset:0 lds
buffer_load_dwordx4 v33, s[8:11], s43 offen offset:1024 lds
buffer_load_dwordx4 v34, s[8:11], s43 offen offset:2048 lds
buffer_load_dwordx4 v35, s[8:11], s43 offen offset:3072 lds
s_add_u32 m0, s50, 98304
s_nop 0
buffer_load_dwordx4 v36, s[8:11], s43 offen offset:0 lds
buffer_load_dwordx4 v37, s[8:11], s43 offen offset:1024 lds
buffer_load_dwordx4 v38, s[8:11], s43 offen offset:2048 lds
buffer_load_dwordx4 v39, s[8:11], s43 offen offset:3072 lds
s_add_u32 m0, s50, 147456
s_nop 0
buffer_load_dwordx4 v40, s[12:15], s44 offen offset:0 lds
buffer_load_dwordx4 v41, s[12:15], s44 offen offset:1024 lds
buffer_load_dwordx4 v42, s[12:15], s44 offen offset:2048 lds
buffer_load_dwordx4 v43, s[12:15], s44 offen offset:3072 lds
s_add_u32 s43, s43, 128
s_add_u32 s44, s44, 524288
s_add_u32 m0, s50, 49152
s_nop 0
buffer_load_dwordx4 v32, s[8:11], s43 offen offset:0 lds
buffer_load_dwordx4 v33, s[8:11], s43 offen offset:1024 lds
buffer_load_dwordx4 v34, s[8:11], s43 offen offset:2048 lds
buffer_load_dwordx4 v35, s[8:11], s43 offen offset:3072 lds
s_add_u32 m0, s50, 114688
s_nop 0
buffer_load_dwordx4 v36, s[8:11], s43 offen offset:0 lds
buffer_load_dwordx4 v37, s[8:11], s43 offen offset:1024 lds
buffer_load_dwordx4 v38, s[8:11], s43 offen offset:2048 lds
buffer_load_dwordx4 v39, s[8:11], s43 offen offset:3072 lds
s_add_u32 m0, s50, 131072
s_nop 0
buffer_load_dwordx4 v40, s[12:15], s44 offen offset:0 lds
buffer_load_dwordx4 v41, s[12:15], s44 offen offset:1024 lds
buffer_load_dwordx4 v42, s[12:15], s44 offen offset:2048 lds
buffer_load_dwordx4 v43, s[12:15], s44 offen offset:3072 lds
s_add_u32 s43, s43, 128
s_add_u32 s44, s44, 524288
v_lshlrev_b32 v30, 4, v0
v_add_u32 v4, s5, v30
v_lshl_add_u32 v5, s39, 13, v30
v_and_b32 v1, 31, v0
v_lshrrev_b32 v2, 5, v0
v_lshl_add_u32 v29, s39, 6, v1
v_lshlrev_b32 v2, 2, v2
v_sub_u32 v29, v29, v2
s_lshl_b32 s5, s38, 6
v_subrev_u32 v29, s5, v29
s_lshl_b32 s5, s36, 19
s_lshl_b32 s6, s38, 14
s_add_u32 s45, s5, s6
s_mov_b32 s46, s45
s_lshl_b32 s5, s39, 13
v_and_b32 v1, 31, v0
v_bfe_u32 v2, v0, 1, 3
v_lshrrev_b32 v3, 5, v0
v_xor_b32 v2, v2, v3
v_lshlrev_b32 v2, 4, v2
v_mul_u32_u24 v1, 128, v1
v_add_u32 v1, v1, v2
v_xor_b32 v44, 0, v1
v_add_u32 v44, s5, v44
v_xor_b32 v45, 32, v1
v_add_u32 v45, s5, v45
v_xor_b32 v46, 64, v1
v_add_u32 v46, s5, v46
v_xor_b32 v47, 96, v1
v_add_u32 v47, s5, v47
v_add_u32 v48, 65536, v44
v_add_u32 v49, 65536, v45
v_add_u32 v50, 65536, v46
v_add_u32 v51, 65536, v47
v_bfe_u32 v1, v0, 2, 2
v_lshrrev_b32 v2, 5, v0
v_lshl_add_u32 v2, v2, 3, v1
v_mul_u32_u24 v2, 256, v2
v_bfe_u32 v3, v0, 4, 1
v_lshl_add_u32 v2, v3, 5, v2
v_and_b32 v3, 3, v0
v_lshl_add_u32 v2, v3, 3, v2
v_add_u32 v2, 0, v2
v_xor_b32 v3, s62, v1
v_xor_b32 v3, 0, v3
v_lshl_add_u32 v52, v3, 6, v2
v_xor_b32 v3, s62, v1
v_xor_b32 v3, 1, v3
v_lshl_add_u32 v53, v3, 6, v2
v_add_u32 v54, 131072, v52
v_add_u32 v55, 131072, v53
v_add_u32 v52, 65536, v52
v_add_u32 v53, 65536, v53
s_waitcnt vmcnt(24)
s_barrier
ds_read_b64_tr_b16 v[64:65], v52 offset:0
ds_read_b64_tr_b16 v[66:67], v52 offset:1024
ds_read_b64_tr_b16 v[68:69], v53 offset:0
ds_read_b64_tr_b16 v[70:71], v53 offset:1024
ds_read_b128 v[72:75], v44 offset:16384
ds_read_b128 v[76:79], v44 offset:20480
ds_read_b128 v[80:83], v48 offset:16384
ds_read_b128 v[84:87], v48 offset:20480
s_waitcnt lgkmcnt(0)
v_mfma_f32_32x32x16_bf16 a[0:15], v[64:67], v[72:75], 0
ds_read_b64_tr_b16 v[88:89], v52 offset:4096
ds_read_b64_tr_b16 v[90:91], v52 offset:5120
v_mfma_f32_32x32x16_bf16 a[16:31], v[68:71], v[72:75], 0
ds_read_b64_tr_b16 v[92:93], v53 offset:4096
ds_read_b64_tr_b16 v[94:95], v53 offset:5120
v_mfma_f32_32x32x16_bf16 a[32:47], v[64:67], v[76:79], 0
ds_read_b128 v[96:99], v45 offset:16384
ds_read_b128 v[100:103], v45 offset:20480
v_mfma_f32_32x32x16_bf16 a[48:63], v[68:71], v[76:79], 0
ds_read_b128 v[104:107], v49 offset:16384
ds_read_b128 v[108:111], v49 offset:20480
v_mfma_f32_32x32x16_bf16 a[64:79], v[64:67], v[80:83], 0
v_mfma_f32_32x32x16_bf16 a[80:95], v[68:71], v[80:83], 0
v_mfma_f32_32x32x16_bf16 a[96:111], v[64:67], v[84:87], 0
v_mfma_f32_32x32x16_bf16 a[112:127], v[68:71], v[84:87], 0
s_waitcnt lgkmcnt(0)
v_mfma_f32_32x32x16_bf16 a[0:15], v[88:91], v[96:99], a[0:15]
ds_read_b64_tr_b16 v[64:65], v52 offset:8192
ds_read_b64_tr_b16 v[66:67], v52 offset:9216
v_mfma_f32_32x32x16_bf16 a[16:31], v[92:95], v[96:99], a[16:31]
ds_read_b64_tr_b16 v[68:69], v53 offset:8192
ds_read_b64_tr_b16 v[70:71], v53 offset:9216
v_mfma_f32_32x32x16_bf16 a[32:47], v[88:91], v[100:103], a[32:47]
ds_read_b128 v[72:75], v46 offset:16384
ds_read_b128 v[76:79], v46 offset:20480
v_mfma_f32_32x32x16_bf16 a[48:63], v[92:95], v[100:103], a[48:63]
ds_read_b128 v[80:83], v50 offset:16384
ds_read_b128 v[84:87], v50 offset:20480
v_mfma_f32_32x32x16_bf16 a[64:79], v[88:91], v[104:107], a[64:79]
v_mfma_f32_32x32x16_bf16 a[80:95], v[92:95], v[104:107], a[80:95]
v_mfma_f32_32x32x16_bf16 a[96:111], v[88:91], v[108:111], a[96:111]
v_mfma_f32_32x32x16_bf16 a[112:127], v[92:95], v[108:111], a[112:127]
s_waitcnt lgkmcnt(0)
v_mfma_f32_32x32x16_bf16 a[0:15], v[64:67], v[72:75], a[0:15]
ds_read_b64_tr_b16 v[88:89], v52 offset:12288
ds_read_b64_tr_b16 v[90:91], v52 offset:13312
v_mfma_f32_32x32x16_bf16 a[16:31], v[68:71], v[72:75], a[16:31]
ds_read_b64_tr_b16 v[92:93], v53 offset:12288
ds_read_b64_tr_b16 v[94:95], v53 offset:13312
v_mfma_f32_32x32x16_bf16 a[32:47], v[64:67], v[76:79], a[32:47]
ds_read_b128 v[96:99], v47 offset:16384
ds_read_b128 v[100:103], v47 offset:20480
v_mfma_f32_32x32x16_bf16 a[48:63], v[68:71], v[76:79], a[48:63]
ds_read_b128 v[104:107], v51 offset:16384
ds_read_b128 v[108:111], v51 offset:20480
v_mfma_f32_32x32x16_bf16 a[64:79], v[64:67], v[80:83], a[64:79]
v_mfma_f32_32x32x16_bf16 a[80:95], v[68:71], v[80:83], a[80:95]
v_mfma_f32_32x32x16_bf16 a[96:111], v[64:67], v[84:87], a[96:111]
v_mfma_f32_32x32x16_bf16 a[112:127], v[68:71], v[84:87], a[112:127]
s_waitcnt lgkmcnt(0)
s_waitcnt vmcnt(12)
s_barrier
v_mfma_f32_32x32x16_bf16 a[0:15], v[88:91], v[96:99], a[0:15]
ds_read_b64_tr_b16 v[64:65], v54 offset:16384
ds_read_b64_tr_b16 v[66:67], v54 offset:17408
v_mfma_f32_32x32x16_bf16 a[16:31], v[92:95], v[96:99], a[16:31]
ds_read_b64_tr_b16 v[68:69], v55 offset:16384
ds_read_b64_tr_b16 v[70:71], v55 offset:17408
v_mfma_f32_32x32x16_bf16 a[32:47], v[88:91], v[100:103], a[32:47]
ds_read_b128 v[72:75], v44 offset:32768
ds_read_b128 v[76:79], v44 offset:36864
v_mfma_f32_32x32x16_bf16 a[48:63], v[92:95], v[100:103], a[48:63]
ds_read_b128 v[80:83], v48 offset:32768
ds_read_b128 v[84:87], v48 offset:36864
v_mfma_f32_32x32x16_bf16 a[64:79], v[88:91], v[104:107], a[64:79]
s_add_u32 m0, s50, 16384
s_nop 0
buffer_load_dwordx4 v32, s[8:11], s43 offen offset:0 lds
v_mfma_f32_32x32x16_bf16 a[80:95], v[92:95], v[104:107], a[80:95]
buffer_load_dwordx4 v33, s[8:11], s43 offen offset:1024 lds
v_mfma_f32_32x32x16_bf16 a[96:111], v[88:91], v[108:111], a[96:111]
buffer_load_dwordx4 v34, s[8:11], s43 offen offset:2048 lds
v_mfma_f32_32x32x16_bf16 a[112:127], v[92:95], v[108:111], a[112:127]
buffer_load_dwordx4 v35, s[8:11], s43 offen offset:3072 lds
s_waitcnt lgkmcnt(0)
v_mfma_f32_32x32x16_bf16 a[0:15], v[64:67], v[72:75], a[0:15]
ds_read_b64_tr_b16 v[88:89], v54 offset:20480
ds_read_b64_tr_b16 v[90:91], v54 offset:21504
v_mfma_f32_32x32x16_bf16 a[16:31], v[68:71], v[72:75], a[16:31]
ds_read_b64_tr_b16 v[92:93], v55 offset:20480
ds_read_b64_tr_b16 v[94:95], v55 offset:21504
v_mfma_f32_32x32x16_bf16 a[32:47], v[64:67], v[76:79], a[32:47]
ds_read_b128 v[96:99], v45 offset:32768
ds_read_b128 v[100:103], v45 offset:36864
v_mfma_f32_32x32x16_bf16 a[48:63], v[68:71], v[76:79], a[48:63]
ds_read_b128 v[104:107], v49 offset:32768
ds_read_b128 v[108:111], v49 offset:36864
v_mfma_f32_32x32x16_bf16 a[64:79], v[64:67], v[80:83], a[64:79]
s_add_u32 m0, s50, 81920
s_nop 0
buffer_load_dwordx4 v36, s[8:11], s43 offen offset:0 lds
v_mfma_f32_32x32x16_bf16 a[80:95], v[68:71], v[80:83], a[80:95]
buffer_load_dwordx4 v37, s[8:11], s43 offen offset:1024 lds
v_mfma_f32_32x32x16_bf16 a[96:111], v[64:67], v[84:87], a[96:111]
buffer_load_dwordx4 v38, s[8:11], s43 offen offset:2048 lds
v_mfma_f32_32x32x16_bf16 a[112:127], v[68:71], v[84:87], a[112:127]
buffer_load_dwordx4 v39, s[8:11], s43 offen offset:3072 lds
s_waitcnt lgkmcnt(0)
v_mfma_f32_32x32x16_bf16 a[0:15], v[88:91], v[96:99], a[0:15]
ds_read_b64_tr_b16 v[64:65], v54 offset:24576
ds_read_b64_tr_b16 v[66:67], v54 offset:25600
v_mfma_f32_32x32x16_bf16 a[16:31], v[92:95], v[96:99], a[16:31]
ds_read_b64_tr_b16 v[68:69], v55 offset:24576
ds_read_b64_tr_b16 v[70:71], v55 offset:25600
v_mfma_f32_32x32x16_bf16 a[32:47], v[88:91], v[100:103], a[32:47]
ds_read_b128 v[72:75], v46 offset:32768
ds_read_b128 v[76:79], v46 offset:36864
v_mfma_f32_32x32x16_bf16 a[48:63], v[92:95], v[100:103], a[48:63]
ds_read_b128 v[80:83], v50 offset:32768
ds_read_b128 v[84:87], v50 offset:36864
v_mfma_f32_32x32x16_bf16 a[64:79], v[88:91], v[104:107], a[64:79]
s_add_u32 m0, s50, 65536
s_nop 0
buffer_load_dwordx4 v40, s[12:15], s44 offen offset:0 lds
buffer_load_dwordx4 v41, s[12:15], s44 offen offset:1024 lds
v_mfma_f32_32x32x16_bf16 a[80:95], v[92:95], v[104:107], a[80:95]
buffer_load_dwordx4 v42, s[12:15], s44 offen offset:2048 lds
v_mfma_f32_32x32x16_bf16 a[96:111], v[88:91], v[108:111], a[96:111]
buffer_load_dwordx4 v43, s[12:15], s44 offen offset:3072 lds
v_mfma_f32_32x32x16_bf16 a[112:127], v[92:95], v[108:111], a[112:127]
s_add_u32 s43, s43, 128
s_add_u32 s44, s44, 524288
s_waitcnt lgkmcnt(0)
v_mfma_f32_32x32x16_bf16 a[0:15], v[64:67], v[72:75], a[0:15]
ds_read_b64_tr_b16 v[88:89], v54 offset:28672
ds_read_b64_tr_b16 v[90:91], v54 offset:29696
v_mfma_f32_32x32x16_bf16 a[16:31], v[68:71], v[72:75], a[16:31]
ds_read_b64_tr_b16 v[92:93], v55 offset:28672
ds_read_b64_tr_b16 v[94:95], v55 offset:29696
v_mfma_f32_32x32x16_bf16 a[32:47], v[64:67], v[76:79], a[32:47]
ds_read_b128 v[96:99], v47 offset:32768
ds_read_b128 v[100:103], v47 offset:36864
v_mfma_f32_32x32x16_bf16 a[48:63], v[68:71], v[76:79], a[48:63]
ds_read_b128 v[104:107], v51 offset:32768
ds_read_b128 v[108:111], v51 offset:36864
v_mfma_f32_32x32x16_bf16 a[64:79], v[64:67], v[80:83], a[64:79]
v_mfma_f32_32x32x16_bf16 a[80:95], v[68:71], v[80:83], a[80:95]
v_mfma_f32_32x32x16_bf16 a[96:111], v[64:67], v[84:87], a[96:111]
v_mfma_f32_32x32x16_bf16 a[112:127], v[68:71], v[84:87], a[112:127]
s_waitcnt lgkmcnt(0)
s_waitcnt vmcnt(12)
s_barrier
v_mfma_f32_32x32x16_bf16 a[0:15], v[88:91], v[96:99], a[0:15]
ds_read_b64_tr_b16 v[64:65], v54 offset:0
ds_read_b64_tr_b16 v[66:67], v54 offset:1024
v_mfma_f32_32x32x16_bf16 a[16:31], v[92:95], v[96:99], a[16:31]
ds_read_b64_tr_b16 v[68:69], v55 offset:0
ds_read_b64_tr_b16 v[70:71], v55 offset:1024
v_mfma_f32_32x32x16_bf16 a[32:47], v[88:91], v[100:103], a[32:47]
ds_read_b128 v[72:75], v44 offset:49152
ds_read_b128 v[76:79], v44 offset:53248
v_mfma_f32_32x32x16_bf16 a[48:63], v[92:95], v[100:103], a[48:63]
ds_read_b128 v[80:83], v48 offset:49152
ds_read_b128 v[84:87], v48 offset:53248
v_mfma_f32_32x32x16_bf16 a[64:79], v[88:91], v[104:107], a[64:79]
s_add_u32 m0, s50, 32768
s_nop 0
buffer_load_dwordx4 v32, s[8:11], s43 offen offset:0 lds
v_mfma_f32_32x32x16_bf16 a[80:95], v[92:95], v[104:107], a[80:95]
buffer_load_dwordx4 v33, s[8:11], s43 offen offset:1024 lds
v_mfma_f32_32x32x16_bf16 a[96:111], v[88:91], v[108:111], a[96:111]
buffer_load_dwordx4 v34, s[8:11], s43 offen offset:2048 lds
v_mfma_f32_32x32x16_bf16 a[112:127], v[92:95], v[108:111], a[112:127]
buffer_load_dwordx4 v35, s[8:11], s43 offen offset:3072 lds
s_waitcnt lgkmcnt(0)
v_mfma_f32_32x32x16_bf16 a[0:15], v[64:67], v[72:75], a[0:15]
ds_read_b64_tr_b16 v[88:89], v54 offset:4096
ds_read_b64_tr_b16 v[90:91], v54 offset:5120
v_mfma_f32_32x32x16_bf16 a[16:31], v[68:71], v[72:75], a[16:31]
ds_read_b64_tr_b16 v[92:93], v55 offset:4096
ds_read_b64_tr_b16 v[94:95], v55 offset:5120
v_mfma_f32_32x32x16_bf16 a[32:47], v[64:67], v[76:79], a[32:47]
ds_read_b128 v[96:99], v45 offset:49152
ds_read_b128 v[100:103], v45 offset:53248
v_mfma_f32_32x32x16_bf16 a[48:63], v[68:71], v[76:79], a[48:63]
ds_read_b128 v[104:107], v49 offset:49152
ds_read_b128 v[108:111], v49 offset:53248
v_mfma_f32_32x32x16_bf16 a[64:79], v[64:67], v[80:83], a[64:79]
s_add_u32 m0, s50, 98304
s_nop 0
buffer_load_dwordx4 v36, s[8:11], s43 offen offset:0 lds
v_mfma_f32_32x32x16_bf16 a[80:95], v[68:71], v[80:83], a[80:95]
buffer_load_dwordx4 v37, s[8:11], s43 offen offset:1024 lds
v_mfma_f32_32x32x16_bf16 a[96:111], v[64:67], v[84:87], a[96:111]
buffer_load_dwordx4 v38, s[8:11], s43 offen offset:2048 lds
v_mfma_f32_32x32x16_bf16 a[112:127], v[68:71], v[84:87], a[112:127]
buffer_load_dwordx4 v39, s[8:11], s43 offen offset:3072 lds
s_waitcnt lgkmcnt(0)
v_mfma_f32_32x32x16_bf16 a[0:15], v[88:91], v[96:99], a[0:15]
ds_read_b64_tr_b16 v[64:65], v54 offset:8192
ds_read_b64_tr_b16 v[66:67], v54 offset:9216
v_mfma_f32_32x32x16_bf16 a[16:31], v[92:95], v[96:99], a[16:31]
ds_read_b64_tr_b16 v[68:69], v55 offset:8192
ds_read_b64_tr_b16 v[70:71], v55 offset:9216
v_mfma_f32_32x32x16_bf16 a[32:47], v[88:91], v[100:103], a[32:47]
ds_read_b128 v[72:75], v46 offset:49152
ds_read_b128 v[76:79], v46 offset:53248
v_mfma_f32_32x32x16_bf16 a[48:63], v[92:95], v[100:103], a[48:63]
ds_read_b128 v[80:83], v50 offset:49152
ds_read_b128 v[84:87], v50 offset:53248
v_mfma_f32_32x32x16_bf16 a[64:79], v[88:91], v[104:107], a[64:79]
s_add_u32 m0, s50, 147456
s_nop 0
buffer_load_dwordx4 v40, s[12:15], s44 offen offset:0 lds
buffer_load_dwordx4 v41, s[12:15], s44 offen offset:1024 lds
v_mfma_f32_32x32x16_bf16 a[80:95], v[92:95], v[104:107], a[80:95]
buffer_load_dwordx4 v42, s[12:15], s44 offen offset:2048 lds
v_mfma_f32_32x32x16_bf16 a[96:111], v[88:91], v[108:111], a[96:111]
buffer_load_dwordx4 v43, s[12:15], s44 offen offset:3072 lds
v_mfma_f32_32x32x16_bf16 a[112:127], v[92:95], v[108:111], a[112:127]
s_add_u32 s43, s43, 128
s_add_u32 s44, s44, 524288
s_waitcnt lgkmcnt(0)
v_mfma_f32_32x32x16_bf16 a[0:15], v[64:67], v[72:75], a[0:15]
ds_read_b64_tr_b16 v[88:89], v54 offset:12288
ds_read_b64_tr_b16 v[90:91], v54 offset:13312
v_mfma_f32_32x32x16_bf16 a[16:31], v[68:71], v[72:75], a[16:31]
ds_read_b64_tr_b16 v[92:93], v55 offset:12288
ds_read_b64_tr_b16 v[94:95], v55 offset:13312
v_mfma_f32_32x32x16_bf16 a[32:47], v[64:67], v[76:79], a[32:47]
ds_read_b128 v[96:99], v47 offset:49152
ds_read_b128 v[100:103], v47 offset:53248
v_mfma_f32_32x32x16_bf16 a[48:63], v[68:71], v[76:79], a[48:63]
ds_read_b128 v[104:107], v51 offset:49152
ds_read_b128 v[108:111], v51 offset:53248
v_mfma_f32_32x32x16_bf16 a[64:79], v[64:67], v[80:83], a[64:79]
v_mfma_f32_32x32x16_bf16 a[80:95], v[68:71], v[80:83], a[80:95]
v_mfma_f32_32x32x16_bf16 a[96:111], v[64:67], v[84:87], a[96:111]
v_mfma_f32_32x32x16_bf16 a[112:127], v[68:71], v[84:87], a[112:127]
s_waitcnt lgkmcnt(0)
s_waitcnt vmcnt(12)
s_barrier
v_mfma_f32_32x32x16_bf16 a[0:15], v[88:91], v[96:99], a[0:15]
ds_read_b64_tr_b16 v[64:65], v52 offset:0
ds_read_b64_tr_b16 v[66:67], v52 offset:1024
v_mfma_f32_32x32x16_bf16 a[16:31], v[92:95], v[96:99], a[16:31]
ds_read_b64_tr_b16 v[68:69], v53 offset:0
ds_read_b64_tr_b16 v[70:71], v53 offset:1024
v_mfma_f32_32x32x16_bf16 a[32:47], v[88:91], v[100:103], a[32:47]
ds_read_b128 v[72:75], v44 offset:16384
ds_read_b128 v[76:79], v44 offset:20480
v_mfma_f32_32x32x16_bf16 a[48:63], v[92:95], v[100:103], a[48:63]
ds_read_b128 v[80:83], v48 offset:16384
ds_read_b128 v[84:87], v48 offset:20480
v_mfma_f32_32x32x16_bf16 a[64:79], v[88:91], v[104:107], a[64:79]
s_add_u32 m0, s50, 49152
s_nop 0
buffer_load_dwordx4 v32, s[8:11], s43 offen offset:0 lds
v_mfma_f32_32x32x16_bf16 a[80:95], v[92:95], v[104:107], a[80:95]
buffer_load_dwordx4 v33, s[8:11], s43 offen offset:1024 lds
v_mfma_f32_32x32x16_bf16 a[96:111], v[88:91], v[108:111], a[96:111]
buffer_load_dwordx4 v34, s[8:11], s43 offen offset:2048 lds
v_mfma_f32_32x32x16_bf16 a[112:127], v[92:95], v[108:111], a[112:127]
buffer_load_dwordx4 v35, s[8:11], s43 offen offset:3072 lds
s_waitcnt lgkmcnt(0)
v_mfma_f32_32x32x16_bf16 a[0:15], v[64:67], v[72:75], a[0:15]
ds_read_b64_tr_b16 v[88:89], v52 offset:4096
ds_read_b64_tr_b16 v[90:91], v52 offset:5120
v_mfma_f32_32x32x16_bf16 a[16:31], v[68:71], v[72:75], a[16:31]
ds_read_b64_tr_b16 v[92:93], v53 offset:4096
ds_read_b64_tr_b16 v[94:95], v53 offset:5120
v_mfma_f32_32x32x16_bf16 a[32:47], v[64:67], v[76:79], a[32:47]
ds_read_b128 v[96:99], v45 offset:16384
ds_read_b128 v[100:103], v45 offset:20480
v_mfma_f32_32x32x16_bf16 a[48:63], v[68:71], v[76:79], a[48:63]
ds_read_b128 v[104:107], v49 offset:16384
ds_read_b128 v[108:111], v49 offset:20480
v_mfma_f32_32x32x16_bf16 a[64:79], v[64:67], v[80:83], a[64:79]
s_add_u32 m0, s50, 114688
s_nop 0
buffer_load_dwordx4 v36, s[8:11], s43 offen offset:0 lds
v_mfma_f32_32x32x16_bf16 a[80:95], v[68:71], v[80:83], a[80:95]
buffer_load_dwordx4 v37, s[8:11], s43 offen offset:1024 lds
v_mfma_f32_32x32x16_bf16 a[96:111], v[64:67], v[84:87], a[96:111]
buffer_load_dwordx4 v38, s[8:11], s43 offen offset:2048 lds
v_mfma_f32_32x32x16_bf16 a[112:127], v[68:71], v[84:87], a[112:127]
buffer_load_dwordx4 v39, s[8:11], s43 offen offset:3072 lds
s_waitcnt lgkmcnt(0)
v_mfma_f32_32x32x16_bf16 a[0:15], v[88:91], v[96:99], a[0:15]
ds_read_b64_tr_b16 v[64:65], v52 offset:8192
ds_read_b64_tr_b16 v[66:67], v52 offset:9216
v_mfma_f32_32x32x16_bf16 a[16:31], v[92:95], v[96:99], a[16:31]
ds_read_b64_tr_b16 v[68:69], v53 offset:8192
ds_read_b64_tr_b16 v[70:71], v53 offset:9216
v_mfma_f32_32x32x16_bf16 a[32:47], v[88:91], v[100:103], a[32:47]
ds_read_b128 v[72:75], v46 offset:16384
ds_read_b128 v[76:79], v46 offset:20480
v_mfma_f32_32x32x16_bf16 a[48:63], v[92:95], v[100:103], a[48:63]
ds_read_b128 v[80:83], v50 offset:16384
ds_read_b128 v[84:87], v50 offset:20480
v_mfma_f32_32x32x16_bf16 a[64:79], v[88:91], v[104:107], a[64:79]
s_add_u32 m0, s50, 131072
s_nop 0
buffer_load_dwordx4 v40, s[12:15], s44 offen offset:0 lds
buffer_load_dwordx4 v41, s[12:15], s44 offen offset:1024 lds
v_mfma_f32_32x32x16_bf16 a[80:95], v[92:95], v[104:107], a[80:95]
buffer_load_dwordx4 v42, s[12:15], s44 offen offset:2048 lds
v_mfma_f32_32x32x16_bf16 a[96:111], v[88:91], v[108:111], a[96:111]
buffer_load_dwordx4 v43, s[12:15], s44 offen offset:3072 lds
v_mfma_f32_32x32x16_bf16 a[112:127], v[92:95], v[108:111], a[112:127]
s_add_u32 s43, s43, 128
s_add_u32 s44, s44, 524288
s_waitcnt lgkmcnt(0)
v_mfma_f32_32x32x16_bf16 a[0:15], v[64:67], v[72:75], a[0:15]
ds_read_b64_tr_b16 v[88:89], v52 offset:12288
ds_read_b64_tr_b16 v[90:91], v52 offset:13312
v_mfma_f32_32x32x16_bf16 a[16:31], v[68:71], v[72:75], a[16:31]
ds_read_b64_tr_b16 v[92:93], v53 offset:12288
ds_read_b64_tr_b16 v[94:95], v53 offset:13312
v_mfma_f32_32x32x16_bf16 a[32:47], v[64:67], v[76:79], a[32:47]
ds_read_b128 v[96:99], v47 offset:16384
ds_read_b128 v[100:103], v47 offset:20480
v_mfma_f32_32x32x16_bf16 a[48:63], v[68:71], v[76:79], a[48:63]
ds_read_b128 v[104:107], v51 offset:16384
ds_read_b128 v[108:111], v51 offset:20480
v_mfma_f32_32x32x16_bf16 a[64:79], v[64:67], v[80:83], a[64:79]
v_mfma_f32_32x32x16_bf16 a[80:95], v[68:71], v[80:83], a[80:95]
v_mfma_f32_32x32x16_bf16 a[96:111], v[64:67], v[84:87], a[96:111]
v_mfma_f32_32x32x16_bf16 a[112:127], v[68:71], v[84:87], a[112:127]
s_waitcnt lgkmcnt(0)
s_waitcnt vmcnt(12)
s_barrier
v_mfma_f32_32x32x16_bf16 a[0:15], v[88:91], v[96:99], a[0:15]
ds_read_b64_tr_b16 v[64:65], v54 offset:16384
ds_read_b64_tr_b16 v[66:67], v54 offset:17408
v_mfma_f32_32x32x16_bf16 a[16:31], v[92:95], v[96:99], a[16:31]
ds_read_b64_tr_b16 v[68:69], v55 offset:16384
ds_read_b64_tr_b16 v[70:71], v55 offset:17408
v_mfma_f32_32x32x16_bf16 a[32:47], v[88:91], v[100:103], a[32:47]
ds_read_b128 v[72:75], v44 offset:32768
ds_read_b128 v[76:79], v44 offset:36864
v_mfma_f32_32x32x16_bf16 a[48:63], v[92:95], v[100:103], a[48:63]
ds_read_b128 v[80:83], v48 offset:32768
ds_read_b128 v[84:87], v48 offset:36864
v_mfma_f32_32x32x16_bf16 a[64:79], v[88:91], v[104:107], a[64:79]
s_add_u32 m0, s50, 16384
s_nop 0
buffer_load_dwordx4 v32, s[8:11], s43 offen offset:0 lds
v_mfma_f32_32x32x16_bf16 a[80:95], v[92:95], v[104:107], a[80:95]
buffer_load_dwordx4 v33, s[8:11], s43 offen offset:1024 lds
v_mfma_f32_32x32x16_bf16 a[96:111], v[88:91], v[108:111], a[96:111]
buffer_load_dwordx4 v34, s[8:11], s43 offen offset:2048 lds
v_mfma_f32_32x32x16_bf16 a[112:127], v[92:95], v[108:111], a[112:127]
buffer_load_dwordx4 v35, s[8:11], s43 offen offset:3072 lds
s_waitcnt lgkmcnt(0)
v_mfma_f32_32x32x16_bf16 a[0:15], v[64:67], v[72:75], a[0:15]
ds_read_b64_tr_b16 v[88:89], v54 offset:20480
ds_read_b64_tr_b16 v[90:91], v54 offset:21504
v_mfma_f32_32x32x16_bf16 a[16:31], v[68:71], v[72:75], a[16:31]
ds_read_b64_tr_b16 v[92:93], v55 offset:20480
ds_read_b64_tr_b16 v[94:95], v55 offset:21504
v_mfma_f32_32x32x16_bf16 a[32:47], v[64:67], v[76:79], a[32:47]
ds_read_b128 v[96:99], v45 offset:32768
ds_read_b128 v[100:103], v45 offset:36864
v_mfma_f32_32x32x16_bf16 a[48:63], v[68:71], v[76:79], a[48:63]
ds_read_b128 v[104:107], v49 offset:32768
ds_read_b128 v[108:111], v49 offset:36864
v_mfma_f32_32x32x16_bf16 a[64:79], v[64:67], v[80:83], a[64:79]
s_add_u32 m0, s50, 81920
s_nop 0
buffer_load_dwordx4 v36, s[8:11], s43 offen offset:0 lds
v_mfma_f32_32x32x16_bf16 a[80:95], v[68:71], v[80:83], a[80:95]
buffer_load_dwordx4 v37, s[8:11], s43 offen offset:1024 lds
v_mfma_f32_32x32x16_bf16 a[96:111], v[64:67], v[84:87], a[96:111]
buffer_load_dwordx4 v38, s[8:11], s43 offen offset:2048 lds
v_mfma_f32_32x32x16_bf16 a[112:127], v[68:71], v[84:87], a[112:127]
buffer_load_dwordx4 v39, s[8:11], s43 offen offset:3072 lds
s_waitcnt lgkmcnt(0)
v_mfma_f32_32x32x16_bf16 a[0:15], v[88:91], v[96:99], a[0:15]
ds_read_b64_tr_b16 v[64:65], v54 offset:24576
ds_read_b64_tr_b16 v[66:67], v54 offset:25600
v_mfma_f32_32x32x16_bf16 a[16:31], v[92:95], v[96:99], a[16:31]
ds_read_b64_tr_b16 v[68:69], v55 offset:24576
ds_read_b64_tr_b16 v[70:71], v55 offset:25600
v_mfma_f32_32x32x16_bf16 a[32:47], v[88:91], v[100:103], a[32:47]
ds_read_b128 v[72:75], v46 offset:32768
ds_read_b128 v[76:79], v46 offset:36864
v_mfma_f32_32x32x16_bf16 a[48:63], v[92:95], v[100:103], a[48:63]
ds_read_b128 v[80:83], v50 offset:32768
ds_read_b128 v[84:87], v50 offset:36864
v_mfma_f32_32x32x16_bf16 a[64:79], v[88:91], v[104:107], a[64:79]
s_add_u32 m0, s50, 65536
s_nop 0
buffer_load_dwordx4 v40, s[12:15], s44 offen offset:0 lds
buffer_load_dwordx4 v41, s[12:15], s44 offen offset:1024 lds
v_mfma_f32_32x32x16_bf16 a[80:95], v[92:95], v[104:107], a[80:95]
buffer_load_dwordx4 v42, s[12:15], s44 offen offset:2048 lds
v_mfma_f32_32x32x16_bf16 a[96:111], v[88:91], v[108:111], a[96:111]
buffer_load_dwordx4 v43, s[12:15], s44 offen offset:3072 lds
v_mfma_f32_32x32x16_bf16 a[112:127], v[92:95], v[108:111], a[112:127]
s_add_u32 s43, s43, 128
s_add_u32 s44, s44, 524288
s_waitcnt lgkmcnt(0)
v_mfma_f32_32x32x16_bf16 a[0:15], v[64:67], v[72:75], a[0:15]
ds_read_b64_tr_b16 v[88:89], v54 offset:28672
ds_read_b64_tr_b16 v[90:91], v54 offset:29696
v_mfma_f32_32x32x16_bf16 a[16:31], v[68:71], v[72:75], a[16:31]
ds_read_b64_tr_b16 v[92:93], v55 offset:28672
ds_read_b64_tr_b16 v[94:95], v55 offset:29696
v_mfma_f32_32x32x16_bf16 a[32:47], v[64:67], v[76:79], a[32:47]
ds_read_b128 v[96:99], v47 offset:32768
ds_read_b128 v[100:103], v47 offset:36864
v_mfma_f32_32x32x16_bf16 a[48:63], v[68:71], v[76:79], a[48:63]
ds_read_b128 v[104:107], v51 offset:32768
ds_read_b128 v[108:111], v51 offset:36864
v_mfma_f32_32x32x16_bf16 a[64:79], v[64:67], v[80:83], a[64:79]
v_mfma_f32_32x32x16_bf16 a[80:95], v[68:71], v[80:83], a[80:95]
v_mfma_f32_32x32x16_bf16 a[96:111], v[64:67], v[84:87], a[96:111]
v_mfma_f32_32x32x16_bf16 a[112:127], v[68:71], v[84:87], a[112:127]
s_waitcnt lgkmcnt(0)
s_waitcnt vmcnt(12)
s_barrier
v_mfma_f32_32x32x16_bf16 a[0:15], v[88:91], v[96:99], a[0:15]
ds_read_b64_tr_b16 v[64:65], v54 offset:0
ds_read_b64_tr_b16 v[66:67], v54 offset:1024
v_mfma_f32_32x32x16_bf16 a[16:31], v[92:95], v[96:99], a[16:31]
ds_read_b64_tr_b16 v[68:69], v55 offset:0
ds_read_b64_tr_b16 v[70:71], v55 offset:1024
v_mfma_f32_32x32x16_bf16 a[32:47], v[88:91], v[100:103], a[32:47]
ds_read_b128 v[72:75], v44 offset:49152
ds_read_b128 v[76:79], v44 offset:53248
v_mfma_f32_32x32x16_bf16 a[48:63], v[92:95], v[100:103], a[48:63]
ds_read_b128 v[80:83], v48 offset:49152
ds_read_b128 v[84:87], v48 offset:53248
v_mfma_f32_32x32x16_bf16 a[64:79], v[88:91], v[104:107], a[64:79]
s_add_u32 m0, s50, 32768
s_nop 0
buffer_load_dwordx4 v32, s[8:11], s43 offen offset:0 lds
v_mfma_f32_32x32x16_bf16 a[80:95], v[92:95], v[104:107], a[80:95]
buffer_load_dwordx4 v33, s[8:11], s43 offen offset:1024 lds
v_mfma_f32_32x32x16_bf16 a[96:111], v[88:91], v[108:111], a[96:111]
buffer_load_dwordx4 v34, s[8:11], s43 offen offset:2048 lds
v_mfma_f32_32x32x16_bf16 a[112:127], v[92:95], v[108:111], a[112:127]
buffer_load_dwordx4 v35, s[8:11], s43 offen offset:3072 lds
s_waitcnt lgkmcnt(0)
v_mfma_f32_32x32x16_bf16 a[0:15], v[64:67], v[72:75], a[0:15]
ds_read_b64_tr_b16 v[88:89], v54 offset:4096
ds_read_b64_tr_b16 v[90:91], v54 offset:5120
v_mfma_f32_32x32x16_bf16 a[16:31], v[68:71], v[72:75], a[16:31]
ds_read_b64_tr_b16 v[92:93], v55 offset:4096
ds_read_b64_tr_b16 v[94:95], v55 offset:5120
v_mfma_f32_32x32x16_bf16 a[32:47], v[64:67], v[76:79], a[32:47]
ds_read_b128 v[96:99], v45 offset:49152
ds_read_b128 v[100:103], v45 offset:53248
v_mfma_f32_32x32x16_bf16 a[48:63], v[68:71], v[76:79], a[48:63]
ds_read_b128 v[104:107], v49 offset:49152
ds_read_b128 v[108:111], v49 offset:53248
v_mfma_f32_32x32x16_bf16 a[64:79], v[64:67], v[80:83], a[64:79]
s_add_u32 m0, s50, 98304
s_nop 0
buffer_load_dwordx4 v36, s[8:11], s43 offen offset:0 lds
v_mfma_f32_32x32x16_bf16 a[80:95], v[68:71], v[80:83], a[80:95]
buffer_load_dwordx4 v37, s[8:11], s43 offen offset:1024 lds
v_mfma_f32_32x32x16_bf16 a[96:111], v[64:67], v[84:87], a[96:111]
buffer_load_dwordx4 v38, s[8:11], s43 offen offset:2048 lds
v_mfma_f32_32x32x16_bf16 a[112:127], v[68:71], v[84:87], a[112:127]
buffer_load_dwordx4 v39, s[8:11], s43 offen offset:3072 lds
s_waitcnt lgkmcnt(0)
v_mfma_f32_32x32x16_bf16 a[0:15], v[88:91], v[96:99], a[0:15]
ds_read_b64_tr_b16 v[64:65], v54 offset:8192
ds_read_b64_tr_b16 v[66:67], v54 offset:9216
v_mfma_f32_32x32x16_bf16 a[16:31], v[92:95], v[96:99], a[16:31]
ds_read_b64_tr_b16 v[68:69], v55 offset:8192
ds_read_b64_tr_b16 v[70:71], v55 offset:9216
v_mfma_f32_32x32x16_bf16 a[32:47], v[88:91], v[100:103], a[32:47]
ds_read_b128 v[72:75], v46 offset:49152
ds_read_b128 v[76:79], v46 offset:53248
v_mfma_f32_32x32x16_bf16 a[48:63], v[92:95], v[100:103], a[48:63]
ds_read_b128 v[80:83], v50 offset:49152
ds_read_b128 v[84:87], v50 offset:53248
v_mfma_f32_32x32x16_bf16 a[64:79], v[88:91], v[104:107], a[64:79]
s_add_u32 m0, s50, 147456
s_nop 0
buffer_load_dwordx4 v40, s[12:15], s44 offen offset:0 lds
buffer_load_dwordx4 v41, s[12:15], s44 offen offset:1024 lds
v_mfma_f32_32x32x16_bf16 a[80:95], v[92:95], v[104:107], a[80:95]
buffer_load_dwordx4 v42, s[12:15], s44 offen offset:2048 lds
v_mfma_f32_32x32x16_bf16 a[96:111], v[88:91], v[108:111], a[96:111]
buffer_load_dwordx4 v43, s[12:15], s44 offen offset:3072 lds
v_mfma_f32_32x32x16_bf16 a[112:127], v[92:95], v[108:111], a[112:127]
s_add_u32 s43, s43, 128
s_add_u32 s44, s44, 524288
s_waitcnt lgkmcnt(0)
v_mfma_f32_32x32x16_bf16 a[0:15], v[64:67], v[72:75], a[0:15]
ds_read_b64_tr_b16 v[88:89], v54 offset:12288
ds_read_b64_tr_b16 v[90:91], v54 offset:13312
v_mfma_f32_32x32x16_bf16 a[16:31], v[68:71], v[72:75], a[16:31]
ds_read_b64_tr_b16 v[92:93], v55 offset:12288
ds_read_b64_tr_b16 v[94:95], v55 offset:13312
v_mfma_f32_32x32x16_bf16 a[32:47], v[64:67], v[76:79], a[32:47]
ds_read_b128 v[96:99], v47 offset:49152
ds_read_b128 v[100:103], v47 offset:53248
v_mfma_f32_32x32x16_bf16 a[48:63], v[68:71], v[76:79], a[48:63]
ds_read_b128 v[104:107], v51 offset:49152
ds_read_b128 v[108:111], v51 offset:53248
v_mfma_f32_32x32x16_bf16 a[64:79], v[64:67], v[80:83], a[64:79]
v_mfma_f32_32x32x16_bf16 a[80:95], v[68:71], v[80:83], a[80:95]
v_mfma_f32_32x32x16_bf16 a[96:111], v[64:67], v[84:87], a[96:111]
v_mfma_f32_32x32x16_bf16 a[112:127], v[68:71], v[84:87], a[112:127]
s_waitcnt lgkmcnt(0)
s_waitcnt vmcnt(12)
s_barrier
v_mfma_f32_32x32x16_bf16 a[0:15], v[88:91], v[96:99], a[0:15]
ds_read_b64_tr_b16 v[64:65], v52 offset:0
ds_read_b64_tr_b16 v[66:67], v52 offset:1024
v_mfma_f32_32x32x16_bf16 a[16:31], v[92:95], v[96:99], a[16:31]
ds_read_b64_tr_b16 v[68:69], v53 offset:0
ds_read_b64_tr_b16 v[70:71], v53 offset:1024
v_mfma_f32_32x32x16_bf16 a[32:47], v[88:91], v[100:103], a[32:47]
ds_read_b128 v[72:75], v44 offset:16384
ds_read_b128 v[76:79], v44 offset:20480
v_mfma_f32_32x32x16_bf16 a[48:63], v[92:95], v[100:103], a[48:63]
ds_read_b128 v[80:83], v48 offset:16384
ds_read_b128 v[84:87], v48 offset:20480
v_mfma_f32_32x32x16_bf16 a[64:79], v[88:91], v[104:107], a[64:79]
s_add_u32 m0, s50, 49152
s_nop 0
buffer_load_dwordx4 v32, s[8:11], s43 offen offset:0 lds
v_mfma_f32_32x32x16_bf16 a[80:95], v[92:95], v[104:107], a[80:95]
buffer_load_dwordx4 v33, s[8:11], s43 offen offset:1024 lds
v_mfma_f32_32x32x16_bf16 a[96:111], v[88:91], v[108:111], a[96:111]
buffer_load_dwordx4 v34, s[8:11], s43 offen offset:2048 lds
v_mfma_f32_32x32x16_bf16 a[112:127], v[92:95], v[108:111], a[112:127]
buffer_load_dwordx4 v35, s[8:11], s43 offen offset:3072 lds
s_waitcnt lgkmcnt(0)
v_mfma_f32_32x32x16_bf16 a[0:15], v[64:67], v[72:75], a[0:15]
ds_read_b64_tr_b16 v[88:89], v52 offset:4096
ds_read_b64_tr_b16 v[90:91], v52 offset:5120
v_mfma_f32_32x32x16_bf16 a[16:31], v[68:71], v[72:75], a[16:31]
ds_read_b64_tr_b16 v[92:93], v53 offset:4096
ds_read_b64_tr_b16 v[94:95], v53 offset:5120
v_mfma_f32_32x32x16_bf16 a[32:47], v[64:67], v[76:79], a[32:47]
ds_read_b128 v[96:99], v45 offset:16384
ds_read_b128 v[100:103], v45 offset:20480
v_mfma_f32_32x32x16_bf16 a[48:63], v[68:71], v[76:79], a[48:63]
ds_read_b128 v[104:107], v49 offset:16384
ds_read_b128 v[108:111], v49 offset:20480
v_mfma_f32_32x32x16_bf16 a[64:79], v[64:67], v[80:83], a[64:79]
s_add_u32 m0, s50, 114688
s_nop 0
buffer_load_dwordx4 v36, s[8:11], s43 offen offset:0 lds
v_mfma_f32_32x32x16_bf16 a[80:95], v[68:71], v[80:83], a[80:95]
buffer_load_dwordx4 v37, s[8:11], s43 offen offset:1024 lds
v_mfma_f32_32x32x16_bf16 a[96:111], v[64:67], v[84:87], a[96:111]
buffer_load_dwordx4 v38, s[8:11], s43 offen offset:2048 lds
v_mfma_f32_32x32x16_bf16 a[112:127], v[68:71], v[84:87], a[112:127]
buffer_load_dwordx4 v39, s[8:11], s43 offen offset:3072 lds
s_waitcnt lgkmcnt(0)
v_mfma_f32_32x32x16_bf16 a[0:15], v[88:91], v[96:99], a[0:15]
ds_read_b64_tr_b16 v[64:65], v52 offset:8192
ds_read_b64_tr_b16 v[66:67], v52 offset:9216
v_mfma_f32_32x32x16_bf16 a[16:31], v[92:95], v[96:99], a[16:31]
ds_read_b64_tr_b16 v[68:69], v53 offset:8192
ds_read_b64_tr_b16 v[70:71], v53 offset:9216
v_mfma_f32_32x32x16_bf16 a[32:47], v[88:91], v[100:103], a[32:47]
ds_read_b128 v[72:75], v46 offset:16384
ds_read_b128 v[76:79], v46 offset:20480
v_mfma_f32_32x32x16_bf16 a[48:63], v[92:95], v[100:103], a[48:63]
ds_read_b128 v[80:83], v50 offset:16384
ds_read_b128 v[84:87], v50 offset:20480
v_mfma_f32_32x32x16_bf16 a[64:79], v[88:91], v[104:107], a[64:79]
s_add_u32 m0, s50, 131072
s_nop 0
buffer_load_dwordx4 v40, s[12:15], s44 offen offset:0 lds
buffer_load_dwordx4 v41, s[12:15], s44 offen offset:1024 lds
v_mfma_f32_32x32x16_bf16 a[80:95], v[92:95], v[104:107], a[80:95]
buffer_load_dwordx4 v42, s[12:15], s44 offen offset:2048 lds
v_mfma_f32_32x32x16_bf16 a[96:111], v[88:91], v[108:111], a[96:111]
buffer_load_dwordx4 v43, s[12:15], s44 offen offset:3072 lds
v_mfma_f32_32x32x16_bf16 a[112:127], v[92:95], v[108:111], a[112:127]
s_add_u32 s43, s43, 128
s_add_u32 s44, s44, 524288
s_waitcnt lgkmcnt(0)
v_mfma_f32_32x32x16_bf16 a[0:15], v[64:67], v[72:75], a[0:15]
ds_read_b64_tr_b16 v[88:89], v52 offset:12288
ds_read_b64_tr_b16 v[90:91], v52 offset:13312
v_mfma_f32_32x32x16_bf16 a[16:31], v[68:71], v[72:75], a[16:31]
ds_read_b64_tr_b16 v[92:93], v53 offset:12288
ds_read_b64_tr_b16 v[94:95], v53 offset:13312
v_mfma_f32_32x32x16_bf16 a[32:47], v[64:67], v[76:79], a[32:47]
ds_read_b128 v[96:99], v47 offset:16384
ds_read_b128 v[100:103], v47 offset:20480
v_mfma_f32_32x32x16_bf16 a[48:63], v[68:71], v[76:79], a[48:63]
ds_read_b128 v[104:107], v51 offset:16384
ds_read_b128 v[108:111], v51 offset:20480
v_mfma_f32_32x32x16_bf16 a[64:79], v[64:67], v[80:83], a[64:79]
v_mfma_f32_32x32x16_bf16 a[80:95], v[68:71], v[80:83], a[80:95]
v_mfma_f32_32x32x16_bf16 a[96:111], v[64:67], v[84:87], a[96:111]
v_mfma_f32_32x32x16_bf16 a[112:127], v[68:71], v[84:87], a[112:127]
s_waitcnt lgkmcnt(0)
s_waitcnt vmcnt(12)
s_barrier
v_mfma_f32_32x32x16_bf16 a[0:15], v[88:91], v[96:99], a[0:15]
ds_read_b64_tr_b16 v[64:65], v54 offset:16384
ds_read_b64_tr_b16 v[66:67], v54 offset:17408
v_mfma_f32_32x32x16_bf16 a[16:31], v[92:95], v[96:99], a[16:31]
ds_read_b64_tr_b16 v[68:69], v55 offset:16384
ds_read_b64_tr_b16 v[70:71], v55 offset:17408
v_mfma_f32_32x32x16_bf16 a[32:47], v[88:91], v[100:103], a[32:47]
ds_read_b128 v[72:75], v44 offset:32768
ds_read_b128 v[76:79], v44 offset:36864
v_mfma_f32_32x32x16_bf16 a[48:63], v[92:95], v[100:103], a[48:63]
ds_read_b128 v[80:83], v48 offset:32768
ds_read_b128 v[84:87], v48 offset:36864
v_mfma_f32_32x32x16_bf16 a[64:79], v[88:91], v[104:107], a[64:79]
s_add_u32 m0, s49, 0
s_nop 0
buffer_load_dwordx4 v5, s[16:19], s45 offen offset:0 lds
buffer_load_dwordx4 v5, s[16:19], s45 offen offset:1024 lds
v_mfma_f32_32x32x16_bf16 a[80:95], v[92:95], v[104:107], a[80:95]
buffer_load_dwordx4 v5, s[16:19], s45 offen offset:2048 lds
v_mfma_f32_32x32x16_bf16 a[96:111], v[88:91], v[108:111], a[96:111]
buffer_load_dwordx4 v5, s[16:19], s45 offen offset:3072 lds
v_mfma_f32_32x32x16_bf16 a[112:127], v[92:95], v[108:111], a[112:127]
s_add_u32 m0, s49, 4096
s_add_u32 s45, s45, 4096
buffer_load_dwordx4 v5, s[16:19], s45 offen offset:0 lds
s_waitcnt lgkmcnt(0)
v_mfma_f32_32x32x16_bf16 a[0:15], v[64:67], v[72:75], a[0:15]
ds_read_b64_tr_b16 v[88:89], v54 offset:20480
ds_read_b64_tr_b16 v[90:91], v54 offset:21504
v_mfma_f32_32x32x16_bf16 a[16:31], v[68:71], v[72:75], a[16:31]
ds_read_b64_tr_b16 v[92:93], v55 offset:20480
ds_read_b64_tr_b16 v[94:95], v55 offset:21504
v_mfma_f32_32x32x16_bf16 a[32:47], v[64:67], v[76:79], a[32:47]
ds_read_b128 v[96:99], v45 offset:32768
ds_read_b128 v[100:103], v45 offset:36864
v_mfma_f32_32x32x16_bf16 a[48:63], v[68:71], v[76:79], a[48:63]
ds_read_b128 v[104:107], v49 offset:32768
ds_read_b128 v[108:111], v49 offset:36864
v_mfma_f32_32x32x16_bf16 a[64:79], v[64:67], v[80:83], a[64:79]
buffer_load_dwordx4 v5, s[16:19], s45 offen offset:1024 lds
buffer_load_dwordx4 v5, s[16:19], s45 offen offset:2048 lds
v_mfma_f32_32x32x16_bf16 a[80:95], v[68:71], v[80:83], a[80:95]
buffer_load_dwordx4 v5, s[16:19], s45 offen offset:3072 lds
s_add_u32 s45, s45, 0x7000
v_mfma_f32_32x32x16_bf16 a[96:111], v[64:67], v[84:87], a[96:111]
s_add_u32 m0, s49, 16384
s_nop 0
buffer_load_dwordx4 v5, s[16:19], s45 offen offset:0 lds
v_mfma_f32_32x32x16_bf16 a[112:127], v[68:71], v[84:87], a[112:127]
buffer_load_dwordx4 v5, s[16:19], s45 offen offset:1024 lds
s_waitcnt lgkmcnt(0)
v_mfma_f32_32x32x16_bf16 a[0:15], v[88:91], v[96:99], a[0:15]
ds_read_b64_tr_b16 v[64:65], v54 offset:24576
ds_read_b64_tr_b16 v[66:67], v54 offset:25600
v_mfma_f32_32x32x16_bf16 a[16:31], v[92:95], v[96:99], a[16:31]
ds_read_b64_tr_b16 v[68:69], v55 offset:24576
ds_read_b64_tr_b16 v[70:71], v55 offset:25600
v_mfma_f32_32x32x16_bf16 a[32:47], v[88:91], v[100:103], a[32:47]
ds_read_b128 v[72:75], v46 offset:32768
ds_read_b128 v[76:79], v46 offset:36864
v_mfma_f32_32x32x16_bf16 a[48:63], v[92:95], v[100:103], a[48:63]
ds_read_b128 v[80:83], v50 offset:32768
ds_read_b128 v[84:87], v50 offset:36864
v_mfma_f32_32x32x16_bf16 a[64:79], v[88:91], v[104:107], a[64:79]
buffer_load_dwordx4 v5, s[16:19], s45 offen offset:2048 lds
buffer_load_dwordx4 v5, s[16:19], s45 offen offset:3072 lds
v_mfma_f32_32x32x16_bf16 a[80:95], v[92:95], v[104:107], a[80:95]
s_add_u32 m0, s49, 20480
s_add_u32 s45, s45, 4096
buffer_load_dwordx4 v5, s[16:19], s45 offen offset:0 lds
v_mfma_f32_32x32x16_bf16 a[96:111], v[88:91], v[108:111], a[96:111]
buffer_load_dwordx4 v5, s[16:19], s45 offen offset:1024 lds
buffer_load_dwordx4 v5, s[16:19], s45 offen offset:2048 lds
v_mfma_f32_32x32x16_bf16 a[112:127], v[92:95], v[108:111], a[112:127]
buffer_load_dwordx4 v5, s[16:19], s45 offen offset:3072 lds
s_add_u32 s45, s45, 0x7000
s_waitcnt lgkmcnt(0)
v_mfma_f32_32x32x16_bf16 a[0:15], v[64:67], v[72:75], a[0:15]
ds_read_b64_tr_b16 v[88:89], v54 offset:28672
ds_read_b64_tr_b16 v[90:91], v54 offset:29696
v_mfma_f32_32x32x16_bf16 a[16:31], v[68:71], v[72:75], a[16:31]
ds_read_b64_tr_b16 v[92:93], v55 offset:28672
ds_read_b64_tr_b16 v[94:95], v55 offset:29696
v_mfma_f32_32x32x16_bf16 a[32:47], v[64:67], v[76:79], a[32:47]
ds_read_b128 v[96:99], v47 offset:32768
ds_read_b128 v[100:103], v47 offset:36864
v_mfma_f32_32x32x16_bf16 a[48:63], v[68:71], v[76:79], a[48:63]
ds_read_b128 v[104:107], v51 offset:32768
ds_read_b128 v[108:111], v51 offset:36864
v_mfma_f32_32x32x16_bf16 a[64:79], v[64:67], v[80:83], a[64:79]
v_mfma_f32_32x32x16_bf16 a[80:95], v[68:71], v[80:83], a[80:95]
v_mfma_f32_32x32x16_bf16 a[96:111], v[64:67], v[84:87], a[96:111]
v_mfma_f32_32x32x16_bf16 a[112:127], v[68:71], v[84:87], a[112:127]
s_waitcnt lgkmcnt(0)
s_waitcnt vmcnt(16)
s_barrier
v_mfma_f32_32x32x16_bf16 a[0:15], v[88:91], v[96:99], a[0:15]
ds_read_b64_tr_b16 v[64:65], v54 offset:0
ds_read_b64_tr_b16 v[66:67], v54 offset:1024
v_mfma_f32_32x32x16_bf16 a[16:31], v[92:95], v[96:99], a[16:31]
ds_read_b64_tr_b16 v[68:69], v55 offset:0
ds_read_b64_tr_b16 v[70:71], v55 offset:1024
v_mfma_f32_32x32x16_bf16 a[32:47], v[88:91], v[100:103], a[32:47]
ds_read_b128 v[72:75], v44 offset:49152
ds_read_b128 v[76:79], v44 offset:53248
v_mfma_f32_32x32x16_bf16 a[48:63], v[92:95], v[100:103], a[48:63]
ds_read_b128 v[80:83], v48 offset:49152
ds_read_b128 v[84:87], v48 offset:53248
v_mfma_f32_32x32x16_bf16 a[64:79], v[88:91], v[104:107], a[64:79]
s_add_u32 m0, s49, 32768
s_nop 0
buffer_load_dwordx4 v5, s[20:23], s46 offen offset:0 lds
v_mfma_f32_32x32x16_bf16 a[80:95], v[92:95], v[104:107], a[80:95]
v_mfma_f32_32x32x16_bf16 a[96:111], v[88:91], v[108:111], a[96:111]
buffer_load_dwordx4 v5, s[20:23], s46 offen offset:1024 lds
v_mfma_f32_32x32x16_bf16 a[112:127], v[92:95], v[108:111], a[112:127]
s_waitcnt lgkmcnt(0)
v_mfma_f32_32x32x16_bf16 a[0:15], v[64:67], v[72:75], a[0:15]
ds_read_b64_tr_b16 v[88:89], v54 offset:4096
ds_read_b64_tr_b16 v[90:91], v54 offset:5120
v_mfma_f32_32x32x16_bf16 a[16:31], v[68:71], v[72:75], a[16:31]
ds_read_b64_tr_b16 v[92:93], v55 offset:4096
ds_read_b64_tr_b16 v[94:95], v55 offset:5120
v_mfma_f32_32x32x16_bf16 a[32:47], v[64:67], v[76:79], a[32:47]
ds_read_b128 v[96:99], v45 offset:49152
ds_read_b128 v[100:103], v45 offset:53248
v_mfma_f32_32x32x16_bf16 a[48:63], v[68:71], v[76:79], a[48:63]
ds_read_b128 v[104:107], v49 offset:49152
ds_read_b128 v[108:111], v49 offset:53248
v_mfma_f32_32x32x16_bf16 a[64:79], v[64:67], v[80:83], a[64:79]
buffer_load_dwordx4 v5, s[20:23], s46 offen offset:2048 lds
v_mfma_f32_32x32x16_bf16 a[80:95], v[68:71], v[80:83], a[80:95]
buffer_load_dwordx4 v5, s[20:23], s46 offen offset:3072 lds
v_mfma_f32_32x32x16_bf16 a[96:111], v[64:67], v[84:87], a[96:111]
s_add_u32 m0, s49, 36864
s_add_u32 s46, s46, 4096
buffer_load_dwordx4 v5, s[20:23], s46 offen offset:0 lds
v_mfma_f32_32x32x16_bf16 a[112:127], v[68:71], v[84:87], a[112:127]
s_waitcnt lgkmcnt(0)
v_mfma_f32_32x32x16_bf16 a[0:15], v[88:91], v[96:99], a[0:15]
ds_read_b64_tr_b16 v[64:65], v54 offset:8192
ds_read_b64_tr_b16 v[66:67], v54 offset:9216
v_mfma_f32_32x32x16_bf16 a[16:31], v[92:95], v[96:99], a[16:31]
ds_read_b64_tr_b16 v[68:69], v55 offset:8192
ds_read_b64_tr_b16 v[70:71], v55 offset:9216
v_mfma_f32_32x32x16_bf16 a[32:47], v[88:91], v[100:103], a[32:47]
ds_read_b128 v[72:75], v46 offset:49152
ds_read_b128 v[76:79], v46 offset:53248
v_mfma_f32_32x32x16_bf16 a[48:63], v[92:95], v[100:103], a[48:63]
ds_read_b128 v[80:83], v50 offset:49152
ds_read_b128 v[84:87], v50 offset:53248
v_mfma_f32_32x32x16_bf16 a[64:79], v[88:91], v[104:107], a[64:79]
buffer_load_dwordx4 v5, s[20:23], s46 offen offset:1024 lds
v_mfma_f32_32x32x16_bf16 a[80:95], v[92:95], v[104:107], a[80:95]
buffer_load_dwordx4 v5, s[20:23], s46 offen offset:2048 lds
v_mfma_f32_32x32x16_bf16 a[96:111], v[88:91], v[108:111], a[96:111]
buffer_load_dwordx4 v5, s[20:23], s46 offen offset:3072 lds
s_add_u32 s46, s46, 0x7000
v_mfma_f32_32x32x16_bf16 a[112:127], v[92:95], v[108:111], a[112:127]
s_waitcnt lgkmcnt(0)
v_mfma_f32_32x32x16_bf16 a[0:15], v[64:67], v[72:75], a[0:15]
ds_read_b64_tr_b16 v[88:89], v54 offset:12288
ds_read_b64_tr_b16 v[90:91], v54 offset:13312
v_mfma_f32_32x32x16_bf16 a[16:31], v[68:71], v[72:75], a[16:31]
ds_read_b64_tr_b16 v[92:93], v55 offset:12288
ds_read_b64_tr_b16 v[94:95], v55 offset:13312
v_mfma_f32_32x32x16_bf16 a[32:47], v[64:67], v[76:79], a[32:47]
ds_read_b128 v[96:99], v47 offset:49152
ds_read_b128 v[100:103], v47 offset:53248
v_mfma_f32_32x32x16_bf16 a[48:63], v[68:71], v[76:79], a[48:63]
ds_read_b128 v[104:107], v51 offset:49152
ds_read_b128 v[108:111], v51 offset:53248
v_mfma_f32_32x32x16_bf16 a[64:79], v[64:67], v[80:83], a[64:79]
v_mfma_f32_32x32x16_bf16 a[80:95], v[68:71], v[80:83], a[80:95]
v_mfma_f32_32x32x16_bf16 a[96:111], v[64:67], v[84:87], a[96:111]
v_mfma_f32_32x32x16_bf16 a[112:127], v[68:71], v[84:87], a[112:127]
s_waitcnt lgkmcnt(0)
s_barrier
v_mfma_f32_32x32x16_bf16 a[0:15], v[88:91], v[96:99], a[0:15]
v_mfma_f32_32x32x16_bf16 a[16:31], v[92:95], v[96:99], a[16:31]
v_mfma_f32_32x32x16_bf16 a[32:47], v[88:91], v[100:103], a[32:47]
v_mfma_f32_32x32x16_bf16 a[48:63], v[92:95], v[100:103], a[48:63]
v_mfma_f32_32x32x16_bf16 a[64:79], v[88:91], v[104:107], a[64:79]
v_mfma_f32_32x32x16_bf16 a[80:95], v[92:95], v[104:107], a[80:95]
v_mfma_f32_32x32x16_bf16 a[96:111], v[88:91], v[108:111], a[96:111]
v_mfma_f32_32x32x16_bf16 a[112:127], v[92:95], v[108:111], a[112:127]
s_load_dwordx2 s[8:9], s[0:1], 56
s_load_dwordx2 s[12:13], s[0:1], 72
v_lshlrev_b32 v1, 4, v0
s_lshl_b32 s5, s3, 13
s_add_u32 s5, s5, 131072
v_add_u32 v2, s5, v1
s_lshl_b32 s5, s39, 13
s_add_u32 s6, s5, 131072
v_add_u32 v31, s6, v1
s_add_u32 s6, s5, 49152
v_add_u32 v3, s6, v1
v_add_u32 v32, 65536, v3
s_add_u32 s6, s49, 49152
v_add_u32 v1, s6, v1
s_mov_b32 s5, 0x3e0293ee
s_nop 5
v_accvgpr_read_b32 v64, a0
v_accvgpr_read_b32 v65, a1
v_accvgpr_read_b32 v66, a2
v_accvgpr_read_b32 v67, a3
v_accvgpr_read_b32 v68, a4
v_accvgpr_read_b32 v69, a5
v_accvgpr_read_b32 v70, a6
v_accvgpr_read_b32 v71, a7
v_accvgpr_read_b32 v72, a8
v_accvgpr_read_b32 v73, a9
v_accvgpr_read_b32 v74, a10
v_accvgpr_read_b32 v75, a11
v_accvgpr_read_b32 v76, a12
v_accvgpr_read_b32 v77, a13
v_accvgpr_read_b32 v78, a14
v_accvgpr_read_b32 v79, a15
v_accvgpr_read_b32 v80, a16
v_accvgpr_read_b32 v81, a17
v_accvgpr_read_b32 v82, a18
v_accvgpr_read_b32 v83, a19
v_accvgpr_read_b32 v84, a20
v_accvgpr_read_b32 v85, a21
v_accvgpr_read_b32 v86, a22
v_accvgpr_read_b32 v87, a23
v_accvgpr_read_b32 v88, a24
v_accvgpr_read_b32 v89, a25
v_accvgpr_read_b32 v90, a26
v_accvgpr_read_b32 v91, a27
v_accvgpr_read_b32 v92, a28
v_accvgpr_read_b32 v93, a29
v_accvgpr_read_b32 v94, a30
v_accvgpr_read_b32 v95, a31
v_mul_f32 v64, s5, v64
v_mul_f32 v65, s5, v65
v_mul_f32 v66, s5, v66
v_mul_f32 v67, s5, v67
v_mul_f32 v68, s5, v68
v_mul_f32 v69, s5, v69
v_mul_f32 v70, s5, v70
v_mul_f32 v71, s5, v71
v_mul_f32 v72, s5, v72
v_mul_f32 v73, s5, v73
v_mul_f32 v74, s5, v74
v_mul_f32 v75, s5, v75
v_mul_f32 v76, s5, v76
v_mul_f32 v77, s5, v77
v_mul_f32 v78, s5, v78
v_mul_f32 v79, s5, v79
v_mul_f32 v80, s5, v80
v_mul_f32 v81, s5, v81
v_mul_f32 v82, s5, v82
v_mul_f32 v83, s5, v83
v_mul_f32 v84, s5, v84
v_mul_f32 v85, s5, v85
v_mul_f32 v86, s5, v86
v_mul_f32 v87, s5, v87
v_mul_f32 v88, s5, v88
v_mul_f32 v89, s5, v89
v_mul_f32 v90, s5, v90
v_mul_f32 v91, s5, v91
v_mul_f32 v92, s5, v92
v_mul_f32 v93, s5, v93
v_mul_f32 v94, s5, v94
v_mul_f32 v95, s5, v95
v_cvt_pk_bf16_f32 v96, v64, v65
v_cvt_pk_bf16_f32 v97, v66, v67
v_cvt_pk_bf16_f32 v98, v68, v69
v_cvt_pk_bf16_f32 v99, v70, v71
v_cvt_pk_bf16_f32 v100, v72, v73
v_cvt_pk_bf16_f32 v101, v74, v75
v_cvt_pk_bf16_f32 v102, v76, v77
v_cvt_pk_bf16_f32 v103, v78, v79
v_cvt_pk_bf16_f32 v104, v80, v81
v_cvt_pk_bf16_f32 v105, v82, v83
v_cvt_pk_bf16_f32 v106, v84, v85
v_cvt_pk_bf16_f32 v107, v86, v87
v_cvt_pk_bf16_f32 v108, v88, v89
v_cvt_pk_bf16_f32 v109, v90, v91
v_cvt_pk_bf16_f32 v110, v92, v93
v_cvt_pk_bf16_f32 v111, v94, v95
ds_write_b128 v1, v[96:99] offset:0
ds_write_b128 v1, v[100:103] offset:1024
ds_write_b128 v1, v[104:107] offset:2048
ds_write_b128 v1, v[108:111] offset:3072
v_accvgpr_read_b32 v64, a32
v_accvgpr_read_b32 v65, a33
v_accvgpr_read_b32 v66, a34
v_accvgpr_read_b32 v67, a35
v_accvgpr_read_b32 v68, a36
v_accvgpr_read_b32 v69, a37
v_accvgpr_read_b32 v70, a38
v_accvgpr_read_b32 v71, a39
v_accvgpr_read_b32 v72, a40
v_accvgpr_read_b32 v73, a41
v_accvgpr_read_b32 v74, a42
v_accvgpr_read_b32 v75, a43
v_accvgpr_read_b32 v76, a44
v_accvgpr_read_b32 v77, a45
v_accvgpr_read_b32 v78, a46
v_accvgpr_read_b32 v79, a47
v_accvgpr_read_b32 v80, a48
v_accvgpr_read_b32 v81, a49
v_accvgpr_read_b32 v82, a50
v_accvgpr_read_b32 v83, a51
v_accvgpr_read_b32 v84, a52
v_accvgpr_read_b32 v85, a53
v_accvgpr_read_b32 v86, a54
v_accvgpr_read_b32 v87, a55
v_accvgpr_read_b32 v88, a56
v_accvgpr_read_b32 v89, a57
v_accvgpr_read_b32 v90, a58
v_accvgpr_read_b32 v91, a59
v_accvgpr_read_b32 v92, a60
v_accvgpr_read_b32 v93, a61
v_accvgpr_read_b32 v94, a62
v_accvgpr_read_b32 v95, a63
v_mul_f32 v64, s5, v64
v_mul_f32 v65, s5, v65
v_mul_f32 v66, s5, v66
v_mul_f32 v67, s5, v67
v_mul_f32 v68, s5, v68
v_mul_f32 v69, s5, v69
v_mul_f32 v70, s5, v70
v_mul_f32 v71, s5, v71
v_mul_f32 v72, s5, v72
v_mul_f32 v73, s5, v73
v_mul_f32 v74, s5, v74
v_mul_f32 v75, s5, v75
v_mul_f32 v76, s5, v76
v_mul_f32 v77, s5, v77
v_mul_f32 v78, s5, v78
v_mul_f32 v79, s5, v79
v_mul_f32 v80, s5, v80
v_mul_f32 v81, s5, v81
v_mul_f32 v82, s5, v82
v_mul_f32 v83, s5, v83
v_mul_f32 v84, s5, v84
v_mul_f32 v85, s5, v85
v_mul_f32 v86, s5, v86
v_mul_f32 v87, s5, v87
v_mul_f32 v88, s5, v88
v_mul_f32 v89, s5, v89
v_mul_f32 v90, s5, v90
v_mul_f32 v91, s5, v91
v_mul_f32 v92, s5, v92
v_mul_f32 v93, s5, v93
v_mul_f32 v94, s5, v94
v_mul_f32 v95, s5, v95
v_cvt_pk_bf16_f32 v112, v64, v65
v_cvt_pk_bf16_f32 v113, v66, v67
v_cvt_pk_bf16_f32 v114, v68, v69
v_cvt_pk_bf16_f32 v115, v70, v71
v_cvt_pk_bf16_f32 v116, v72, v73
v_cvt_pk_bf16_f32 v117, v74, v75
v_cvt_pk_bf16_f32 v118, v76, v77
v_cvt_pk_bf16_f32 v119, v78, v79
v_cvt_pk_bf16_f32 v120, v80, v81
v_cvt_pk_bf16_f32 v121, v82, v83
v_cvt_pk_bf16_f32 v122, v84, v85
v_cvt_pk_bf16_f32 v123, v86, v87
v_cvt_pk_bf16_f32 v124, v88, v89
v_cvt_pk_bf16_f32 v125, v90, v91
v_cvt_pk_bf16_f32 v126, v92, v93
v_cvt_pk_bf16_f32 v127, v94, v95
ds_write_b128 v1, v[112:115] offset:4096
ds_write_b128 v1, v[116:119] offset:5120
ds_write_b128 v1, v[120:123] offset:6144
ds_write_b128 v1, v[124:127] offset:7168
v_accvgpr_read_b32 v64, a64
v_accvgpr_read_b32 v65, a65
v_accvgpr_read_b32 v66, a66
v_accvgpr_read_b32 v67, a67
v_accvgpr_read_b32 v68, a68
v_accvgpr_read_b32 v69, a69
v_accvgpr_read_b32 v70, a70
v_accvgpr_read_b32 v71, a71
v_accvgpr_read_b32 v72, a72
v_accvgpr_read_b32 v73, a73
v_accvgpr_read_b32 v74, a74
v_accvgpr_read_b32 v75, a75
v_accvgpr_read_b32 v76, a76
v_accvgpr_read_b32 v77, a77
v_accvgpr_read_b32 v78, a78
v_accvgpr_read_b32 v79, a79
v_accvgpr_read_b32 v80, a80
v_accvgpr_read_b32 v81, a81
v_accvgpr_read_b32 v82, a82
v_accvgpr_read_b32 v83, a83
v_accvgpr_read_b32 v84, a84
v_accvgpr_read_b32 v85, a85
v_accvgpr_read_b32 v86, a86
v_accvgpr_read_b32 v87, a87
v_accvgpr_read_b32 v88, a88
v_accvgpr_read_b32 v89, a89
v_accvgpr_read_b32 v90, a90
v_accvgpr_read_b32 v91, a91
v_accvgpr_read_b32 v92, a92
v_accvgpr_read_b32 v93, a93
v_accvgpr_read_b32 v94, a94
v_accvgpr_read_b32 v95, a95
v_mul_f32 v64, s5, v64
v_mul_f32 v65, s5, v65
v_mul_f32 v66, s5, v66
v_mul_f32 v67, s5, v67
v_mul_f32 v68, s5, v68
v_mul_f32 v69, s5, v69
v_mul_f32 v70, s5, v70
v_mul_f32 v71, s5, v71
v_mul_f32 v72, s5, v72
v_mul_f32 v73, s5, v73
v_mul_f32 v74, s5, v74
v_mul_f32 v75, s5, v75
v_mul_f32 v76, s5, v76
v_mul_f32 v77, s5, v77
v_mul_f32 v78, s5, v78
v_mul_f32 v79, s5, v79
v_mul_f32 v80, s5, v80
v_mul_f32 v81, s5, v81
v_mul_f32 v82, s5, v82
v_mul_f32 v83, s5, v83
v_mul_f32 v84, s5, v84
v_mul_f32 v85, s5, v85
v_mul_f32 v86, s5, v86
v_mul_f32 v87, s5, v87
v_mul_f32 v88, s5, v88
v_mul_f32 v89, s5, v89
v_mul_f32 v90, s5, v90
v_mul_f32 v91, s5, v91
v_mul_f32 v92, s5, v92
v_mul_f32 v93, s5, v93
v_mul_f32 v94, s5, v94
v_mul_f32 v95, s5, v95
v_cvt_pk_bf16_f32 v128, v64, v65
v_cvt_pk_bf16_f32 v129, v66, v67
v_cvt_pk_bf16_f32 v130, v68, v69
v_cvt_pk_bf16_f32 v131, v70, v71
v_cvt_pk_bf16_f32 v132, v72, v73
v_cvt_pk_bf16_f32 v133, v74, v75
v_cvt_pk_bf16_f32 v134, v76, v77
v_cvt_pk_bf16_f32 v135, v78, v79
v_cvt_pk_bf16_f32 v136, v80, v81
v_cvt_pk_bf16_f32 v137, v82, v83
v_cvt_pk_bf16_f32 v138, v84, v85
v_cvt_pk_bf16_f32 v139, v86, v87
v_cvt_pk_bf16_f32 v140, v88, v89
v_cvt_pk_bf16_f32 v141, v90, v91
v_cvt_pk_bf16_f32 v142, v92, v93
v_cvt_pk_bf16_f32 v143, v94, v95
ds_write_b128 v2, v[128:131] offset:0
ds_write_b128 v2, v[132:135] offset:1024
ds_write_b128 v2, v[136:139] offset:2048
ds_write_b128 v2, v[140:143] offset:3072
v_accvgpr_read_b32 v64, a96
v_accvgpr_read_b32 v65, a97
v_accvgpr_read_b32 v66, a98
v_accvgpr_read_b32 v67, a99
v_accvgpr_read_b32 v68, a100
v_accvgpr_read_b32 v69, a101
v_accvgpr_read_b32 v70, a102
v_accvgpr_read_b32 v71, a103
v_accvgpr_read_b32 v72, a104
v_accvgpr_read_b32 v73, a105
v_accvgpr_read_b32 v74, a106
v_accvgpr_read_b32 v75, a107
v_accvgpr_read_b32 v76, a108
v_accvgpr_read_b32 v77, a109
v_accvgpr_read_b32 v78, a110
v_accvgpr_read_b32 v79, a111
v_accvgpr_read_b32 v80, a112
v_accvgpr_read_b32 v81, a113
v_accvgpr_read_b32 v82, a114
v_accvgpr_read_b32 v83, a115
v_accvgpr_read_b32 v84, a116
v_accvgpr_read_b32 v85, a117
v_accvgpr_read_b32 v86, a118
v_accvgpr_read_b32 v87, a119
v_accvgpr_read_b32 v88, a120
v_accvgpr_read_b32 v89, a121
v_accvgpr_read_b32 v90, a122
v_accvgpr_read_b32 v91, a123
v_accvgpr_read_b32 v92, a124
v_accvgpr_read_b32 v93, a125
v_accvgpr_read_b32 v94, a126
v_accvgpr_read_b32 v95, a127
v_mul_f32 v64, s5, v64
v_mul_f32 v65, s5, v65
v_mul_f32 v66, s5, v66
v_mul_f32 v67, s5, v67
v_mul_f32 v68, s5, v68
v_mul_f32 v69, s5, v69
v_mul_f32 v70, s5, v70
v_mul_f32 v71, s5, v71
v_mul_f32 v72, s5, v72
v_mul_f32 v73, s5, v73
v_mul_f32 v74, s5, v74
v_mul_f32 v75, s5, v75
v_mul_f32 v76, s5, v76
v_mul_f32 v77, s5, v77
v_mul_f32 v78, s5, v78
v_mul_f32 v79, s5, v79
v_mul_f32 v80, s5, v80
v_mul_f32 v81, s5, v81
v_mul_f32 v82, s5, v82
v_mul_f32 v83, s5, v83
v_mul_f32 v84, s5, v84
v_mul_f32 v85, s5, v85
v_mul_f32 v86, s5, v86
v_mul_f32 v87, s5, v87
v_mul_f32 v88, s5, v88
v_mul_f32 v89, s5, v89
v_mul_f32 v90, s5, v90
v_mul_f32 v91, s5, v91
v_mul_f32 v92, s5, v92
v_mul_f32 v93, s5, v93
v_mul_f32 v94, s5, v94
v_mul_f32 v95, s5, v95
v_cvt_pk_bf16_f32 v144, v64, v65
v_cvt_pk_bf16_f32 v145, v66, v67
v_cvt_pk_bf16_f32 v146, v68, v69
v_cvt_pk_bf16_f32 v147, v70, v71
v_cvt_pk_bf16_f32 v148, v72, v73
v_cvt_pk_bf16_f32 v149, v74, v75
v_cvt_pk_bf16_f32 v150, v76, v77
v_cvt_pk_bf16_f32 v151, v78, v79
v_cvt_pk_bf16_f32 v152, v80, v81
v_cvt_pk_bf16_f32 v153, v82, v83
v_cvt_pk_bf16_f32 v154, v84, v85
v_cvt_pk_bf16_f32 v155, v86, v87
v_cvt_pk_bf16_f32 v156, v88, v89
v_cvt_pk_bf16_f32 v157, v90, v91
v_cvt_pk_bf16_f32 v158, v92, v93
v_cvt_pk_bf16_f32 v159, v94, v95
ds_write_b128 v2, v[144:147] offset:4096
ds_write_b128 v2, v[148:151] offset:5120
ds_write_b128 v2, v[152:155] offset:6144
ds_write_b128 v2, v[156:159] offset:7168
s_waitcnt lgkmcnt(0)
s_mov_b32 s10, 0x1200000
s_mov_b32 s11, 0x00020000
s_mov_b32 s14, 0x1200000
s_mov_b32 s15, 0x00020000
s_mul_i32 s61, s2, 73728
s_add_u32 s62, s61, 69632
s_add_u32 s61, s61, s50
s_mov_b32 s60, s61
s_waitcnt vmcnt(16)
s_barrier
ds_read_b128 a[128:131], v3 offset:0
ds_read_b128 a[132:135], v3 offset:1024
ds_read_b128 a[136:139], v3 offset:2048
ds_read_b128 a[140:143], v3 offset:3072
ds_read_b128 a[144:147], v32 offset:0
ds_read_b128 a[148:151], v32 offset:1024
ds_read_b128 a[152:155], v32 offset:2048
ds_read_b128 a[156:159], v32 offset:3072
ds_read_b128 a[160:163], v3 offset:4096
ds_read_b128 a[164:167], v3 offset:5120
ds_read_b128 a[168:171], v3 offset:6144
ds_read_b128 a[172:175], v3 offset:7168
ds_read_b128 a[176:179], v32 offset:4096
ds_read_b128 a[180:183], v32 offset:5120
ds_read_b128 a[184:187], v32 offset:6144
ds_read_b128 a[188:191], v32 offset:7168
at_blk:
s_add_u32 s40, s37, 1
s_sub_u32 s47, s37, 1
s_mov_b32 s48, s37
ds_read_b128 v[224:227], v4 offset:0
ds_read_b128 v[228:231], v4 offset:1024
ds_read_b128 v[232:235], v4 offset:2048
ds_read_b128 v[236:239], v4 offset:3072
ds_read_b128 v[240:243], v4 offset:4096
ds_read_b128 v[244:247], v4 offset:5120
ds_read_b128 v[248:251], v4 offset:6144
ds_read_b128 v[252:255], v4 offset:7168
v_mov_b32 v24, 0
v_mov_b32 v25, 0
v_lshlrev_b32 v2, 6, v0
s_waitcnt lgkmcnt(7)
v_mfma_f32_32x32x16_bf16 v[96:111], v[224:227], a[128:131], 0
v_accvgpr_write_b32 a0, 0
v_accvgpr_write_b32 a1, 0
v_accvgpr_write_b32 a2, 0
v_accvgpr_write_b32 a3, 0
v_mfma_f32_32x32x16_bf16 v[128:143], v[224:227], a[160:163], 0
v_accvgpr_write_b32 a4, 0
v_accvgpr_write_b32 a5, 0
v_accvgpr_write_b32 a6, 0
v_accvgpr_write_b32 a7, 0
s_waitcnt lgkmcnt(6)
v_mfma_f32_32x32x16_bf16 v[96:111], v[228:231], a[132:135], v[96:111]
ds_read_b128 v[224:227], v4 offset:8192
v_accvgpr_write_b32 a8, 0
v_accvgpr_write_b32 a9, 0
v_accvgpr_write_b32 a10, 0
v_accvgpr_write_b32 a11, 0
v_mfma_f32_32x32x16_bf16 v[128:143], v[228:231], a[164:167], v[128:143]
v_accvgpr_write_b32 a12, 0
v_accvgpr_write_b32 a13, 0
v_accvgpr_write_b32 a14, 0
v_accvgpr_write_b32 a15, 0
s_waitcnt lgkmcnt(6)
v_mfma_f32_32x32x16_bf16 v[96:111], v[232:235], a[136:139], v[96:111]
ds_read_b128 v[228:231], v4 offset:9216
v_accvgpr_write_b32 a16, 0
v_accvgpr_write_b32 a17, 0
v_accvgpr_write_b32 a18, 0
v_accvgpr_write_b32 a19, 0
v_mfma_f32_32x32x16_bf16 v[128:143], v[232:235], a[168:171], v[128:143]
v_accvgpr_write_b32 a20, 0
v_accvgpr_write_b32 a21, 0
v_accvgpr_write_b32 a22, 0
v_accvgpr_write_b32 a23, 0
s_waitcnt lgkmcnt(6)
v_mfma_f32_32x32x16_bf16 v[96:111], v[236:239], a[140:143], v[96:111]
ds_read_b128 v[232:235], v4 offset:10240
v_accvgpr_write_b32 a24, 0
v_accvgpr_write_b32 a25, 0
v_accvgpr_write_b32 a26, 0
v_accvgpr_write_b32 a27, 0
v_mfma_f32_32x32x16_bf16 v[128:143], v[236:239], a[172:175], v[128:143]
v_accvgpr_write_b32 a28, 0
v_accvgpr_write_b32 a29, 0
v_accvgpr_write_b32 a30, 0
v_accvgpr_write_b32 a31, 0
s_waitcnt lgkmcnt(6)
v_mfma_f32_32x32x16_bf16 v[96:111], v[240:243], a[144:147], v[96:111]
ds_read_b128 v[236:239], v4 offset:11264
v_accvgpr_write_b32 a32, 0
v_accvgpr_write_b32 a33, 0
v_accvgpr_write_b32 a34, 0
v_accvgpr_write_b32 a35, 0
v_mfma_f32_32x32x16_bf16 v[128:143], v[240:243], a[176:179], v[128:143]
v_accvgpr_write_b32 a36, 0
v_accvgpr_write_b32 a37, 0
v_accvgpr_write_b32 a38, 0
v_accvgpr_write_b32 a39, 0
s_waitcnt lgkmcnt(6)
v_mfma_f32_32x32x16_bf16 v[96:111], v[244:247], a[148:151], v[96:111]
ds_read_b128 v[240:243], v4 offset:12288
v_accvgpr_write_b32 a40, 0
v_accvgpr_write_b32 a41, 0
v_accvgpr_write_b32 a42, 0
v_accvgpr_write_b32 a43, 0
v_mfma_f32_32x32x16_bf16 v[128:143], v[244:247], a[180:183], v[128:143]
v_accvgpr_write_b32 a44, 0
v_accvgpr_write_b32 a45, 0
v_accvgpr_write_b32 a46, 0
v_accvgpr_write_b32 a47, 0
s_waitcnt lgkmcnt(6)
v_mfma_f32_32x32x16_bf16 v[96:111], v[248:251], a[152:155], v[96:111]
ds_read_b128 v[244:247], v4 offset:13312
v_accvgpr_write_b32 a48, 0
v_accvgpr_write_b32 a49, 0
v_accvgpr_write_b32 a50, 0
v_accvgpr_write_b32 a51, 0
v_mfma_f32_32x32x16_bf16 v[128:143], v[248:251], a[184:187], v[128:143]
v_accvgpr_write_b32 a52, 0
v_accvgpr_write_b32 a53, 0
v_accvgpr_write_b32 a54, 0
v_accvgpr_write_b32 a55, 0
s_waitcnt lgkmcnt(6)
v_mfma_f32_32x32x16_bf16 v[96:111], v[252:255], a[156:159], v[96:111]
ds_read_b128 v[248:251], v4 offset:14336
v_accvgpr_write_b32 a56, 0
v_accvgpr_write_b32 a57, 0
v_accvgpr_write_b32 a58, 0
v_accvgpr_write_b32 a59, 0
v_mfma_f32_32x32x16_bf16 v[128:143], v[252:255], a[188:191], v[128:143]
v_accvgpr_write_b32 a60, 0
v_accvgpr_write_b32 a61, 0
v_accvgpr_write_b32 a62, 0
v_accvgpr_write_b32 a63, 0
s_waitcnt lgkmcnt(6)
v_mfma_f32_32x32x16_bf16 v[112:127], v[224:227], a[128:131], 0
ds_read_b128 v[252:255], v4 offset:15360
v_accvgpr_write_b32 a64, 0
v_accvgpr_write_b32 a65, 0
v_accvgpr_write_b32 a66, 0
v_accvgpr_write_b32 a67, 0
v_mfma_f32_32x32x16_bf16 v[144:159], v[224:227], a[160:163], 0
v_accvgpr_write_b32 a68, 0
v_accvgpr_write_b32 a69, 0
v_accvgpr_write_b32 a70, 0
v_accvgpr_write_b32 a71, 0
s_waitcnt lgkmcnt(6)
v_mfma_f32_32x32x16_bf16 v[112:127], v[228:231], a[132:135], v[112:127]
v_accvgpr_write_b32 a72, 0
v_accvgpr_write_b32 a73, 0
v_accvgpr_write_b32 a74, 0
v_accvgpr_write_b32 a75, 0
v_mfma_f32_32x32x16_bf16 v[144:159], v[228:231], a[164:167], v[144:159]
v_accvgpr_write_b32 a76, 0
v_accvgpr_write_b32 a77, 0
v_accvgpr_write_b32 a78, 0
v_accvgpr_write_b32 a79, 0
s_waitcnt lgkmcnt(5)
v_mfma_f32_32x32x16_bf16 v[112:127], v[232:235], a[136:139], v[112:127]
v_accvgpr_write_b32 a80, 0
v_accvgpr_write_b32 a81, 0
v_accvgpr_write_b32 a82, 0
v_accvgpr_write_b32 a83, 0
v_mfma_f32_32x32x16_bf16 v[144:159], v[232:235], a[168:171], v[144:159]
v_accvgpr_write_b32 a84, 0
v_accvgpr_write_b32 a85, 0
v_accvgpr_write_b32 a86, 0
v_accvgpr_write_b32 a87, 0
s_waitcnt lgkmcnt(4)
v_mfma_f32_32x32x16_bf16 v[112:127], v[236:239], a[140:143], v[112:127]
v_accvgpr_write_b32 a88, 0
v_accvgpr_write_b32 a89, 0
v_accvgpr_write_b32 a90, 0
v_accvgpr_write_b32 a91, 0
v_mfma_f32_32x32x16_bf16 v[144:159], v[236:239], a[172:175], v[144:159]
v_accvgpr_write_b32 a92, 0
v_accvgpr_write_b32 a93, 0
v_accvgpr_write_b32 a94, 0
v_accvgpr_write_b32 a95, 0
s_waitcnt lgkmcnt(3)
v_mfma_f32_32x32x16_bf16 v[112:127], v[240:243], a[144:147], v[112:127]
v_accvgpr_write_b32 a96, 0
v_accvgpr_write_b32 a97, 0
v_accvgpr_write_b32 a98, 0
v_accvgpr_write_b32 a99, 0
v_mfma_f32_32x32x16_bf16 v[144:159], v[240:243], a[176:179], v[144:159]
v_accvgpr_write_b32 a100, 0
v_accvgpr_write_b32 a101, 0
v_accvgpr_write_b32 a102, 0
v_accvgpr_write_b32 a103, 0
s_waitcnt lgkmcnt(2)
v_mfma_f32_32x32x16_bf16 v[112:127], v[244:247], a[148:151], v[112:127]
v_accvgpr_write_b32 a104, 0
v_accvgpr_write_b32 a105, 0
v_accvgpr_write_b32 a106, 0
v_accvgpr_write_b32 a107, 0
v_mfma_f32_32x32x16_bf16 v[144:159], v[244:247], a[180:183], v[144:159]
v_accvgpr_write_b32 a108, 0
v_accvgpr_write_b32 a109, 0
v_accvgpr_write_b32 a110, 0
v_accvgpr_write_b32 a111, 0
s_waitcnt lgkmcnt(1)
v_mfma_f32_32x32x16_bf16 v[112:127], v[248:251], a[152:155], v[112:127]
v_accvgpr_write_b32 a112, 0
v_accvgpr_write_b32 a113, 0
v_accvgpr_write_b32 a114, 0
v_accvgpr_write_b32 a115, 0
v_mfma_f32_32x32x16_bf16 v[144:159], v[248:251], a[184:187], v[144:159]
v_accvgpr_write_b32 a116, 0
v_accvgpr_write_b32 a117, 0
v_accvgpr_write_b32 a118, 0
v_accvgpr_write_b32 a119, 0
s_waitcnt lgkmcnt(0)
v_mfma_f32_32x32x16_bf16 v[112:127], v[252:255], a[156:159], v[112:127]
v_accvgpr_write_b32 a120, 0
v_accvgpr_write_b32 a121, 0
v_accvgpr_write_b32 a122, 0
v_accvgpr_write_b32 a123, 0
v_mfma_f32_32x32x16_bf16 v[144:159], v[252:255], a[188:191], v[144:159]
v_accvgpr_write_b32 a124, 0
v_accvgpr_write_b32 a125, 0
v_accvgpr_write_b32 a126, 0
v_accvgpr_write_b32 a127, 0
s_waitcnt vmcnt(0)
s_barrier
ds_read_b128 v[224:227], v4 offset:16384
ds_read_b128 v[228:231], v4 offset:17408
ds_read_b128 v[232:235], v4 offset:18432
ds_read_b128 v[236:239], v4 offset:19456
ds_read_b128 v[240:243], v4 offset:20480
ds_read_b128 v[244:247], v4 offset:21504
s_cmp_lt_i32 s47, 1
s_cbranch_scc1 L_11
s_add_u32 m0, s49, 0
s_nop 0
buffer_load_dwordx4 v5, s[16:19], s45 offen offset:0 lds
buffer_load_dwordx4 v5, s[16:19], s45 offen offset:1024 lds
buffer_load_dwordx4 v5, s[16:19], s45 offen offset:2048 lds
buffer_load_dwordx4 v5, s[16:19], s45 offen offset:3072 lds
s_add_u32 m0, s49, 4096
s_add_u32 s45, s45, 4096
buffer_load_dwordx4 v5, s[16:19], s45 offen offset:0 lds
buffer_load_dwordx4 v5, s[16:19], s45 offen offset:1024 lds
buffer_load_dwordx4 v5, s[16:19], s45 offen offset:2048 lds
buffer_load_dwordx4 v5, s[16:19], s45 offen offset:3072 lds
s_add_u32 s45, s45, 0x7000
L_11:
s_sub_u32 s47, s47, 1
s_nop 2
s_cmp_lg_u32 s40, 1
s_cbranch_scc1 L_12
v_mov_b32 v28, 0xce6e6b28
v_add_u32 v27, 32, v29
v_cmp_gt_i32 s[52:53], 0, v29
v_cmp_gt_i32 s[54:55], 1, v29
v_cmp_gt_i32 s[56:57], 2, v29
v_cmp_gt_i32 s[58:59], 3, v29
v_cndmask_b32 v96, v96, v28, s[52:53]
v_cndmask_b32 v97, v97, v28, s[54:55]
v_cndmask_b32 v98, v98, v28, s[56:57]
v_cndmask_b32 v99, v99, v28, s[58:59]
v_cmp_gt_i32 s[52:53], 8, v29
v_cmp_gt_i32 s[54:55], 9, v29
v_cmp_gt_i32 s[56:57], 10, v29
v_cmp_gt_i32 s[58:59], 11, v29
v_cndmask_b32 v100, v100, v28, s[52:53]
v_cndmask_b32 v101, v101, v28, s[54:55]
v_cndmask_b32 v102, v102, v28, s[56:57]
v_cndmask_b32 v103, v103, v28, s[58:59]
v_cmp_gt_i32 s[52:53], 16, v29
v_cmp_gt_i32 s[54:55], 17, v29
v_cmp_gt_i32 s[56:57], 18, v29
v_cmp_gt_i32 s[58:59], 19, v29
v_cndmask_b32 v104, v104, v28, s[52:53]
v_cndmask_b32 v105, v105, v28, s[54:55]
v_cndmask_b32 v106, v106, v28, s[56:57]
v_cndmask_b32 v107, v107, v28, s[58:59]
v_cmp_gt_i32 s[52:53], 24, v29
v_cmp_gt_i32 s[54:55], 25, v29
v_cmp_gt_i32 s[56:57], 26, v29
v_cmp_gt_i32 s[58:59], 27, v29
v_cndmask_b32 v108, v108, v28, s[52:53]
v_cndmask_b32 v109, v109, v28, s[54:55]
v_cndmask_b32 v110, v110, v28, s[56:57]
v_cndmask_b32 v111, v111, v28, s[58:59]
v_cmp_gt_i32 s[52:53], 32, v29
v_cmp_gt_i32 s[54:55], 33, v29
v_cmp_gt_i32 s[56:57], 34, v29
v_cmp_gt_i32 s[58:59], 35, v29
v_cndmask_b32 v112, v112, v28, s[52:53]
v_cndmask_b32 v113, v113, v28, s[54:55]
v_cndmask_b32 v114, v114, v28, s[56:57]
v_cndmask_b32 v115, v115, v28, s[58:59]
v_cmp_gt_i32 s[52:53], 40, v29
v_cmp_gt_i32 s[54:55], 41, v29
v_cmp_gt_i32 s[56:57], 42, v29
v_cmp_gt_i32 s[58:59], 43, v29
v_cndmask_b32 v116, v116, v28, s[52:53]
v_cndmask_b32 v117, v117, v28, s[54:55]
v_cndmask_b32 v118, v118, v28, s[56:57]
v_cndmask_b32 v119, v119, v28, s[58:59]
v_cmp_gt_i32 s[52:53], 48, v29
v_cmp_gt_i32 s[54:55], 49, v29
v_cmp_gt_i32 s[56:57], 50, v29
v_cmp_gt_i32 s[58:59], 51, v29
v_cndmask_b32 v120, v120, v28, s[52:53]
v_cndmask_b32 v121, v121, v28, s[54:55]
v_cndmask_b32 v122, v122, v28, s[56:57]
v_cndmask_b32 v123, v123, v28, s[58:59]
v_cmp_gt_i32 s[52:53], 56, v29
v_cmp_gt_i32 s[54:55], 57, v29
v_cmp_gt_i32 s[56:57], 58, v29
v_cmp_gt_i32 s[58:59], 59, v29
v_cndmask_b32 v124, v124, v28, s[52:53]
v_cndmask_b32 v125, v125, v28, s[54:55]
v_cndmask_b32 v126, v126, v28, s[56:57]
v_cndmask_b32 v127, v127, v28, s[58:59]
v_cmp_gt_i32 s[52:53], 0, v27
v_cmp_gt_i32 s[54:55], 1, v27
v_cmp_gt_i32 s[56:57], 2, v27
v_cmp_gt_i32 s[58:59], 3, v27
v_cndmask_b32 v128, v128, v28, s[52:53]
v_cndmask_b32 v129, v129, v28, s[54:55]
v_cndmask_b32 v130, v130, v28, s[56:57]
v_cndmask_b32 v131, v131, v28, s[58:59]
v_cmp_gt_i32 s[52:53], 8, v27
v_cmp_gt_i32 s[54:55], 9, v27
v_cmp_gt_i32 s[56:57], 10, v27
v_cmp_gt_i32 s[58:59], 11, v27
v_cndmask_b32 v132, v132, v28, s[52:53]
v_cndmask_b32 v133, v133, v28, s[54:55]
v_cndmask_b32 v134, v134, v28, s[56:57]
v_cndmask_b32 v135, v135, v28, s[58:59]
v_cmp_gt_i32 s[52:53], 16, v27
v_cmp_gt_i32 s[54:55], 17, v27
v_cmp_gt_i32 s[56:57], 18, v27
v_cmp_gt_i32 s[58:59], 19, v27
v_cndmask_b32 v136, v136, v28, s[52:53]
v_cndmask_b32 v137, v137, v28, s[54:55]
v_cndmask_b32 v138, v138, v28, s[56:57]
v_cndmask_b32 v139, v139, v28, s[58:59]
v_cmp_gt_i32 s[52:53], 24, v27
v_cmp_gt_i32 s[54:55], 25, v27
v_cmp_gt_i32 s[56:57], 26, v27
v_cmp_gt_i32 s[58:59], 27, v27
v_cndmask_b32 v140, v140, v28, s[52:53]
v_cndmask_b32 v141, v141, v28, s[54:55]
v_cndmask_b32 v142, v142, v28, s[56:57]
v_cndmask_b32 v143, v143, v28, s[58:59]
v_cmp_gt_i32 s[52:53], 32, v27
v_cmp_gt_i32 s[54:55], 33, v27
v_cmp_gt_i32 s[56:57], 34, v27
v_cmp_gt_i32 s[58:59], 35, v27
v_cndmask_b32 v144, v144, v28, s[52:53]
v_cndmask_b32 v145, v145, v28, s[54:55]
v_cndmask_b32 v146, v146, v28, s[56:57]
v_cndmask_b32 v147, v147, v28, s[58:59]
v_cmp_gt_i32 s[52:53], 40, v27
v_cmp_gt_i32 s[54:55], 41, v27
v_cmp_gt_i32 s[56:57], 42, v27
v_cmp_gt_i32 s[58:59], 43, v27
v_cndmask_b32 v148, v148, v28, s[52:53]
v_cndmask_b32 v149, v149, v28, s[54:55]
v_cndmask_b32 v150, v150, v28, s[56:57]
v_cndmask_b32 v151, v151, v28, s[58:59]
v_cmp_gt_i32 s[52:53], 48, v27
v_cmp_gt_i32 s[54:55], 49, v27
v_cmp_gt_i32 s[56:57], 50, v27
v_cmp_gt_i32 s[58:59], 51, v27
v_cndmask_b32 v152, v152, v28, s[52:53]
v_cndmask_b32 v153, v153, v28, s[54:55]
v_cndmask_b32 v154, v154, v28, s[56:57]
v_cndmask_b32 v155, v155, v28, s[58:59]
v_cmp_gt_i32 s[52:53], 56, v27
v_cmp_gt_i32 s[54:55], 57, v27
v_cmp_gt_i32 s[56:57], 58, v27
v_cmp_gt_i32 s[58:59], 59, v27
v_cndmask_b32 v156, v156, v28, s[52:53]
v_cndmask_b32 v157, v157, v28, s[54:55]
v_cndmask_b32 v158, v158, v28, s[56:57]
v_cndmask_b32 v159, v159, v28, s[58:59]
L_12:
v_max3_f32 v27, v96, v97, v98
v_max3_f32 v28, v99, v100, v101
v_max3_f32 v27, v27, v102, v103
v_max3_f32 v28, v28, v104, v105
v_max3_f32 v27, v27, v106, v107
v_max3_f32 v28, v28, v108, v109
v_max3_f32 v27, v27, v110, v111
v_max3_f32 v28, v28, v112, v113
v_max3_f32 v27, v27, v114, v115
v_max3_f32 v28, v28, v116, v117
v_max3_f32 v27, v27, v118, v119
v_max3_f32 v28, v28, v120, v121
v_max3_f32 v27, v27, v122, v123
v_max3_f32 v28, v28, v124, v125
v_max3_f32 v27, v27, v126, v127
v_max_f32 v27, v27, v28
v_mov_b32 v28, v27
s_nop 1
v_permlane32_swap_b32 v28, v27
s_nop 1
v_max_f32 v27, v27, v28
v_mov_b32 v26, v27
v_sub_f32 v96, v96, v27
v_sub_f32 v97, v97, v27
v_sub_f32 v98, v98, v27
v_sub_f32 v99, v99, v27
v_sub_f32 v100, v100, v27
v_sub_f32 v101, v101, v27
v_sub_f32 v102, v102, v27
v_sub_f32 v103, v103, v27
v_sub_f32 v104, v104, v27
v_sub_f32 v105, v105, v27
v_sub_f32 v106, v106, v27
v_sub_f32 v107, v107, v27
v_sub_f32 v108, v108, v27
v_sub_f32 v109, v109, v27
v_sub_f32 v110, v110, v27
v_sub_f32 v111, v111, v27
v_sub_f32 v112, v112, v27
v_sub_f32 v113, v113, v27
v_sub_f32 v114, v114, v27
v_sub_f32 v115, v115, v27
v_sub_f32 v116, v116, v27
v_sub_f32 v117, v117, v27
v_sub_f32 v118, v118, v27
v_sub_f32 v119, v119, v27
v_sub_f32 v120, v120, v27
v_sub_f32 v121, v121, v27
v_sub_f32 v122, v122, v27
v_sub_f32 v123, v123, v27
v_sub_f32 v124, v124, v27
v_sub_f32 v125, v125, v27
v_sub_f32 v126, v126, v27
v_sub_f32 v127, v127, v27
v_sub_f32 v32, 0, v27
v_sub_f32 v33, 0, v27
v_sub_f32 v34, 0, v27
v_sub_f32 v35, 0, v27
v_sub_f32 v36, 0, v27
v_sub_f32 v37, 0, v27
v_sub_f32 v38, 0, v27
v_sub_f32 v39, 0, v27
v_sub_f32 v40, 0, v27
v_sub_f32 v41, 0, v27
v_sub_f32 v42, 0, v27
v_sub_f32 v43, 0, v27
v_sub_f32 v44, 0, v27
v_sub_f32 v45, 0, v27
v_sub_f32 v46, 0, v27
v_sub_f32 v47, 0, v27
v_max3_f32 v27, v128, v129, v130
v_max3_f32 v28, v131, v132, v133
v_max3_f32 v27, v27, v134, v135
v_max3_f32 v28, v28, v136, v137
v_max3_f32 v27, v27, v138, v139
v_max3_f32 v28, v28, v140, v141
v_max3_f32 v27, v27, v142, v143
v_max3_f32 v28, v28, v144, v145
v_max3_f32 v27, v27, v146, v147
v_max3_f32 v28, v28, v148, v149
v_max3_f32 v27, v27, v150, v151
v_max3_f32 v28, v28, v152, v153
v_max3_f32 v27, v27, v154, v155
v_max3_f32 v28, v28, v156, v157
v_max3_f32 v27, v27, v158, v159
v_max_f32 v27, v27, v28
v_mov_b32 v28, v27
s_nop 1
v_permlane32_swap_b32 v28, v27
s_nop 1
v_max_f32 v27, v27, v28
v_mov_b32 v3, v27
v_sub_f32 v128, v128, v27
v_sub_f32 v129, v129, v27
v_sub_f32 v130, v130, v27
v_sub_f32 v131, v131, v27
v_sub_f32 v132, v132, v27
v_sub_f32 v133, v133, v27
v_sub_f32 v134, v134, v27
v_sub_f32 v135, v135, v27
v_sub_f32 v136, v136, v27
v_sub_f32 v137, v137, v27
v_sub_f32 v138, v138, v27
v_sub_f32 v139, v139, v27
v_sub_f32 v140, v140, v27
v_sub_f32 v141, v141, v27
v_sub_f32 v142, v142, v27
v_sub_f32 v143, v143, v27
v_sub_f32 v144, v144, v27
v_sub_f32 v145, v145, v27
v_sub_f32 v146, v146, v27
v_sub_f32 v147, v147, v27
v_sub_f32 v148, v148, v27
v_sub_f32 v149, v149, v27
v_sub_f32 v150, v150, v27
v_sub_f32 v151, v151, v27
v_sub_f32 v152, v152, v27
v_sub_f32 v153, v153, v27
v_sub_f32 v154, v154, v27
v_sub_f32 v155, v155, v27
v_sub_f32 v156, v156, v27
v_sub_f32 v157, v157, v27
v_sub_f32 v158, v158, v27
v_sub_f32 v159, v159, v27
v_sub_f32 v48, 0, v27
v_sub_f32 v49, 0, v27
v_sub_f32 v50, 0, v27
v_sub_f32 v51, 0, v27
v_sub_f32 v52, 0, v27
v_sub_f32 v53, 0, v27
v_sub_f32 v54, 0, v27
v_sub_f32 v55, 0, v27
v_sub_f32 v56, 0, v27
v_sub_f32 v57, 0, v27
v_sub_f32 v58, 0, v27
v_sub_f32 v59, 0, v27
v_sub_f32 v60, 0, v27
v_sub_f32 v61, 0, v27
v_sub_f32 v62, 0, v27
v_sub_f32 v63, 0, v27
at_loop:
s_cmp_eq_u32 s40, 1
s_cbranch_scc1 at_tail0
s_waitcnt lgkmcnt(5)
v_mfma_f32_32x32x16_bf16 v[160:175], v[224:227], a[128:131], v[32:47]
ds_read_b128 v[248:251], v4 offset:22528
s_add_u32 m0, s49, 49152
s_nop 0
buffer_load_dwordx4 v5, s[20:23], s46 offen offset:0 lds
v_exp_f32 v96, v96
v_exp_f32 v97, v97
v_exp_f32 v128, v128
v_mfma_f32_32x32x16_bf16 v[192:207], v[224:227], a[160:163], v[48:63]
v_exp_f32 v129, v129
v_add_f32 v24, v24, v96
v_cvt_pk_bf16_f32 v64, v96, v97
s_waitcnt lgkmcnt(5)
v_mfma_f32_32x32x16_bf16 v[160:175], v[228:231], a[132:135], v[160:175]
ds_read_b128 v[252:255], v4 offset:23552
buffer_load_dwordx4 v5, s[20:23], s46 offen offset:1024 lds
v_add_f32 v24, v24, v97
v_exp_f32 v98, v98
v_exp_f32 v99, v99
v_mfma_f32_32x32x16_bf16 v[192:207], v[228:231], a[164:167], v[192:207]
v_add_f32 v25, v25, v128
v_cvt_pk_bf16_f32 v80, v128, v129
v_add_f32 v25, v25, v129
s_waitcnt lgkmcnt(5)
v_mfma_f32_32x32x16_bf16 v[160:175], v[232:235], a[136:139], v[160:175]
ds_read_b128 v[224:227], v4 offset:24576
buffer_load_dwordx4 v5, s[20:23], s46 offen offset:2048 lds
v_exp_f32 v130, v130
v_exp_f32 v131, v131
v_add_f32 v24, v24, v98
v_mfma_f32_32x32x16_bf16 v[192:207], v[232:235], a[168:171], v[192:207]
v_cvt_pk_bf16_f32 v65, v98, v99
v_add_f32 v24, v24, v99
v_exp_f32 v100, v100
s_waitcnt lgkmcnt(5)
v_mfma_f32_32x32x16_bf16 v[160:175], v[236:239], a[140:143], v[160:175]
ds_read_b128 v[228:231], v4 offset:25600
buffer_load_dwordx4 v5, s[20:23], s46 offen offset:3072 lds
v_exp_f32 v101, v101
v_add_f32 v25, v25, v130
v_cvt_pk_bf16_f32 v81, v130, v131
v_mfma_f32_32x32x16_bf16 v[192:207], v[236:239], a[172:175], v[192:207]
v_add_f32 v25, v25, v131
v_exp_f32 v132, v132
v_exp_f32 v133, v133
s_waitcnt lgkmcnt(5)
v_mfma_f32_32x32x16_bf16 v[160:175], v[240:243], a[144:147], v[160:175]
ds_read_b128 v[232:235], v4 offset:26624
s_add_u32 m0, s49, 53248
s_add_u32 s46, s46, 4096
buffer_load_dwordx4 v5, s[20:23], s46 offen offset:0 lds
v_add_f32 v24, v24, v100
v_cvt_pk_bf16_f32 v66, v100, v101
v_add_f32 v24, v24, v101
v_mfma_f32_32x32x16_bf16 v[192:207], v[240:243], a[176:179], v[192:207]
v_exp_f32 v102, v102
v_exp_f32 v103, v103
v_add_f32 v25, v25, v132
s_waitcnt lgkmcnt(5)
v_mfma_f32_32x32x16_bf16 v[160:175], v[244:247], a[148:151], v[160:175]
ds_read_b128 v[236:239], v4 offset:27648
buffer_load_dwordx4 v5, s[20:23], s46 offen offset:1024 lds
v_cvt_pk_bf16_f32 v82, v132, v133
v_add_f32 v25, v25, v133
v_exp_f32 v134, v134
v_exp_f32 v135, v135
v_mfma_f32_32x32x16_bf16 v[192:207], v[244:247], a[180:183], v[192:207]
v_add_f32 v24, v24, v102
v_cvt_pk_bf16_f32 v67, v102, v103
v_add_f32 v24, v24, v103
s_waitcnt lgkmcnt(5)
v_mfma_f32_32x32x16_bf16 v[160:175], v[248:251], a[152:155], v[160:175]
ds_read_b128 v[240:243], v4 offset:28672
buffer_load_dwordx4 v5, s[20:23], s46 offen offset:2048 lds
v_exp_f32 v104, v104
v_exp_f32 v105, v105
v_add_f32 v25, v25, v134
v_mfma_f32_32x32x16_bf16 v[192:207], v[248:251], a[184:187], v[192:207]
v_cvt_pk_bf16_f32 v83, v134, v135
v_add_f32 v25, v25, v135
v_exp_f32 v136, v136
s_waitcnt lgkmcnt(5)
v_mfma_f32_32x32x16_bf16 v[160:175], v[252:255], a[156:159], v[160:175]
ds_read_b128 v[244:247], v4 offset:29696
buffer_load_dwordx4 v5, s[20:23], s46 offen offset:3072 lds
s_add_u32 s46, s46, 0x7000
v_exp_f32 v137, v137
v_add_f32 v24, v24, v104
v_cvt_pk_bf16_f32 v68, v104, v105
v_mfma_f32_32x32x16_bf16 v[192:207], v[252:255], a[188:191], v[192:207]
v_add_f32 v24, v24, v105
v_exp_f32 v106, v106
v_exp_f32 v107, v107
s_waitcnt lgkmcnt(5)
v_mfma_f32_32x32x16_bf16 v[176:191], v[224:227], a[128:131], v[32:47]
ds_read_b128 v[248:251], v4 offset:30720
v_add_f32 v25, v25, v136
v_cvt_pk_bf16_f32 v84, v136, v137
v_add_f32 v25, v25, v137
v_mfma_f32_32x32x16_bf16 v[208:223], v[224:227], a[160:163], v[48:63]
v_exp_f32 v138, v138
v_exp_f32 v139, v139
v_add_f32 v24, v24, v106
s_waitcnt lgkmcnt(5)
v_mfma_f32_32x32x16_bf16 v[176:191], v[228:231], a[132:135], v[176:191]
ds_read_b128 v[252:255], v4 offset:31744
v_cvt_pk_bf16_f32 v69, v106, v107
v_add_f32 v24, v24, v107
v_exp_f32 v108, v108
v_mfma_f32_32x32x16_bf16 v[208:223], v[228:231], a[164:167], v[208:223]
v_exp_f32 v109, v109
v_add_f32 v25, v25, v138
v_cvt_pk_bf16_f32 v85, v138, v139
s_waitcnt lgkmcnt(5)
v_mfma_f32_32x32x16_bf16 v[176:191], v[232:235], a[136:139], v[176:191]
ds_read_b128 v[224:227], v4 offset:32768
v_add_f32 v25, v25, v139
v_exp_f32 v140, v140
v_exp_f32 v141, v141
v_add_f32 v24, v24, v108
v_mfma_f32_32x32x16_bf16 v[208:223], v[232:235], a[168:171], v[208:223]
v_cvt_pk_bf16_f32 v70, v108, v109
v_add_f32 v24, v24, v109
v_exp_f32 v110, v110
s_waitcnt lgkmcnt(5)
v_mfma_f32_32x32x16_bf16 v[176:191], v[236:239], a[140:143], v[176:191]
ds_read_b128 v[228:231], v4 offset:33792
v_exp_f32 v111, v111
v_add_f32 v25, v25, v140
v_cvt_pk_bf16_f32 v86, v140, v141
v_mfma_f32_32x32x16_bf16 v[208:223], v[236:239], a[172:175], v[208:223]
v_add_f32 v25, v25, v141
v_exp_f32 v142, v142
v_exp_f32 v143, v143
s_waitcnt lgkmcnt(5)
v_mfma_f32_32x32x16_bf16 v[176:191], v[240:243], a[144:147], v[176:191]
ds_read_b128 v[232:235], v4 offset:34816
v_add_f32 v24, v24, v110
v_cvt_pk_bf16_f32 v71, v110, v111
v_add_f32 v24, v24, v111
v_mfma_f32_32x32x16_bf16 v[208:223], v[240:243], a[176:179], v[208:223]
v_exp_f32 v112, v112
v_exp_f32 v113, v113
v_add_f32 v25, v25, v142
s_waitcnt lgkmcnt(5)
v_mfma_f32_32x32x16_bf16 v[176:191], v[244:247], a[148:151], v[176:191]
ds_read_b128 v[236:239], v4 offset:35840
v_cvt_pk_bf16_f32 v87, v142, v143
v_add_f32 v25, v25, v143
v_exp_f32 v144, v144
v_mfma_f32_32x32x16_bf16 v[208:223], v[244:247], a[180:183], v[208:223]
v_exp_f32 v145, v145
v_add_f32 v24, v24, v112
v_cvt_pk_bf16_f32 v72, v112, v113
s_waitcnt lgkmcnt(5)
v_mfma_f32_32x32x16_bf16 v[176:191], v[248:251], a[152:155], v[176:191]
ds_read_b128 v[240:243], v4 offset:36864
v_add_f32 v24, v24, v113
v_exp_f32 v114, v114
v_exp_f32 v115, v115
v_mfma_f32_32x32x16_bf16 v[208:223], v[248:251], a[184:187], v[208:223]
v_add_f32 v25, v25, v144
v_cvt_pk_bf16_f32 v88, v144, v145
v_add_f32 v25, v25, v145
s_waitcnt lgkmcnt(5)
v_mfma_f32_32x32x16_bf16 v[176:191], v[252:255], a[156:159], v[176:191]
ds_read_b128 v[244:247], v4 offset:37888
v_exp_f32 v146, v146
v_exp_f32 v147, v147
v_add_f32 v24, v24, v114
v_mfma_f32_32x32x16_bf16 v[208:223], v[252:255], a[188:191], v[208:223]
v_cvt_pk_bf16_f32 v73, v114, v115
v_add_f32 v24, v24, v115
v_exp_f32 v116, v116
v_exp_f32 v117, v117
s_waitcnt lgkmcnt(5)
v_mfma_f32_32x32x16_bf16 a[0:15], v[224:227], v[64:67], a[0:15]
ds_read_b128 v[248:251], v4 offset:38912
v_add_f32 v25, v25, v146
v_cvt_pk_bf16_f32 v89, v146, v147
v_add_f32 v25, v25, v147
v_mfma_f32_32x32x16_bf16 a[64:79], v[224:227], v[80:83], a[64:79]
v_exp_f32 v148, v148
v_exp_f32 v149, v149
v_add_f32 v24, v24, v116
s_waitcnt lgkmcnt(5)
v_mfma_f32_32x32x16_bf16 a[16:31], v[228:231], v[64:67], a[16:31]
ds_read_b128 v[252:255], v4 offset:39936
v_cvt_pk_bf16_f32 v74, v116, v117
v_add_f32 v24, v24, v117
v_exp_f32 v118, v118
v_mfma_f32_32x32x16_bf16 a[80:95], v[228:231], v[80:83], a[80:95]
v_exp_f32 v119, v119
v_add_f32 v25, v25, v148
v_cvt_pk_bf16_f32 v90, v148, v149
s_waitcnt lgkmcnt(5)
v_mfma_f32_32x32x16_bf16 a[32:47], v[232:235], v[64:67], a[32:47]
ds_read_b128 v[224:227], v4 offset:40960
v_add_f32 v25, v25, v149
v_exp_f32 v150, v150
v_exp_f32 v151, v151
v_mfma_f32_32x32x16_bf16 a[96:111], v[232:235], v[80:83], a[96:111]
v_add_f32 v24, v24, v118
v_cvt_pk_bf16_f32 v75, v118, v119
v_add_f32 v24, v24, v119
s_waitcnt lgkmcnt(5)
v_mfma_f32_32x32x16_bf16 a[48:63], v[236:239], v[64:67], a[48:63]
ds_read_b128 v[228:231], v4 offset:41984
v_exp_f32 v120, v120
v_exp_f32 v121, v121
v_add_f32 v25, v25, v150
v_mfma_f32_32x32x16_bf16 a[112:127], v[236:239], v[80:83], a[112:127]
v_cvt_pk_bf16_f32 v91, v150, v151
v_add_f32 v25, v25, v151
v_exp_f32 v152, v152
s_waitcnt lgkmcnt(5)
v_mfma_f32_32x32x16_bf16 a[0:15], v[240:243], v[68:71], a[0:15]
ds_read_b128 v[232:235], v4 offset:43008
v_exp_f32 v153, v153
v_add_f32 v24, v24, v120
v_cvt_pk_bf16_f32 v76, v120, v121
v_mfma_f32_32x32x16_bf16 a[64:79], v[240:243], v[84:87], a[64:79]
v_add_f32 v24, v24, v121
v_exp_f32 v122, v122
v_exp_f32 v123, v123
v_add_f32 v25, v25, v152
s_waitcnt lgkmcnt(5)
v_mfma_f32_32x32x16_bf16 a[16:31], v[244:247], v[68:71], a[16:31]
ds_read_b128 v[236:239], v4 offset:44032
v_cvt_pk_bf16_f32 v92, v152, v153
v_add_f32 v25, v25, v153
v_exp_f32 v154, v154
v_mfma_f32_32x32x16_bf16 a[80:95], v[244:247], v[84:87], a[80:95]
s_cmp_lg_u32 s40, 2
s_cbranch_scc1 L_13
v_mov_b32 v28, 0xce6e6b28
v_add_u32 v27, 32, v29
v_cmp_gt_i32 s[52:53], 0, v29
v_cmp_gt_i32 s[54:55], 1, v29
v_cmp_gt_i32 s[56:57], 2, v29
v_cmp_gt_i32 s[58:59], 3, v29
v_cndmask_b32 v160, v160, v28, s[52:53]
v_cndmask_b32 v161, v161, v28, s[54:55]
v_cndmask_b32 v162, v162, v28, s[56:57]
v_cndmask_b32 v163, v163, v28, s[58:59]
v_cmp_gt_i32 s[52:53], 8, v29
v_cmp_gt_i32 s[54:55], 9, v29
v_cmp_gt_i32 s[56:57], 10, v29
v_cmp_gt_i32 s[58:59], 11, v29
v_cndmask_b32 v164, v164, v28, s[52:53]
v_cndmask_b32 v165, v165, v28, s[54:55]
v_cndmask_b32 v166, v166, v28, s[56:57]
v_cndmask_b32 v167, v167, v28, s[58:59]
v_cmp_gt_i32 s[52:53], 16, v29
v_cmp_gt_i32 s[54:55], 17, v29
v_cmp_gt_i32 s[56:57], 18, v29
v_cmp_gt_i32 s[58:59], 19, v29
v_cndmask_b32 v168, v168, v28, s[52:53]
v_cndmask_b32 v169, v169, v28, s[54:55]
v_cndmask_b32 v170, v170, v28, s[56:57]
v_cndmask_b32 v171, v171, v28, s[58:59]
v_cmp_gt_i32 s[52:53], 24, v29
v_cmp_gt_i32 s[54:55], 25, v29
v_cmp_gt_i32 s[56:57], 26, v29
v_cmp_gt_i32 s[58:59], 27, v29
v_cndmask_b32 v172, v172, v28, s[52:53]
v_cndmask_b32 v173, v173, v28, s[54:55]
v_cndmask_b32 v174, v174, v28, s[56:57]
v_cndmask_b32 v175, v175, v28, s[58:59]
v_cmp_gt_i32 s[52:53], 32, v29
v_cmp_gt_i32 s[54:55], 33, v29
v_cmp_gt_i32 s[56:57], 34, v29
v_cmp_gt_i32 s[58:59], 35, v29
v_cndmask_b32 v176, v176, v28, s[52:53]
v_cndmask_b32 v177, v177, v28, s[54:55]
v_cndmask_b32 v178, v178, v28, s[56:57]
v_cndmask_b32 v179, v179, v28, s[58:59]
v_cmp_gt_i32 s[52:53], 40, v29
v_cmp_gt_i32 s[54:55], 41, v29
v_cmp_gt_i32 s[56:57], 42, v29
v_cmp_gt_i32 s[58:59], 43, v29
v_cndmask_b32 v180, v180, v28, s[52:53]
v_cndmask_b32 v181, v181, v28, s[54:55]
v_cndmask_b32 v182, v182, v28, s[56:57]
v_cndmask_b32 v183, v183, v28, s[58:59]
v_cmp_gt_i32 s[52:53], 48, v29
v_cmp_gt_i32 s[54:55], 49, v29
v_cmp_gt_i32 s[56:57], 50, v29
v_cmp_gt_i32 s[58:59], 51, v29
v_cndmask_b32 v184, v184, v28, s[52:53]
v_cndmask_b32 v185, v185, v28, s[54:55]
v_cndmask_b32 v186, v186, v28, s[56:57]
v_cndmask_b32 v187, v187, v28, s[58:59]
v_cmp_gt_i32 s[52:53], 56, v29
v_cmp_gt_i32 s[54:55], 57, v29
v_cmp_gt_i32 s[56:57], 58, v29
v_cmp_gt_i32 s[58:59], 59, v29
v_cndmask_b32 v188, v188, v28, s[52:53]
v_cndmask_b32 v189, v189, v28, s[54:55]
v_cndmask_b32 v190, v190, v28, s[56:57]
v_cndmask_b32 v191, v191, v28, s[58:59]
v_cmp_gt_i32 s[52:53], 0, v27
v_cmp_gt_i32 s[54:55], 1, v27
v_cmp_gt_i32 s[56:57], 2, v27
v_cmp_gt_i32 s[58:59], 3, v27
v_cndmask_b32 v192, v192, v28, s[52:53]
v_cndmask_b32 v193, v193, v28, s[54:55]
v_cndmask_b32 v194, v194, v28, s[56:57]
v_cndmask_b32 v195, v195, v28, s[58:59]
v_cmp_gt_i32 s[52:53], 8, v27
v_cmp_gt_i32 s[54:55], 9, v27
v_cmp_gt_i32 s[56:57], 10, v27
v_cmp_gt_i32 s[58:59], 11, v27
v_cndmask_b32 v196, v196, v28, s[52:53]
v_cndmask_b32 v197, v197, v28, s[54:55]
v_cndmask_b32 v198, v198, v28, s[56:57]
v_cndmask_b32 v199, v199, v28, s[58:59]
v_cmp_gt_i32 s[52:53], 16, v27
v_cmp_gt_i32 s[54:55], 17, v27
v_cmp_gt_i32 s[56:57], 18, v27
v_cmp_gt_i32 s[58:59], 19, v27
v_cndmask_b32 v200, v200, v28, s[52:53]
v_cndmask_b32 v201, v201, v28, s[54:55]
v_cndmask_b32 v202, v202, v28, s[56:57]
v_cndmask_b32 v203, v203, v28, s[58:59]
v_cmp_gt_i32 s[52:53], 24, v27
v_cmp_gt_i32 s[54:55], 25, v27
v_cmp_gt_i32 s[56:57], 26, v27
v_cmp_gt_i32 s[58:59], 27, v27
v_cndmask_b32 v204, v204, v28, s[52:53]
v_cndmask_b32 v205, v205, v28, s[54:55]
v_cndmask_b32 v206, v206, v28, s[56:57]
v_cndmask_b32 v207, v207, v28, s[58:59]
v_cmp_gt_i32 s[52:53], 32, v27
v_cmp_gt_i32 s[54:55], 33, v27
v_cmp_gt_i32 s[56:57], 34, v27
v_cmp_gt_i32 s[58:59], 35, v27
v_cndmask_b32 v208, v208, v28, s[52:53]
v_cndmask_b32 v209, v209, v28, s[54:55]
v_cndmask_b32 v210, v210, v28, s[56:57]
v_cndmask_b32 v211, v211, v28, s[58:59]
v_cmp_gt_i32 s[52:53], 40, v27
v_cmp_gt_i32 s[54:55], 41, v27
v_cmp_gt_i32 s[56:57], 42, v27
v_cmp_gt_i32 s[58:59], 43, v27
v_cndmask_b32 v212, v212, v28, s[52:53]
v_cndmask_b32 v213, v213, v28, s[54:55]
v_cndmask_b32 v214, v214, v28, s[56:57]
v_cndmask_b32 v215, v215, v28, s[58:59]
v_cmp_gt_i32 s[52:53], 48, v27
v_cmp_gt_i32 s[54:55], 49, v27
v_cmp_gt_i32 s[56:57], 50, v27
v_cmp_gt_i32 s[58:59], 51, v27
v_cndmask_b32 v216, v216, v28, s[52:53]
v_cndmask_b32 v217, v217, v28, s[54:55]
v_cndmask_b32 v218, v218, v28, s[56:57]
v_cndmask_b32 v219, v219, v28, s[58:59]
v_cmp_gt_i32 s[52:53], 56, v27
v_cmp_gt_i32 s[54:55], 57, v27
v_cmp_gt_i32 s[56:57], 58, v27
v_cmp_gt_i32 s[58:59], 59, v27
v_cndmask_b32 v220, v220, v28, s[52:53]
v_cndmask_b32 v221, v221, v28, s[54:55]
v_cndmask_b32 v222, v222, v28, s[56:57]
v_cndmask_b32 v223, v223, v28, s[58:59]
L_13:
v_exp_f32 v155, v155
v_add_f32 v24, v24, v122
v_cvt_pk_bf16_f32 v77, v122, v123
s_waitcnt lgkmcnt(5)
v_mfma_f32_32x32x16_bf16 a[32:47], v[248:251], v[68:71], a[32:47]
ds_read_b128 v[240:243], v4 offset:45056
v_add_f32 v24, v24, v123
v_exp_f32 v124, v124
v_exp_f32 v125, v125
v_max3_f32 v27, v160, v161, v162
v_mfma_f32_32x32x16_bf16 a[96:111], v[248:251], v[84:87], a[96:111]
v_add_f32 v25, v25, v154
v_cvt_pk_bf16_f32 v93, v154, v155
v_add_f32 v25, v25, v155
v_max3_f32 v28, v163, v164, v165
v_max3_f32 v27, v27, v166, v167
s_waitcnt lgkmcnt(5)
v_mfma_f32_32x32x16_bf16 a[48:63], v[252:255], v[68:71], a[48:63]
ds_read_b128 v[244:247], v4 offset:46080
v_exp_f32 v156, v156
v_exp_f32 v157, v157
v_add_f32 v24, v24, v124
v_max3_f32 v28, v28, v168, v169
v_max3_f32 v27, v27, v170, v171
v_mfma_f32_32x32x16_bf16 a[112:127], v[252:255], v[84:87], a[112:127]
v_cvt_pk_bf16_f32 v78, v124, v125
v_add_f32 v24, v24, v125
v_exp_f32 v126, v126
v_max3_f32 v28, v28, v172, v173
v_max3_f32 v27, v27, v174, v175
s_waitcnt lgkmcnt(5)
v_mfma_f32_32x32x16_bf16 a[0:15], v[224:227], v[72:75], a[0:15]
ds_read_b128 v[248:251], v4 offset:47104
v_exp_f32 v127, v127
v_add_f32 v25, v25, v156
v_cvt_pk_bf16_f32 v94, v156, v157
v_max3_f32 v28, v28, v176, v177
v_mfma_f32_32x32x16_bf16 a[64:79], v[224:227], v[88:91], a[64:79]
v_add_f32 v25, v25, v157
v_exp_f32 v158, v158
v_exp_f32 v159, v159
v_max3_f32 v27, v27, v178, v179
v_max3_f32 v28, v28, v180, v181
s_waitcnt lgkmcnt(5)
v_mfma_f32_32x32x16_bf16 a[16:31], v[228:231], v[72:75], a[16:31]
ds_read_b128 v[252:255], v4 offset:48128
v_add_f32 v24, v24, v126
v_cvt_pk_bf16_f32 v79, v126, v127
v_add_f32 v24, v24, v127
v_max3_f32 v27, v27, v182, v183
v_max3_f32 v28, v28, v184, v185
v_mfma_f32_32x32x16_bf16 a[80:95], v[228:231], v[88:91], a[80:95]
s_nop 0
v_add_f32 v25, v25, v158
v_cvt_pk_bf16_f32 v95, v158, v159
v_add_f32 v25, v25, v159
v_max3_f32 v27, v27, v186, v187
v_max3_f32 v28, v28, v188, v189
s_waitcnt lgkmcnt(5)
v_mfma_f32_32x32x16_bf16 a[32:47], v[232:235], v[72:75], a[32:47]
v_max3_f32 v27, v27, v190, v191
v_max3_f32 v28, v28, v192, v193
v_mfma_f32_32x32x16_bf16 a[96:111], v[232:235], v[88:91], a[96:111]
buffer_load_dword a192, v2, s[8:11], s60 offen
s_add_u32 s60, s60, 16384
s_min_u32 s60, s60, s62
v_max3_f32 v27, v27, v194, v195
s_waitcnt lgkmcnt(4)
v_mfma_f32_32x32x16_bf16 a[48:63], v[236:239], v[72:75], a[48:63]
v_max3_f32 v28, v28, v196, v197
v_max3_f32 v27, v27, v198, v199
v_mfma_f32_32x32x16_bf16 a[112:127], v[236:239], v[88:91], a[112:127]
s_waitcnt vmcnt(1) lgkmcnt(0)
s_barrier
ds_read_b128 v[224:227], v4 offset:0
ds_read_b128 v[228:231], v4 offset:1024
ds_read_b128 v[232:235], v4 offset:2048
ds_read_b128 v[236:239], v4 offset:3072
v_max3_f32 v28, v28, v200, v201
v_max3_f32 v27, v27, v202, v203
v_mfma_f32_32x32x16_bf16 a[0:15], v[240:243], v[76:79], a[0:15]
s_cmp_lt_i32 s47, 1
s_cbranch_scc1 L_14
s_add_u32 m0, s49, 16384
s_nop 0
buffer_load_dwordx4 v5, s[16:19], s45 offen offset:0 lds
L_14:
v_max3_f32 v28, v28, v204, v205
v_max3_f32 v27, v27, v206, v207
v_mfma_f32_32x32x16_bf16 a[64:79], v[240:243], v[92:95], a[64:79]
ds_read_b128 v[240:243], v4 offset:4096
s_cmp_lt_i32 s47, 1
s_cbranch_scc1 L_15
buffer_load_dwordx4 v5, s[16:19], s45 offen offset:1024 lds
L_15:
v_max3_f32 v28, v28, v208, v209
v_mfma_f32_32x32x16_bf16 a[16:31], v[244:247], v[76:79], a[16:31]
s_cmp_lt_i32 s47, 1
s_cbranch_scc1 L_16
buffer_load_dwordx4 v5, s[16:19], s45 offen offset:2048 lds
L_16:
v_max3_f32 v27, v27, v210, v211
v_max3_f32 v28, v28, v212, v213
v_mfma_f32_32x32x16_bf16 a[80:95], v[244:247], v[92:95], a[80:95]
ds_read_b128 v[244:247], v4 offset:5120
s_cmp_lt_i32 s47, 1
s_cbranch_scc1 L_17
buffer_load_dwordx4 v5, s[16:19], s45 offen offset:3072 lds
L_17:
v_max3_f32 v27, v27, v214, v215
v_max3_f32 v28, v28, v216, v217
v_mfma_f32_32x32x16_bf16 a[32:47], v[248:251], v[76:79], a[32:47]
s_cmp_lt_i32 s47, 1
s_cbranch_scc1 L_18
s_add_u32 m0, s49, 20480
s_add_u32 s45, s45, 4096
buffer_load_dwordx4 v5, s[16:19], s45 offen offset:0 lds
L_18:
v_max3_f32 v27, v27, v218, v219
v_max3_f32 v28, v28, v220, v221
v_mfma_f32_32x32x16_bf16 a[96:111], v[248:251], v[92:95], a[96:111]
s_cmp_lt_i32 s47, 1
s_cbranch_scc1 L_19
buffer_load_dwordx4 v5, s[16:19], s45 offen offset:1024 lds
L_19:
v_max3_f32 v27, v27, v222, v223
v_max_f32 v27, v27, v28
v_mfma_f32_32x32x16_bf16 a[48:63], v[252:255], v[76:79], a[48:63]
s_cmp_lt_i32 s47, 1
s_cbranch_scc1 L_20
buffer_load_dwordx4 v5, s[16:19], s45 offen offset:2048 lds
L_20:
v_cmp_lt_f32 vcc, 0x42000000, v27
v_mfma_f32_32x32x16_bf16 a[112:127], v[252:255], v[92:95], a[112:127]
s_cmp_lt_i32 s47, 1
s_cbranch_scc1 L_21
buffer_load_dwordx4 v5, s[16:19], s45 offen offset:3072 lds
s_add_u32 s45, s45, 0x7000
L_21:
s_sub_u32 s47, s47, 1
s_cbranch_vccnz at_rs0
at_rb0:
s_sub_u32 s40, s40, 1
s_cmp_eq_u32 s40, 1
s_cbranch_scc1 at_tail1
s_waitcnt lgkmcnt(5)
v_mfma_f32_32x32x16_bf16 v[96:111], v[224:227], a[128:131], v[32:47]
ds_read_b128 v[248:251], v4 offset:6144
s_add_u32 m0, s49, 32768
s_nop 0
buffer_load_dwordx4 v5, s[20:23], s46 offen offset:0 lds
v_exp_f32 v160, v160
v_exp_f32 v161, v161
v_exp_f32 v192, v192
v_mfma_f32_32x32x16_bf16 v[128:143], v[224:227], a[160:163], v[48:63]
v_exp_f32 v193, v193
v_add_f32 v24, v24, v160
v_cvt_pk_bf16_f32 v64, v160, v161
s_waitcnt lgkmcnt(5)
v_mfma_f32_32x32x16_bf16 v[96:111], v[228:231], a[132:135], v[96:111]
ds_read_b128 v[252:255], v4 offset:7168
buffer_load_dwordx4 v5, s[20:23], s46 offen offset:1024 lds
v_add_f32 v24, v24, v161
v_exp_f32 v162, v162
v_exp_f32 v163, v163
v_mfma_f32_32x32x16_bf16 v[128:143], v[228:231], a[164:167], v[128:143]
v_add_f32 v25, v25, v192
v_cvt_pk_bf16_f32 v80, v192, v193
v_add_f32 v25, v25, v193
s_waitcnt lgkmcnt(5)
v_mfma_f32_32x32x16_bf16 v[96:111], v[232:235], a[136:139], v[96:111]
ds_read_b128 v[224:227], v4 offset:8192
buffer_load_dwordx4 v5, s[20:23], s46 offen offset:2048 lds
v_exp_f32 v194, v194
v_exp_f32 v195, v195
v_add_f32 v24, v24, v162
v_mfma_f32_32x32x16_bf16 v[128:143], v[232:235], a[168:171], v[128:143]
v_cvt_pk_bf16_f32 v65, v162, v163
v_add_f32 v24, v24, v163
v_exp_f32 v164, v164
s_waitcnt lgkmcnt(5)
v_mfma_f32_32x32x16_bf16 v[96:111], v[236:239], a[140:143], v[96:111]
ds_read_b128 v[228:231], v4 offset:9216
buffer_load_dwordx4 v5, s[20:23], s46 offen offset:3072 lds
v_exp_f32 v165, v165
v_add_f32 v25, v25, v194
v_cvt_pk_bf16_f32 v81, v194, v195
v_mfma_f32_32x32x16_bf16 v[128:143], v[236:239], a[172:175], v[128:143]
v_add_f32 v25, v25, v195
v_exp_f32 v196, v196
v_exp_f32 v197, v197
s_waitcnt lgkmcnt(5)
v_mfma_f32_32x32x16_bf16 v[96:111], v[240:243], a[144:147], v[96:111]
ds_read_b128 v[232:235], v4 offset:10240
s_add_u32 m0, s49, 36864
s_add_u32 s46, s46, 4096
buffer_load_dwordx4 v5, s[20:23], s46 offen offset:0 lds
v_add_f32 v24, v24, v164
v_cvt_pk_bf16_f32 v66, v164, v165
v_add_f32 v24, v24, v165
v_mfma_f32_32x32x16_bf16 v[128:143], v[240:243], a[176:179], v[128:143]
v_exp_f32 v166, v166
v_exp_f32 v167, v167
v_add_f32 v25, v25, v196
s_waitcnt lgkmcnt(5)
v_mfma_f32_32x32x16_bf16 v[96:111], v[244:247], a[148:151], v[96:111]
ds_read_b128 v[236:239], v4 offset:11264
buffer_load_dwordx4 v5, s[20:23], s46 offen offset:1024 lds
v_cvt_pk_bf16_f32 v82, v196, v197
v_add_f32 v25, v25, v197
v_exp_f32 v198, v198
v_exp_f32 v199, v199
v_mfma_f32_32x32x16_bf16 v[128:143], v[244:247], a[180:183], v[128:143]
v_add_f32 v24, v24, v166
v_cvt_pk_bf16_f32 v67, v166, v167
v_add_f32 v24, v24, v167
s_waitcnt lgkmcnt(5)
v_mfma_f32_32x32x16_bf16 v[96:111], v[248:251], a[152:155], v[96:111]
ds_read_b128 v[240:243], v4 offset:12288
buffer_load_dwordx4 v5, s[20:23], s46 offen offset:2048 lds
v_exp_f32 v168, v168
v_exp_f32 v169, v169
v_add_f32 v25, v25, v198
v_mfma_f32_32x32x16_bf16 v[128:143], v[248:251], a[184:187], v[128:143]
v_cvt_pk_bf16_f32 v83, v198, v199
v_add_f32 v25, v25, v199
v_exp_f32 v200, v200
s_waitcnt lgkmcnt(5)
v_mfma_f32_32x32x16_bf16 v[96:111], v[252:255], a[156:159], v[96:111]
ds_read_b128 v[244:247], v4 offset:13312
buffer_load_dwordx4 v5, s[20:23], s46 offen offset:3072 lds
s_add_u32 s46, s46, 0x7000
v_exp_f32 v201, v201
v_add_f32 v24, v24, v168
v_cvt_pk_bf16_f32 v68, v168, v169
v_mfma_f32_32x32x16_bf16 v[128:143], v[252:255], a[188:191], v[128:143]
v_add_f32 v24, v24, v169
v_exp_f32 v170, v170
v_exp_f32 v171, v171
s_waitcnt lgkmcnt(5)
v_mfma_f32_32x32x16_bf16 v[112:127], v[224:227], a[128:131], v[32:47]
ds_read_b128 v[248:251], v4 offset:14336
v_add_f32 v25, v25, v200
v_cvt_pk_bf16_f32 v84, v200, v201
v_add_f32 v25, v25, v201
v_mfma_f32_32x32x16_bf16 v[144:159], v[224:227], a[160:163], v[48:63]
v_exp_f32 v202, v202
v_exp_f32 v203, v203
v_add_f32 v24, v24, v170
s_waitcnt lgkmcnt(5)
v_mfma_f32_32x32x16_bf16 v[112:127], v[228:231], a[132:135], v[112:127]
ds_read_b128 v[252:255], v4 offset:15360
v_cvt_pk_bf16_f32 v69, v170, v171
v_add_f32 v24, v24, v171
v_exp_f32 v172, v172
v_mfma_f32_32x32x16_bf16 v[144:159], v[228:231], a[164:167], v[144:159]
v_exp_f32 v173, v173
v_add_f32 v25, v25, v202
v_cvt_pk_bf16_f32 v85, v202, v203
s_waitcnt lgkmcnt(5)
v_mfma_f32_32x32x16_bf16 v[112:127], v[232:235], a[136:139], v[112:127]
ds_read_b128 v[224:227], v4 offset:49152
v_add_f32 v25, v25, v203
v_exp_f32 v204, v204
v_exp_f32 v205, v205
v_add_f32 v24, v24, v172
v_mfma_f32_32x32x16_bf16 v[144:159], v[232:235], a[168:171], v[144:159]
v_cvt_pk_bf16_f32 v70, v172, v173
v_add_f32 v24, v24, v173
v_exp_f32 v174, v174
s_waitcnt lgkmcnt(5)
v_mfma_f32_32x32x16_bf16 v[112:127], v[236:239], a[140:143], v[112:127]
ds_read_b128 v[228:231], v4 offset:50176
v_exp_f32 v175, v175
v_add_f32 v25, v25, v204
v_cvt_pk_bf16_f32 v86, v204, v205
v_mfma_f32_32x32x16_bf16 v[144:159], v[236:239], a[172:175], v[144:159]
v_add_f32 v25, v25, v205
v_exp_f32 v206, v206
v_exp_f32 v207, v207
s_waitcnt lgkmcnt(5)
v_mfma_f32_32x32x16_bf16 v[112:127], v[240:243], a[144:147], v[112:127]
ds_read_b128 v[232:235], v4 offset:51200
v_add_f32 v24, v24, v174
v_cvt_pk_bf16_f32 v71, v174, v175
v_add_f32 v24, v24, v175
v_mfma_f32_32x32x16_bf16 v[144:159], v[240:243], a[176:179], v[144:159]
v_exp_f32 v176, v176
v_exp_f32 v177, v177
v_add_f32 v25, v25, v206
s_waitcnt lgkmcnt(5)
v_mfma_f32_32x32x16_bf16 v[112:127], v[244:247], a[148:151], v[112:127]
ds_read_b128 v[236:239], v4 offset:52224
v_cvt_pk_bf16_f32 v87, v206, v207
v_add_f32 v25, v25, v207
v_exp_f32 v208, v208
v_mfma_f32_32x32x16_bf16 v[144:159], v[244:247], a[180:183], v[144:159]
v_exp_f32 v209, v209
v_add_f32 v24, v24, v176
v_cvt_pk_bf16_f32 v72, v176, v177
s_waitcnt lgkmcnt(5)
v_mfma_f32_32x32x16_bf16 v[112:127], v[248:251], a[152:155], v[112:127]
ds_read_b128 v[240:243], v4 offset:53248
v_add_f32 v24, v24, v177
v_exp_f32 v178, v178
v_exp_f32 v179, v179
v_mfma_f32_32x32x16_bf16 v[144:159], v[248:251], a[184:187], v[144:159]
v_add_f32 v25, v25, v208
v_cvt_pk_bf16_f32 v88, v208, v209
v_add_f32 v25, v25, v209
s_waitcnt lgkmcnt(5)
v_mfma_f32_32x32x16_bf16 v[112:127], v[252:255], a[156:159], v[112:127]
ds_read_b128 v[244:247], v4 offset:54272
v_exp_f32 v210, v210
v_exp_f32 v211, v211
v_add_f32 v24, v24, v178
v_mfma_f32_32x32x16_bf16 v[144:159], v[252:255], a[188:191], v[144:159]
v_cvt_pk_bf16_f32 v73, v178, v179
v_add_f32 v24, v24, v179
v_exp_f32 v180, v180
v_exp_f32 v181, v181
s_waitcnt lgkmcnt(5)
v_mfma_f32_32x32x16_bf16 a[0:15], v[224:227], v[64:67], a[0:15]
ds_read_b128 v[248:251], v4 offset:55296
v_add_f32 v25, v25, v210
v_cvt_pk_bf16_f32 v89, v210, v211
v_add_f32 v25, v25, v211
v_mfma_f32_32x32x16_bf16 a[64:79], v[224:227], v[80:83], a[64:79]
v_exp_f32 v212, v212
v_exp_f32 v213, v213
v_add_f32 v24, v24, v180
s_waitcnt lgkmcnt(5)
v_mfma_f32_32x32x16_bf16 a[16:31], v[228:231], v[64:67], a[16:31]
ds_read_b128 v[252:255], v4 offset:56320
v_cvt_pk_bf16_f32 v74, v180, v181
v_add_f32 v24, v24, v181
v_exp_f32 v182, v182
v_mfma_f32_32x32x16_bf16 a[80:95], v[228:231], v[80:83], a[80:95]
v_exp_f32 v183, v183
v_add_f32 v25, v25, v212
v_cvt_pk_bf16_f32 v90, v212, v213
s_waitcnt lgkmcnt(5)
v_mfma_f32_32x32x16_bf16 a[32:47], v[232:235], v[64:67], a[32:47]
ds_read_b128 v[224:227], v4 offset:57344
v_add_f32 v25, v25, v213
v_exp_f32 v214, v214
v_exp_f32 v215, v215
v_mfma_f32_32x32x16_bf16 a[96:111], v[232:235], v[80:83], a[96:111]
v_add_f32 v24, v24, v182
v_cvt_pk_bf16_f32 v75, v182, v183
v_add_f32 v24, v24, v183
s_waitcnt lgkmcnt(5)
v_mfma_f32_32x32x16_bf16 a[48:63], v[236:239], v[64:67], a[48:63]
ds_read_b128 v[228:231], v4 offset:58368
v_exp_f32 v184, v184
v_exp_f32 v185, v185
v_add_f32 v25, v25, v214
v_mfma_f32_32x32x16_bf16 a[112:127], v[236:239], v[80:83], a[112:127]
v_cvt_pk_bf16_f32 v91, v214, v215
v_add_f32 v25, v25, v215
v_exp_f32 v216, v216
s_waitcnt lgkmcnt(5)
v_mfma_f32_32x32x16_bf16 a[0:15], v[240:243], v[68:71], a[0:15]
ds_read_b128 v[232:235], v4 offset:59392
v_exp_f32 v217, v217
v_add_f32 v24, v24, v184
v_cvt_pk_bf16_f32 v76, v184, v185
v_mfma_f32_32x32x16_bf16 a[64:79], v[240:243], v[84:87], a[64:79]
v_add_f32 v24, v24, v185
v_exp_f32 v186, v186
v_exp_f32 v187, v187
v_add_f32 v25, v25, v216
s_waitcnt lgkmcnt(5)
v_mfma_f32_32x32x16_bf16 a[16:31], v[244:247], v[68:71], a[16:31]
ds_read_b128 v[236:239], v4 offset:60416
v_cvt_pk_bf16_f32 v92, v216, v217
v_add_f32 v25, v25, v217
v_exp_f32 v218, v218
v_mfma_f32_32x32x16_bf16 a[80:95], v[244:247], v[84:87], a[80:95]
s_cmp_lg_u32 s40, 2
s_cbranch_scc1 L_22
v_mov_b32 v28, 0xce6e6b28
v_add_u32 v27, 32, v29
v_cmp_gt_i32 s[52:53], 0, v29
v_cmp_gt_i32 s[54:55], 1, v29
v_cmp_gt_i32 s[56:57], 2, v29
v_cmp_gt_i32 s[58:59], 3, v29
v_cndmask_b32 v96, v96, v28, s[52:53]
v_cndmask_b32 v97, v97, v28, s[54:55]
v_cndmask_b32 v98, v98, v28, s[56:57]
v_cndmask_b32 v99, v99, v28, s[58:59]
v_cmp_gt_i32 s[52:53], 8, v29
v_cmp_gt_i32 s[54:55], 9, v29
v_cmp_gt_i32 s[56:57], 10, v29
v_cmp_gt_i32 s[58:59], 11, v29
v_cndmask_b32 v100, v100, v28, s[52:53]
v_cndmask_b32 v101, v101, v28, s[54:55]
v_cndmask_b32 v102, v102, v28, s[56:57]
v_cndmask_b32 v103, v103, v28, s[58:59]
v_cmp_gt_i32 s[52:53], 16, v29
v_cmp_gt_i32 s[54:55], 17, v29
v_cmp_gt_i32 s[56:57], 18, v29
v_cmp_gt_i32 s[58:59], 19, v29
v_cndmask_b32 v104, v104, v28, s[52:53]
v_cndmask_b32 v105, v105, v28, s[54:55]
v_cndmask_b32 v106, v106, v28, s[56:57]
v_cndmask_b32 v107, v107, v28, s[58:59]
v_cmp_gt_i32 s[52:53], 24, v29
v_cmp_gt_i32 s[54:55], 25, v29
v_cmp_gt_i32 s[56:57], 26, v29
v_cmp_gt_i32 s[58:59], 27, v29
v_cndmask_b32 v108, v108, v28, s[52:53]
v_cndmask_b32 v109, v109, v28, s[54:55]
v_cndmask_b32 v110, v110, v28, s[56:57]
v_cndmask_b32 v111, v111, v28, s[58:59]
v_cmp_gt_i32 s[52:53], 32, v29
v_cmp_gt_i32 s[54:55], 33, v29
v_cmp_gt_i32 s[56:57], 34, v29
v_cmp_gt_i32 s[58:59], 35, v29
v_cndmask_b32 v112, v112, v28, s[52:53]
v_cndmask_b32 v113, v113, v28, s[54:55]
v_cndmask_b32 v114, v114, v28, s[56:57]
v_cndmask_b32 v115, v115, v28, s[58:59]
v_cmp_gt_i32 s[52:53], 40, v29
v_cmp_gt_i32 s[54:55], 41, v29
v_cmp_gt_i32 s[56:57], 42, v29
v_cmp_gt_i32 s[58:59], 43, v29
v_cndmask_b32 v116, v116, v28, s[52:53]
v_cndmask_b32 v117, v117, v28, s[54:55]
v_cndmask_b32 v118, v118, v28, s[56:57]
v_cndmask_b32 v119, v119, v28, s[58:59]
v_cmp_gt_i32 s[52:53], 48, v29
v_cmp_gt_i32 s[54:55], 49, v29
v_cmp_gt_i32 s[56:57], 50, v29
v_cmp_gt_i32 s[58:59], 51, v29
v_cndmask_b32 v120, v120, v28, s[52:53]
v_cndmask_b32 v121, v121, v28, s[54:55]
v_cndmask_b32 v122, v122, v28, s[56:57]
v_cndmask_b32 v123, v123, v28, s[58:59]
v_cmp_gt_i32 s[52:53], 56, v29
v_cmp_gt_i32 s[54:55], 57, v29
v_cmp_gt_i32 s[56:57], 58, v29
v_cmp_gt_i32 s[58:59], 59, v29
v_cndmask_b32 v124, v124, v28, s[52:53]
v_cndmask_b32 v125, v125, v28, s[54:55]
v_cndmask_b32 v126, v126, v28, s[56:57]
v_cndmask_b32 v127, v127, v28, s[58:59]
v_cmp_gt_i32 s[52:53], 0, v27
v_cmp_gt_i32 s[54:55], 1, v27
v_cmp_gt_i32 s[56:57], 2, v27
v_cmp_gt_i32 s[58:59], 3, v27
v_cndmask_b32 v128, v128, v28, s[52:53]
v_cndmask_b32 v129, v129, v28, s[54:55]
v_cndmask_b32 v130, v130, v28, s[56:57]
v_cndmask_b32 v131, v131, v28, s[58:59]
v_cmp_gt_i32 s[52:53], 8, v27
v_cmp_gt_i32 s[54:55], 9, v27
v_cmp_gt_i32 s[56:57], 10, v27
v_cmp_gt_i32 s[58:59], 11, v27
v_cndmask_b32 v132, v132, v28, s[52:53]
v_cndmask_b32 v133, v133, v28, s[54:55]
v_cndmask_b32 v134, v134, v28, s[56:57]
v_cndmask_b32 v135, v135, v28, s[58:59]
v_cmp_gt_i32 s[52:53], 16, v27
v_cmp_gt_i32 s[54:55], 17, v27
v_cmp_gt_i32 s[56:57], 18, v27
v_cmp_gt_i32 s[58:59], 19, v27
v_cndmask_b32 v136, v136, v28, s[52:53]
v_cndmask_b32 v137, v137, v28, s[54:55]
v_cndmask_b32 v138, v138, v28, s[56:57]
v_cndmask_b32 v139, v139, v28, s[58:59]
v_cmp_gt_i32 s[52:53], 24, v27
v_cmp_gt_i32 s[54:55], 25, v27
v_cmp_gt_i32 s[56:57], 26, v27
v_cmp_gt_i32 s[58:59], 27, v27
v_cndmask_b32 v140, v140, v28, s[52:53]
v_cndmask_b32 v141, v141, v28, s[54:55]
v_cndmask_b32 v142, v142, v28, s[56:57]
v_cndmask_b32 v143, v143, v28, s[58:59]
v_cmp_gt_i32 s[52:53], 32, v27
v_cmp_gt_i32 s[54:55], 33, v27
v_cmp_gt_i32 s[56:57], 34, v27
v_cmp_gt_i32 s[58:59], 35, v27
v_cndmask_b32 v144, v144, v28, s[52:53]
v_cndmask_b32 v145, v145, v28, s[54:55]
v_cndmask_b32 v146, v146, v28, s[56:57]
v_cndmask_b32 v147, v147, v28, s[58:59]
v_cmp_gt_i32 s[52:53], 40, v27
v_cmp_gt_i32 s[54:55], 41, v27
v_cmp_gt_i32 s[56:57], 42, v27
v_cmp_gt_i32 s[58:59], 43, v27
v_cndmask_b32 v148, v148, v28, s[52:53]
v_cndmask_b32 v149, v149, v28, s[54:55]
v_cndmask_b32 v150, v150, v28, s[56:57]
v_cndmask_b32 v151, v151, v28, s[58:59]
v_cmp_gt_i32 s[52:53], 48, v27
v_cmp_gt_i32 s[54:55], 49, v27
v_cmp_gt_i32 s[56:57], 50, v27
v_cmp_gt_i32 s[58:59], 51, v27
v_cndmask_b32 v152, v152, v28, s[52:53]
v_cndmask_b32 v153, v153, v28, s[54:55]
v_cndmask_b32 v154, v154, v28, s[56:57]
v_cndmask_b32 v155, v155, v28, s[58:59]
v_cmp_gt_i32 s[52:53], 56, v27
v_cmp_gt_i32 s[54:55], 57, v27
v_cmp_gt_i32 s[56:57], 58, v27
v_cmp_gt_i32 s[58:59], 59, v27
v_cndmask_b32 v156, v156, v28, s[52:53]
v_cndmask_b32 v157, v157, v28, s[54:55]
v_cndmask_b32 v158, v158, v28, s[56:57]
v_cndmask_b32 v159, v159, v28, s[58:59]
L_22:
v_exp_f32 v219, v219
v_add_f32 v24, v24, v186
v_cvt_pk_bf16_f32 v77, v186, v187
s_waitcnt lgkmcnt(5)
v_mfma_f32_32x32x16_bf16 a[32:47], v[248:251], v[68:71], a[32:47]
ds_read_b128 v[240:243], v4 offset:61440
v_add_f32 v24, v24, v187
v_exp_f32 v188, v188
v_exp_f32 v189, v189
v_max3_f32 v27, v96, v97, v98
v_mfma_f32_32x32x16_bf16 a[96:111], v[248:251], v[84:87], a[96:111]
v_add_f32 v25, v25, v218
v_cvt_pk_bf16_f32 v93, v218, v219
v_add_f32 v25, v25, v219
v_max3_f32 v28, v99, v100, v101
v_max3_f32 v27, v27, v102, v103
s_waitcnt lgkmcnt(5)
v_mfma_f32_32x32x16_bf16 a[48:63], v[252:255], v[68:71], a[48:63]
ds_read_b128 v[244:247], v4 offset:62464
v_exp_f32 v220, v220
v_exp_f32 v221, v221
v_add_f32 v24, v24, v188
v_max3_f32 v28, v28, v104, v105
v_max3_f32 v27, v27, v106, v107
v_mfma_f32_32x32x16_bf16 a[112:127], v[252:255], v[84:87], a[112:127]
v_cvt_pk_bf16_f32 v78, v188, v189
v_add_f32 v24, v24, v189
v_exp_f32 v190, v190
v_max3_f32 v28, v28, v108, v109
v_max3_f32 v27, v27, v110, v111
s_waitcnt lgkmcnt(5)
v_mfma_f32_32x32x16_bf16 a[0:15], v[224:227], v[72:75], a[0:15]
ds_read_b128 v[248:251], v4 offset:63488
v_exp_f32 v191, v191
v_add_f32 v25, v25, v220
v_cvt_pk_bf16_f32 v94, v220, v221
v_max3_f32 v28, v28, v112, v113
v_mfma_f32_32x32x16_bf16 a[64:79], v[224:227], v[88:91], a[64:79]
v_add_f32 v25, v25, v221
v_exp_f32 v222, v222
v_exp_f32 v223, v223
v_max3_f32 v27, v27, v114, v115
v_max3_f32 v28, v28, v116, v117
s_waitcnt lgkmcnt(5)
v_mfma_f32_32x32x16_bf16 a[16:31], v[228:231], v[72:75], a[16:31]
ds_read_b128 v[252:255], v4 offset:64512
v_add_f32 v24, v24, v190
v_cvt_pk_bf16_f32 v79, v190, v191
v_add_f32 v24, v24, v191
v_max3_f32 v27, v27, v118, v119
v_max3_f32 v28, v28, v120, v121
v_mfma_f32_32x32x16_bf16 a[80:95], v[228:231], v[88:91], a[80:95]
s_nop 0
v_add_f32 v25, v25, v222
v_cvt_pk_bf16_f32 v95, v222, v223
v_add_f32 v25, v25, v223
v_max3_f32 v27, v27, v122, v123
v_max3_f32 v28, v28, v124, v125
s_waitcnt lgkmcnt(5)
v_mfma_f32_32x32x16_bf16 a[32:47], v[232:235], v[72:75], a[32:47]
v_max3_f32 v27, v27, v126, v127
v_max3_f32 v28, v28, v128, v129
v_mfma_f32_32x32x16_bf16 a[96:111], v[232:235], v[88:91], a[96:111]
buffer_load_dword a192, v2, s[12:15], s61 offen
s_add_u32 s61, s61, 16384
s_min_u32 s61, s61, s62
v_max3_f32 v27, v27, v130, v131
s_waitcnt lgkmcnt(4)
v_mfma_f32_32x32x16_bf16 a[48:63], v[236:239], v[72:75], a[48:63]
v_max3_f32 v28, v28, v132, v133
v_max3_f32 v27, v27, v134, v135
v_mfma_f32_32x32x16_bf16 a[112:127], v[236:239], v[88:91], a[112:127]
s_waitcnt vmcnt(1) lgkmcnt(0)
s_barrier
ds_read_b128 v[224:227], v4 offset:16384
ds_read_b128 v[228:231], v4 offset:17408
ds_read_b128 v[232:235], v4 offset:18432
ds_read_b128 v[236:239], v4 offset:19456
v_max3_f32 v28, v28, v136, v137
v_max3_f32 v27, v27, v138, v139
v_mfma_f32_32x32x16_bf16 a[0:15], v[240:243], v[76:79], a[0:15]
s_cmp_lt_i32 s47, 1
s_cbranch_scc1 L_23
s_add_u32 m0, s49, 0
s_nop 0
buffer_load_dwordx4 v5, s[16:19], s45 offen offset:0 lds
L_23:
v_max3_f32 v28, v28, v140, v141
v_max3_f32 v27, v27, v142, v143
v_mfma_f32_32x32x16_bf16 a[64:79], v[240:243], v[92:95], a[64:79]
ds_read_b128 v[240:243], v4 offset:20480
s_cmp_lt_i32 s47, 1
s_cbranch_scc1 L_24
buffer_load_dwordx4 v5, s[16:19], s45 offen offset:1024 lds
L_24:
v_max3_f32 v28, v28, v144, v145
v_mfma_f32_32x32x16_bf16 a[16:31], v[244:247], v[76:79], a[16:31]
s_cmp_lt_i32 s47, 1
s_cbranch_scc1 L_25
buffer_load_dwordx4 v5, s[16:19], s45 offen offset:2048 lds
L_25:
v_max3_f32 v27, v27, v146, v147
v_max3_f32 v28, v28, v148, v149
v_mfma_f32_32x32x16_bf16 a[80:95], v[244:247], v[92:95], a[80:95]
ds_read_b128 v[244:247], v4 offset:21504
s_cmp_lt_i32 s47, 1
s_cbranch_scc1 L_26
buffer_load_dwordx4 v5, s[16:19], s45 offen offset:3072 lds
L_26:
v_max3_f32 v27, v27, v150, v151
v_max3_f32 v28, v28, v152, v153
v_mfma_f32_32x32x16_bf16 a[32:47], v[248:251], v[76:79], a[32:47]
s_cmp_lt_i32 s47, 1
s_cbranch_scc1 L_27
s_add_u32 m0, s49, 4096
s_add_u32 s45, s45, 4096
buffer_load_dwordx4 v5, s[16:19], s45 offen offset:0 lds
L_27:
v_max3_f32 v27, v27, v154, v155
v_max3_f32 v28, v28, v156, v157
v_mfma_f32_32x32x16_bf16 a[96:111], v[248:251], v[92:95], a[96:111]
s_cmp_lt_i32 s47, 1
s_cbranch_scc1 L_28
buffer_load_dwordx4 v5, s[16:19], s45 offen offset:1024 lds
L_28:
v_max3_f32 v27, v27, v158, v159
v_max_f32 v27, v27, v28
v_mfma_f32_32x32x16_bf16 a[48:63], v[252:255], v[76:79], a[48:63]
s_cmp_lt_i32 s47, 1
s_cbranch_scc1 L_29
buffer_load_dwordx4 v5, s[16:19], s45 offen offset:2048 lds
L_29:
v_cmp_lt_f32 vcc, 0x42000000, v27
v_mfma_f32_32x32x16_bf16 a[112:127], v[252:255], v[92:95], a[112:127]
s_cmp_lt_i32 s47, 1
s_cbranch_scc1 L_30
buffer_load_dwordx4 v5, s[16:19], s45 offen offset:3072 lds
s_add_u32 s45, s45, 0x7000
L_30:
s_sub_u32 s47, s47, 1
s_cbranch_vccnz at_rs1
at_rb1:
s_sub_u32 s40, s40, 1
s_branch at_loop
at_rs0:
v_max3_f32 v27, v160, v161, v162
v_max3_f32 v28, v163, v164, v165
v_max3_f32 v27, v27, v166, v167
v_max3_f32 v28, v28, v168, v169
v_max3_f32 v27, v27, v170, v171
v_max3_f32 v28, v28, v172, v173
v_max3_f32 v27, v27, v174, v175
v_max3_f32 v28, v28, v176, v177
v_max3_f32 v27, v27, v178, v179
v_max3_f32 v28, v28, v180, v181
v_max3_f32 v27, v27, v182, v183
v_max3_f32 v28, v28, v184, v185
v_max3_f32 v27, v27, v186, v187
v_max3_f32 v28, v28, v188, v189
v_max3_f32 v27, v27, v190, v191
v_max_f32 v27, v27, v28
v_mov_b32 v28, v27
s_nop 1
v_permlane32_swap_b32 v28, v27
s_nop 1
v_max_f32 v27, v27, v28
v_max_f32 v27, 0, v27
v_add_f32 v26, v26, v27
v_sub_f32 v28, 0, v27
v_exp_f32 v28, v28
v_sub_f32 v160, v160, v27
v_sub_f32 v161, v161, v27
v_sub_f32 v162, v162, v27
v_sub_f32 v163, v163, v27
v_sub_f32 v164, v164, v27
v_sub_f32 v165, v165, v27
v_sub_f32 v166, v166, v27
v_sub_f32 v167, v167, v27
v_sub_f32 v168, v168, v27
v_sub_f32 v169, v169, v27
v_sub_f32 v170, v170, v27
v_sub_f32 v171, v171, v27
v_sub_f32 v172, v172, v27
v_sub_f32 v173, v173, v27
v_sub_f32 v174, v174, v27
v_sub_f32 v175, v175, v27
v_sub_f32 v176, v176, v27
v_sub_f32 v177, v177, v27
v_sub_f32 v178, v178, v27
v_sub_f32 v179, v179, v27
v_sub_f32 v180, v180, v27
v_sub_f32 v181, v181, v27
v_sub_f32 v182, v182, v27
v_sub_f32 v183, v183, v27
v_sub_f32 v184, v184, v27
v_sub_f32 v185, v185, v27
v_sub_f32 v186, v186, v27
v_sub_f32 v187, v187, v27
v_sub_f32 v188, v188, v27
v_sub_f32 v189, v189, v27
v_sub_f32 v190, v190, v27
v_sub_f32 v191, v191, v27
v_sub_f32 v32, 0, v26
v_sub_f32 v33, 0, v26
v_sub_f32 v34, 0, v26
v_sub_f32 v35, 0, v26
v_sub_f32 v36, 0, v26
v_sub_f32 v37, 0, v26
v_sub_f32 v38, 0, v26
v_sub_f32 v39, 0, v26
v_sub_f32 v40, 0, v26
v_sub_f32 v41, 0, v26
v_sub_f32 v42, 0, v26
v_sub_f32 v43, 0, v26
v_sub_f32 v44, 0, v26
v_sub_f32 v45, 0, v26
v_sub_f32 v46, 0, v26
v_sub_f32 v47, 0, v26
v_mul_f32 v24, v24, v28
v_accvgpr_read_b32 v64, a0
v_accvgpr_read_b32 v65, a1
v_accvgpr_read_b32 v66, a2
v_accvgpr_read_b32 v67, a3
v_mul_f32 v64, v64, v28
v_mul_f32 v65, v65, v28
v_mul_f32 v66, v66, v28
v_mul_f32 v67, v67, v28
v_accvgpr_write_b32 a0, v64
v_accvgpr_write_b32 a1, v65
v_accvgpr_write_b32 a2, v66
v_accvgpr_write_b32 a3, v67
v_accvgpr_read_b32 v64, a4
v_accvgpr_read_b32 v65, a5
v_accvgpr_read_b32 v66, a6
v_accvgpr_read_b32 v67, a7
v_mul_f32 v64, v64, v28
v_mul_f32 v65, v65, v28
v_mul_f32 v66, v66, v28
v_mul_f32 v67, v67, v28
v_accvgpr_write_b32 a4, v64
v_accvgpr_write_b32 a5, v65
v_accvgpr_write_b32 a6, v66
v_accvgpr_write_b32 a7, v67
v_accvgpr_read_b32 v64, a8
v_accvgpr_read_b32 v65, a9
v_accvgpr_read_b32 v66, a10
v_accvgpr_read_b32 v67, a11
v_mul_f32 v64, v64, v28
v_mul_f32 v65, v65, v28
v_mul_f32 v66, v66, v28
v_mul_f32 v67, v67, v28
v_accvgpr_write_b32 a8, v64
v_accvgpr_write_b32 a9, v65
v_accvgpr_write_b32 a10, v66
v_accvgpr_write_b32 a11, v67
v_accvgpr_read_b32 v64, a12
v_accvgpr_read_b32 v65, a13
v_accvgpr_read_b32 v66, a14
v_accvgpr_read_b32 v67, a15
v_mul_f32 v64, v64, v28
v_mul_f32 v65, v65, v28
v_mul_f32 v66, v66, v28
v_mul_f32 v67, v67, v28
v_accvgpr_write_b32 a12, v64
v_accvgpr_write_b32 a13, v65
v_accvgpr_write_b32 a14, v66
v_accvgpr_write_b32 a15, v67
v_accvgpr_read_b32 v64, a16
v_accvgpr_read_b32 v65, a17
v_accvgpr_read_b32 v66, a18
v_accvgpr_read_b32 v67, a19
v_mul_f32 v64, v64, v28
v_mul_f32 v65, v65, v28
v_mul_f32 v66, v66, v28
v_mul_f32 v67, v67, v28
v_accvgpr_write_b32 a16, v64
v_accvgpr_write_b32 a17, v65
v_accvgpr_write_b32 a18, v66
v_accvgpr_write_b32 a19, v67
v_accvgpr_read_b32 v64, a20
v_accvgpr_read_b32 v65, a21
v_accvgpr_read_b32 v66, a22
v_accvgpr_read_b32 v67, a23
v_mul_f32 v64, v64, v28
v_mul_f32 v65, v65, v28
v_mul_f32 v66, v66, v28
v_mul_f32 v67, v67, v28
v_accvgpr_write_b32 a20, v64
v_accvgpr_write_b32 a21, v65
v_accvgpr_write_b32 a22, v66
v_accvgpr_write_b32 a23, v67
v_accvgpr_read_b32 v64, a24
v_accvgpr_read_b32 v65, a25
v_accvgpr_read_b32 v66, a26
v_accvgpr_read_b32 v67, a27
v_mul_f32 v64, v64, v28
v_mul_f32 v65, v65, v28
v_mul_f32 v66, v66, v28
v_mul_f32 v67, v67, v28
v_accvgpr_write_b32 a24, v64
v_accvgpr_write_b32 a25, v65
v_accvgpr_write_b32 a26, v66
v_accvgpr_write_b32 a27, v67
v_accvgpr_read_b32 v64, a28
v_accvgpr_read_b32 v65, a29
v_accvgpr_read_b32 v66, a30
v_accvgpr_read_b32 v67, a31
v_mul_f32 v64, v64, v28
v_mul_f32 v65, v65, v28
v_mul_f32 v66, v66, v28
v_mul_f32 v67, v67, v28
v_accvgpr_write_b32 a28, v64
v_accvgpr_write_b32 a29, v65
v_accvgpr_write_b32 a30, v66
v_accvgpr_write_b32 a31, v67
v_accvgpr_read_b32 v64, a32
v_accvgpr_read_b32 v65, a33
v_accvgpr_read_b32 v66, a34
v_accvgpr_read_b32 v67, a35
v_mul_f32 v64, v64, v28
v_mul_f32 v65, v65, v28
v_mul_f32 v66, v66, v28
v_mul_f32 v67, v67, v28
v_accvgpr_write_b32 a32, v64
v_accvgpr_write_b32 a33, v65
v_accvgpr_write_b32 a34, v66
v_accvgpr_write_b32 a35, v67
v_accvgpr_read_b32 v64, a36
v_accvgpr_read_b32 v65, a37
v_accvgpr_read_b32 v66, a38
v_accvgpr_read_b32 v67, a39
v_mul_f32 v64, v64, v28
v_mul_f32 v65, v65, v28
v_mul_f32 v66, v66, v28
v_mul_f32 v67, v67, v28
v_accvgpr_write_b32 a36, v64
v_accvgpr_write_b32 a37, v65
v_accvgpr_write_b32 a38, v66
v_accvgpr_write_b32 a39, v67
v_accvgpr_read_b32 v64, a40
v_accvgpr_read_b32 v65, a41
v_accvgpr_read_b32 v66, a42
v_accvgpr_read_b32 v67, a43
v_mul_f32 v64, v64, v28
v_mul_f32 v65, v65, v28
v_mul_f32 v66, v66, v28
v_mul_f32 v67, v67, v28
v_accvgpr_write_b32 a40, v64
v_accvgpr_write_b32 a41, v65
v_accvgpr_write_b32 a42, v66
v_accvgpr_write_b32 a43, v67
v_accvgpr_read_b32 v64, a44
v_accvgpr_read_b32 v65, a45
v_accvgpr_read_b32 v66, a46
v_accvgpr_read_b32 v67, a47
v_mul_f32 v64, v64, v28
v_mul_f32 v65, v65, v28
v_mul_f32 v66, v66, v28
v_mul_f32 v67, v67, v28
v_accvgpr_write_b32 a44, v64
v_accvgpr_write_b32 a45, v65
v_accvgpr_write_b32 a46, v66
v_accvgpr_write_b32 a47, v67
v_accvgpr_read_b32 v64, a48
v_accvgpr_read_b32 v65, a49
v_accvgpr_read_b32 v66, a50
v_accvgpr_read_b32 v67, a51
v_mul_f32 v64, v64, v28
v_mul_f32 v65, v65, v28
v_mul_f32 v66, v66, v28
v_mul_f32 v67, v67, v28
v_accvgpr_write_b32 a48, v64
v_accvgpr_write_b32 a49, v65
v_accvgpr_write_b32 a50, v66
v_accvgpr_write_b32 a51, v67
v_accvgpr_read_b32 v64, a52
v_accvgpr_read_b32 v65, a53
v_accvgpr_read_b32 v66, a54
v_accvgpr_read_b32 v67, a55
v_mul_f32 v64, v64, v28
v_mul_f32 v65, v65, v28
v_mul_f32 v66, v66, v28
v_mul_f32 v67, v67, v28
v_accvgpr_write_b32 a52, v64
v_accvgpr_write_b32 a53, v65
v_accvgpr_write_b32 a54, v66
v_accvgpr_write_b32 a55, v67
v_accvgpr_read_b32 v64, a56
v_accvgpr_read_b32 v65, a57
v_accvgpr_read_b32 v66, a58
v_accvgpr_read_b32 v67, a59
v_mul_f32 v64, v64, v28
v_mul_f32 v65, v65, v28
v_mul_f32 v66, v66, v28
v_mul_f32 v67, v67, v28
v_accvgpr_write_b32 a56, v64
v_accvgpr_write_b32 a57, v65
v_accvgpr_write_b32 a58, v66
v_accvgpr_write_b32 a59, v67
v_accvgpr_read_b32 v64, a60
v_accvgpr_read_b32 v65, a61
v_accvgpr_read_b32 v66, a62
v_accvgpr_read_b32 v67, a63
v_mul_f32 v64, v64, v28
v_mul_f32 v65, v65, v28
v_mul_f32 v66, v66, v28
v_mul_f32 v67, v67, v28
v_accvgpr_write_b32 a60, v64
v_accvgpr_write_b32 a61, v65
v_accvgpr_write_b32 a62, v66
v_accvgpr_write_b32 a63, v67
v_max3_f32 v27, v192, v193, v194
v_max3_f32 v28, v195, v196, v197
v_max3_f32 v27, v27, v198, v199
v_max3_f32 v28, v28, v200, v201
v_max3_f32 v27, v27, v202, v203
v_max3_f32 v28, v28, v204, v205
v_max3_f32 v27, v27, v206, v207
v_max3_f32 v28, v28, v208, v209
v_max3_f32 v27, v27, v210, v211
v_max3_f32 v28, v28, v212, v213
v_max3_f32 v27, v27, v214, v215
v_max3_f32 v28, v28, v216, v217
v_max3_f32 v27, v27, v218, v219
v_max3_f32 v28, v28, v220, v221
v_max3_f32 v27, v27, v222, v223
v_max_f32 v27, v27, v28
v_mov_b32 v28, v27
s_nop 1
v_permlane32_swap_b32 v28, v27
s_nop 1
v_max_f32 v27, v27, v28
v_max_f32 v27, 0, v27
v_add_f32 v3, v3, v27
v_sub_f32 v28, 0, v27
v_exp_f32 v28, v28
v_sub_f32 v192, v192, v27
v_sub_f32 v193, v193, v27
v_sub_f32 v194, v194, v27
v_sub_f32 v195, v195, v27
v_sub_f32 v196, v196, v27
v_sub_f32 v197, v197, v27
v_sub_f32 v198, v198, v27
v_sub_f32 v199, v199, v27
v_sub_f32 v200, v200, v27
v_sub_f32 v201, v201, v27
v_sub_f32 v202, v202, v27
v_sub_f32 v203, v203, v27
v_sub_f32 v204, v204, v27
v_sub_f32 v205, v205, v27
v_sub_f32 v206, v206, v27
v_sub_f32 v207, v207, v27
v_sub_f32 v208, v208, v27
v_sub_f32 v209, v209, v27
v_sub_f32 v210, v210, v27
v_sub_f32 v211, v211, v27
v_sub_f32 v212, v212, v27
v_sub_f32 v213, v213, v27
v_sub_f32 v214, v214, v27
v_sub_f32 v215, v215, v27
v_sub_f32 v216, v216, v27
v_sub_f32 v217, v217, v27
v_sub_f32 v218, v218, v27
v_sub_f32 v219, v219, v27
v_sub_f32 v220, v220, v27
v_sub_f32 v221, v221, v27
v_sub_f32 v222, v222, v27
v_sub_f32 v223, v223, v27
v_sub_f32 v48, 0, v3
v_sub_f32 v49, 0, v3
v_sub_f32 v50, 0, v3
v_sub_f32 v51, 0, v3
v_sub_f32 v52, 0, v3
v_sub_f32 v53, 0, v3
v_sub_f32 v54, 0, v3
v_sub_f32 v55, 0, v3
v_sub_f32 v56, 0, v3
v_sub_f32 v57, 0, v3
v_sub_f32 v58, 0, v3
v_sub_f32 v59, 0, v3
v_sub_f32 v60, 0, v3
v_sub_f32 v61, 0, v3
v_sub_f32 v62, 0, v3
v_sub_f32 v63, 0, v3
v_mul_f32 v25, v25, v28
v_accvgpr_read_b32 v64, a64
v_accvgpr_read_b32 v65, a65
v_accvgpr_read_b32 v66, a66
v_accvgpr_read_b32 v67, a67
v_mul_f32 v64, v64, v28
v_mul_f32 v65, v65, v28
v_mul_f32 v66, v66, v28
v_mul_f32 v67, v67, v28
v_accvgpr_write_b32 a64, v64
v_accvgpr_write_b32 a65, v65
v_accvgpr_write_b32 a66, v66
v_accvgpr_write_b32 a67, v67
v_accvgpr_read_b32 v64, a68
v_accvgpr_read_b32 v65, a69
v_accvgpr_read_b32 v66, a70
v_accvgpr_read_b32 v67, a71
v_mul_f32 v64, v64, v28
v_mul_f32 v65, v65, v28
v_mul_f32 v66, v66, v28
v_mul_f32 v67, v67, v28
v_accvgpr_write_b32 a68, v64
v_accvgpr_write_b32 a69, v65
v_accvgpr_write_b32 a70, v66
v_accvgpr_write_b32 a71, v67
v_accvgpr_read_b32 v64, a72
v_accvgpr_read_b32 v65, a73
v_accvgpr_read_b32 v66, a74
v_accvgpr_read_b32 v67, a75
v_mul_f32 v64, v64, v28
v_mul_f32 v65, v65, v28
v_mul_f32 v66, v66, v28
v_mul_f32 v67, v67, v28
v_accvgpr_write_b32 a72, v64
v_accvgpr_write_b32 a73, v65
v_accvgpr_write_b32 a74, v66
v_accvgpr_write_b32 a75, v67
v_accvgpr_read_b32 v64, a76
v_accvgpr_read_b32 v65, a77
v_accvgpr_read_b32 v66, a78
v_accvgpr_read_b32 v67, a79
v_mul_f32 v64, v64, v28
v_mul_f32 v65, v65, v28
v_mul_f32 v66, v66, v28
v_mul_f32 v67, v67, v28
v_accvgpr_write_b32 a76, v64
v_accvgpr_write_b32 a77, v65
v_accvgpr_write_b32 a78, v66
v_accvgpr_write_b32 a79, v67
v_accvgpr_read_b32 v64, a80
v_accvgpr_read_b32 v65, a81
v_accvgpr_read_b32 v66, a82
v_accvgpr_read_b32 v67, a83
v_mul_f32 v64, v64, v28
v_mul_f32 v65, v65, v28
v_mul_f32 v66, v66, v28
v_mul_f32 v67, v67, v28
v_accvgpr_write_b32 a80, v64
v_accvgpr_write_b32 a81, v65
v_accvgpr_write_b32 a82, v66
v_accvgpr_write_b32 a83, v67
v_accvgpr_read_b32 v64, a84
v_accvgpr_read_b32 v65, a85
v_accvgpr_read_b32 v66, a86
v_accvgpr_read_b32 v67, a87
v_mul_f32 v64, v64, v28
v_mul_f32 v65, v65, v28
v_mul_f32 v66, v66, v28
v_mul_f32 v67, v67, v28
v_accvgpr_write_b32 a84, v64
v_accvgpr_write_b32 a85, v65
v_accvgpr_write_b32 a86, v66
v_accvgpr_write_b32 a87, v67
v_accvgpr_read_b32 v64, a88
v_accvgpr_read_b32 v65, a89
v_accvgpr_read_b32 v66, a90
v_accvgpr_read_b32 v67, a91
v_mul_f32 v64, v64, v28
v_mul_f32 v65, v65, v28
v_mul_f32 v66, v66, v28
v_mul_f32 v67, v67, v28
v_accvgpr_write_b32 a88, v64
v_accvgpr_write_b32 a89, v65
v_accvgpr_write_b32 a90, v66
v_accvgpr_write_b32 a91, v67
v_accvgpr_read_b32 v64, a92
v_accvgpr_read_b32 v65, a93
v_accvgpr_read_b32 v66, a94
v_accvgpr_read_b32 v67, a95
v_mul_f32 v64, v64, v28
v_mul_f32 v65, v65, v28
v_mul_f32 v66, v66, v28
v_mul_f32 v67, v67, v28
v_accvgpr_write_b32 a92, v64
v_accvgpr_write_b32 a93, v65
v_accvgpr_write_b32 a94, v66
v_accvgpr_write_b32 a95, v67
v_accvgpr_read_b32 v64, a96
v_accvgpr_read_b32 v65, a97
v_accvgpr_read_b32 v66, a98
v_accvgpr_read_b32 v67, a99
v_mul_f32 v64, v64, v28
v_mul_f32 v65, v65, v28
v_mul_f32 v66, v66, v28
v_mul_f32 v67, v67, v28
v_accvgpr_write_b32 a96, v64
v_accvgpr_write_b32 a97, v65
v_accvgpr_write_b32 a98, v66
v_accvgpr_write_b32 a99, v67
v_accvgpr_read_b32 v64, a100
v_accvgpr_read_b32 v65, a101
v_accvgpr_read_b32 v66, a102
v_accvgpr_read_b32 v67, a103
v_mul_f32 v64, v64, v28
v_mul_f32 v65, v65, v28
v_mul_f32 v66, v66, v28
v_mul_f32 v67, v67, v28
v_accvgpr_write_b32 a100, v64
v_accvgpr_write_b32 a101, v65
v_accvgpr_write_b32 a102, v66
v_accvgpr_write_b32 a103, v67
v_accvgpr_read_b32 v64, a104
v_accvgpr_read_b32 v65, a105
v_accvgpr_read_b32 v66, a106
v_accvgpr_read_b32 v67, a107
v_mul_f32 v64, v64, v28
v_mul_f32 v65, v65, v28
v_mul_f32 v66, v66, v28
v_mul_f32 v67, v67, v28
v_accvgpr_write_b32 a104, v64
v_accvgpr_write_b32 a105, v65
v_accvgpr_write_b32 a106, v66
v_accvgpr_write_b32 a107, v67
v_accvgpr_read_b32 v64, a108
v_accvgpr_read_b32 v65, a109
v_accvgpr_read_b32 v66, a110
v_accvgpr_read_b32 v67, a111
v_mul_f32 v64, v64, v28
v_mul_f32 v65, v65, v28
v_mul_f32 v66, v66, v28
v_mul_f32 v67, v67, v28
v_accvgpr_write_b32 a108, v64
v_accvgpr_write_b32 a109, v65
v_accvgpr_write_b32 a110, v66
v_accvgpr_write_b32 a111, v67
v_accvgpr_read_b32 v64, a112
v_accvgpr_read_b32 v65, a113
v_accvgpr_read_b32 v66, a114
v_accvgpr_read_b32 v67, a115
v_mul_f32 v64, v64, v28
v_mul_f32 v65, v65, v28
v_mul_f32 v66, v66, v28
v_mul_f32 v67, v67, v28
v_accvgpr_write_b32 a112, v64
v_accvgpr_write_b32 a113, v65
v_accvgpr_write_b32 a114, v66
v_accvgpr_write_b32 a115, v67
v_accvgpr_read_b32 v64, a116
v_accvgpr_read_b32 v65, a117
v_accvgpr_read_b32 v66, a118
v_accvgpr_read_b32 v67, a119
v_mul_f32 v64, v64, v28
v_mul_f32 v65, v65, v28
v_mul_f32 v66, v66, v28
v_mul_f32 v67, v67, v28
v_accvgpr_write_b32 a116, v64
v_accvgpr_write_b32 a117, v65
v_accvgpr_write_b32 a118, v66
v_accvgpr_write_b32 a119, v67
v_accvgpr_read_b32 v64, a120
v_accvgpr_read_b32 v65, a121
v_accvgpr_read_b32 v66, a122
v_accvgpr_read_b32 v67, a123
v_mul_f32 v64, v64, v28
v_mul_f32 v65, v65, v28
v_mul_f32 v66, v66, v28
v_mul_f32 v67, v67, v28
v_accvgpr_write_b32 a120, v64
v_accvgpr_write_b32 a121, v65
v_accvgpr_write_b32 a122, v66
v_accvgpr_write_b32 a123, v67
v_accvgpr_read_b32 v64, a124
v_accvgpr_read_b32 v65, a125
v_accvgpr_read_b32 v66, a126
v_accvgpr_read_b32 v67, a127
v_mul_f32 v64, v64, v28
v_mul_f32 v65, v65, v28
v_mul_f32 v66, v66, v28
v_mul_f32 v67, v67, v28
v_accvgpr_write_b32 a124, v64
v_accvgpr_write_b32 a125, v65
v_accvgpr_write_b32 a126, v66
v_accvgpr_write_b32 a127, v67
s_nop 1
s_branch at_rb0
at_rs1:
v_max3_f32 v27, v96, v97, v98
v_max3_f32 v28, v99, v100, v101
v_max3_f32 v27, v27, v102, v103
v_max3_f32 v28, v28, v104, v105
v_max3_f32 v27, v27, v106, v107
v_max3_f32 v28, v28, v108, v109
v_max3_f32 v27, v27, v110, v111
v_max3_f32 v28, v28, v112, v113
v_max3_f32 v27, v27, v114, v115
v_max3_f32 v28, v28, v116, v117
v_max3_f32 v27, v27, v118, v119
v_max3_f32 v28, v28, v120, v121
v_max3_f32 v27, v27, v122, v123
v_max3_f32 v28, v28, v124, v125
v_max3_f32 v27, v27, v126, v127
v_max_f32 v27, v27, v28
v_mov_b32 v28, v27
s_nop 1
v_permlane32_swap_b32 v28, v27
s_nop 1
v_max_f32 v27, v27, v28
v_max_f32 v27, 0, v27
v_add_f32 v26, v26, v27
v_sub_f32 v28, 0, v27
v_exp_f32 v28, v28
v_sub_f32 v96, v96, v27
v_sub_f32 v97, v97, v27
v_sub_f32 v98, v98, v27
v_sub_f32 v99, v99, v27
v_sub_f32 v100, v100, v27
v_sub_f32 v101, v101, v27
v_sub_f32 v102, v102, v27
v_sub_f32 v103, v103, v27
v_sub_f32 v104, v104, v27
v_sub_f32 v105, v105, v27
v_sub_f32 v106, v106, v27
v_sub_f32 v107, v107, v27
v_sub_f32 v108, v108, v27
v_sub_f32 v109, v109, v27
v_sub_f32 v110, v110, v27
v_sub_f32 v111, v111, v27
v_sub_f32 v112, v112, v27
v_sub_f32 v113, v113, v27
v_sub_f32 v114, v114, v27
v_sub_f32 v115, v115, v27
v_sub_f32 v116, v116, v27
v_sub_f32 v117, v117, v27
v_sub_f32 v118, v118, v27
v_sub_f32 v119, v119, v27
v_sub_f32 v120, v120, v27
v_sub_f32 v121, v121, v27
v_sub_f32 v122, v122, v27
v_sub_f32 v123, v123, v27
v_sub_f32 v124, v124, v27
v_sub_f32 v125, v125, v27
v_sub_f32 v126, v126, v27
v_sub_f32 v127, v127, v27
v_sub_f32 v32, 0, v26
v_sub_f32 v33, 0, v26
v_sub_f32 v34, 0, v26
v_sub_f32 v35, 0, v26
v_sub_f32 v36, 0, v26
v_sub_f32 v37, 0, v26
v_sub_f32 v38, 0, v26
v_sub_f32 v39, 0, v26
v_sub_f32 v40, 0, v26
v_sub_f32 v41, 0, v26
v_sub_f32 v42, 0, v26
v_sub_f32 v43, 0, v26
v_sub_f32 v44, 0, v26
v_sub_f32 v45, 0, v26
v_sub_f32 v46, 0, v26
v_sub_f32 v47, 0, v26
v_mul_f32 v24, v24, v28
v_accvgpr_read_b32 v64, a0
v_accvgpr_read_b32 v65, a1
v_accvgpr_read_b32 v66, a2
v_accvgpr_read_b32 v67, a3
v_mul_f32 v64, v64, v28
v_mul_f32 v65, v65, v28
v_mul_f32 v66, v66, v28
v_mul_f32 v67, v67, v28
v_accvgpr_write_b32 a0, v64
v_accvgpr_write_b32 a1, v65
v_accvgpr_write_b32 a2, v66
v_accvgpr_write_b32 a3, v67
v_accvgpr_read_b32 v64, a4
v_accvgpr_read_b32 v65, a5
v_accvgpr_read_b32 v66, a6
v_accvgpr_read_b32 v67, a7
v_mul_f32 v64, v64, v28
v_mul_f32 v65, v65, v28
v_mul_f32 v66, v66, v28
v_mul_f32 v67, v67, v28
v_accvgpr_write_b32 a4, v64
v_accvgpr_write_b32 a5, v65
v_accvgpr_write_b32 a6, v66
v_accvgpr_write_b32 a7, v67
v_accvgpr_read_b32 v64, a8
v_accvgpr_read_b32 v65, a9
v_accvgpr_read_b32 v66, a10
v_accvgpr_read_b32 v67, a11
v_mul_f32 v64, v64, v28
v_mul_f32 v65, v65, v28
v_mul_f32 v66, v66, v28
v_mul_f32 v67, v67, v28
v_accvgpr_write_b32 a8, v64
v_accvgpr_write_b32 a9, v65
v_accvgpr_write_b32 a10, v66
v_accvgpr_write_b32 a11, v67
v_accvgpr_read_b32 v64, a12
v_accvgpr_read_b32 v65, a13
v_accvgpr_read_b32 v66, a14
v_accvgpr_read_b32 v67, a15
v_mul_f32 v64, v64, v28
v_mul_f32 v65, v65, v28
v_mul_f32 v66, v66, v28
v_mul_f32 v67, v67, v28
v_accvgpr_write_b32 a12, v64
v_accvgpr_write_b32 a13, v65
v_accvgpr_write_b32 a14, v66
v_accvgpr_write_b32 a15, v67
v_accvgpr_read_b32 v64, a16
v_accvgpr_read_b32 v65, a17
v_accvgpr_read_b32 v66, a18
v_accvgpr_read_b32 v67, a19
v_mul_f32 v64, v64, v28
v_mul_f32 v65, v65, v28
v_mul_f32 v66, v66, v28
v_mul_f32 v67, v67, v28
v_accvgpr_write_b32 a16, v64
v_accvgpr_write_b32 a17, v65
v_accvgpr_write_b32 a18, v66
v_accvgpr_write_b32 a19, v67
v_accvgpr_read_b32 v64, a20
v_accvgpr_read_b32 v65, a21
v_accvgpr_read_b32 v66, a22
v_accvgpr_read_b32 v67, a23
v_mul_f32 v64, v64, v28
v_mul_f32 v65, v65, v28
v_mul_f32 v66, v66, v28
v_mul_f32 v67, v67, v28
v_accvgpr_write_b32 a20, v64
v_accvgpr_write_b32 a21, v65
v_accvgpr_write_b32 a22, v66
v_accvgpr_write_b32 a23, v67
v_accvgpr_read_b32 v64, a24
v_accvgpr_read_b32 v65, a25
v_accvgpr_read_b32 v66, a26
v_accvgpr_read_b32 v67, a27
v_mul_f32 v64, v64, v28
v_mul_f32 v65, v65, v28
v_mul_f32 v66, v66, v28
v_mul_f32 v67, v67, v28
v_accvgpr_write_b32 a24, v64
v_accvgpr_write_b32 a25, v65
v_accvgpr_write_b32 a26, v66
v_accvgpr_write_b32 a27, v67
v_accvgpr_read_b32 v64, a28
v_accvgpr_read_b32 v65, a29
v_accvgpr_read_b32 v66, a30
v_accvgpr_read_b32 v67, a31
v_mul_f32 v64, v64, v28
v_mul_f32 v65, v65, v28
v_mul_f32 v66, v66, v28
v_mul_f32 v67, v67, v28
v_accvgpr_write_b32 a28, v64
v_accvgpr_write_b32 a29, v65
v_accvgpr_write_b32 a30, v66
v_accvgpr_write_b32 a31, v67
v_accvgpr_read_b32 v64, a32
v_accvgpr_read_b32 v65, a33
v_accvgpr_read_b32 v66, a34
v_accvgpr_read_b32 v67, a35
v_mul_f32 v64, v64, v28
v_mul_f32 v65, v65, v28
v_mul_f32 v66, v66, v28
v_mul_f32 v67, v67, v28
v_accvgpr_write_b32 a32, v64
v_accvgpr_write_b32 a33, v65
v_accvgpr_write_b32 a34, v66
v_accvgpr_write_b32 a35, v67
v_accvgpr_read_b32 v64, a36
v_accvgpr_read_b32 v65, a37
v_accvgpr_read_b32 v66, a38
v_accvgpr_read_b32 v67, a39
v_mul_f32 v64, v64, v28
v_mul_f32 v65, v65, v28
v_mul_f32 v66, v66, v28
v_mul_f32 v67, v67, v28
v_accvgpr_write_b32 a36, v64
v_accvgpr_write_b32 a37, v65
v_accvgpr_write_b32 a38, v66
v_accvgpr_write_b32 a39, v67
v_accvgpr_read_b32 v64, a40
v_accvgpr_read_b32 v65, a41
v_accvgpr_read_b32 v66, a42
v_accvgpr_read_b32 v67, a43
v_mul_f32 v64, v64, v28
v_mul_f32 v65, v65, v28
v_mul_f32 v66, v66, v28
v_mul_f32 v67, v67, v28
v_accvgpr_write_b32 a40, v64
v_accvgpr_write_b32 a41, v65
v_accvgpr_write_b32 a42, v66
v_accvgpr_write_b32 a43, v67
v_accvgpr_read_b32 v64, a44
v_accvgpr_read_b32 v65, a45
v_accvgpr_read_b32 v66, a46
v_accvgpr_read_b32 v67, a47
v_mul_f32 v64, v64, v28
v_mul_f32 v65, v65, v28
v_mul_f32 v66, v66, v28
v_mul_f32 v67, v67, v28
v_accvgpr_write_b32 a44, v64
v_accvgpr_write_b32 a45, v65
v_accvgpr_write_b32 a46, v66
v_accvgpr_write_b32 a47, v67
v_accvgpr_read_b32 v64, a48
v_accvgpr_read_b32 v65, a49
v_accvgpr_read_b32 v66, a50
v_accvgpr_read_b32 v67, a51
v_mul_f32 v64, v64, v28
v_mul_f32 v65, v65, v28
v_mul_f32 v66, v66, v28
v_mul_f32 v67, v67, v28
v_accvgpr_write_b32 a48, v64
v_accvgpr_write_b32 a49, v65
v_accvgpr_write_b32 a50, v66
v_accvgpr_write_b32 a51, v67
v_accvgpr_read_b32 v64, a52
v_accvgpr_read_b32 v65, a53
v_accvgpr_read_b32 v66, a54
v_accvgpr_read_b32 v67, a55
v_mul_f32 v64, v64, v28
v_mul_f32 v65, v65, v28
v_mul_f32 v66, v66, v28
v_mul_f32 v67, v67, v28
v_accvgpr_write_b32 a52, v64
v_accvgpr_write_b32 a53, v65
v_accvgpr_write_b32 a54, v66
v_accvgpr_write_b32 a55, v67
v_accvgpr_read_b32 v64, a56
v_accvgpr_read_b32 v65, a57
v_accvgpr_read_b32 v66, a58
v_accvgpr_read_b32 v67, a59
v_mul_f32 v64, v64, v28
v_mul_f32 v65, v65, v28
v_mul_f32 v66, v66, v28
v_mul_f32 v67, v67, v28
v_accvgpr_write_b32 a56, v64
v_accvgpr_write_b32 a57, v65
v_accvgpr_write_b32 a58, v66
v_accvgpr_write_b32 a59, v67
v_accvgpr_read_b32 v64, a60
v_accvgpr_read_b32 v65, a61
v_accvgpr_read_b32 v66, a62
v_accvgpr_read_b32 v67, a63
v_mul_f32 v64, v64, v28
v_mul_f32 v65, v65, v28
v_mul_f32 v66, v66, v28
v_mul_f32 v67, v67, v28
v_accvgpr_write_b32 a60, v64
v_accvgpr_write_b32 a61, v65
v_accvgpr_write_b32 a62, v66
v_accvgpr_write_b32 a63, v67
v_max3_f32 v27, v128, v129, v130
v_max3_f32 v28, v131, v132, v133
v_max3_f32 v27, v27, v134, v135
v_max3_f32 v28, v28, v136, v137
v_max3_f32 v27, v27, v138, v139
v_max3_f32 v28, v28, v140, v141
v_max3_f32 v27, v27, v142, v143
v_max3_f32 v28, v28, v144, v145
v_max3_f32 v27, v27, v146, v147
v_max3_f32 v28, v28, v148, v149
v_max3_f32 v27, v27, v150, v151
v_max3_f32 v28, v28, v152, v153
v_max3_f32 v27, v27, v154, v155
v_max3_f32 v28, v28, v156, v157
v_max3_f32 v27, v27, v158, v159
v_max_f32 v27, v27, v28
v_mov_b32 v28, v27
s_nop 1
v_permlane32_swap_b32 v28, v27
s_nop 1
v_max_f32 v27, v27, v28
v_max_f32 v27, 0, v27
v_add_f32 v3, v3, v27
v_sub_f32 v28, 0, v27
v_exp_f32 v28, v28
v_sub_f32 v128, v128, v27
v_sub_f32 v129, v129, v27
v_sub_f32 v130, v130, v27
v_sub_f32 v131, v131, v27
v_sub_f32 v132, v132, v27
v_sub_f32 v133, v133, v27
v_sub_f32 v134, v134, v27
v_sub_f32 v135, v135, v27
v_sub_f32 v136, v136, v27
v_sub_f32 v137, v137, v27
v_sub_f32 v138, v138, v27
v_sub_f32 v139, v139, v27
v_sub_f32 v140, v140, v27
v_sub_f32 v141, v141, v27
v_sub_f32 v142, v142, v27
v_sub_f32 v143, v143, v27
v_sub_f32 v144, v144, v27
v_sub_f32 v145, v145, v27
v_sub_f32 v146, v146, v27
v_sub_f32 v147, v147, v27
v_sub_f32 v148, v148, v27
v_sub_f32 v149, v149, v27
v_sub_f32 v150, v150, v27
v_sub_f32 v151, v151, v27
v_sub_f32 v152, v152, v27
v_sub_f32 v153, v153, v27
v_sub_f32 v154, v154, v27
v_sub_f32 v155, v155, v27
v_sub_f32 v156, v156, v27
v_sub_f32 v157, v157, v27
v_sub_f32 v158, v158, v27
v_sub_f32 v159, v159, v27
v_sub_f32 v48, 0, v3
v_sub_f32 v49, 0, v3
v_sub_f32 v50, 0, v3
v_sub_f32 v51, 0, v3
v_sub_f32 v52, 0, v3
v_sub_f32 v53, 0, v3
v_sub_f32 v54, 0, v3
v_sub_f32 v55, 0, v3
v_sub_f32 v56, 0, v3
v_sub_f32 v57, 0, v3
v_sub_f32 v58, 0, v3
v_sub_f32 v59, 0, v3
v_sub_f32 v60, 0, v3
v_sub_f32 v61, 0, v3
v_sub_f32 v62, 0, v3
v_sub_f32 v63, 0, v3
v_mul_f32 v25, v25, v28
v_accvgpr_read_b32 v64, a64
v_accvgpr_read_b32 v65, a65
v_accvgpr_read_b32 v66, a66
v_accvgpr_read_b32 v67, a67
v_mul_f32 v64, v64, v28
v_mul_f32 v65, v65, v28
v_mul_f32 v66, v66, v28
v_mul_f32 v67, v67, v28
v_accvgpr_write_b32 a64, v64
v_accvgpr_write_b32 a65, v65
v_accvgpr_write_b32 a66, v66
v_accvgpr_write_b32 a67, v67
v_accvgpr_read_b32 v64, a68
v_accvgpr_read_b32 v65, a69
v_accvgpr_read_b32 v66, a70
v_accvgpr_read_b32 v67, a71
v_mul_f32 v64, v64, v28
v_mul_f32 v65, v65, v28
v_mul_f32 v66, v66, v28
v_mul_f32 v67, v67, v28
v_accvgpr_write_b32 a68, v64
v_accvgpr_write_b32 a69, v65
v_accvgpr_write_b32 a70, v66
v_accvgpr_write_b32 a71, v67
v_accvgpr_read_b32 v64, a72
v_accvgpr_read_b32 v65, a73
v_accvgpr_read_b32 v66, a74
v_accvgpr_read_b32 v67, a75
v_mul_f32 v64, v64, v28
v_mul_f32 v65, v65, v28
v_mul_f32 v66, v66, v28
v_mul_f32 v67, v67, v28
v_accvgpr_write_b32 a72, v64
v_accvgpr_write_b32 a73, v65
v_accvgpr_write_b32 a74, v66
v_accvgpr_write_b32 a75, v67
v_accvgpr_read_b32 v64, a76
v_accvgpr_read_b32 v65, a77
v_accvgpr_read_b32 v66, a78
v_accvgpr_read_b32 v67, a79
v_mul_f32 v64, v64, v28
v_mul_f32 v65, v65, v28
v_mul_f32 v66, v66, v28
v_mul_f32 v67, v67, v28
v_accvgpr_write_b32 a76, v64
v_accvgpr_write_b32 a77, v65
v_accvgpr_write_b32 a78, v66
v_accvgpr_write_b32 a79, v67
v_accvgpr_read_b32 v64, a80
v_accvgpr_read_b32 v65, a81
v_accvgpr_read_b32 v66, a82
v_accvgpr_read_b32 v67, a83
v_mul_f32 v64, v64, v28
v_mul_f32 v65, v65, v28
v_mul_f32 v66, v66, v28
v_mul_f32 v67, v67, v28
v_accvgpr_write_b32 a80, v64
v_accvgpr_write_b32 a81, v65
v_accvgpr_write_b32 a82, v66
v_accvgpr_write_b32 a83, v67
v_accvgpr_read_b32 v64, a84
v_accvgpr_read_b32 v65, a85
v_accvgpr_read_b32 v66, a86
v_accvgpr_read_b32 v67, a87
v_mul_f32 v64, v64, v28
v_mul_f32 v65, v65, v28
v_mul_f32 v66, v66, v28
v_mul_f32 v67, v67, v28
v_accvgpr_write_b32 a84, v64
v_accvgpr_write_b32 a85, v65
v_accvgpr_write_b32 a86, v66
v_accvgpr_write_b32 a87, v67
v_accvgpr_read_b32 v64, a88
v_accvgpr_read_b32 v65, a89
v_accvgpr_read_b32 v66, a90
v_accvgpr_read_b32 v67, a91
v_mul_f32 v64, v64, v28
v_mul_f32 v65, v65, v28
v_mul_f32 v66, v66, v28
v_mul_f32 v67, v67, v28
v_accvgpr_write_b32 a88, v64
v_accvgpr_write_b32 a89, v65
v_accvgpr_write_b32 a90, v66
v_accvgpr_write_b32 a91, v67
v_accvgpr_read_b32 v64, a92
v_accvgpr_read_b32 v65, a93
v_accvgpr_read_b32 v66, a94
v_accvgpr_read_b32 v67, a95
v_mul_f32 v64, v64, v28
v_mul_f32 v65, v65, v28
v_mul_f32 v66, v66, v28
v_mul_f32 v67, v67, v28
v_accvgpr_write_b32 a92, v64
v_accvgpr_write_b32 a93, v65
v_accvgpr_write_b32 a94, v66
v_accvgpr_write_b32 a95, v67
v_accvgpr_read_b32 v64, a96
v_accvgpr_read_b32 v65, a97
v_accvgpr_read_b32 v66, a98
v_accvgpr_read_b32 v67, a99
v_mul_f32 v64, v64, v28
v_mul_f32 v65, v65, v28
v_mul_f32 v66, v66, v28
v_mul_f32 v67, v67, v28
v_accvgpr_write_b32 a96, v64
v_accvgpr_write_b32 a97, v65
v_accvgpr_write_b32 a98, v66
v_accvgpr_write_b32 a99, v67
v_accvgpr_read_b32 v64, a100
v_accvgpr_read_b32 v65, a101
v_accvgpr_read_b32 v66, a102
v_accvgpr_read_b32 v67, a103
v_mul_f32 v64, v64, v28
v_mul_f32 v65, v65, v28
v_mul_f32 v66, v66, v28
v_mul_f32 v67, v67, v28
v_accvgpr_write_b32 a100, v64
v_accvgpr_write_b32 a101, v65
v_accvgpr_write_b32 a102, v66
v_accvgpr_write_b32 a103, v67
v_accvgpr_read_b32 v64, a104
v_accvgpr_read_b32 v65, a105
v_accvgpr_read_b32 v66, a106
v_accvgpr_read_b32 v67, a107
v_mul_f32 v64, v64, v28
v_mul_f32 v65, v65, v28
v_mul_f32 v66, v66, v28
v_mul_f32 v67, v67, v28
v_accvgpr_write_b32 a104, v64
v_accvgpr_write_b32 a105, v65
v_accvgpr_write_b32 a106, v66
v_accvgpr_write_b32 a107, v67
v_accvgpr_read_b32 v64, a108
v_accvgpr_read_b32 v65, a109
v_accvgpr_read_b32 v66, a110
v_accvgpr_read_b32 v67, a111
v_mul_f32 v64, v64, v28
v_mul_f32 v65, v65, v28
v_mul_f32 v66, v66, v28
v_mul_f32 v67, v67, v28
v_accvgpr_write_b32 a108, v64
v_accvgpr_write_b32 a109, v65
v_accvgpr_write_b32 a110, v66
v_accvgpr_write_b32 a111, v67
v_accvgpr_read_b32 v64, a112
v_accvgpr_read_b32 v65, a113
v_accvgpr_read_b32 v66, a114
v_accvgpr_read_b32 v67, a115
v_mul_f32 v64, v64, v28
v_mul_f32 v65, v65, v28
v_mul_f32 v66, v66, v28
v_mul_f32 v67, v67, v28
v_accvgpr_write_b32 a112, v64
v_accvgpr_write_b32 a113, v65
v_accvgpr_write_b32 a114, v66
v_accvgpr_write_b32 a115, v67
v_accvgpr_read_b32 v64, a116
v_accvgpr_read_b32 v65, a117
v_accvgpr_read_b32 v66, a118
v_accvgpr_read_b32 v67, a119
v_mul_f32 v64, v64, v28
v_mul_f32 v65, v65, v28
v_mul_f32 v66, v66, v28
v_mul_f32 v67, v67, v28
v_accvgpr_write_b32 a116, v64
v_accvgpr_write_b32 a117, v65
v_accvgpr_write_b32 a118, v66
v_accvgpr_write_b32 a119, v67
v_accvgpr_read_b32 v64, a120
v_accvgpr_read_b32 v65, a121
v_accvgpr_read_b32 v66, a122
v_accvgpr_read_b32 v67, a123
v_mul_f32 v64, v64, v28
v_mul_f32 v65, v65, v28
v_mul_f32 v66, v66, v28
v_mul_f32 v67, v67, v28
v_accvgpr_write_b32 a120, v64
v_accvgpr_write_b32 a121, v65
v_accvgpr_write_b32 a122, v66
v_accvgpr_write_b32 a123, v67
v_accvgpr_read_b32 v64, a124
v_accvgpr_read_b32 v65, a125
v_accvgpr_read_b32 v66, a126
v_accvgpr_read_b32 v67, a127
v_mul_f32 v64, v64, v28
v_mul_f32 v65, v65, v28
v_mul_f32 v66, v66, v28
v_mul_f32 v67, v67, v28
v_accvgpr_write_b32 a124, v64
v_accvgpr_write_b32 a125, v65
v_accvgpr_write_b32 a126, v66
v_accvgpr_write_b32 a127, v67
s_nop 1
s_branch at_rb1
at_tail1:
ds_read_b128 v[224:227], v4 offset:49152
ds_read_b128 v[228:231], v4 offset:50176
ds_read_b128 v[232:235], v4 offset:51200
ds_read_b128 v[236:239], v4 offset:52224
ds_read_b128 v[240:243], v4 offset:53248
ds_read_b128 v[244:247], v4 offset:54272
s_movk_i32 s58, -32768
s_cmp_eq_u32 s41, 1
s_cbranch_scc1 at_t1
s_lshl_b32 s5, s36, 19
s_lshl_b32 s6, s38, 14
s_add_u32 s45, s5, s6
s_mov_b32 s46, s45
s_add_u32 m0, s49, 0
s_nop 0
buffer_load_dwordx4 v5, s[16:19], s45 offen offset:0 lds
buffer_load_dwordx4 v5, s[16:19], s45 offen offset:1024 lds
buffer_load_dwordx4 v5, s[16:19], s45 offen offset:2048 lds
buffer_load_dwordx4 v5, s[16:19], s45 offen offset:3072 lds
s_add_u32 m0, s49, 4096
s_add_u32 s45, s45, 4096
buffer_load_dwordx4 v5, s[16:19], s45 offen offset:0 lds
buffer_load_dwordx4 v5, s[16:19], s45 offen offset:1024 lds
buffer_load_dwordx4 v5, s[16:19], s45 offen offset:2048 lds
buffer_load_dwordx4 v5, s[16:19], s45 offen offset:3072 lds
s_add_u32 s45, s45, 0x7000
s_add_u32 m0, s49, 16384
s_nop 0
buffer_load_dwordx4 v5, s[16:19], s45 offen offset:0 lds
buffer_load_dwordx4 v5, s[16:19], s45 offen offset:1024 lds
buffer_load_dwordx4 v5, s[16:19], s45 offen offset:2048 lds
buffer_load_dwordx4 v5, s[16:19], s45 offen offset:3072 lds
s_add_u32 m0, s49, 20480
s_add_u32 s45, s45, 4096
buffer_load_dwordx4 v5, s[16:19], s45 offen offset:0 lds
buffer_load_dwordx4 v5, s[16:19], s45 offen offset:1024 lds
buffer_load_dwordx4 v5, s[16:19], s45 offen offset:2048 lds
buffer_load_dwordx4 v5, s[16:19], s45 offen offset:3072 lds
s_add_u32 s45, s45, 0x7000
ds_read_b128 a[128:131], v31 offset:0
ds_read_b128 a[132:135], v31 offset:1024
ds_read_b128 a[136:139], v31 offset:2048
ds_read_b128 a[140:143], v31 offset:3072
ds_read_b128 a[144:147], v31 offset:16384
ds_read_b128 a[148:151], v31 offset:17408
ds_read_b128 a[152:155], v31 offset:18432
ds_read_b128 a[156:159], v31 offset:19456
ds_read_b128 a[160:163], v31 offset:4096
ds_read_b128 a[164:167], v31 offset:5120
ds_read_b128 a[168:171], v31 offset:6144
ds_read_b128 a[172:175], v31 offset:7168
ds_read_b128 a[176:179], v31 offset:20480
ds_read_b128 a[180:183], v31 offset:21504
ds_read_b128 a[184:187], v31 offset:22528
ds_read_b128 a[188:191], v31 offset:23552
s_waitcnt lgkmcnt(0)
at_t1:
v_exp_f32 v160, v160
v_exp_f32 v161, v161
v_exp_f32 v192, v192
v_exp_f32 v193, v193
v_add_f32 v24, v24, v160
v_cvt_pk_bf16_f32 v64, v160, v161
v_add_f32 v24, v24, v161
v_exp_f32 v162, v162
v_exp_f32 v163, v163
v_add_f32 v25, v25, v192
v_cvt_pk_bf16_f32 v80, v192, v193
v_add_f32 v25, v25, v193
v_exp_f32 v194, v194
v_exp_f32 v195, v195
v_add_f32 v24, v24, v162
v_cvt_pk_bf16_f32 v65, v162, v163
v_add_f32 v24, v24, v163
v_exp_f32 v164, v164
v_exp_f32 v165, v165
v_add_f32 v25, v25, v194
v_cvt_pk_bf16_f32 v81, v194, v195
v_add_f32 v25, v25, v195
v_exp_f32 v196, v196
v_exp_f32 v197, v197
v_add_f32 v24, v24, v164
v_cvt_pk_bf16_f32 v66, v164, v165
v_add_f32 v24, v24, v165
v_exp_f32 v166, v166
v_exp_f32 v167, v167
v_add_f32 v25, v25, v196
v_cvt_pk_bf16_f32 v82, v196, v197
v_add_f32 v25, v25, v197
v_exp_f32 v198, v198
v_exp_f32 v199, v199
v_add_f32 v24, v24, v166
v_cvt_pk_bf16_f32 v67, v166, v167
v_add_f32 v24, v24, v167
v_exp_f32 v168, v168
v_exp_f32 v169, v169
v_add_f32 v25, v25, v198
v_cvt_pk_bf16_f32 v83, v198, v199
v_add_f32 v25, v25, v199
s_waitcnt lgkmcnt(5)
v_mfma_f32_32x32x16_bf16 a[0:15], v[224:227], v[64:67], a[0:15]
ds_read_b128 v[248:251], v4 offset:55296
v_exp_f32 v200, v200
v_exp_f32 v201, v201
v_add_f32 v24, v24, v168
v_cvt_pk_bf16_f32 v68, v168, v169
v_add_f32 v24, v24, v169
v_mfma_f32_32x32x16_bf16 a[64:79], v[224:227], v[80:83], a[64:79]
v_exp_f32 v170, v170
v_exp_f32 v171, v171
v_add_f32 v25, v25, v200
v_cvt_pk_bf16_f32 v84, v200, v201
v_add_f32 v25, v25, v201
s_waitcnt lgkmcnt(5)
v_mfma_f32_32x32x16_bf16 a[16:31], v[228:231], v[64:67], a[16:31]
ds_read_b128 v[252:255], v4 offset:56320
v_exp_f32 v202, v202
v_exp_f32 v203, v203
v_add_f32 v24, v24, v170
v_cvt_pk_bf16_f32 v69, v170, v171
v_add_f32 v24, v24, v171
v_exp_f32 v172, v172
v_mfma_f32_32x32x16_bf16 a[80:95], v[228:231], v[80:83], a[80:95]
v_exp_f32 v173, v173
v_add_f32 v25, v25, v202
v_cvt_pk_bf16_f32 v85, v202, v203
v_add_f32 v25, v25, v203
v_exp_f32 v204, v204
s_waitcnt lgkmcnt(5)
v_mfma_f32_32x32x16_bf16 a[32:47], v[232:235], v[64:67], a[32:47]
ds_read_b128 v[224:227], v4 offset:57344
v_exp_f32 v205, v205
v_add_f32 v24, v24, v172
v_cvt_pk_bf16_f32 v70, v172, v173
v_add_f32 v24, v24, v173
v_exp_f32 v174, v174
v_exp_f32 v175, v175
v_mfma_f32_32x32x16_bf16 a[96:111], v[232:235], v[80:83], a[96:111]
v_add_f32 v25, v25, v204
v_cvt_pk_bf16_f32 v86, v204, v205
v_add_f32 v25, v25, v205
v_exp_f32 v206, v206
v_exp_f32 v207, v207
s_waitcnt lgkmcnt(5)
v_mfma_f32_32x32x16_bf16 a[48:63], v[236:239], v[64:67], a[48:63]
ds_read_b128 v[228:231], v4 offset:58368
v_add_f32 v24, v24, v174
v_cvt_pk_bf16_f32 v71, v174, v175
v_add_f32 v24, v24, v175
v_exp_f32 v176, v176
v_exp_f32 v177, v177
v_mfma_f32_32x32x16_bf16 a[112:127], v[236:239], v[80:83], a[112:127]
v_add_f32 v25, v25, v206
v_cvt_pk_bf16_f32 v87, v206, v207
v_add_f32 v25, v25, v207
v_exp_f32 v208, v208
v_exp_f32 v209, v209
v_add_f32 v24, v24, v176
s_waitcnt lgkmcnt(5)
v_mfma_f32_32x32x16_bf16 a[0:15], v[240:243], v[68:71], a[0:15]
ds_read_b128 v[232:235], v4 offset:59392
v_cvt_pk_bf16_f32 v72, v176, v177
v_add_f32 v24, v24, v177
v_exp_f32 v178, v178
v_exp_f32 v179, v179
v_add_f32 v25, v25, v208
v_mfma_f32_32x32x16_bf16 a[64:79], v[240:243], v[84:87], a[64:79]
v_cvt_pk_bf16_f32 v88, v208, v209
v_add_f32 v25, v25, v209
v_exp_f32 v210, v210
v_exp_f32 v211, v211
v_add_f32 v24, v24, v178
v_cvt_pk_bf16_f32 v73, v178, v179
s_waitcnt lgkmcnt(5)
v_mfma_f32_32x32x16_bf16 a[16:31], v[244:247], v[68:71], a[16:31]
ds_read_b128 v[236:239], v4 offset:60416
v_add_f32 v24, v24, v179
v_exp_f32 v180, v180
v_exp_f32 v181, v181
v_add_f32 v25, v25, v210
v_cvt_pk_bf16_f32 v89, v210, v211
v_mfma_f32_32x32x16_bf16 a[80:95], v[244:247], v[84:87], a[80:95]
v_add_f32 v25, v25, v211
v_exp_f32 v212, v212
v_exp_f32 v213, v213
v_add_f32 v24, v24, v180
v_cvt_pk_bf16_f32 v74, v180, v181
s_waitcnt lgkmcnt(5)
v_mfma_f32_32x32x16_bf16 a[32:47], v[248:251], v[68:71], a[32:47]
ds_read_b128 v[240:243], v4 offset:61440
v_add_f32 v24, v24, v181
v_exp_f32 v182, v182
v_exp_f32 v183, v183
v_add_f32 v25, v25, v212
v_cvt_pk_bf16_f32 v90, v212, v213
v_add_f32 v25, v25, v213
v_mfma_f32_32x32x16_bf16 a[96:111], v[248:251], v[84:87], a[96:111]
v_exp_f32 v214, v214
v_exp_f32 v215, v215
v_add_f32 v24, v24, v182
v_cvt_pk_bf16_f32 v75, v182, v183
v_add_f32 v24, v24, v183
s_waitcnt lgkmcnt(5)
v_mfma_f32_32x32x16_bf16 a[48:63], v[252:255], v[68:71], a[48:63]
ds_read_b128 v[244:247], v4 offset:62464
v_exp_f32 v184, v184
v_exp_f32 v185, v185
v_add_f32 v25, v25, v214
v_cvt_pk_bf16_f32 v91, v214, v215
v_add_f32 v25, v25, v215
v_exp_f32 v216, v216
v_mfma_f32_32x32x16_bf16 a[112:127], v[252:255], v[84:87], a[112:127]
v_exp_f32 v217, v217
v_add_f32 v24, v24, v184
v_cvt_pk_bf16_f32 v76, v184, v185
v_add_f32 v24, v24, v185
v_exp_f32 v186, v186
s_waitcnt lgkmcnt(5)
v_mfma_f32_32x32x16_bf16 a[0:15], v[224:227], v[72:75], a[0:15]
ds_read_b128 v[248:251], v4 offset:63488
v_exp_f32 v187, v187
v_add_f32 v25, v25, v216
v_cvt_pk_bf16_f32 v92, v216, v217
v_add_f32 v25, v25, v217
v_exp_f32 v218, v218
v_mfma_f32_32x32x16_bf16 a[64:79], v[224:227], v[88:91], a[64:79]
v_exp_f32 v219, v219
v_add_f32 v24, v24, v186
v_cvt_pk_bf16_f32 v77, v186, v187
v_add_f32 v24, v24, v187
v_exp_f32 v188, v188
v_exp_f32 v189, v189
s_waitcnt lgkmcnt(5)
v_mfma_f32_32x32x16_bf16 a[16:31], v[228:231], v[72:75], a[16:31]
ds_read_b128 v[252:255], v4 offset:64512
v_add_f32 v25, v25, v218
v_cvt_pk_bf16_f32 v93, v218, v219
v_add_f32 v25, v25, v219
v_exp_f32 v220, v220
v_exp_f32 v221, v221
v_mfma_f32_32x32x16_bf16 a[80:95], v[228:231], v[88:91], a[80:95]
v_add_f32 v24, v24, v188
v_cvt_pk_bf16_f32 v78, v188, v189
v_add_f32 v24, v24, v189
v_exp_f32 v190, v190
v_exp_f32 v191, v191
v_add_f32 v25, v25, v220
s_waitcnt lgkmcnt(5)
v_mfma_f32_32x32x16_bf16 a[32:47], v[232:235], v[72:75], a[32:47]
v_cvt_pk_bf16_f32 v94, v220, v221
v_add_f32 v25, v25, v221
v_exp_f32 v222, v222
v_exp_f32 v223, v223
v_add_f32 v24, v24, v190
v_mfma_f32_32x32x16_bf16 a[96:111], v[232:235], v[88:91], a[96:111]
v_cvt_pk_bf16_f32 v79, v190, v191
v_add_f32 v24, v24, v191
s_nop 0
v_add_f32 v25, v25, v222
v_cvt_pk_bf16_f32 v95, v222, v223
v_add_f32 v25, v25, v223
s_waitcnt lgkmcnt(4)
v_mfma_f32_32x32x16_bf16 a[48:63], v[236:239], v[72:75], a[48:63]
v_mfma_f32_32x32x16_bf16 a[112:127], v[236:239], v[88:91], a[112:127]
s_waitcnt lgkmcnt(0)
v_mfma_f32_32x32x16_bf16 a[0:15], v[240:243], v[76:79], a[0:15]
v_mfma_f32_32x32x16_bf16 a[64:79], v[240:243], v[92:95], a[64:79]
v_mfma_f32_32x32x16_bf16 a[16:31], v[244:247], v[76:79], a[16:31]
v_mfma_f32_32x32x16_bf16 a[80:95], v[244:247], v[92:95], a[80:95]
v_mfma_f32_32x32x16_bf16 a[32:47], v[248:251], v[76:79], a[32:47]
v_mfma_f32_32x32x16_bf16 a[96:111], v[248:251], v[92:95], a[96:111]
v_mfma_f32_32x32x16_bf16 a[48:63], v[252:255], v[76:79], a[48:63]
v_mfma_f32_32x32x16_bf16 a[112:127], v[252:255], v[92:95], a[112:127]
s_branch at_merge
at_tail0:
ds_read_b128 v[224:227], v4 offset:32768
ds_read_b128 v[228:231], v4 offset:33792
ds_read_b128 v[232:235], v4 offset:34816
ds_read_b128 v[236:239], v4 offset:35840
ds_read_b128 v[240:243], v4 offset:36864
ds_read_b128 v[244:247], v4 offset:37888
s_movk_i32 s58, -16384
s_cmp_eq_u32 s41, 1
s_cbranch_scc1 at_t0
s_lshl_b32 s5, s36, 19
s_lshl_b32 s6, s38, 14
s_add_u32 s45, s5, s6
s_mov_b32 s46, s45
s_add_u32 m0, s49, 0
s_nop 0
buffer_load_dwordx4 v5, s[16:19], s45 offen offset:0 lds
buffer_load_dwordx4 v5, s[16:19], s45 offen offset:1024 lds
buffer_load_dwordx4 v5, s[16:19], s45 offen offset:2048 lds
buffer_load_dwordx4 v5, s[16:19], s45 offen offset:3072 lds
s_add_u32 m0, s49, 4096
s_add_u32 s45, s45, 4096
buffer_load_dwordx4 v5, s[16:19], s45 offen offset:0 lds
buffer_load_dwordx4 v5, s[16:19], s45 offen offset:1024 lds
buffer_load_dwordx4 v5, s[16:19], s45 offen offset:2048 lds
buffer_load_dwordx4 v5, s[16:19], s45 offen offset:3072 lds
s_add_u32 s45, s45, 0x7000
s_add_u32 m0, s49, 16384
s_nop 0
buffer_load_dwordx4 v5, s[16:19], s45 offen offset:0 lds
buffer_load_dwordx4 v5, s[16:19], s45 offen offset:1024 lds
buffer_load_dwordx4 v5, s[16:19], s45 offen offset:2048 lds
buffer_load_dwordx4 v5, s[16:19], s45 offen offset:3072 lds
s_add_u32 m0, s49, 20480
s_add_u32 s45, s45, 4096
buffer_load_dwordx4 v5, s[16:19], s45 offen offset:0 lds
buffer_load_dwordx4 v5, s[16:19], s45 offen offset:1024 lds
buffer_load_dwordx4 v5, s[16:19], s45 offen offset:2048 lds
buffer_load_dwordx4 v5, s[16:19], s45 offen offset:3072 lds
s_add_u32 s45, s45, 0x7000
ds_read_b128 a[128:131], v31 offset:0
ds_read_b128 a[132:135], v31 offset:1024
ds_read_b128 a[136:139], v31 offset:2048
ds_read_b128 a[140:143], v31 offset:3072
ds_read_b128 a[144:147], v31 offset:16384
ds_read_b128 a[148:151], v31 offset:17408
ds_read_b128 a[152:155], v31 offset:18432
ds_read_b128 a[156:159], v31 offset:19456
ds_read_b128 a[160:163], v31 offset:4096
ds_read_b128 a[164:167], v31 offset:5120
ds_read_b128 a[168:171], v31 offset:6144
ds_read_b128 a[172:175], v31 offset:7168
ds_read_b128 a[176:179], v31 offset:20480
ds_read_b128 a[180:183], v31 offset:21504
ds_read_b128 a[184:187], v31 offset:22528
ds_read_b128 a[188:191], v31 offset:23552
s_waitcnt lgkmcnt(0)
at_t0:
v_exp_f32 v96, v96
v_exp_f32 v97, v97
v_exp_f32 v128, v128
v_exp_f32 v129, v129
v_add_f32 v24, v24, v96
v_cvt_pk_bf16_f32 v64, v96, v97
v_add_f32 v24, v24, v97
v_exp_f32 v98, v98
v_exp_f32 v99, v99
v_add_f32 v25, v25, v128
v_cvt_pk_bf16_f32 v80, v128, v129
v_add_f32 v25, v25, v129
v_exp_f32 v130, v130
v_exp_f32 v131, v131
v_add_f32 v24, v24, v98
v_cvt_pk_bf16_f32 v65, v98, v99
v_add_f32 v24, v24, v99
v_exp_f32 v100, v100
v_exp_f32 v101, v101
v_add_f32 v25, v25, v130
v_cvt_pk_bf16_f32 v81, v130, v131
v_add_f32 v25, v25, v131
v_exp_f32 v132, v132
v_exp_f32 v133, v133
v_add_f32 v24, v24, v100
v_cvt_pk_bf16_f32 v66, v100, v101
v_add_f32 v24, v24, v101
v_exp_f32 v102, v102
v_exp_f32 v103, v103
v_add_f32 v25, v25, v132
v_cvt_pk_bf16_f32 v82, v132, v133
v_add_f32 v25, v25, v133
v_exp_f32 v134, v134
v_exp_f32 v135, v135
v_add_f32 v24, v24, v102
v_cvt_pk_bf16_f32 v67, v102, v103
v_add_f32 v24, v24, v103
v_exp_f32 v104, v104
v_exp_f32 v105, v105
v_add_f32 v25, v25, v134
v_cvt_pk_bf16_f32 v83, v134, v135
v_add_f32 v25, v25, v135
s_waitcnt lgkmcnt(5)
v_mfma_f32_32x32x16_bf16 a[0:15], v[224:227], v[64:67], a[0:15]
ds_read_b128 v[248:251], v4 offset:38912
v_exp_f32 v136, v136
v_exp_f32 v137, v137
v_add_f32 v24, v24, v104
v_cvt_pk_bf16_f32 v68, v104, v105
v_add_f32 v24, v24, v105
v_mfma_f32_32x32x16_bf16 a[64:79], v[224:227], v[80:83], a[64:79]
v_exp_f32 v106, v106
v_exp_f32 v107, v107
v_add_f32 v25, v25, v136
v_cvt_pk_bf16_f32 v84, v136, v137
v_add_f32 v25, v25, v137
s_waitcnt lgkmcnt(5)
v_mfma_f32_32x32x16_bf16 a[16:31], v[228:231], v[64:67], a[16:31]
ds_read_b128 v[252:255], v4 offset:39936
v_exp_f32 v138, v138
v_exp_f32 v139, v139
v_add_f32 v24, v24, v106
v_cvt_pk_bf16_f32 v69, v106, v107
v_add_f32 v24, v24, v107
v_exp_f32 v108, v108
v_mfma_f32_32x32x16_bf16 a[80:95], v[228:231], v[80:83], a[80:95]
v_exp_f32 v109, v109
v_add_f32 v25, v25, v138
v_cvt_pk_bf16_f32 v85, v138, v139
v_add_f32 v25, v25, v139
v_exp_f32 v140, v140
s_waitcnt lgkmcnt(5)
v_mfma_f32_32x32x16_bf16 a[32:47], v[232:235], v[64:67], a[32:47]
ds_read_b128 v[224:227], v4 offset:40960
v_exp_f32 v141, v141
v_add_f32 v24, v24, v108
v_cvt_pk_bf16_f32 v70, v108, v109
v_add_f32 v24, v24, v109
v_exp_f32 v110, v110
v_exp_f32 v111, v111
v_mfma_f32_32x32x16_bf16 a[96:111], v[232:235], v[80:83], a[96:111]
v_add_f32 v25, v25, v140
v_cvt_pk_bf16_f32 v86, v140, v141
v_add_f32 v25, v25, v141
v_exp_f32 v142, v142
v_exp_f32 v143, v143
s_waitcnt lgkmcnt(5)
v_mfma_f32_32x32x16_bf16 a[48:63], v[236:239], v[64:67], a[48:63]
ds_read_b128 v[228:231], v4 offset:41984
v_add_f32 v24, v24, v110
v_cvt_pk_bf16_f32 v71, v110, v111
v_add_f32 v24, v24, v111
v_exp_f32 v112, v112
v_exp_f32 v113, v113
v_mfma_f32_32x32x16_bf16 a[112:127], v[236:239], v[80:83], a[112:127]
v_add_f32 v25, v25, v142
v_cvt_pk_bf16_f32 v87, v142, v143
v_add_f32 v25, v25, v143
v_exp_f32 v144, v144
v_exp_f32 v145, v145
v_add_f32 v24, v24, v112
s_waitcnt lgkmcnt(5)
v_mfma_f32_32x32x16_bf16 a[0:15], v[240:243], v[68:71], a[0:15]
ds_read_b128 v[232:235], v4 offset:43008
v_cvt_pk_bf16_f32 v72, v112, v113
v_add_f32 v24, v24, v113
v_exp_f32 v114, v114
v_exp_f32 v115, v115
v_add_f32 v25, v25, v144
v_mfma_f32_32x32x16_bf16 a[64:79], v[240:243], v[84:87], a[64:79]
v_cvt_pk_bf16_f32 v88, v144, v145
v_add_f32 v25, v25, v145
v_exp_f32 v146, v146
v_exp_f32 v147, v147
v_add_f32 v24, v24, v114
v_cvt_pk_bf16_f32 v73, v114, v115
s_waitcnt lgkmcnt(5)
v_mfma_f32_32x32x16_bf16 a[16:31], v[244:247], v[68:71], a[16:31]
ds_read_b128 v[236:239], v4 offset:44032
v_add_f32 v24, v24, v115
v_exp_f32 v116, v116
v_exp_f32 v117, v117
v_add_f32 v25, v25, v146
v_cvt_pk_bf16_f32 v89, v146, v147
v_mfma_f32_32x32x16_bf16 a[80:95], v[244:247], v[84:87], a[80:95]
v_add_f32 v25, v25, v147
v_exp_f32 v148, v148
v_exp_f32 v149, v149
v_add_f32 v24, v24, v116
v_cvt_pk_bf16_f32 v74, v116, v117
s_waitcnt lgkmcnt(5)
v_mfma_f32_32x32x16_bf16 a[32:47], v[248:251], v[68:71], a[32:47]
ds_read_b128 v[240:243], v4 offset:45056
v_add_f32 v24, v24, v117
v_exp_f32 v118, v118
v_exp_f32 v119, v119
v_add_f32 v25, v25, v148
v_cvt_pk_bf16_f32 v90, v148, v149
v_add_f32 v25, v25, v149
v_mfma_f32_32x32x16_bf16 a[96:111], v[248:251], v[84:87], a[96:111]
v_exp_f32 v150, v150
v_exp_f32 v151, v151
v_add_f32 v24, v24, v118
v_cvt_pk_bf16_f32 v75, v118, v119
v_add_f32 v24, v24, v119
s_waitcnt lgkmcnt(5)
v_mfma_f32_32x32x16_bf16 a[48:63], v[252:255], v[68:71], a[48:63]
ds_read_b128 v[244:247], v4 offset:46080
v_exp_f32 v120, v120
v_exp_f32 v121, v121
v_add_f32 v25, v25, v150
v_cvt_pk_bf16_f32 v91, v150, v151
v_add_f32 v25, v25, v151
v_exp_f32 v152, v152
v_mfma_f32_32x32x16_bf16 a[112:127], v[252:255], v[84:87], a[112:127]
v_exp_f32 v153, v153
v_add_f32 v24, v24, v120
v_cvt_pk_bf16_f32 v76, v120, v121
v_add_f32 v24, v24, v121
v_exp_f32 v122, v122
s_waitcnt lgkmcnt(5)
v_mfma_f32_32x32x16_bf16 a[0:15], v[224:227], v[72:75], a[0:15]
ds_read_b128 v[248:251], v4 offset:47104
v_exp_f32 v123, v123
v_add_f32 v25, v25, v152
v_cvt_pk_bf16_f32 v92, v152, v153
v_add_f32 v25, v25, v153
v_exp_f32 v154, v154
v_mfma_f32_32x32x16_bf16 a[64:79], v[224:227], v[88:91], a[64:79]
v_exp_f32 v155, v155
v_add_f32 v24, v24, v122
v_cvt_pk_bf16_f32 v77, v122, v123
v_add_f32 v24, v24, v123
v_exp_f32 v124, v124
v_exp_f32 v125, v125
s_waitcnt lgkmcnt(5)
v_mfma_f32_32x32x16_bf16 a[16:31], v[228:231], v[72:75], a[16:31]
ds_read_b128 v[252:255], v4 offset:48128
v_add_f32 v25, v25, v154
v_cvt_pk_bf16_f32 v93, v154, v155
v_add_f32 v25, v25, v155
v_exp_f32 v156, v156
v_exp_f32 v157, v157
v_mfma_f32_32x32x16_bf16 a[80:95], v[228:231], v[88:91], a[80:95]
v_add_f32 v24, v24, v124
v_cvt_pk_bf16_f32 v78, v124, v125
v_add_f32 v24, v24, v125
v_exp_f32 v126, v126
v_exp_f32 v127, v127
v_add_f32 v25, v25, v156
s_waitcnt lgkmcnt(5)
v_mfma_f32_32x32x16_bf16 a[32:47], v[232:235], v[72:75], a[32:47]
v_cvt_pk_bf16_f32 v94, v156, v157
v_add_f32 v25, v25, v157
v_exp_f32 v158, v158
v_exp_f32 v159, v159
v_add_f32 v24, v24, v126
v_mfma_f32_32x32x16_bf16 a[96:111], v[232:235], v[88:91], a[96:111]
v_cvt_pk_bf16_f32 v79, v126, v127
v_add_f32 v24, v24, v127
s_nop 0
v_add_f32 v25, v25, v158
v_cvt_pk_bf16_f32 v95, v158, v159
v_add_f32 v25, v25, v159
s_waitcnt lgkmcnt(4)
v_mfma_f32_32x32x16_bf16 a[48:63], v[236:239], v[72:75], a[48:63]
v_mfma_f32_32x32x16_bf16 a[112:127], v[236:239], v[88:91], a[112:127]
s_waitcnt lgkmcnt(0)
v_mfma_f32_32x32x16_bf16 a[0:15], v[240:243], v[76:79], a[0:15]
v_mfma_f32_32x32x16_bf16 a[64:79], v[240:243], v[92:95], a[64:79]
v_mfma_f32_32x32x16_bf16 a[16:31], v[244:247], v[76:79], a[16:31]
v_mfma_f32_32x32x16_bf16 a[80:95], v[244:247], v[92:95], a[80:95]
v_mfma_f32_32x32x16_bf16 a[32:47], v[248:251], v[76:79], a[32:47]
v_mfma_f32_32x32x16_bf16 a[96:111], v[248:251], v[92:95], a[96:111]
v_mfma_f32_32x32x16_bf16 a[48:63], v[252:255], v[76:79], a[48:63]
v_mfma_f32_32x32x16_bf16 a[112:127], v[252:255], v[92:95], a[112:127]
at_merge:
v_mov_b32 v27, v24
v_mov_b32 v28, v25
v_mov_b32 v34, v26
v_mov_b32 v35, v3
v_permlane32_swap_b32 v27, v24
v_permlane32_swap_b32 v28, v25
s_nop 1
v_add_f32 v32, v24, v27
v_add_f32 v33, v25, v28
v_lshlrev_b32 v1, 4, v0
s_lshl_b32 s5, s3, 10
s_add_u32 s5, s5, s58
s_add_u32 s5, s5, 65536
v_add_u32 v2, s5, v1
s_xor_b32 s5, s5, 2048
v_add_u32 v3, s5, v1
ds_write_b128 v2, v[32:35]
s_waitcnt lgkmcnt(0)
s_barrier
ds_read_b128 v[36:39], v3
s_lshl_b32 s5, s39, 13
s_add_u32 s5, s5, s49
s_add_u32 s5, s5, 32768
v_add_u32 v2, s5, v1
s_xor_b32 s5, s5, 65536
v_add_u32 v3, s5, v1
s_lshl_b32 s5, s37, 20
s_lshl_b32 s6, s36, 13
s_add_u32 s5, s5, s6
s_lshl_b32 s6, s38, 12
s_add_u32 s5, s5, s6
s_lshl_b32 s6, s39, 19
s_add_u32 s5, s5, s6
s_add_u32 s6, s5, 262144
s_waitcnt lgkmcnt(0)
s_barrier
v_max_f32 v27, v34, v38
v_sub_f32 v34, v34, v27
v_sub_f32 v38, v38, v27
v_exp_f32 v34, v34
v_exp_f32 v38, v38
s_nop 0
v_mul_f32 v24, v32, v34
v_fmac_f32 v24, v36, v38
v_rcp_f32 v24, v24
s_nop 0
v_mul_f32 v24, v24, v34
v_max_f32 v27, v35, v39
v_sub_f32 v35, v35, v27
v_sub_f32 v39, v39, v27
v_exp_f32 v35, v35
v_exp_f32 v39, v39
s_nop 0
v_mul_f32 v25, v33, v35
v_fmac_f32 v25, v37, v39
v_rcp_f32 v25, v25
s_nop 0
v_mul_f32 v25, v25, v35
s_cmp_eq_u32 s38, 1
s_cbranch_scc1 at_m1
v_accvgpr_read_b32 v64, a32
v_accvgpr_read_b32 v65, a33
v_accvgpr_read_b32 v66, a34
v_accvgpr_read_b32 v67, a35
v_accvgpr_read_b32 v68, a36
v_accvgpr_read_b32 v69, a37
v_accvgpr_read_b32 v70, a38
v_accvgpr_read_b32 v71, a39
v_mul_f32 v64, v64, v24
v_mul_f32 v65, v65, v24
v_mul_f32 v66, v66, v24
v_mul_f32 v67, v67, v24
v_mul_f32 v68, v68, v24
v_mul_f32 v69, v69, v24
v_mul_f32 v70, v70, v24
v_mul_f32 v71, v71, v24
ds_write_b128 v2, v[64:67] offset:0
ds_write_b128 v2, v[68:71] offset:1024
v_accvgpr_read_b32 v72, a40
v_accvgpr_read_b32 v73, a41
v_accvgpr_read_b32 v74, a42
v_accvgpr_read_b32 v75, a43
v_accvgpr_read_b32 v76, a44
v_accvgpr_read_b32 v77, a45
v_accvgpr_read_b32 v78, a46
v_accvgpr_read_b32 v79, a47
v_mul_f32 v72, v72, v24
v_mul_f32 v73, v73, v24
v_mul_f32 v74, v74, v24
v_mul_f32 v75, v75, v24
v_mul_f32 v76, v76, v24
v_mul_f32 v77, v77, v24
v_mul_f32 v78, v78, v24
v_mul_f32 v79, v79, v24
ds_write_b128 v2, v[72:75] offset:2048
ds_write_b128 v2, v[76:79] offset:3072
v_accvgpr_read_b32 v80, a48
v_accvgpr_read_b32 v81, a49
v_accvgpr_read_b32 v82, a50
v_accvgpr_read_b32 v83, a51
v_accvgpr_read_b32 v84, a52
v_accvgpr_read_b32 v85, a53
v_accvgpr_read_b32 v86, a54
v_accvgpr_read_b32 v87, a55
v_mul_f32 v80, v80, v24
v_mul_f32 v81, v81, v24
v_mul_f32 v82, v82, v24
v_mul_f32 v83, v83, v24
v_mul_f32 v84, v84, v24
v_mul_f32 v85, v85, v24
v_mul_f32 v86, v86, v24
v_mul_f32 v87, v87, v24
ds_write_b128 v2, v[80:83] offset:4096
ds_write_b128 v2, v[84:87] offset:5120
v_accvgpr_read_b32 v88, a56
v_accvgpr_read_b32 v89, a57
v_accvgpr_read_b32 v90, a58
v_accvgpr_read_b32 v91, a59
v_accvgpr_read_b32 v92, a60
v_accvgpr_read_b32 v93, a61
v_accvgpr_read_b32 v94, a62
v_accvgpr_read_b32 v95, a63
v_mul_f32 v88, v88, v24
v_mul_f32 v89, v89, v24
v_mul_f32 v90, v90, v24
v_mul_f32 v91, v91, v24
v_mul_f32 v92, v92, v24
v_mul_f32 v93, v93, v24
v_mul_f32 v94, v94, v24
v_mul_f32 v95, v95, v24
ds_write_b128 v2, v[88:91] offset:6144
ds_write_b128 v2, v[92:95] offset:7168
v_accvgpr_read_b32 v96, a96
v_accvgpr_read_b32 v97, a97
v_accvgpr_read_b32 v98, a98
v_accvgpr_read_b32 v99, a99
v_accvgpr_read_b32 v100, a100
v_accvgpr_read_b32 v101, a101
v_accvgpr_read_b32 v102, a102
v_accvgpr_read_b32 v103, a103
v_mul_f32 v96, v96, v25
v_mul_f32 v97, v97, v25
v_mul_f32 v98, v98, v25
v_mul_f32 v99, v99, v25
v_mul_f32 v100, v100, v25
v_mul_f32 v101, v101, v25
v_mul_f32 v102, v102, v25
v_mul_f32 v103, v103, v25
ds_write_b128 v2, v[96:99] offset:8192
ds_write_b128 v2, v[100:103] offset:9216
v_accvgpr_read_b32 v104, a104
v_accvgpr_read_b32 v105, a105
v_accvgpr_read_b32 v106, a106
v_accvgpr_read_b32 v107, a107
v_accvgpr_read_b32 v108, a108
v_accvgpr_read_b32 v109, a109
v_accvgpr_read_b32 v110, a110
v_accvgpr_read_b32 v111, a111
v_mul_f32 v104, v104, v25
v_mul_f32 v105, v105, v25
v_mul_f32 v106, v106, v25
v_mul_f32 v107, v107, v25
v_mul_f32 v108, v108, v25
v_mul_f32 v109, v109, v25
v_mul_f32 v110, v110, v25
v_mul_f32 v111, v111, v25
ds_write_b128 v2, v[104:107] offset:10240
ds_write_b128 v2, v[108:111] offset:11264
v_accvgpr_read_b32 v112, a112
v_accvgpr_read_b32 v113, a113
v_accvgpr_read_b32 v114, a114
v_accvgpr_read_b32 v115, a115
v_accvgpr_read_b32 v116, a116
v_accvgpr_read_b32 v117, a117
v_accvgpr_read_b32 v118, a118
v_accvgpr_read_b32 v119, a119
v_mul_f32 v112, v112, v25
v_mul_f32 v113, v113, v25
v_mul_f32 v114, v114, v25
v_mul_f32 v115, v115, v25
v_mul_f32 v116, v116, v25
v_mul_f32 v117, v117, v25
v_mul_f32 v118, v118, v25
v_mul_f32 v119, v119, v25
ds_write_b128 v2, v[112:115] offset:12288
ds_write_b128 v2, v[116:119] offset:13312
v_accvgpr_read_b32 v120, a120
v_accvgpr_read_b32 v121, a121
v_accvgpr_read_b32 v122, a122
v_accvgpr_read_b32 v123, a123
v_accvgpr_read_b32 v124, a124
v_accvgpr_read_b32 v125, a125
v_accvgpr_read_b32 v126, a126
v_accvgpr_read_b32 v127, a127
v_mul_f32 v120, v120, v25
v_mul_f32 v121, v121, v25
v_mul_f32 v122, v122, v25
v_mul_f32 v123, v123, v25
v_mul_f32 v124, v124, v25
v_mul_f32 v125, v125, v25
v_mul_f32 v126, v126, v25
v_mul_f32 v127, v127, v25
ds_write_b128 v2, v[120:123] offset:14336
ds_write_b128 v2, v[124:127] offset:15360
v_accvgpr_read_b32 v128, a0
v_accvgpr_read_b32 v129, a1
v_accvgpr_read_b32 v130, a2
v_accvgpr_read_b32 v131, a3
v_accvgpr_read_b32 v132, a4
v_accvgpr_read_b32 v133, a5
v_accvgpr_read_b32 v134, a6
v_accvgpr_read_b32 v135, a7
v_accvgpr_read_b32 v136, a8
v_accvgpr_read_b32 v137, a9
v_accvgpr_read_b32 v138, a10
v_accvgpr_read_b32 v139, a11
v_accvgpr_read_b32 v140, a12
v_accvgpr_read_b32 v141, a13
v_accvgpr_read_b32 v142, a14
v_accvgpr_read_b32 v143, a15
v_accvgpr_read_b32 v144, a16
v_accvgpr_read_b32 v145, a17
v_accvgpr_read_b32 v146, a18
v_accvgpr_read_b32 v147, a19
v_accvgpr_read_b32 v148, a20
v_accvgpr_read_b32 v149, a21
v_accvgpr_read_b32 v150, a22
v_accvgpr_read_b32 v151, a23
v_accvgpr_read_b32 v152, a24
v_accvgpr_read_b32 v153, a25
v_accvgpr_read_b32 v154, a26
v_accvgpr_read_b32 v155, a27
v_accvgpr_read_b32 v156, a28
v_accvgpr_read_b32 v157, a29
v_accvgpr_read_b32 v158, a30
v_accvgpr_read_b32 v159, a31
v_accvgpr_read_b32 v160, a64
v_accvgpr_read_b32 v161, a65
v_accvgpr_read_b32 v162, a66
v_accvgpr_read_b32 v163, a67
v_accvgpr_read_b32 v164, a68
v_accvgpr_read_b32 v165, a69
v_accvgpr_read_b32 v166, a70
v_accvgpr_read_b32 v167, a71
v_accvgpr_read_b32 v168, a72
v_accvgpr_read_b32 v169, a73
v_accvgpr_read_b32 v170, a74
v_accvgpr_read_b32 v171, a75
v_accvgpr_read_b32 v172, a76
v_accvgpr_read_b32 v173, a77
v_accvgpr_read_b32 v174, a78
v_accvgpr_read_b32 v175, a79
v_accvgpr_read_b32 v176, a80
v_accvgpr_read_b32 v177, a81
v_accvgpr_read_b32 v178, a82
v_accvgpr_read_b32 v179, a83
v_accvgpr_read_b32 v180, a84
v_accvgpr_read_b32 v181, a85
v_accvgpr_read_b32 v182, a86
v_accvgpr_read_b32 v183, a87
v_accvgpr_read_b32 v184, a88
v_accvgpr_read_b32 v185, a89
v_accvgpr_read_b32 v186, a90
v_accvgpr_read_b32 v187, a91
v_accvgpr_read_b32 v188, a92
v_accvgpr_read_b32 v189, a93
v_accvgpr_read_b32 v190, a94
v_accvgpr_read_b32 v191, a95
s_branch at_m2
at_m1:
v_accvgpr_read_b32 v64, a0
v_accvgpr_read_b32 v65, a1
v_accvgpr_read_b32 v66, a2
v_accvgpr_read_b32 v67, a3
v_accvgpr_read_b32 v68, a4
v_accvgpr_read_b32 v69, a5
v_accvgpr_read_b32 v70, a6
v_accvgpr_read_b32 v71, a7
v_mul_f32 v64, v64, v24
v_mul_f32 v65, v65, v24
v_mul_f32 v66, v66, v24
v_mul_f32 v67, v67, v24
v_mul_f32 v68, v68, v24
v_mul_f32 v69, v69, v24
v_mul_f32 v70, v70, v24
v_mul_f32 v71, v71, v24
ds_write_b128 v2, v[64:67] offset:0
ds_write_b128 v2, v[68:71] offset:1024
v_accvgpr_read_b32 v72, a8
v_accvgpr_read_b32 v73, a9
v_accvgpr_read_b32 v74, a10
v_accvgpr_read_b32 v75, a11
v_accvgpr_read_b32 v76, a12
v_accvgpr_read_b32 v77, a13
v_accvgpr_read_b32 v78, a14
v_accvgpr_read_b32 v79, a15
v_mul_f32 v72, v72, v24
v_mul_f32 v73, v73, v24
v_mul_f32 v74, v74, v24
v_mul_f32 v75, v75, v24
v_mul_f32 v76, v76, v24
v_mul_f32 v77, v77, v24
v_mul_f32 v78, v78, v24
v_mul_f32 v79, v79, v24
ds_write_b128 v2, v[72:75] offset:2048
ds_write_b128 v2, v[76:79] offset:3072
v_accvgpr_read_b32 v80, a16
v_accvgpr_read_b32 v81, a17
v_accvgpr_read_b32 v82, a18
v_accvgpr_read_b32 v83, a19
v_accvgpr_read_b32 v84, a20
v_accvgpr_read_b32 v85, a21
v_accvgpr_read_b32 v86, a22
v_accvgpr_read_b32 v87, a23
v_mul_f32 v80, v80, v24
v_mul_f32 v81, v81, v24
v_mul_f32 v82, v82, v24
v_mul_f32 v83, v83, v24
v_mul_f32 v84, v84, v24
v_mul_f32 v85, v85, v24
v_mul_f32 v86, v86, v24
v_mul_f32 v87, v87, v24
ds_write_b128 v2, v[80:83] offset:4096
ds_write_b128 v2, v[84:87] offset:5120
v_accvgpr_read_b32 v88, a24
v_accvgpr_read_b32 v89, a25
v_accvgpr_read_b32 v90, a26
v_accvgpr_read_b32 v91, a27
v_accvgpr_read_b32 v92, a28
v_accvgpr_read_b32 v93, a29
v_accvgpr_read_b32 v94, a30
v_accvgpr_read_b32 v95, a31
v_mul_f32 v88, v88, v24
v_mul_f32 v89, v89, v24
v_mul_f32 v90, v90, v24
v_mul_f32 v91, v91, v24
v_mul_f32 v92, v92, v24
v_mul_f32 v93, v93, v24
v_mul_f32 v94, v94, v24
v_mul_f32 v95, v95, v24
ds_write_b128 v2, v[88:91] offset:6144
ds_write_b128 v2, v[92:95] offset:7168
v_accvgpr_read_b32 v96, a64
v_accvgpr_read_b32 v97, a65
v_accvgpr_read_b32 v98, a66
v_accvgpr_read_b32 v99, a67
v_accvgpr_read_b32 v100, a68
v_accvgpr_read_b32 v101, a69
v_accvgpr_read_b32 v102, a70
v_accvgpr_read_b32 v103, a71
v_mul_f32 v96, v96, v25
v_mul_f32 v97, v97, v25
v_mul_f32 v98, v98, v25
v_mul_f32 v99, v99, v25
v_mul_f32 v100, v100, v25
v_mul_f32 v101, v101, v25
v_mul_f32 v102, v102, v25
v_mul_f32 v103, v103, v25
ds_write_b128 v2, v[96:99] offset:8192
ds_write_b128 v2, v[100:103] offset:9216
v_accvgpr_read_b32 v104, a72
v_accvgpr_read_b32 v105, a73
v_accvgpr_read_b32 v106, a74
v_accvgpr_read_b32 v107, a75
v_accvgpr_read_b32 v108, a76
v_accvgpr_read_b32 v109, a77
v_accvgpr_read_b32 v110, a78
v_accvgpr_read_b32 v111, a79
v_mul_f32 v104, v104, v25
v_mul_f32 v105, v105, v25
v_mul_f32 v106, v106, v25
v_mul_f32 v107, v107, v25
v_mul_f32 v108, v108, v25
v_mul_f32 v109, v109, v25
v_mul_f32 v110, v110, v25
v_mul_f32 v111, v111, v25
ds_write_b128 v2, v[104:107] offset:10240
ds_write_b128 v2, v[108:111] offset:11264
v_accvgpr_read_b32 v112, a80
v_accvgpr_read_b32 v113, a81
v_accvgpr_read_b32 v114, a82
v_accvgpr_read_b32 v115, a83
v_accvgpr_read_b32 v116, a84
v_accvgpr_read_b32 v117, a85
v_accvgpr_read_b32 v118, a86
v_accvgpr_read_b32 v119, a87
v_mul_f32 v112, v112, v25
v_mul_f32 v113, v113, v25
v_mul_f32 v114, v114, v25
v_mul_f32 v115, v115, v25
v_mul_f32 v116, v116, v25
v_mul_f32 v117, v117, v25
v_mul_f32 v118, v118, v25
v_mul_f32 v119, v119, v25
ds_write_b128 v2, v[112:115] offset:12288
ds_write_b128 v2, v[116:119] offset:13312
v_accvgpr_read_b32 v120, a88
v_accvgpr_read_b32 v121, a89
v_accvgpr_read_b32 v122, a90
v_accvgpr_read_b32 v123, a91
v_accvgpr_read_b32 v124, a92
v_accvgpr_read_b32 v125, a93
v_accvgpr_read_b32 v126, a94
v_accvgpr_read_b32 v127, a95
v_mul_f32 v120, v120, v25
v_mul_f32 v121, v121, v25
v_mul_f32 v122, v122, v25
v_mul_f32 v123, v123, v25
v_mul_f32 v124, v124, v25
v_mul_f32 v125, v125, v25
v_mul_f32 v126, v126, v25
v_mul_f32 v127, v127, v25
ds_write_b128 v2, v[120:123] offset:14336
ds_write_b128 v2, v[124:127] offset:15360
v_accvgpr_read_b32 v128, a32
v_accvgpr_read_b32 v129, a33
v_accvgpr_read_b32 v130, a34
v_accvgpr_read_b32 v131, a35
v_accvgpr_read_b32 v132, a36
v_accvgpr_read_b32 v133, a37
v_accvgpr_read_b32 v134, a38
v_accvgpr_read_b32 v135, a39
v_accvgpr_read_b32 v136, a40
v_accvgpr_read_b32 v137, a41
v_accvgpr_read_b32 v138, a42
v_accvgpr_read_b32 v139, a43
v_accvgpr_read_b32 v140, a44
v_accvgpr_read_b32 v141, a45
v_accvgpr_read_b32 v142, a46
v_accvgpr_read_b32 v143, a47
v_accvgpr_read_b32 v144, a48
v_accvgpr_read_b32 v145, a49
v_accvgpr_read_b32 v146, a50
v_accvgpr_read_b32 v147, a51
v_accvgpr_read_b32 v148, a52
v_accvgpr_read_b32 v149, a53
v_accvgpr_read_b32 v150, a54
v_accvgpr_read_b32 v151, a55
v_accvgpr_read_b32 v152, a56
v_accvgpr_read_b32 v153, a57
v_accvgpr_read_b32 v154, a58
v_accvgpr_read_b32 v155, a59
v_accvgpr_read_b32 v156, a60
v_accvgpr_read_b32 v157, a61
v_accvgpr_read_b32 v158, a62
v_accvgpr_read_b32 v159, a63
v_accvgpr_read_b32 v160, a96
v_accvgpr_read_b32 v161, a97
v_accvgpr_read_b32 v162, a98
v_accvgpr_read_b32 v163, a99
v_accvgpr_read_b32 v164, a100
v_accvgpr_read_b32 v165, a101
v_accvgpr_read_b32 v166, a102
v_accvgpr_read_b32 v167, a103
v_accvgpr_read_b32 v168, a104
v_accvgpr_read_b32 v169, a105
v_accvgpr_read_b32 v170, a106
v_accvgpr_read_b32 v171, a107
v_accvgpr_read_b32 v172, a108
v_accvgpr_read_b32 v173, a109
v_accvgpr_read_b32 v174, a110
v_accvgpr_read_b32 v175, a111
v_accvgpr_read_b32 v176, a112
v_accvgpr_read_b32 v177, a113
v_accvgpr_read_b32 v178, a114
v_accvgpr_read_b32 v179, a115
v_accvgpr_read_b32 v180, a116
v_accvgpr_read_b32 v181, a117
v_accvgpr_read_b32 v182, a118
v_accvgpr_read_b32 v183, a119
v_accvgpr_read_b32 v184, a120
v_accvgpr_read_b32 v185, a121
v_accvgpr_read_b32 v186, a122
v_accvgpr_read_b32 v187, a123
v_accvgpr_read_b32 v188, a124
v_accvgpr_read_b32 v189, a125
v_accvgpr_read_b32 v190, a126
v_accvgpr_read_b32 v191, a127
at_m2:
s_waitcnt lgkmcnt(0)
s_barrier
ds_read_b128 v[64:67], v3 offset:0
ds_read_b128 v[68:71], v3 offset:1024
ds_read_b128 v[72:75], v3 offset:2048
ds_read_b128 v[76:79], v3 offset:3072
ds_read_b128 v[80:83], v3 offset:4096
ds_read_b128 v[84:87], v3 offset:5120
ds_read_b128 v[88:91], v3 offset:6144
ds_read_b128 v[92:95], v3 offset:7168
ds_read_b128 v[96:99], v3 offset:8192
ds_read_b128 v[100:103], v3 offset:9216
ds_read_b128 v[104:107], v3 offset:10240
ds_read_b128 v[108:111], v3 offset:11264
ds_read_b128 v[112:115], v3 offset:12288
ds_read_b128 v[116:119], v3 offset:13312
ds_read_b128 v[120:123], v3 offset:14336
ds_read_b128 v[124:127], v3 offset:15360
s_waitcnt lgkmcnt(14)
v_fmac_f32 v64, v128, v24
v_fmac_f32 v65, v129, v24
v_fmac_f32 v66, v130, v24
v_fmac_f32 v67, v131, v24
v_fmac_f32 v68, v132, v24
v_fmac_f32 v69, v133, v24
v_fmac_f32 v70, v134, v24
v_fmac_f32 v71, v135, v24
v_cvt_pk_bf16_f32 v192, v64, v65
v_cvt_pk_bf16_f32 v193, v66, v67
v_cvt_pk_bf16_f32 v194, v68, v69
v_cvt_pk_bf16_f32 v195, v70, v71
buffer_store_dwordx4 v[192:195], v30, s[24:27], s5 offen offset:0 sc0 sc1
s_waitcnt lgkmcnt(12)
v_fmac_f32 v72, v136, v24
v_fmac_f32 v73, v137, v24
v_fmac_f32 v74, v138, v24
v_fmac_f32 v75, v139, v24
v_fmac_f32 v76, v140, v24
v_fmac_f32 v77, v141, v24
v_fmac_f32 v78, v142, v24
v_fmac_f32 v79, v143, v24
v_cvt_pk_bf16_f32 v196, v72, v73
v_cvt_pk_bf16_f32 v197, v74, v75
v_cvt_pk_bf16_f32 v198, v76, v77
v_cvt_pk_bf16_f32 v199, v78, v79
buffer_store_dwordx4 v[196:199], v30, s[24:27], s5 offen offset:1024 sc0 sc1
s_waitcnt lgkmcnt(10)
v_fmac_f32 v80, v144, v24
v_fmac_f32 v81, v145, v24
v_fmac_f32 v82, v146, v24
v_fmac_f32 v83, v147, v24
v_fmac_f32 v84, v148, v24
v_fmac_f32 v85, v149, v24
v_fmac_f32 v86, v150, v24
v_fmac_f32 v87, v151, v24
v_cvt_pk_bf16_f32 v200, v80, v81
v_cvt_pk_bf16_f32 v201, v82, v83
v_cvt_pk_bf16_f32 v202, v84, v85
v_cvt_pk_bf16_f32 v203, v86, v87
buffer_store_dwordx4 v[200:203], v30, s[24:27], s5 offen offset:2048 sc0 sc1
s_waitcnt lgkmcnt(8)
v_fmac_f32 v88, v152, v24
v_fmac_f32 v89, v153, v24
v_fmac_f32 v90, v154, v24
v_fmac_f32 v91, v155, v24
v_fmac_f32 v92, v156, v24
v_fmac_f32 v93, v157, v24
v_fmac_f32 v94, v158, v24
v_fmac_f32 v95, v159, v24
v_cvt_pk_bf16_f32 v204, v88, v89
v_cvt_pk_bf16_f32 v205, v90, v91
v_cvt_pk_bf16_f32 v206, v92, v93
v_cvt_pk_bf16_f32 v207, v94, v95
buffer_store_dwordx4 v[204:207], v30, s[24:27], s5 offen offset:3072 sc0 sc1
s_waitcnt lgkmcnt(6)
v_fmac_f32 v96, v160, v25
v_fmac_f32 v97, v161, v25
v_fmac_f32 v98, v162, v25
v_fmac_f32 v99, v163, v25
v_fmac_f32 v100, v164, v25
v_fmac_f32 v101, v165, v25
v_fmac_f32 v102, v166, v25
v_fmac_f32 v103, v167, v25
v_cvt_pk_bf16_f32 v208, v96, v97
v_cvt_pk_bf16_f32 v209, v98, v99
v_cvt_pk_bf16_f32 v210, v100, v101
v_cvt_pk_bf16_f32 v211, v102, v103
buffer_store_dwordx4 v[208:211], v30, s[24:27], s6 offen offset:0 sc0 sc1
s_waitcnt lgkmcnt(4)
v_fmac_f32 v104, v168, v25
v_fmac_f32 v105, v169, v25
v_fmac_f32 v106, v170, v25
v_fmac_f32 v107, v171, v25
v_fmac_f32 v108, v172, v25
v_fmac_f32 v109, v173, v25
v_fmac_f32 v110, v174, v25
v_fmac_f32 v111, v175, v25
v_cvt_pk_bf16_f32 v212, v104, v105
v_cvt_pk_bf16_f32 v213, v106, v107
v_cvt_pk_bf16_f32 v214, v108, v109
v_cvt_pk_bf16_f32 v215, v110, v111
buffer_store_dwordx4 v[212:215], v30, s[24:27], s6 offen offset:1024 sc0 sc1
s_waitcnt lgkmcnt(2)
v_fmac_f32 v112, v176, v25
v_fmac_f32 v113, v177, v25
v_fmac_f32 v114, v178, v25
v_fmac_f32 v115, v179, v25
v_fmac_f32 v116, v180, v25
v_fmac_f32 v117, v181, v25
v_fmac_f32 v118, v182, v25
v_fmac_f32 v119, v183, v25
v_cvt_pk_bf16_f32 v216, v112, v113
v_cvt_pk_bf16_f32 v217, v114, v115
v_cvt_pk_bf16_f32 v218, v116, v117
v_cvt_pk_bf16_f32 v219, v118, v119
buffer_store_dwordx4 v[216:219], v30, s[24:27], s6 offen offset:2048 sc0 sc1
s_waitcnt lgkmcnt(0)
v_fmac_f32 v120, v184, v25
v_fmac_f32 v121, v185, v25
v_fmac_f32 v122, v186, v25
v_fmac_f32 v123, v187, v25
v_fmac_f32 v124, v188, v25
v_fmac_f32 v125, v189, v25
v_fmac_f32 v126, v190, v25
v_fmac_f32 v127, v191, v25
v_cvt_pk_bf16_f32 v220, v120, v121
v_cvt_pk_bf16_f32 v221, v122, v123
v_cvt_pk_bf16_f32 v222, v124, v125
v_cvt_pk_bf16_f32 v223, v126, v127
buffer_store_dwordx4 v[220:223], v30, s[24:27], s6 offen offset:3072 sc0 sc1
s_sub_u32 s41, s41, 1
s_cmp_eq_u32 s41, 0
s_cbranch_scc1 at_end
s_mov_b32 s37, s51
s_waitcnt vmcnt(8)
s_barrier
s_add_u32 m0, s49, 32768
s_nop 0
buffer_load_dwordx4 v5, s[20:23], s46 offen offset:0 lds
buffer_load_dwordx4 v5, s[20:23], s46 offen offset:1024 lds
buffer_load_dwordx4 v5, s[20:23], s46 offen offset:2048 lds
buffer_load_dwordx4 v5, s[20:23], s46 offen offset:3072 lds
s_add_u32 m0, s49, 36864
s_add_u32 s46, s46, 4096
buffer_load_dwordx4 v5, s[20:23], s46 offen offset:0 lds
buffer_load_dwordx4 v5, s[20:23], s46 offen offset:1024 lds
buffer_load_dwordx4 v5, s[20:23], s46 offen offset:2048 lds
buffer_load_dwordx4 v5, s[20:23], s46 offen offset:3072 lds
s_add_u32 s46, s46, 0x7000
s_branch at_blk
at_end:
s_endpgm
.section .rodata,"a"
.p2align 6
.amdhsa_kernel at_kernel
  .amdhsa_next_free_vgpr 456
  .amdhsa_next_free_sgpr 96
  .amdhsa_accum_offset 256
  .amdhsa_group_segment_fixed_size 0
  .amdhsa_kernarg_size 112
  .amdhsa_user_sgpr_count 2
  .amdhsa_user_sgpr_kernarg_segment_ptr 1
  .amdhsa_system_sgpr_workgroup_id_x 1
.end_amdhsa_kernel
.text
.globl op_kernel
.p2align 8
.type op_kernel,@function
op_kernel:
s_cmp_ge_u32 s2, 192
s_cbranch_scc0 op_kernel_go
s_endpgm
op_kernel_go:
v_lshrrev_b32 v1, 6, v0
v_and_b32 v0, 63, v0
s_nop 0
v_readfirstlane_b32 s3, v1
s_load_dwordx2 s[8:9], s[0:1], 104
s_load_dwordx2 s[12:13], s[0:1], 104
s_load_dwordx2 s[16:17], s[0:1], 0
s_load_dwordx2 s[20:21], s[0:1], 104
s_and_b32 s5, s2, 7
s_mul_i32 s5, s5, 24
s_lshr_b32 s6, s2, 3
s_add_u32 s5, s5, s6
s_mul_i32 s36, s5, 0xaaab
s_lshr_b32 s36, s36, 18
s_mul_i32 s6, s36, 6
s_sub_u32 s37, s5, s6
s_lshr_b32 s5, s2, 3
s_mul_i32 s36, s5, 0x5556
s_lshr_b32 s36, s36, 16
s_mul_i32 s6, s36, 3
s_sub_u32 s37, s5, s6
s_bfe_u32 s5, s2, 0x20001
s_lshl_b32 s5, s5, 3
s_add_u32 s36, s36, s5
s_and_b32 s5, s2, 1
s_mul_i32 s5, s5, 3
s_add_u32 s37, s37, s5
s_mul_i32 s43, s37, 786432
s_lshl_b32 s44, s36, 19
s_mul_i32 s45, s3, 6
s_lshl_b32 s46, s45, 10
v_add_u32 v1, 0, v0
v_lshl_add_u32 v1, s45, 6, v1
v_mul_u32_u24 v2, 0x5556, v1
v_lshrrev_b32 v2, 18, v2
v_mul_u32_u24 v3, 12, v2
v_sub_u32 v1, v1, v3
v_mul_u32_u24 v2, 192, v2
v_lshl_add_u32 v4, v1, 4, v2
v_add_u32 v1, 64, v0
v_lshl_add_u32 v1, s45, 6, v1
v_mul_u32_u24 v2, 0x5556, v1
v_lshrrev_b32 v2, 18, v2
v_mul_u32_u24 v3, 12, v2
v_sub_u32 v1, v1, v3
v_mul_u32_u24 v2, 192, v2
v_lshl_add_u32 v5, v1, 4, v2
v_subrev_u32 v5, 1024, v5
v_add_u32 v1, 128, v0
v_lshl_add_u32 v1, s45, 6, v1
v_mul_u32_u24 v2, 0x5556, v1
v_lshrrev_b32 v2, 18, v2
v_mul_u32_u24 v3, 12, v2
v_sub_u32 v1, v1, v3
v_mul_u32_u24 v2, 192, v2
v_lshl_add_u32 v6, v1, 4, v2
v_subrev_u32 v6, 2048, v6
v_add_u32 v1, 192, v0
v_lshl_add_u32 v1, s45, 6, v1
v_mul_u32_u24 v2, 0x5556, v1
v_lshrrev_b32 v2, 18, v2
v_mul_u32_u24 v3, 12, v2
v_sub_u32 v1, v1, v3
v_mul_u32_u24 v2, 192, v2
v_lshl_add_u32 v7, v1, 4, v2
v_subrev_u32 v7, 3072, v7
v_add_u32 v1, 256, v0
v_lshl_add_u32 v1, s45, 6, v1
v_mul_u32_u24 v2, 0x5556, v1
v_lshrrev_b32 v2, 18, v2
v_mul_u32_u24 v3, 12, v2
v_sub_u32 v1, v1, v3
v_mul_u32_u24 v2, 192, v2
v_lshl_add_u32 v8, v1, 4, v2
v_add_u32 v1, 320, v0
v_lshl_add_u32 v1, s45, 6, v1
v_mul_u32_u24 v2, 0x5556, v1
v_lshrrev_b32 v2, 18, v2
v_mul_u32_u24 v3, 12, v2
v_sub_u32 v1, v1, v3
v_mul_u32_u24 v2, 192, v2
v_lshl_add_u32 v9, v1, 4, v2
v_subrev_u32 v9, 1024, v9
s_mul_i32 s47, s3, 4
s_lshl_b32 s48, s47, 10
v_add_u32 v1, 0, v0
v_lshl_add_u32 v1, s47, 6, v1
v_lshrrev_b32 v2, 9, v1
v_and_b32 v1, 511, v1
v_mul_u32_u24 v2, 262144, v2
v_lshl_add_u32 v10, v1, 4, v2
v_add_u32 v1, 64, v0
v_lshl_add_u32 v1, s47, 6, v1
v_lshrrev_b32 v2, 9, v1
v_and_b32 v1, 511, v1
v_mul_u32_u24 v2, 262144, v2
v_lshl_add_u32 v11, v1, 4, v2
v_subrev_u32 v11, 1024, v11
v_add_u32 v1, 128, v0
v_lshl_add_u32 v1, s47, 6, v1
v_lshrrev_b32 v2, 9, v1
v_and_b32 v1, 511, v1
v_mul_u32_u24 v2, 262144, v2
v_lshl_add_u32 v12, v1, 4, v2
v_subrev_u32 v12, 2048, v12
v_add_u32 v1, 192, v0
v_lshl_add_u32 v1, s47, 6, v1
v_lshrrev_b32 v2, 9, v1
v_and_b32 v1, 511, v1
v_mul_u32_u24 v2, 262144, v2
v_lshl_add_u32 v13, v1, 4, v2
v_subrev_u32 v13, 3072, v13
s_waitcnt lgkmcnt(0)
s_add_u32 s8, s8, 0x4400000
s_addc_u32 s9, s9, 0
s_mov_b32 s10, 0x480000
s_mov_b32 s11, 0x00020000
s_add_u32 s12, s12, 0x2400000
s_addc_u32 s13, s13, 0
s_mov_b32 s14, 0x1000000
s_mov_b32 s15, 0x00020000
s_mov_b32 s18, 0x240000
s_mov_b32 s19, 0x00020000
s_add_u32 s20, s20, 0x3400000
s_addc_u32 s21, s21, 0
s_mov_b32 s22, 0x240000
s_mov_b32 s23, 0x00020000
s_add_u32 m0, s46, 0
s_nop 0
buffer_load_dwordx4 v4, s[8:11], s43 offen offset:0 lds
buffer_load_dwordx4 v5, s[8:11], s43 offen offset:1024 lds
buffer_load_dwordx4 v6, s[8:11], s43 offen offset:2048 lds
buffer_load_dwordx4 v7, s[8:11], s43 offen offset:3072 lds
s_add_u32 m0, s46, 4096
s_nop 0
buffer_load_dwordx4 v8, s[8:11], s43 offen offset:0 lds
buffer_load_dwordx4 v9, s[8:11], s43 offen offset:1024 lds
s_add_u32 m0, s48, 24576
s_nop 0
buffer_load_dwordx4 v10, s[12:15], s44 offen offset:0 lds
buffer_load_dwordx4 v11, s[12:15], s44 offen offset:1024 lds
buffer_load_dwordx4 v12, s[12:15], s44 offen offset:2048 lds
buffer_load_dwordx4 v13, s[12:15], s44 offen offset:3072 lds
s_add_u32 s43, s43, 24576
s_add_u32 s44, s44, 8192
s_add_u32 m0, s46, 40960
s_nop 0
buffer_load_dwordx4 v4, s[8:11], s43 offen offset:0 lds
buffer_load_dwordx4 v5, s[8:11], s43 offen offset:1024 lds
buffer_load_dwordx4 v6, s[8:11], s43 offen offset:2048 lds
buffer_load_dwordx4 v7, s[8:11], s43 offen offset:3072 lds
s_add_u32 m0, s46, 45056
s_nop 0
buffer_load_dwordx4 v8, s[8:11], s43 offen offset:0 lds
buffer_load_dwordx4 v9, s[8:11], s43 offen offset:1024 lds
s_add_u32 m0, s48, 65536
s_nop 0
buffer_load_dwordx4 v10, s[12:15], s44 offen offset:0 lds
buffer_load_dwordx4 v11, s[12:15], s44 offen offset:1024 lds
buffer_load_dwordx4 v12, s[12:15], s44 offen offset:2048 lds
buffer_load_dwordx4 v13, s[12:15], s44 offen offset:3072 lds
s_add_u32 s43, s43, 24576
s_add_u32 s44, s44, 8192
s_add_u32 m0, s46, 81920
s_nop 0
buffer_load_dwordx4 v4, s[8:11], s43 offen offset:0 lds
buffer_load_dwordx4 v5, s[8:11], s43 offen offset:1024 lds
buffer_load_dwordx4 v6, s[8:11], s43 offen offset:2048 lds
buffer_load_dwordx4 v7, s[8:11], s43 offen offset:3072 lds
s_add_u32 m0, s46, 86016
s_nop 0
buffer_load_dwordx4 v8, s[8:11], s43 offen offset:0 lds
buffer_load_dwordx4 v9, s[8:11], s43 offen offset:1024 lds
s_add_u32 m0, s48, 106496
s_nop 0
buffer_load_dwordx4 v10, s[12:15], s44 offen offset:0 lds
buffer_load_dwordx4 v11, s[12:15], s44 offen offset:1024 lds
buffer_load_dwordx4 v12, s[12:15], s44 offen offset:2048 lds
buffer_load_dwordx4 v13, s[12:15], s44 offen offset:3072 lds
s_add_u32 s43, s43, 24576
s_add_u32 s44, s44, 8192
s_add_u32 m0, s46, 122880
s_nop 0
buffer_load_dwordx4 v4, s[8:11], s43 offen offset:0 lds
buffer_load_dwordx4 v5, s[8:11], s43 offen offset:1024 lds
buffer_load_dwordx4 v6, s[8:11], s43 offen offset:2048 lds
buffer_load_dwordx4 v7, s[8:11], s43 offen offset:3072 lds
s_add_u32 m0, s46, 126976
s_nop 0
buffer_load_dwordx4 v8, s[8:11], s43 offen offset:0 lds
v_accvgpr_write_b32 a0, 0
v_accvgpr_write_b32 a1, 0
v_accvgpr_write_b32 a2, 0
v_accvgpr_write_b32 a3, 0
v_accvgpr_write_b32 a4, 0
v_accvgpr_write_b32 a5, 0
v_accvgpr_write_b32 a6, 0
v_accvgpr_write_b32 a7, 0
v_accvgpr_write_b32 a8, 0
v_accvgpr_write_b32 a9, 0
v_accvgpr_write_b32 a10, 0
v_accvgpr_write_b32 a11, 0
v_accvgpr_write_b32 a12, 0
v_accvgpr_write_b32 a13, 0
v_accvgpr_write_b32 a14, 0
v_accvgpr_write_b32 a15, 0
v_accvgpr_write_b32 a16, 0
v_accvgpr_write_b32 a17, 0
v_accvgpr_write_b32 a18, 0
v_accvgpr_write_b32 a19, 0
v_accvgpr_write_b32 a20, 0
v_accvgpr_write_b32 a21, 0
v_accvgpr_write_b32 a22, 0
v_accvgpr_write_b32 a23, 0
v_accvgpr_write_b32 a24, 0
v_accvgpr_write_b32 a25, 0
v_accvgpr_write_b32 a26, 0
v_accvgpr_write_b32 a27, 0
v_accvgpr_write_b32 a28, 0
v_accvgpr_write_b32 a29, 0
v_accvgpr_write_b32 a30, 0
v_accvgpr_write_b32 a31, 0
v_accvgpr_write_b32 a32, 0
v_accvgpr_write_b32 a33, 0
v_accvgpr_write_b32 a34, 0
v_accvgpr_write_b32 a35, 0
v_accvgpr_write_b32 a36, 0
v_accvgpr_write_b32 a37, 0
v_accvgpr_write_b32 a38, 0
v_accvgpr_write_b32 a39, 0
v_accvgpr_write_b32 a40, 0
v_accvgpr_write_b32 a41, 0
v_accvgpr_write_b32 a42, 0
v_accvgpr_write_b32 a43, 0
v_accvgpr_write_b32 a44, 0
v_accvgpr_write_b32 a45, 0
v_accvgpr_write_b32 a46, 0
v_accvgpr_write_b32 a47, 0
v_accvgpr_write_b32 a48, 0
v_accvgpr_write_b32 a49, 0
v_accvgpr_write_b32 a50, 0
v_accvgpr_write_b32 a51, 0
v_accvgpr_write_b32 a52, 0
v_accvgpr_write_b32 a53, 0
v_accvgpr_write_b32 a54, 0
v_accvgpr_write_b32 a55, 0
v_accvgpr_write_b32 a56, 0
v_accvgpr_write_b32 a57, 0
v_accvgpr_write_b32 a58, 0
v_accvgpr_write_b32 a59, 0
v_accvgpr_write_b32 a60, 0
v_accvgpr_write_b32 a61, 0
v_accvgpr_write_b32 a62, 0
v_accvgpr_write_b32 a63, 0
v_accvgpr_write_b32 a64, 0
v_accvgpr_write_b32 a65, 0
v_accvgpr_write_b32 a66, 0
v_accvgpr_write_b32 a67, 0
v_accvgpr_write_b32 a68, 0
v_accvgpr_write_b32 a69, 0
v_accvgpr_write_b32 a70, 0
v_accvgpr_write_b32 a71, 0
v_accvgpr_write_b32 a72, 0
v_accvgpr_write_b32 a73, 0
v_accvgpr_write_b32 a74, 0
v_accvgpr_write_b32 a75, 0
v_accvgpr_write_b32 a76, 0
v_accvgpr_write_b32 a77, 0
v_accvgpr_write_b32 a78, 0
v_accvgpr_write_b32 a79, 0
v_accvgpr_write_b32 a80, 0
v_accvgpr_write_b32 a81, 0
v_accvgpr_write_b32 a82, 0
v_accvgpr_write_b32 a83, 0
v_accvgpr_write_b32 a84, 0
v_accvgpr_write_b32 a85, 0
v_accvgpr_write_b32 a86, 0
v_accvgpr_write_b32 a87, 0
v_accvgpr_write_b32 a88, 0
v_accvgpr_write_b32 a89, 0
v_accvgpr_write_b32 a90, 0
v_accvgpr_write_b32 a91, 0
v_accvgpr_write_b32 a92, 0
v_accvgpr_write_b32 a93, 0
v_accvgpr_write_b32 a94, 0
v_accvgpr_write_b32 a95, 0
s_mul_i32 s42, s3, 6144
v_bfe_u32 v1, v0, 2, 2
v_lshrrev_b32 v2, 5, v0
v_lshl_add_u32 v2, v2, 2, v1
v_mul_u32_u24 v2, 192, v2
v_bfe_u32 v3, v0, 4, 1
v_lshl_add_u32 v2, v3, 5, v2
v_and_b32 v3, 3, v0
v_lshl_add_u32 v2, v3, 3, v2
v_add_u32 v2, s42, v2
v_mov_b32 v14, v2
v_add_u32 v16, 131072, v14
v_add_u32 v15, 65536, v14
s_mul_i32 s42, s3, 2048
v_lshlrev_b32 v17, 4, v0
v_add_u32 v17, s42, v17
v_add_u32 v19, 131072, v17
v_add_u32 v18, 65536, v17
s_waitcnt vmcnt(25)
s_barrier
ds_read_b64_tr_b16 v[32:33], v14 offset:0
ds_read_b64_tr_b16 v[34:35], v14 offset:1536
ds_read_b64_tr_b16 v[36:37], v14 offset:64
ds_read_b64_tr_b16 v[38:39], v14 offset:1600
ds_read_b64_tr_b16 v[40:41], v14 offset:128
ds_read_b64_tr_b16 v[42:43], v14 offset:1664
ds_read_b128 v[44:47], v17 offset:24576
ds_read_b128 v[48:51], v17 offset:32768
s_mov_b32 s4, 7
gl_31:
s_waitcnt lgkmcnt(0)
v_mfma_f32_32x32x16_bf16 a[0:15], v[32:35], v[44:47], a[0:15]
ds_read_b64_tr_b16 v[52:53], v14 offset:3072
ds_read_b64_tr_b16 v[54:55], v14 offset:4608
ds_read_b64_tr_b16 v[56:57], v14 offset:3136
v_mfma_f32_32x32x16_bf16 a[16:31], v[32:35], v[48:51], a[16:31]
ds_read_b64_tr_b16 v[58:59], v14 offset:4672
ds_read_b64_tr_b16 v[60:61], v14 offset:3200
ds_read_b64_tr_b16 v[62:63], v14 offset:4736
v_mfma_f32_32x32x16_bf16 a[32:47], v[36:39], v[44:47], a[32:47]
ds_read_b128 v[64:67], v17 offset:25600
ds_read_b128 v[68:71], v17 offset:33792
v_mfma_f32_32x32x16_bf16 a[48:63], v[36:39], v[48:51], a[48:63]
buffer_load_dwordx4 v9, s[8:11], s43 offen offset:1024 lds
s_add_u32 m0, s48, 147456
s_nop 0
buffer_load_dwordx4 v10, s[12:15], s44 offen offset:0 lds
v_mfma_f32_32x32x16_bf16 a[64:79], v[40:43], v[44:47], a[64:79]
buffer_load_dwordx4 v11, s[12:15], s44 offen offset:1024 lds
buffer_load_dwordx4 v12, s[12:15], s44 offen offset:2048 lds
v_mfma_f32_32x32x16_bf16 a[80:95], v[40:43], v[48:51], a[80:95]
buffer_load_dwordx4 v13, s[12:15], s44 offen offset:3072 lds
s_add_u32 s43, s43, 24576
s_add_u32 s44, s44, 8192
s_waitcnt lgkmcnt(0)
s_waitcnt vmcnt(20)
s_barrier
v_mfma_f32_32x32x16_bf16 a[0:15], v[52:55], v[64:67], a[0:15]
ds_read_b64_tr_b16 v[32:33], v14 offset:40960
ds_read_b64_tr_b16 v[34:35], v14 offset:42496
ds_read_b64_tr_b16 v[36:37], v14 offset:41024
v_mfma_f32_32x32x16_bf16 a[16:31], v[52:55], v[68:71], a[16:31]
ds_read_b64_tr_b16 v[38:39], v14 offset:42560
ds_read_b64_tr_b16 v[40:41], v14 offset:41088
ds_read_b64_tr_b16 v[42:43], v14 offset:42624
v_mfma_f32_32x32x16_bf16 a[32:47], v[56:59], v[64:67], a[32:47]
ds_read_b128 v[44:47], v18 offset:0
ds_read_b128 v[48:51], v18 offset:8192
v_mfma_f32_32x32x16_bf16 a[48:63], v[56:59], v[68:71], a[48:63]
s_add_u32 m0, s46, 0
s_nop 0
buffer_load_dwordx4 v4, s[8:11], s43 offen offset:0 lds
buffer_load_dwordx4 v5, s[8:11], s43 offen offset:1024 lds
v_mfma_f32_32x32x16_bf16 a[64:79], v[60:63], v[64:67], a[64:79]
buffer_load_dwordx4 v6, s[8:11], s43 offen offset:2048 lds
buffer_load_dwordx4 v7, s[8:11], s43 offen offset:3072 lds
v_mfma_f32_32x32x16_bf16 a[80:95], v[60:63], v[68:71], a[80:95]
s_add_u32 m0, s46, 4096
s_nop 0
buffer_load_dwordx4 v8, s[8:11], s43 offen offset:0 lds
s_waitcnt lgkmcnt(0)
v_mfma_f32_32x32x16_bf16 a[0:15], v[32:35], v[44:47], a[0:15]
ds_read_b64_tr_b16 v[52:53], v14 offset:44032
ds_read_b64_tr_b16 v[54:55], v14 offset:45568
ds_read_b64_tr_b16 v[56:57], v14 offset:44096
v_mfma_f32_32x32x16_bf16 a[16:31], v[32:35], v[48:51], a[16:31]
ds_read_b64_tr_b16 v[58:59], v14 offset:45632
ds_read_b64_tr_b16 v[60:61], v14 offset:44160
ds_read_b64_tr_b16 v[62:63], v14 offset:45696
v_mfma_f32_32x32x16_bf16 a[32:47], v[36:39], v[44:47], a[32:47]
ds_read_b128 v[64:67], v18 offset:1024
ds_read_b128 v[68:71], v18 offset:9216
v_mfma_f32_32x32x16_bf16 a[48:63], v[36:39], v[48:51], a[48:63]
buffer_load_dwordx4 v9, s[8:11], s43 offen offset:1024 lds
s_add_u32 m0, s48, 24576
s_nop 0
buffer_load_dwordx4 v10, s[12:15], s44 offen offset:0 lds
v_mfma_f32_32x32x16_bf16 a[64:79], v[40:43], v[44:47], a[64:79]
buffer_load_dwordx4 v11, s[12:15], s44 offen offset:1024 lds
buffer_load_dwordx4 v12, s[12:15], s44 offen offset:2048 lds
v_mfma_f32_32x32x16_bf16 a[80:95], v[40:43], v[48:51], a[80:95]
buffer_load_dwordx4 v13, s[12:15], s44 offen offset:3072 lds
s_add_u32 s43, s43, 24576
s_add_u32 s44, s44, 8192
s_waitcnt lgkmcnt(0)
s_waitcnt vmcnt(20)
s_barrier
v_mfma_f32_32x32x16_bf16 a[0:15], v[52:55], v[64:67], a[0:15]
ds_read_b64_tr_b16 v[32:33], v15 offset:16384
ds_read_b64_tr_b16 v[34:35], v15 offset:17920
ds_read_b64_tr_b16 v[36:37], v15 offset:16448
v_mfma_f32_32x32x16_bf16 a[16:31], v[52:55], v[68:71], a[16:31]
ds_read_b64_tr_b16 v[38:39], v15 offset:17984
ds_read_b64_tr_b16 v[40:41], v15 offset:16512
ds_read_b64_tr_b16 v[42:43], v15 offset:18048
v_mfma_f32_32x32x16_bf16 a[32:47], v[56:59], v[64:67], a[32:47]
ds_read_b128 v[44:47], v18 offset:40960
ds_read_b128 v[48:51], v18 offset:49152
v_mfma_f32_32x32x16_bf16 a[48:63], v[56:59], v[68:71], a[48:63]
s_add_u32 m0, s46, 40960
s_nop 0
buffer_load_dwordx4 v4, s[8:11], s43 offen offset:0 lds
buffer_load_dwordx4 v5, s[8:11], s43 offen offset:1024 lds
v_mfma_f32_32x32x16_bf16 a[64:79], v[60:63], v[64:67], a[64:79]
buffer_load_dwordx4 v6, s[8:11], s43 offen offset:2048 lds
buffer_load_dwordx4 v7, s[8:11], s43 offen offset:3072 lds
v_mfma_f32_32x32x16_bf16 a[80:95], v[60:63], v[68:71], a[80:95]
s_add_u32 m0, s46, 45056
s_nop 0
buffer_load_dwordx4 v8, s[8:11], s43 offen offset:0 lds
s_waitcnt lgkmcnt(0)
v_mfma_f32_32x32x16_bf16 a[0:15], v[32:35], v[44:47], a[0:15]
ds_read_b64_tr_b16 v[52:53], v15 offset:19456
ds_read_b64_tr_b16 v[54:55], v15 offset:20992
ds_read_b64_tr_b16 v[56:57], v15 offset:19520
v_mfma_f32_32x32x16_bf16 a[16:31], v[32:35], v[48:51], a[16:31]
ds_read_b64_tr_b16 v[58:59], v15 offset:21056
ds_read_b64_tr_b16 v[60:61], v15 offset:19584
ds_read_b64_tr_b16 v[62:63], v15 offset:21120
v_mfma_f32_32x32x16_bf16 a[32:47], v[36:39], v[44:47], a[32:47]
ds_read_b128 v[64:67], v18 offset:41984
ds_read_b128 v[68:71], v18 offset:50176
v_mfma_f32_32x32x16_bf16 a[48:63], v[36:39], v[48:51], a[48:63]
buffer_load_dwordx4 v9, s[8:11], s43 offen offset:1024 lds
s_add_u32 m0, s48, 65536
s_nop 0
buffer_load_dwordx4 v10, s[12:15], s44 offen offset:0 lds
v_mfma_f32_32x32x16_bf16 a[64:79], v[40:43], v[44:47], a[64:79]
buffer_load_dwordx4 v11, s[12:15], s44 offen offset:1024 lds
buffer_load_dwordx4 v12, s[12:15], s44 offen offset:2048 lds
v_mfma_f32_32x32x16_bf16 a[80:95], v[40:43], v[48:51], a[80:95]
buffer_load_dwordx4 v13, s[12:15], s44 offen offset:3072 lds
s_add_u32 s43, s43, 24576
s_add_u32 s44, s44, 8192
s_waitcnt lgkmcnt(0)
s_waitcnt vmcnt(20)
s_barrier
v_mfma_f32_32x32x16_bf16 a[0:15], v[52:55], v[64:67], a[0:15]
ds_read_b64_tr_b16 v[32:33], v15 offset:57344
ds_read_b64_tr_b16 v[34:35], v15 offset:58880
ds_read_b64_tr_b16 v[36:37], v15 offset:57408
v_mfma_f32_32x32x16_bf16 a[16:31], v[52:55], v[68:71], a[16:31]
ds_read_b64_tr_b16 v[38:39], v15 offset:58944
ds_read_b64_tr_b16 v[40:41], v15 offset:57472
ds_read_b64_tr_b16 v[42:43], v15 offset:59008
v_mfma_f32_32x32x16_bf16 a[32:47], v[56:59], v[64:67], a[32:47]
ds_read_b128 v[44:47], v19 offset:16384
ds_read_b128 v[48:51], v19 offset:24576
v_mfma_f32_32x32x16_bf16 a[48:63], v[56:59], v[68:71], a[48:63]
s_add_u32 m0, s46, 81920
s_nop 0
buffer_load_dwordx4 v4, s[8:11], s43 offen offset:0 lds
buffer_load_dwordx4 v5, s[8:11], s43 offen offset:1024 lds
v_mfma_f32_32x32x16_bf16 a[64:79], v[60:63], v[64:67], a[64:79]
buffer_load_dwordx4 v6, s[8:11], s43 offen offset:2048 lds
buffer_load_dwordx4 v7, s[8:11], s43 offen offset:3072 lds
v_mfma_f32_32x32x16_bf16 a[80:95], v[60:63], v[68:71], a[80:95]
s_add_u32 m0, s46, 86016
s_nop 0
buffer_load_dwordx4 v8, s[8:11], s43 offen offset:0 lds
s_waitcnt lgkmcnt(0)
v_mfma_f32_32x32x16_bf16 a[0:15], v[32:35], v[44:47], a[0:15]
ds_read_b64_tr_b16 v[52:53], v15 offset:60416
ds_read_b64_tr_b16 v[54:55], v15 offset:61952
ds_read_b64_tr_b16 v[56:57], v15 offset:60480
v_mfma_f32_32x32x16_bf16 a[16:31], v[32:35], v[48:51], a[16:31]
ds_read_b64_tr_b16 v[58:59], v15 offset:62016
ds_read_b64_tr_b16 v[60:61], v15 offset:60544
ds_read_b64_tr_b16 v[62:63], v15 offset:62080
v_mfma_f32_32x32x16_bf16 a[32:47], v[36:39], v[44:47], a[32:47]
ds_read_b128 v[64:67], v19 offset:17408
ds_read_b128 v[68:71], v19 offset:25600
v_mfma_f32_32x32x16_bf16 a[48:63], v[36:39], v[48:51], a[48:63]
buffer_load_dwordx4 v9, s[8:11], s43 offen offset:1024 lds
s_add_u32 m0, s48, 106496
s_nop 0
buffer_load_dwordx4 v10, s[12:15], s44 offen offset:0 lds
v_mfma_f32_32x32x16_bf16 a[64:79], v[40:43], v[44:47], a[64:79]
buffer_load_dwordx4 v11, s[12:15], s44 offen offset:1024 lds
buffer_load_dwordx4 v12, s[12:15], s44 offen offset:2048 lds
v_mfma_f32_32x32x16_bf16 a[80:95], v[40:43], v[48:51], a[80:95]
buffer_load_dwordx4 v13, s[12:15], s44 offen offset:3072 lds
s_add_u32 s43, s43, 24576
s_add_u32 s44, s44, 8192
s_waitcnt lgkmcnt(0)
s_waitcnt vmcnt(20)
s_barrier
v_mfma_f32_32x32x16_bf16 a[0:15], v[52:55], v[64:67], a[0:15]
ds_read_b64_tr_b16 v[32:33], v14 offset:0
ds_read_b64_tr_b16 v[34:35], v14 offset:1536
ds_read_b64_tr_b16 v[36:37], v14 offset:64
v_mfma_f32_32x32x16_bf16 a[16:31], v[52:55], v[68:71], a[16:31]
ds_read_b64_tr_b16 v[38:39], v14 offset:1600
ds_read_b64_tr_b16 v[40:41], v14 offset:128
ds_read_b64_tr_b16 v[42:43], v14 offset:1664
v_mfma_f32_32x32x16_bf16 a[32:47], v[56:59], v[64:67], a[32:47]
ds_read_b128 v[44:47], v17 offset:24576
ds_read_b128 v[48:51], v17 offset:32768
v_mfma_f32_32x32x16_bf16 a[48:63], v[56:59], v[68:71], a[48:63]
s_add_u32 m0, s46, 122880
s_nop 0
buffer_load_dwordx4 v4, s[8:11], s43 offen offset:0 lds
buffer_load_dwordx4 v5, s[8:11], s43 offen offset:1024 lds
v_mfma_f32_32x32x16_bf16 a[64:79], v[60:63], v[64:67], a[64:79]
buffer_load_dwordx4 v6, s[8:11], s43 offen offset:2048 lds
buffer_load_dwordx4 v7, s[8:11], s43 offen offset:3072 lds
v_mfma_f32_32x32x16_bf16 a[80:95], v[60:63], v[68:71], a[80:95]
s_add_u32 m0, s46, 126976
s_nop 0
buffer_load_dwordx4 v8, s[8:11], s43 offen offset:0 lds
s_sub_u32 s4, s4, 1
s_cmp_lg_u32 s4, 0
s_cbranch_scc1 gl_31
s_waitcnt lgkmcnt(0)
v_mfma_f32_32x32x16_bf16 a[0:15], v[32:35], v[44:47], a[0:15]
ds_read_b64_tr_b16 v[52:53], v14 offset:3072
ds_read_b64_tr_b16 v[54:55], v14 offset:4608
ds_read_b64_tr_b16 v[56:57], v14 offset:3136
v_mfma_f32_32x32x16_bf16 a[16:31], v[32:35], v[48:51], a[16:31]
ds_read_b64_tr_b16 v[58:59], v14 offset:4672
ds_read_b64_tr_b16 v[60:61], v14 offset:3200
ds_read_b64_tr_b16 v[62:63], v14 offset:4736
v_mfma_f32_32x32x16_bf16 a[32:47], v[36:39], v[44:47], a[32:47]
ds_read_b128 v[64:67], v17 offset:25600
ds_read_b128 v[68:71], v17 offset:33792
v_mfma_f32_32x32x16_bf16 a[48:63], v[36:39], v[48:51], a[48:63]
buffer_load_dwordx4 v9, s[8:11], s43 offen offset:1024 lds
s_add_u32 m0, s48, 147456
s_nop 0
buffer_load_dwordx4 v10, s[12:15], s44 offen offset:0 lds
v_mfma_f32_32x32x16_bf16 a[64:79], v[40:43], v[44:47], a[64:79]
buffer_load_dwordx4 v11, s[12:15], s44 offen offset:1024 lds
buffer_load_dwordx4 v12, s[12:15], s44 offen offset:2048 lds
v_mfma_f32_32x32x16_bf16 a[80:95], v[40:43], v[48:51], a[80:95]
buffer_load_dwordx4 v13, s[12:15], s44 offen offset:3072 lds
s_add_u32 s43, s43, 24576
s_add_u32 s44, s44, 8192
s_waitcnt lgkmcnt(0)
s_waitcnt vmcnt(20)
s_barrier
v_mfma_f32_32x32x16_bf16 a[0:15], v[52:55], v[64:67], a[0:15]
ds_read_b64_tr_b16 v[32:33], v14 offset:40960
ds_read_b64_tr_b16 v[34:35], v14 offset:42496
v_mfma_f32_32x32x16_bf16 a[16:31], v[52:55], v[68:71], a[16:31]
ds_read_b64_tr_b16 v[36:37], v14 offset:41024
ds_read_b64_tr_b16 v[38:39], v14 offset:42560
v_mfma_f32_32x32x16_bf16 a[32:47], v[56:59], v[64:67], a[32:47]
ds_read_b64_tr_b16 v[40:41], v14 offset:41088
ds_read_b64_tr_b16 v[42:43], v14 offset:42624
v_mfma_f32_32x32x16_bf16 a[48:63], v[56:59], v[68:71], a[48:63]
ds_read_b128 v[44:47], v18 offset:0
ds_read_b128 v[48:51], v18 offset:8192
v_mfma_f32_32x32x16_bf16 a[64:79], v[60:63], v[64:67], a[64:79]
v_mfma_f32_32x32x16_bf16 a[80:95], v[60:63], v[68:71], a[80:95]
s_waitcnt lgkmcnt(0)
v_mfma_f32_32x32x16_bf16 a[0:15], v[32:35], v[44:47], a[0:15]
ds_read_b64_tr_b16 v[52:53], v14 offset:44032
ds_read_b64_tr_b16 v[54:55], v14 offset:45568
v_mfma_f32_32x32x16_bf16 a[16:31], v[32:35], v[48:51], a[16:31]
ds_read_b64_tr_b16 v[56:57], v14 offset:44096
ds_read_b64_tr_b16 v[58:59], v14 offset:45632
v_mfma_f32_32x32x16_bf16 a[32:47], v[36:39], v[44:47], a[32:47]
ds_read_b64_tr_b16 v[60:61], v14 offset:44160
ds_read_b64_tr_b16 v[62:63], v14 offset:45696
v_mfma_f32_32x32x16_bf16 a[48:63], v[36:39], v[48:51], a[48:63]
ds_read_b128 v[64:67], v18 offset:1024
ds_read_b128 v[68:71], v18 offset:9216
v_mfma_f32_32x32x16_bf16 a[64:79], v[40:43], v[44:47], a[64:79]
v_mfma_f32_32x32x16_bf16 a[80:95], v[40:43], v[48:51], a[80:95]
s_waitcnt lgkmcnt(0)
s_waitcnt vmcnt(10)
s_barrier
v_mfma_f32_32x32x16_bf16 a[0:15], v[52:55], v[64:67], a[0:15]
ds_read_b64_tr_b16 v[32:33], v15 offset:16384
ds_read_b64_tr_b16 v[34:35], v15 offset:17920
v_mfma_f32_32x32x16_bf16 a[16:31], v[52:55], v[68:71], a[16:31]
ds_read_b64_tr_b16 v[36:37], v15 offset:16448
ds_read_b64_tr_b16 v[38:39], v15 offset:17984
v_mfma_f32_32x32x16_bf16 a[32:47], v[56:59], v[64:67], a[32:47]
ds_read_b64_tr_b16 v[40:41], v15 offset:16512
ds_read_b64_tr_b16 v[42:43], v15 offset:18048
v_mfma_f32_32x32x16_bf16 a[48:63], v[56:59], v[68:71], a[48:63]
ds_read_b128 v[44:47], v18 offset:40960
ds_read_b128 v[48:51], v18 offset:49152
v_mfma_f32_32x32x16_bf16 a[64:79], v[60:63], v[64:67], a[64:79]
v_mfma_f32_32x32x16_bf16 a[80:95], v[60:63], v[68:71], a[80:95]
s_waitcnt lgkmcnt(0)
v_mfma_f32_32x32x16_bf16 a[0:15], v[32:35], v[44:47], a[0:15]
ds_read_b64_tr_b16 v[52:53], v15 offset:19456
ds_read_b64_tr_b16 v[54:55], v15 offset:20992
v_mfma_f32_32x32x16_bf16 a[16:31], v[32:35], v[48:51], a[16:31]
ds_read_b64_tr_b16 v[56:57], v15 offset:19520
ds_read_b64_tr_b16 v[58:59], v15 offset:21056
v_mfma_f32_32x32x16_bf16 a[32:47], v[36:39], v[44:47], a[32:47]
ds_read_b64_tr_b16 v[60:61], v15 offset:19584
ds_read_b64_tr_b16 v[62:63], v15 offset:21120
v_mfma_f32_32x32x16_bf16 a[48:63], v[36:39], v[48:51], a[48:63]
ds_read_b128 v[64:67], v18 offset:41984
ds_read_b128 v[68:71], v18 offset:50176
v_mfma_f32_32x32x16_bf16 a[64:79], v[40:43], v[44:47], a[64:79]
v_mfma_f32_32x32x16_bf16 a[80:95], v[40:43], v[48:51], a[80:95]
s_waitcnt lgkmcnt(0)
s_waitcnt vmcnt(0)
s_barrier
v_mfma_f32_32x32x16_bf16 a[0:15], v[52:55], v[64:67], a[0:15]
ds_read_b64_tr_b16 v[32:33], v15 offset:57344
ds_read_b64_tr_b16 v[34:35], v15 offset:58880
v_mfma_f32_32x32x16_bf16 a[16:31], v[52:55], v[68:71], a[16:31]
ds_read_b64_tr_b16 v[36:37], v15 offset:57408
ds_read_b64_tr_b16 v[38:39], v15 offset:58944
v_mfma_f32_32x32x16_bf16 a[32:47], v[56:59], v[64:67], a[32:47]
ds_read_b64_tr_b16 v[40:41], v15 offset:57472
ds_read_b64_tr_b16 v[42:43], v15 offset:59008
v_mfma_f32_32x32x16_bf16 a[48:63], v[56:59], v[68:71], a[48:63]
ds_read_b128 v[44:47], v19 offset:16384
ds_read_b128 v[48:51], v19 offset:24576
v_mfma_f32_32x32x16_bf16 a[64:79], v[60:63], v[64:67], a[64:79]
v_mfma_f32_32x32x16_bf16 a[80:95], v[60:63], v[68:71], a[80:95]
s_waitcnt lgkmcnt(0)
v_mfma_f32_32x32x16_bf16 a[0:15], v[32:35], v[44:47], a[0:15]
ds_read_b64_tr_b16 v[52:53], v15 offset:60416
ds_read_b64_tr_b16 v[54:55], v15 offset:61952
v_mfma_f32_32x32x16_bf16 a[16:31], v[32:35], v[48:51], a[16:31]
ds_read_b64_tr_b16 v[56:57], v15 offset:60480
ds_read_b64_tr_b16 v[58:59], v15 offset:62016
v_mfma_f32_32x32x16_bf16 a[32:47], v[36:39], v[44:47], a[32:47]
ds_read_b64_tr_b16 v[60:61], v15 offset:60544
ds_read_b64_tr_b16 v[62:63], v15 offset:62080
v_mfma_f32_32x32x16_bf16 a[48:63], v[36:39], v[48:51], a[48:63]
ds_read_b128 v[64:67], v19 offset:17408
ds_read_b128 v[68:71], v19 offset:25600
v_mfma_f32_32x32x16_bf16 a[64:79], v[40:43], v[44:47], a[64:79]
v_mfma_f32_32x32x16_bf16 a[80:95], v[40:43], v[48:51], a[80:95]
s_waitcnt lgkmcnt(0)
v_mfma_f32_32x32x16_bf16 a[0:15], v[52:55], v[64:67], a[0:15]
v_mfma_f32_32x32x16_bf16 a[16:31], v[52:55], v[68:71], a[16:31]
v_mfma_f32_32x32x16_bf16 a[32:47], v[56:59], v[64:67], a[32:47]
v_mfma_f32_32x32x16_bf16 a[48:63], v[56:59], v[68:71], a[48:63]
v_mfma_f32_32x32x16_bf16 a[64:79], v[60:63], v[64:67], a[64:79]
v_mfma_f32_32x32x16_bf16 a[80:95], v[60:63], v[68:71], a[80:95]
s_nop 7
s_nop 7
v_and_b32 v1, 31, v0
v_mul_u32_u24 v1, 400, v1
v_lshrrev_b32 v2, 5, v0
v_lshl_add_u32 v1, v2, 4, v1
s_mul_i32 s5, s3, 25600
v_add_u32 v1, s5, v1
v_lshl_add_u32 v2, s3, 6, v0
v_add_u32 v3, 0, v2
v_mul_u32_u24 v4, 0x5556, v3
v_lshrrev_b32 v4, 18, v4
v_mul_u32_u24 v8, 12, v4
v_sub_u32 v8, v3, v8
v_mul_u32_u24 v12, 400, v4
v_lshl_add_u32 v12, v8, 5, v12
v_add_u32 v3, 256, v2
v_mul_u32_u24 v5, 0x5556, v3
v_lshrrev_b32 v5, 18, v5
v_mul_u32_u24 v9, 12, v5
v_sub_u32 v9, v3, v9
v_mul_u32_u24 v13, 400, v5
v_lshl_add_u32 v13, v9, 5, v13
v_add_u32 v3, 512, v2
v_mul_u32_u24 v6, 0x5556, v3
v_lshrrev_b32 v6, 18, v6
v_mul_u32_u24 v10, 12, v6
v_sub_u32 v10, v3, v10
v_mul_u32_u24 v14, 400, v6
v_lshl_add_u32 v14, v10, 5, v14
v_add_u32 v15, 51200, v12
v_add_u32 v16, 51200, v13
v_add_u32 v17, 51200, v14
s_mul_i32 s5, s36, 73728
s_mul_i32 s6, s37, 192
s_add_u32 s5, s5, s6
s_lshl_b32 s6, s36, 7
v_mul_u32_u24 v20, 1152, v4
v_lshl_add_u32 v20, v8, 4, v20
buffer_load_dwordx4 v[32:35], v20, s[16:19], s5 offen
v_mul_u32_u24 v21, 1152, v5
v_lshl_add_u32 v21, v9, 4, v21
buffer_load_dwordx4 v[36:39], v21, s[16:19], s5 offen
v_mul_u32_u24 v22, 1152, v6
v_lshl_add_u32 v22, v10, 4, v22
buffer_load_dwordx4 v[40:43], v22, s[16:19], s5 offen
s_barrier
ds_write_b128 v1, a[0:3] offset:0
ds_write_b128 v1, a[4:7] offset:32
ds_write_b128 v1, a[8:11] offset:64
ds_write_b128 v1, a[12:15] offset:96
ds_write_b128 v1, a[16:19] offset:12800
ds_write_b128 v1, a[20:23] offset:12832
ds_write_b128 v1, a[24:27] offset:12864
ds_write_b128 v1, a[28:31] offset:12896
ds_write_b128 v1, a[32:35] offset:128
ds_write_b128 v1, a[36:39] offset:160
ds_write_b128 v1, a[40:43] offset:192
ds_write_b128 v1, a[44:47] offset:224
ds_write_b128 v1, a[48:51] offset:12928
ds_write_b128 v1, a[52:55] offset:12960
ds_write_b128 v1, a[56:59] offset:12992
ds_write_b128 v1, a[60:63] offset:13024
ds_write_b128 v1, a[64:67] offset:256
ds_write_b128 v1, a[68:71] offset:288
ds_write_b128 v1, a[72:75] offset:320
ds_write_b128 v1, a[76:79] offset:352
ds_write_b128 v1, a[80:83] offset:13056
ds_write_b128 v1, a[84:87] offset:13088
ds_write_b128 v1, a[88:91] offset:13120
ds_write_b128 v1, a[92:95] offset:13152
s_waitcnt lgkmcnt(0)
s_barrier
ds_read_b128 v[64:67], v12 offset:0
ds_read_b128 v[68:71], v12 offset:16
ds_read_b128 v[72:75], v12 offset:25600
ds_read_b128 v[76:79], v12 offset:25616
ds_read_b128 v[80:83], v15 offset:0
ds_read_b128 v[84:87], v15 offset:16
ds_read_b128 v[88:91], v15 offset:25600
ds_read_b128 v[92:95], v15 offset:25616
ds_read_b128 v[96:99], v13 offset:0
ds_read_b128 v[100:103], v13 offset:16
ds_read_b128 v[104:107], v13 offset:25600
ds_read_b128 v[108:111], v13 offset:25616
ds_read_b128 v[112:115], v16 offset:0
ds_read_b128 v[116:119], v16 offset:16
ds_read_b128 v[120:123], v16 offset:25600
ds_read_b128 v[124:127], v16 offset:25616
ds_read_b128 v[128:131], v14 offset:0
ds_read_b128 v[132:135], v14 offset:16
ds_read_b128 v[136:139], v14 offset:25600
ds_read_b128 v[140:143], v14 offset:25616
ds_read_b128 v[144:147], v17 offset:0
ds_read_b128 v[148:151], v17 offset:16
ds_read_b128 v[152:155], v17 offset:25600
ds_read_b128 v[156:159], v17 offset:25616
s_waitcnt lgkmcnt(15)
v_add_f32 v64, v64, v72
v_add_f32 v80, v80, v88
v_add_f32 v65, v65, v73
v_add_f32 v81, v81, v89
v_add_f32 v66, v66, v74
v_add_f32 v82, v82, v90
v_add_f32 v67, v67, v75
v_add_f32 v83, v83, v91
v_add_f32 v68, v68, v76
v_add_f32 v84, v84, v92
v_add_f32 v69, v69, v77
v_add_f32 v85, v85, v93
v_add_f32 v70, v70, v78
v_add_f32 v86, v86, v94
v_add_f32 v71, v71, v79
v_add_f32 v87, v87, v95
v_add_f32 v64, v64, v80
v_add_f32 v65, v65, v81
v_add_f32 v66, v66, v82
v_add_f32 v67, v67, v83
v_add_f32 v68, v68, v84
v_add_f32 v69, v69, v85
v_add_f32 v70, v70, v86
v_add_f32 v71, v71, v87
s_waitcnt vmcnt(0)
v_cvt_pk_bf16_f32 v72, v64, v65
v_cvt_pk_bf16_f32 v73, v66, v67
v_cvt_pk_bf16_f32 v74, v68, v69
v_cvt_pk_bf16_f32 v75, v70, v71
v_lshlrev_b32 v64, 16, v72
v_and_b32 v65, 0xffff0000, v72
v_lshlrev_b32 v66, 16, v73
v_and_b32 v67, 0xffff0000, v73
v_lshlrev_b32 v68, 16, v74
v_and_b32 v69, 0xffff0000, v74
v_lshlrev_b32 v70, 16, v75
v_and_b32 v71, 0xffff0000, v75
v_lshlrev_b32 v80, 16, v32
v_and_b32 v81, 0xffff0000, v32
v_lshlrev_b32 v82, 16, v33
v_and_b32 v83, 0xffff0000, v33
v_lshlrev_b32 v84, 16, v34
v_and_b32 v85, 0xffff0000, v34
v_lshlrev_b32 v86, 16, v35
v_and_b32 v87, 0xffff0000, v35
v_add_f32 v64, v64, v80
v_add_f32 v65, v65, v81
v_add_f32 v66, v66, v82
v_add_f32 v67, v67, v83
v_add_f32 v68, v68, v84
v_add_f32 v69, v69, v85
v_add_f32 v70, v70, v86
v_add_f32 v71, v71, v87
v_cvt_pk_bf16_f32 v72, v64, v65
v_cvt_pk_bf16_f32 v73, v66, v67
v_cvt_pk_bf16_f32 v74, v68, v69
v_cvt_pk_bf16_f32 v75, v70, v71
buffer_store_dwordx4 v[72:75], v20, s[20:23], s5 offen sc0 sc1
s_waitcnt lgkmcnt(8)
v_add_f32 v96, v96, v104
v_add_f32 v112, v112, v120
v_add_f32 v97, v97, v105
v_add_f32 v113, v113, v121
v_add_f32 v98, v98, v106
v_add_f32 v114, v114, v122
v_add_f32 v99, v99, v107
v_add_f32 v115, v115, v123
v_add_f32 v100, v100, v108
v_add_f32 v116, v116, v124
v_add_f32 v101, v101, v109
v_add_f32 v117, v117, v125
v_add_f32 v102, v102, v110
v_add_f32 v118, v118, v126
v_add_f32 v103, v103, v111
v_add_f32 v119, v119, v127
v_add_f32 v96, v96, v112
v_add_f32 v97, v97, v113
v_add_f32 v98, v98, v114
v_add_f32 v99, v99, v115
v_add_f32 v100, v100, v116
v_add_f32 v101, v101, v117
v_add_f32 v102, v102, v118
v_add_f32 v103, v103, v119
v_cvt_pk_bf16_f32 v104, v96, v97
v_cvt_pk_bf16_f32 v105, v98, v99
v_cvt_pk_bf16_f32 v106, v100, v101
v_cvt_pk_bf16_f32 v107, v102, v103
v_lshlrev_b32 v96, 16, v104
v_and_b32 v97, 0xffff0000, v104
v_lshlrev_b32 v98, 16, v105
v_and_b32 v99, 0xffff0000, v105
v_lshlrev_b32 v100, 16, v106
v_and_b32 v101, 0xffff0000, v106
v_lshlrev_b32 v102, 16, v107
v_and_b32 v103, 0xffff0000, v107
v_lshlrev_b32 v112, 16, v36
v_and_b32 v113, 0xffff0000, v36
v_lshlrev_b32 v114, 16, v37
v_and_b32 v115, 0xffff0000, v37
v_lshlrev_b32 v116, 16, v38
v_and_b32 v117, 0xffff0000, v38
v_lshlrev_b32 v118, 16, v39
v_and_b32 v119, 0xffff0000, v39
v_add_f32 v96, v96, v112
v_add_f32 v97, v97, v113
v_add_f32 v98, v98, v114
v_add_f32 v99, v99, v115
v_add_f32 v100, v100, v116
v_add_f32 v101, v101, v117
v_add_f32 v102, v102, v118
v_add_f32 v103, v103, v119
v_cvt_pk_bf16_f32 v104, v96, v97
v_cvt_pk_bf16_f32 v105, v98, v99
v_cvt_pk_bf16_f32 v106, v100, v101
v_cvt_pk_bf16_f32 v107, v102, v103
buffer_store_dwordx4 v[104:107], v21, s[20:23], s5 offen sc0 sc1
s_waitcnt lgkmcnt(0)
v_add_f32 v128, v128, v136
v_add_f32 v144, v144, v152
v_add_f32 v129, v129, v137
v_add_f32 v145, v145, v153
v_add_f32 v130, v130, v138
v_add_f32 v146, v146, v154
v_add_f32 v131, v131, v139
v_add_f32 v147, v147, v155
v_add_f32 v132, v132, v140
v_add_f32 v148, v148, v156
v_add_f32 v133, v133, v141
v_add_f32 v149, v149, v157
v_add_f32 v134, v134, v142
v_add_f32 v150, v150, v158
v_add_f32 v135, v135, v143
v_add_f32 v151, v151, v159
v_add_f32 v128, v128, v144
v_add_f32 v129, v129, v145
v_add_f32 v130, v130, v146
v_add_f32 v131, v131, v147
v_add_f32 v132, v132, v148
v_add_f32 v133, v133, v149
v_add_f32 v134, v134, v150
v_add_f32 v135, v135, v151
v_cvt_pk_bf16_f32 v136, v128, v129
v_cvt_pk_bf16_f32 v137, v130, v131
v_cvt_pk_bf16_f32 v138, v132, v133
v_cvt_pk_bf16_f32 v139, v134, v135
v_lshlrev_b32 v128, 16, v136
v_and_b32 v129, 0xffff0000, v136
v_lshlrev_b32 v130, 16, v137
v_and_b32 v131, 0xffff0000, v137
v_lshlrev_b32 v132, 16, v138
v_and_b32 v133, 0xffff0000, v138
v_lshlrev_b32 v134, 16, v139
v_and_b32 v135, 0xffff0000, v139
v_lshlrev_b32 v144, 16, v40
v_and_b32 v145, 0xffff0000, v40
v_lshlrev_b32 v146, 16, v41
v_and_b32 v147, 0xffff0000, v41
v_lshlrev_b32 v148, 16, v42
v_and_b32 v149, 0xffff0000, v42
v_lshlrev_b32 v150, 16, v43
v_and_b32 v151, 0xffff0000, v43
v_add_f32 v128, v128, v144
v_add_f32 v129, v129, v145
v_add_f32 v130, v130, v146
v_add_f32 v131, v131, v147
v_add_f32 v132, v132, v148
v_add_f32 v133, v133, v149
v_add_f32 v134, v134, v150
v_add_f32 v135, v135, v151
v_cvt_pk_bf16_f32 v136, v128, v129
v_cvt_pk_bf16_f32 v137, v130, v131
v_cvt_pk_bf16_f32 v138, v132, v133
v_cvt_pk_bf16_f32 v139, v134, v135
buffer_store_dwordx4 v[136:139], v22, s[20:23], s5 offen sc0 sc1
s_endpgm
.section .rodata,"a"
.p2align 6
.amdhsa_kernel op_kernel
  .amdhsa_next_free_vgpr 352
  .amdhsa_next_free_sgpr 96
  .amdhsa_accum_offset 256
  .amdhsa_group_segment_fixed_size 0
  .amdhsa_kernarg_size 112
  .amdhsa_user_sgpr_count 2
  .amdhsa_user_sgpr_kernarg_segment_ptr 1
  .amdhsa_system_sgpr_workgroup_id_x 1
.end_amdhsa_kernel
.text
.globl ln_kernel
.p2align 8
.type ln_kernel,@function
ln_kernel:
s_cmp_ge_u32 s2, 256
s_cbranch_scc0 ln_kernel_go
s_endpgm
ln_kernel_go:
v_lshrrev_b32 v1, 6, v0
v_and_b32 v0, 63, v0
s_nop 0
v_readfirstlane_b32 s3, v1
s_load_dwordx2 s[8:9], s[0:1], 104
s_load_dwordx2 s[12:13], s[0:1], 104
s_lshl_b32 s47, s2, 3
s_lshl_b32 s5, s3, 2
s_add_u32 s47, s47, s5
s_waitcnt lgkmcnt(0)
s_add_u32 s8, s8, 0x3400000
s_addc_u32 s9, s9, 0
s_mov_b32 s10, 0x240000
s_mov_b32 s11, 0x00020000
s_add_u32 s12, s12, 0x3800000
s_addc_u32 s13, s13, 0
s_mov_b32 s14, 0x240000
s_mov_b32 s15, 0x00020000
v_lshrrev_b32 v4, 4, v0
v_add_u32 v4, s47, v4
v_mul_u32_u24 v4, 1152, v4
v_and_b32 v60, 15, v0
v_lshl_add_u32 v4, v60, 3, v4
buffer_load_dwordx2 v[6:7], v4, s[8:11], 0 offen offset:0
buffer_load_dwordx2 v[8:9], v4, s[8:11], 0 offen offset:128
buffer_load_dwordx2 v[10:11], v4, s[8:11], 0 offen offset:256
buffer_load_dwordx2 v[12:13], v4, s[8:11], 0 offen offset:384
buffer_load_dwordx2 v[14:15], v4, s[8:11], 0 offen offset:512
buffer_load_dwordx2 v[16:17], v4, s[8:11], 0 offen offset:640
buffer_load_dwordx2 v[18:19], v4, s[8:11], 0 offen offset:768
buffer_load_dwordx2 v[20:21], v4, s[8:11], 0 offen offset:896
buffer_load_dwordx2 v[22:23], v4, s[8:11], 0 offen offset:1024
s_waitcnt vmcnt(0)
v_lshlrev_b32 v24, 16, v6
v_and_b32 v25, 0xffff0000, v6
v_lshlrev_b32 v26, 16, v7
v_and_b32 v27, 0xffff0000, v7
v_lshlrev_b32 v28, 16, v8
v_and_b32 v29, 0xffff0000, v8
v_lshlrev_b32 v30, 16, v9
v_and_b32 v31, 0xffff0000, v9
v_lshlrev_b32 v32, 16, v10
v_and_b32 v33, 0xffff0000, v10
v_lshlrev_b32 v34, 16, v11
v_and_b32 v35, 0xffff0000, v11
v_lshlrev_b32 v36, 16, v12
v_and_b32 v37, 0xffff0000, v12
v_lshlrev_b32 v38, 16, v13
v_and_b32 v39, 0xffff0000, v13
v_lshlrev_b32 v40, 16, v14
v_and_b32 v41, 0xffff0000, v14
v_lshlrev_b32 v42, 16, v15
v_and_b32 v43, 0xffff0000, v15
v_lshlrev_b32 v44, 16, v16
v_and_b32 v45, 0xffff0000, v16
v_lshlrev_b32 v46, 16, v17
v_and_b32 v47, 0xffff0000, v17
v_lshlrev_b32 v48, 16, v18
v_and_b32 v49, 0xffff0000, v18
v_lshlrev_b32 v50, 16, v19
v_and_b32 v51, 0xffff0000, v19
v_lshlrev_b32 v52, 16, v20
v_and_b32 v53, 0xffff0000, v20
v_lshlrev_b32 v54, 16, v21
v_and_b32 v55, 0xffff0000, v21
v_lshlrev_b32 v56, 16, v22
v_and_b32 v57, 0xffff0000, v22
v_lshlrev_b32 v58, 16, v23
v_and_b32 v59, 0xffff0000, v23
v_add_f32 v60, v24, v25
v_add_f32 v60, v60, v26
v_add_f32 v60, v60, v27
v_add_f32 v60, v60, v28
v_add_f32 v60, v60, v29
v_add_f32 v60, v60, v30
v_add_f32 v60, v60, v31
v_add_f32 v60, v60, v32
v_add_f32 v60, v60, v33
v_add_f32 v60, v60, v34
v_add_f32 v60, v60, v35
v_add_f32 v60, v60, v36
v_add_f32 v60, v60, v37
v_add_f32 v60, v60, v38
v_add_f32 v60, v60, v39
v_add_f32 v60, v60, v40
v_add_f32 v60, v60, v41
v_add_f32 v60, v60, v42
v_add_f32 v60, v60, v43
v_add_f32 v60, v60, v44
v_add_f32 v60, v60, v45
v_add_f32 v60, v60, v46
v_add_f32 v60, v60, v47
v_add_f32 v60, v60, v48
v_add_f32 v60, v60, v49
v_add_f32 v60, v60, v50
v_add_f32 v60, v60, v51
v_add_f32 v60, v60, v52
v_add_f32 v60, v60, v53
v_add_f32 v60, v60, v54
v_add_f32 v60, v60, v55
v_add_f32 v60, v60, v56
v_add_f32 v60, v60, v57
v_add_f32 v60, v60, v58
v_add_f32 v60, v60, v59
s_nop 1
v_add_f32_dpp v60, v60, v60 row_ror:8 row_mask:0xf bank_mask:0xf
s_nop 1
v_add_f32_dpp v60, v60, v60 row_ror:4 row_mask:0xf bank_mask:0xf
s_nop 1
v_add_f32_dpp v60, v60, v60 row_ror:2 row_mask:0xf bank_mask:0xf
s_nop 1
v_add_f32_dpp v60, v60, v60 row_ror:1 row_mask:0xf bank_mask:0xf
v_mul_f32 v60, 0x3ae38e39, v60
v_sub_f32 v24, v24, v60
v_sub_f32 v25, v25, v60
v_sub_f32 v26, v26, v60
v_sub_f32 v27, v27, v60
v_sub_f32 v28, v28, v60
v_sub_f32 v29, v29, v60
v_sub_f32 v30, v30, v60
v_sub_f32 v31, v31, v60
v_sub_f32 v32, v32, v60
v_sub_f32 v33, v33, v60
v_sub_f32 v34, v34, v60
v_sub_f32 v35, v35, v60
v_sub_f32 v36, v36, v60
v_sub_f32 v37, v37, v60
v_sub_f32 v38, v38, v60
v_sub_f32 v39, v39, v60
v_sub_f32 v40, v40, v60
v_sub_f32 v41, v41, v60
v_sub_f32 v42, v42, v60
v_sub_f32 v43, v43, v60
v_sub_f32 v44, v44, v60
v_sub_f32 v45, v45, v60
v_sub_f32 v46, v46, v60
v_sub_f32 v47, v47, v60
v_sub_f32 v48, v48, v60
v_sub_f32 v49, v49, v60
v_sub_f32 v50, v50, v60
v_sub_f32 v51, v51, v60
v_sub_f32 v52, v52, v60
v_sub_f32 v53, v53, v60
v_sub_f32 v54, v54, v60
v_sub_f32 v55, v55, v60
v_sub_f32 v56, v56, v60
v_sub_f32 v57, v57, v60
v_sub_f32 v58, v58, v60
v_sub_f32 v59, v59, v60
v_mul_f32 v60, v24, v24
v_fmac_f32 v60, v25, v25
v_fmac_f32 v60, v26, v26
v_fmac_f32 v60, v27, v27
v_fmac_f32 v60, v28, v28
v_fmac_f32 v60, v29, v29
v_fmac_f32 v60, v30, v30
v_fmac_f32 v60, v31, v31
v_fmac_f32 v60, v32, v32
v_fmac_f32 v60, v33, v33
v_fmac_f32 v60, v34, v34
v_fmac_f32 v60, v35, v35
v_fmac_f32 v60, v36, v36
v_fmac_f32 v60, v37, v37
v_fmac_f32 v60, v38, v38
v_fmac_f32 v60, v39, v39
v_fmac_f32 v60, v40, v40
v_fmac_f32 v60, v41, v41
v_fmac_f32 v60, v42, v42
v_fmac_f32 v60, v43, v43
v_fmac_f32 v60, v44, v44
v_fmac_f32 v60, v45, v45
v_fmac_f32 v60, v46, v46
v_fmac_f32 v60, v47, v47
v_fmac_f32 v60, v48, v48
v_fmac_f32 v60, v49, v49
v_fmac_f32 v60, v50, v50
v_fmac_f32 v60, v51, v51
v_fmac_f32 v60, v52, v52
v_fmac_f32 v60, v53, v53
v_fmac_f32 v60, v54, v54
v_fmac_f32 v60, v55, v55
v_fmac_f32 v60, v56, v56
v_fmac_f32 v60, v57, v57
v_fmac_f32 v60, v58, v58
v_fmac_f32 v60, v59, v59
s_nop 1
v_add_f32_dpp v60, v60, v60 row_ror:8 row_mask:0xf bank_mask:0xf
s_nop 1
v_add_f32_dpp v60, v60, v60 row_ror:4 row_mask:0xf bank_mask:0xf
s_nop 1
v_add_f32_dpp v60, v60, v60 row_ror:2 row_mask:0xf bank_mask:0xf
s_nop 1
v_add_f32_dpp v60, v60, v60 row_ror:1 row_mask:0xf bank_mask:0xf
v_mov_b32 v61, 0x3727c5ac
v_fmac_f32 v61, 0x3ae38e39, v60
v_rsq_f32 v60, v61
s_nop 0
v_mul_f32 v24, v24, v60
v_mul_f32 v25, v25, v60
v_mul_f32 v26, v26, v60
v_mul_f32 v27, v27, v60
v_mul_f32 v28, v28, v60
v_mul_f32 v29, v29, v60
v_mul_f32 v30, v30, v60
v_mul_f32 v31, v31, v60
v_mul_f32 v32, v32, v60
v_mul_f32 v33, v33, v60
v_mul_f32 v34, v34, v60
v_mul_f32 v35, v35, v60
v_mul_f32 v36, v36, v60
v_mul_f32 v37, v37, v60
v_mul_f32 v38, v38, v60
v_mul_f32 v39, v39, v60
v_mul_f32 v40, v40, v60
v_mul_f32 v41, v41, v60
v_mul_f32 v42, v42, v60
v_mul_f32 v43, v43, v60
v_mul_f32 v44, v44, v60
v_mul_f32 v45, v45, v60
v_mul_f32 v46, v46, v60
v_mul_f32 v47, v47, v60
v_mul_f32 v48, v48, v60
v_mul_f32 v49, v49, v60
v_mul_f32 v50, v50, v60
v_mul_f32 v51, v51, v60
v_mul_f32 v52, v52, v60
v_mul_f32 v53, v53, v60
v_mul_f32 v54, v54, v60
v_mul_f32 v55, v55, v60
v_mul_f32 v56, v56, v60
v_mul_f32 v57, v57, v60
v_mul_f32 v58, v58, v60
v_mul_f32 v59, v59, v60
v_cvt_pk_bf16_f32 v6, v24, v25
v_cvt_pk_bf16_f32 v7, v26, v27
v_cvt_pk_bf16_f32 v8, v28, v29
v_cvt_pk_bf16_f32 v9, v30, v31
v_cvt_pk_bf16_f32 v10, v32, v33
v_cvt_pk_bf16_f32 v11, v34, v35
v_cvt_pk_bf16_f32 v12, v36, v37
v_cvt_pk_bf16_f32 v13, v38, v39
v_cvt_pk_bf16_f32 v14, v40, v41
v_cvt_pk_bf16_f32 v15, v42, v43
v_cvt_pk_bf16_f32 v16, v44, v45
v_cvt_pk_bf16_f32 v17, v46, v47
v_cvt_pk_bf16_f32 v18, v48, v49
v_cvt_pk_bf16_f32 v19, v50, v51
v_cvt_pk_bf16_f32 v20, v52, v53
v_cvt_pk_bf16_f32 v21, v54, v55
v_cvt_pk_bf16_f32 v22, v56, v57
v_cvt_pk_bf16_f32 v23, v58, v59
v_lshlrev_b32 v24, 16, v6
v_and_b32 v25, 0xffff0000, v6
v_lshlrev_b32 v26, 16, v7
v_and_b32 v27, 0xffff0000, v7
v_lshlrev_b32 v28, 16, v8
v_and_b32 v29, 0xffff0000, v8
v_lshlrev_b32 v30, 16, v9
v_and_b32 v31, 0xffff0000, v9
v_lshlrev_b32 v32, 16, v10
v_and_b32 v33, 0xffff0000, v10
v_lshlrev_b32 v34, 16, v11
v_and_b32 v35, 0xffff0000, v11
v_lshlrev_b32 v36, 16, v12
v_and_b32 v37, 0xffff0000, v12
v_lshlrev_b32 v38, 16, v13
v_and_b32 v39, 0xffff0000, v13
v_lshlrev_b32 v40, 16, v14
v_and_b32 v41, 0xffff0000, v14
v_lshlrev_b32 v42, 16, v15
v_and_b32 v43, 0xffff0000, v15
v_lshlrev_b32 v44, 16, v16
v_and_b32 v45, 0xffff0000, v16
v_lshlrev_b32 v46, 16, v17
v_and_b32 v47, 0xffff0000, v17
v_lshlrev_b32 v48, 16, v18
v_and_b32 v49, 0xffff0000, v18
v_lshlrev_b32 v50, 16, v19
v_and_b32 v51, 0xffff0000, v19
v_lshlrev_b32 v52, 16, v20
v_and_b32 v53, 0xffff0000, v20
v_lshlrev_b32 v54, 16, v21
v_and_b32 v55, 0xffff0000, v21
v_lshlrev_b32 v56, 16, v22
v_and_b32 v57, 0xffff0000, v22
v_lshlrev_b32 v58, 16, v23
v_and_b32 v59, 0xffff0000, v23
v_add_f32 v60, v24, v25
v_add_f32 v60, v60, v26
v_add_f32 v60, v60, v27
v_add_f32 v60, v60, v28
v_add_f32 v60, v60, v29
v_add_f32 v60, v60, v30
v_add_f32 v60, v60, v31
v_add_f32 v60, v60, v32
v_add_f32 v60, v60, v33
v_add_f32 v60, v60, v34
v_add_f32 v60, v60, v35
v_add_f32 v60, v60, v36
v_add_f32 v60, v60, v37
v_add_f32 v60, v60, v38
v_add_f32 v60, v60, v39
v_add_f32 v60, v60, v40
v_add_f32 v60, v60, v41
v_add_f32 v60, v60, v42
v_add_f32 v60, v60, v43
v_add_f32 v60, v60, v44
v_add_f32 v60, v60, v45
v_add_f32 v60, v60, v46
v_add_f32 v60, v60, v47
v_add_f32 v60, v60, v48
v_add_f32 v60, v60, v49
v_add_f32 v60, v60, v50
v_add_f32 v60, v60, v51
v_add_f32 v60, v60, v52
v_add_f32 v60, v60, v53
v_add_f32 v60, v60, v54
v_add_f32 v60, v60, v55
v_add_f32 v60, v60, v56
v_add_f32 v60, v60, v57
v_add_f32 v60, v60, v58
v_add_f32 v60, v60, v59
s_nop 1
v_add_f32_dpp v60, v60, v60 row_ror:8 row_mask:0xf bank_mask:0xf
s_nop 1
v_add_f32_dpp v60, v60, v60 row_ror:4 row_mask:0xf bank_mask:0xf
s_nop 1
v_add_f32_dpp v60, v60, v60 row_ror:2 row_mask:0xf bank_mask:0xf
s_nop 1
v_add_f32_dpp v60, v60, v60 row_ror:1 row_mask:0xf bank_mask:0xf
v_mul_f32 v60, 0x3ae38e39, v60
v_sub_f32 v24, v24, v60
v_sub_f32 v25, v25, v60
v_sub_f32 v26, v26, v60
v_sub_f32 v27, v27, v60
v_sub_f32 v28, v28, v60
v_sub_f32 v29, v29, v60
v_sub_f32 v30, v30, v60
v_sub_f32 v31, v31, v60
v_sub_f32 v32, v32, v60
v_sub_f32 v33, v33, v60
v_sub_f32 v34, v34, v60
v_sub_f32 v35, v35, v60
v_sub_f32 v36, v36, v60
v_sub_f32 v37, v37, v60
v_sub_f32 v38, v38, v60
v_sub_f32 v39, v39, v60
v_sub_f32 v40, v40, v60
v_sub_f32 v41, v41, v60
v_sub_f32 v42, v42, v60
v_sub_f32 v43, v43, v60
v_sub_f32 v44, v44, v60
v_sub_f32 v45, v45, v60
v_sub_f32 v46, v46, v60
v_sub_f32 v47, v47, v60
v_sub_f32 v48, v48, v60
v_sub_f32 v49, v49, v60
v_sub_f32 v50, v50, v60
v_sub_f32 v51, v51, v60
v_sub_f32 v52, v52, v60
v_sub_f32 v53, v53, v60
v_sub_f32 v54, v54, v60
v_sub_f32 v55, v55, v60
v_sub_f32 v56, v56, v60
v_sub_f32 v57, v57, v60
v_sub_f32 v58, v58, v60
v_sub_f32 v59, v59, v60
v_mul_f32 v60, v24, v24
v_fmac_f32 v60, v25, v25
v_fmac_f32 v60, v26, v26
v_fmac_f32 v60, v27, v27
v_fmac_f32 v60, v28, v28
v_fmac_f32 v60, v29, v29
v_fmac_f32 v60, v30, v30
v_fmac_f32 v60, v31, v31
v_fmac_f32 v60, v32, v32
v_fmac_f32 v60, v33, v33
v_fmac_f32 v60, v34, v34
v_fmac_f32 v60, v35, v35
v_fmac_f32 v60, v36, v36
v_fmac_f32 v60, v37, v37
v_fmac_f32 v60, v38, v38
v_fmac_f32 v60, v39, v39
v_fmac_f32 v60, v40, v40
v_fmac_f32 v60, v41, v41
v_fmac_f32 v60, v42, v42
v_fmac_f32 v60, v43, v43
v_fmac_f32 v60, v44, v44
v_fmac_f32 v60, v45, v45
v_fmac_f32 v60, v46, v46
v_fmac_f32 v60, v47, v47
v_fmac_f32 v60, v48, v48
v_fmac_f32 v60, v49, v49
v_fmac_f32 v60, v50, v50
v_fmac_f32 v60, v51, v51
v_fmac_f32 v60, v52, v52
v_fmac_f32 v60, v53, v53
v_fmac_f32 v60, v54, v54
v_fmac_f32 v60, v55, v55
v_fmac_f32 v60, v56, v56
v_fmac_f32 v60, v57, v57
v_fmac_f32 v60, v58, v58
v_fmac_f32 v60, v59, v59
s_nop 1
v_add_f32_dpp v60, v60, v60 row_ror:8 row_mask:0xf bank_mask:0xf
s_nop 1
v_add_f32_dpp v60, v60, v60 row_ror:4 row_mask:0xf bank_mask:0xf
s_nop 1
v_add_f32_dpp v60, v60, v60 row_ror:2 row_mask:0xf bank_mask:0xf
s_nop 1
v_add_f32_dpp v60, v60, v60 row_ror:1 row_mask:0xf bank_mask:0xf
v_mov_b32 v61, 0x3727c5ac
v_fmac_f32 v61, 0x3ae38e39, v60
v_rsq_f32 v60, v61
s_nop 0
v_mul_f32 v24, v24, v60
v_mul_f32 v25, v25, v60
v_mul_f32 v26, v26, v60
v_mul_f32 v27, v27, v60
v_mul_f32 v28, v28, v60
v_mul_f32 v29, v29, v60
v_mul_f32 v30, v30, v60
v_mul_f32 v31, v31, v60
v_mul_f32 v32, v32, v60
v_mul_f32 v33, v33, v60
v_mul_f32 v34, v34, v60
v_mul_f32 v35, v35, v60
v_mul_f32 v36, v36, v60
v_mul_f32 v37, v37, v60
v_mul_f32 v38, v38, v60
v_mul_f32 v39, v39, v60
v_mul_f32 v40, v40, v60
v_mul_f32 v41, v41, v60
v_mul_f32 v42, v42, v60
v_mul_f32 v43, v43, v60
v_mul_f32 v44, v44, v60
v_mul_f32 v45, v45, v60
v_mul_f32 v46, v46, v60
v_mul_f32 v47, v47, v60
v_mul_f32 v48, v48, v60
v_mul_f32 v49, v49, v60
v_mul_f32 v50, v50, v60
v_mul_f32 v51, v51, v60
v_mul_f32 v52, v52, v60
v_mul_f32 v53, v53, v60
v_mul_f32 v54, v54, v60
v_mul_f32 v55, v55, v60
v_mul_f32 v56, v56, v60
v_mul_f32 v57, v57, v60
v_mul_f32 v58, v58, v60
v_mul_f32 v59, v59, v60
v_cvt_pk_bf16_f32 v6, v24, v25
v_cvt_pk_bf16_f32 v7, v26, v27
v_cvt_pk_bf16_f32 v8, v28, v29
v_cvt_pk_bf16_f32 v9, v30, v31
v_cvt_pk_bf16_f32 v10, v32, v33
v_cvt_pk_bf16_f32 v11, v34, v35
v_cvt_pk_bf16_f32 v12, v36, v37
v_cvt_pk_bf16_f32 v13, v38, v39
v_cvt_pk_bf16_f32 v14, v40, v41
v_cvt_pk_bf16_f32 v15, v42, v43
v_cvt_pk_bf16_f32 v16, v44, v45
v_cvt_pk_bf16_f32 v17, v46, v47
v_cvt_pk_bf16_f32 v18, v48, v49
v_cvt_pk_bf16_f32 v19, v50, v51
v_cvt_pk_bf16_f32 v20, v52, v53
v_cvt_pk_bf16_f32 v21, v54, v55
v_cvt_pk_bf16_f32 v22, v56, v57
v_cvt_pk_bf16_f32 v23, v58, v59
v_lshrrev_b32 v4, 4, v0
v_add_u32 v4, s47, v4
v_mul_u32_u24 v4, 192, v4
v_and_b32 v60, 15, v0
v_lshl_add_u32 v4, v60, 3, v4
v_add_u32 v24, 0, v60
v_mul_u32_u24 v24, 0xaab, v24
v_lshrrev_b32 v24, 16, v24
v_mul_u32_u24 v24, 393024, v24
v_add_u32 v24, v24, v4
buffer_store_dwordx2 v[6:7], v24, s[12:15], 0 offen offset:0
v_add_u32 v25, 16, v60
v_mul_u32_u24 v25, 0xaab, v25
v_lshrrev_b32 v25, 16, v25
v_mul_u32_u24 v25, 393024, v25
v_add_u32 v25, v25, v4
buffer_store_dwordx2 v[8:9], v25, s[12:15], 0 offen offset:128
v_add_u32 v26, 32, v60
v_mul_u32_u24 v26, 0xaab, v26
v_lshrrev_b32 v26, 16, v26
v_mul_u32_u24 v26, 393024, v26
v_add_u32 v26, v26, v4
buffer_store_dwordx2 v[10:11], v26, s[12:15], 0 offen offset:256
v_add_u32 v27, 48, v60
v_mul_u32_u24 v27, 0xaab, v27
v_lshrrev_b32 v27, 16, v27
v_mul_u32_u24 v27, 393024, v27
v_add_u32 v27, v27, v4
buffer_store_dwordx2 v[12:13], v27, s[12:15], 0 offen offset:384
v_add_u32 v28, 64, v60
v_mul_u32_u24 v28, 0xaab, v28
v_lshrrev_b32 v28, 16, v28
v_mul_u32_u24 v28, 393024, v28
v_add_u32 v28, v28, v4
buffer_store_dwordx2 v[14:15], v28, s[12:15], 0 offen offset:512
v_add_u32 v29, 80, v60
v_mul_u32_u24 v29, 0xaab, v29
v_lshrrev_b32 v29, 16, v29
v_mul_u32_u24 v29, 393024, v29
v_add_u32 v29, v29, v4
buffer_store_dwordx2 v[16:17], v29, s[12:15], 0 offen offset:640
v_add_u32 v30, 96, v60
v_mul_u32_u24 v30, 0xaab, v30
v_lshrrev_b32 v30, 16, v30
v_mul_u32_u24 v30, 393024, v30
v_add_u32 v30, v30, v4
buffer_store_dwordx2 v[18:19], v30, s[12:15], 0 offen offset:768
v_add_u32 v31, 112, v60
v_mul_u32_u24 v31, 0xaab, v31
v_lshrrev_b32 v31, 16, v31
v_mul_u32_u24 v31, 393024, v31
v_add_u32 v31, v31, v4
buffer_store_dwordx2 v[20:21], v31, s[12:15], 0 offen offset:896
v_add_u32 v32, 128, v60
v_mul_u32_u24 v32, 0xaab, v32
v_lshrrev_b32 v32, 16, v32
v_mul_u32_u24 v32, 393024, v32
v_add_u32 v32, v32, v4
buffer_store_dwordx2 v[22:23], v32, s[12:15], 0 offen offset:1024
s_endpgm
.section .rodata,"a"
.p2align 6
.amdhsa_kernel ln_kernel
  .amdhsa_next_free_vgpr 64
  .amdhsa_next_free_sgpr 96
  .amdhsa_accum_offset 64
  .amdhsa_group_segment_fixed_size 0
  .amdhsa_kernarg_size 112
  .amdhsa_user_sgpr_count 2
  .amdhsa_user_sgpr_kernarg_segment_ptr 1
  .amdhsa_system_sgpr_workgroup_id_x 1
.end_amdhsa_kernel
.text
.globl w1_kernel
.p2align 8
.type w1_kernel,@function
w1_kernel:
s_cmp_ge_u32 s2, 216
s_cbranch_scc0 w1_kernel_go
s_endpgm
w1_kernel_go:
v_lshrrev_b32 v1, 6, v0
v_and_b32 v0, 63, v0
s_nop 0
v_readfirstlane_b32 s3, v1
s_load_dwordx2 s[8:9], s[0:1], 56
s_load_dwordx2 s[12:13], s[0:1], 104
s_load_dwordx2 s[16:17], s[0:1], 64
s_load_dwordx2 s[20:21], s[0:1], 104
s_and_b32 s5, s2, 7
s_mul_i32 s5, s5, 27
s_lshr_b32 s6, s2, 3
s_add_u32 s5, s5, s6
s_mul_i32 s36, s5, 0xaaab
s_lshr_b32 s36, s36, 18
s_mul_i32 s6, s36, 6
s_sub_u32 s37, s5, s6
s_lshl_b32 s43, s36, 8
s_mul_i32 s44, s37, 393216
s_mul_i32 s5, s3, 147456
s_add_u32 s43, s43, s5
s_mul_i32 s5, s3, 3072
s_add_u32 s44, s44, s5
s_mul_i32 s42, s3, 35840
v_add_u32 v1, 0, v0
v_lshrrev_b32 v2, 4, v1
v_and_b32 v1, 15, v1
v_and_b32 v3, 3, v2
v_lshlrev_b32 v3, 2, v3
v_xor_b32 v1, v1, v3
v_mul_u32_u24 v2, 9216, v2
v_lshl_add_u32 v4, v1, 4, v2
v_add_u32 v1, 64, v0
v_lshrrev_b32 v2, 4, v1
v_and_b32 v1, 15, v1
v_and_b32 v3, 3, v2
v_lshlrev_b32 v3, 2, v3
v_xor_b32 v1, v1, v3
v_mul_u32_u24 v2, 9216, v2
v_lshl_add_u32 v5, v1, 4, v2
v_subrev_u32 v5, 1024, v5
v_add_u32 v1, 128, v0
v_lshrrev_b32 v2, 4, v1
v_and_b32 v1, 15, v1
v_and_b32 v3, 3, v2
v_lshlrev_b32 v3, 2, v3
v_xor_b32 v1, v1, v3
v_mul_u32_u24 v2, 9216, v2
v_lshl_add_u32 v6, v1, 4, v2
v_subrev_u32 v6, 2048, v6
v_add_u32 v1, 192, v0
v_lshrrev_b32 v2, 4, v1
v_and_b32 v1, 15, v1
v_and_b32 v3, 3, v2
v_lshlrev_b32 v3, 2, v3
v_xor_b32 v1, v1, v3
v_mul_u32_u24 v2, 9216, v2
v_lshl_add_u32 v7, v1, 4, v2
v_subrev_u32 v7, 3072, v7
v_add_u32 v1, 0, v0
v_mul_u32_u24 v2, 0x5556, v1
v_lshrrev_b32 v2, 18, v2
v_mul_u32_u24 v3, 12, v2
v_sub_u32 v1, v1, v3
v_mul_u32_u24 v2, 192, v2
v_lshl_add_u32 v8, v1, 4, v2
v_add_u32 v1, 64, v0
v_mul_u32_u24 v2, 0x5556, v1
v_lshrrev_b32 v2, 18, v2
v_mul_u32_u24 v3, 12, v2
v_sub_u32 v1, v1, v3
v_mul_u32_u24 v2, 192, v2
v_lshl_add_u32 v9, v1, 4, v2
v_subrev_u32 v9, 1024, v9
v_add_u32 v1, 128, v0
v_mul_u32_u24 v2, 0x5556, v1
v_lshrrev_b32 v2, 18, v2
v_mul_u32_u24 v3, 12, v2
v_sub_u32 v1, v1, v3
v_mul_u32_u24 v2, 192, v2
v_lshl_add_u32 v10, v1, 4, v2
v_subrev_u32 v10, 2048, v10
s_waitcnt lgkmcnt(0)
s_mov_b32 s10, 0x1200000
s_mov_b32 s11, 0x00020000
s_add_u32 s12, s12, 0x3800000
s_addc_u32 s13, s13, 0
s_mov_b32 s14, 0x240000
s_mov_b32 s15, 0x00020000
s_mov_b32 s18, 0x2400
s_mov_b32 s19, 0x00020000
s_add_u32 s20, s20, 0x3c00000
s_addc_u32 s21, s21, 0
s_mov_b32 s22, 0x510000
s_mov_b32 s23, 0x00020000
s_add_u32 m0, s42, 0
s_nop 0
buffer_load_dwordx4 v4, s[8:11], s43 offen offset:0 lds
buffer_load_dwordx4 v5, s[8:11], s43 offen offset:1024 lds
buffer_load_dwordx4 v6, s[8:11], s43 offen offset:2048 lds
buffer_load_dwordx4 v7, s[8:11], s43 offen offset:3072 lds
s_add_u32 m0, s42, 4096
s_nop 0
buffer_load_dwordx4 v8, s[12:15], s44 offen offset:0 lds
buffer_load_dwordx4 v9, s[12:15], s44 offen offset:1024 lds
buffer_load_dwordx4 v10, s[12:15], s44 offen offset:2048 lds
s_add_u32 s43, s43, 589824
s_add_u32 s44, s44, 12288
s_add_u32 m0, s42, 7168
s_nop 0
buffer_load_dwordx4 v4, s[8:11], s43 offen offset:0 lds
buffer_load_dwordx4 v5, s[8:11], s43 offen offset:1024 lds
buffer_load_dwordx4 v6, s[8:11], s43 offen offset:2048 lds
buffer_load_dwordx4 v7, s[8:11], s43 offen offset:3072 lds
s_add_u32 m0, s42, 11264
s_nop 0
buffer_load_dwordx4 v8, s[12:15], s44 offen offset:0 lds
buffer_load_dwordx4 v9, s[12:15], s44 offen offset:1024 lds
buffer_load_dwordx4 v10, s[12:15], s44 offen offset:2048 lds
s_add_u32 s43, s43, 589824
s_add_u32 s44, s44, 12288
s_add_u32 m0, s42, 14336
s_nop 0
buffer_load_dwordx4 v4, s[8:11], s43 offen offset:0 lds
buffer_load_dwordx4 v5, s[8:11], s43 offen offset:1024 lds
buffer_load_dwordx4 v6, s[8:11], s43 offen offset:2048 lds
buffer_load_dwordx4 v7, s[8:11], s43 offen offset:3072 lds
s_add_u32 m0, s42, 18432
s_nop 0
buffer_load_dwordx4 v8, s[12:15], s44 offen offset:0 lds
buffer_load_dwordx4 v9, s[12:15], s44 offen offset:1024 lds
buffer_load_dwordx4 v10, s[12:15], s44 offen offset:2048 lds
s_add_u32 s43, s43, 589824
s_add_u32 s44, s44, 12288
s_add_u32 m0, s42, 21504
s_nop 0
buffer_load_dwordx4 v4, s[8:11], s43 offen offset:0 lds
buffer_load_dwordx4 v5, s[8:11], s43 offen offset:1024 lds
buffer_load_dwordx4 v6, s[8:11], s43 offen offset:2048 lds
buffer_load_dwordx4 v7, s[8:11], s43 offen offset:3072 lds
s_add_u32 m0, s42, 25600
s_nop 0
buffer_load_dwordx4 v8, s[12:15], s44 offen offset:0 lds
buffer_load_dwordx4 v9, s[12:15], s44 offen offset:1024 lds
buffer_load_dwordx4 v10, s[12:15], s44 offen offset:2048 lds
s_add_u32 s43, s43, 589824
s_add_u32 s44, s44, 12288
s_add_u32 m0, s42, 28672
s_nop 0
buffer_load_dwordx4 v4, s[8:11], s43 offen offset:0 lds
buffer_load_dwordx4 v5, s[8:11], s43 offen offset:1024 lds
buffer_load_dwordx4 v6, s[8:11], s43 offen offset:2048 lds
buffer_load_dwordx4 v7, s[8:11], s43 offen offset:3072 lds
s_add_u32 m0, s42, 32768
s_nop 0
buffer_load_dwordx4 v8, s[12:15], s44 offen offset:0 lds
buffer_load_dwordx4 v9, s[12:15], s44 offen offset:1024 lds
buffer_load_dwordx4 v10, s[12:15], s44 offen offset:2048 lds
s_add_u32 s43, s43, 589824
s_add_u32 s44, s44, 12288
v_accvgpr_write_b32 a0, 0
v_accvgpr_write_b32 a1, 0
v_accvgpr_write_b32 a2, 0
v_accvgpr_write_b32 a3, 0
v_accvgpr_write_b32 a4, 0
v_accvgpr_write_b32 a5, 0
v_accvgpr_write_b32 a6, 0
v_accvgpr_write_b32 a7, 0
v_accvgpr_write_b32 a8, 0
v_accvgpr_write_b32 a9, 0
v_accvgpr_write_b32 a10, 0
v_accvgpr_write_b32 a11, 0
v_accvgpr_write_b32 a12, 0
v_accvgpr_write_b32 a13, 0
v_accvgpr_write_b32 a14, 0
v_accvgpr_write_b32 a15, 0
v_accvgpr_write_b32 a16, 0
v_accvgpr_write_b32 a17, 0
v_accvgpr_write_b32 a18, 0
v_accvgpr_write_b32 a19, 0
v_accvgpr_write_b32 a20, 0
v_accvgpr_write_b32 a21, 0
v_accvgpr_write_b32 a22, 0
v_accvgpr_write_b32 a23, 0
v_accvgpr_write_b32 a24, 0
v_accvgpr_write_b32 a25, 0
v_accvgpr_write_b32 a26, 0
v_accvgpr_write_b32 a27, 0
v_accvgpr_write_b32 a28, 0
v_accvgpr_write_b32 a29, 0
v_accvgpr_write_b32 a30, 0
v_accvgpr_write_b32 a31, 0
v_accvgpr_write_b32 a32, 0
v_accvgpr_write_b32 a33, 0
v_accvgpr_write_b32 a34, 0
v_accvgpr_write_b32 a35, 0
v_accvgpr_write_b32 a36, 0
v_accvgpr_write_b32 a37, 0
v_accvgpr_write_b32 a38, 0
v_accvgpr_write_b32 a39, 0
v_accvgpr_write_b32 a40, 0
v_accvgpr_write_b32 a41, 0
v_accvgpr_write_b32 a42, 0
v_accvgpr_write_b32 a43, 0
v_accvgpr_write_b32 a44, 0
v_accvgpr_write_b32 a45, 0
v_accvgpr_write_b32 a46, 0
v_accvgpr_write_b32 a47, 0
v_accvgpr_write_b32 a48, 0
v_accvgpr_write_b32 a49, 0
v_accvgpr_write_b32 a50, 0
v_accvgpr_write_b32 a51, 0
v_accvgpr_write_b32 a52, 0
v_accvgpr_write_b32 a53, 0
v_accvgpr_write_b32 a54, 0
v_accvgpr_write_b32 a55, 0
v_accvgpr_write_b32 a56, 0
v_accvgpr_write_b32 a57, 0
v_accvgpr_write_b32 a58, 0
v_accvgpr_write_b32 a59, 0
v_accvgpr_write_b32 a60, 0
v_accvgpr_write_b32 a61, 0
v_accvgpr_write_b32 a62, 0
v_accvgpr_write_b32 a63, 0
v_accvgpr_write_b32 a64, 0
v_accvgpr_write_b32 a65, 0
v_accvgpr_write_b32 a66, 0
v_accvgpr_write_b32 a67, 0
v_accvgpr_write_b32 a68, 0
v_accvgpr_write_b32 a69, 0
v_accvgpr_write_b32 a70, 0
v_accvgpr_write_b32 a71, 0
v_accvgpr_write_b32 a72, 0
v_accvgpr_write_b32 a73, 0
v_accvgpr_write_b32 a74, 0
v_accvgpr_write_b32 a75, 0
v_accvgpr_write_b32 a76, 0
v_accvgpr_write_b32 a77, 0
v_accvgpr_write_b32 a78, 0
v_accvgpr_write_b32 a79, 0
v_accvgpr_write_b32 a80, 0
v_accvgpr_write_b32 a81, 0
v_accvgpr_write_b32 a82, 0
v_accvgpr_write_b32 a83, 0
v_accvgpr_write_b32 a84, 0
v_accvgpr_write_b32 a85, 0
v_accvgpr_write_b32 a86, 0
v_accvgpr_write_b32 a87, 0
v_accvgpr_write_b32 a88, 0
v_accvgpr_write_b32 a89, 0
v_accvgpr_write_b32 a90, 0
v_accvgpr_write_b32 a91, 0
v_accvgpr_write_b32 a92, 0
v_accvgpr_write_b32 a93, 0
v_accvgpr_write_b32 a94, 0
v_accvgpr_write_b32 a95, 0
v_accvgpr_write_b32 a96, 0
v_accvgpr_write_b32 a97, 0
v_accvgpr_write_b32 a98, 0
v_accvgpr_write_b32 a99, 0
v_accvgpr_write_b32 a100, 0
v_accvgpr_write_b32 a101, 0
v_accvgpr_write_b32 a102, 0
v_accvgpr_write_b32 a103, 0
v_accvgpr_write_b32 a104, 0
v_accvgpr_write_b32 a105, 0
v_accvgpr_write_b32 a106, 0
v_accvgpr_write_b32 a107, 0
v_accvgpr_write_b32 a108, 0
v_accvgpr_write_b32 a109, 0
v_accvgpr_write_b32 a110, 0
v_accvgpr_write_b32 a111, 0
v_accvgpr_write_b32 a112, 0
v_accvgpr_write_b32 a113, 0
v_accvgpr_write_b32 a114, 0
v_accvgpr_write_b32 a115, 0
v_accvgpr_write_b32 a116, 0
v_accvgpr_write_b32 a117, 0
v_accvgpr_write_b32 a118, 0
v_accvgpr_write_b32 a119, 0
v_accvgpr_write_b32 a120, 0
v_accvgpr_write_b32 a121, 0
v_accvgpr_write_b32 a122, 0
v_accvgpr_write_b32 a123, 0
v_accvgpr_write_b32 a124, 0
v_accvgpr_write_b32 a125, 0
v_accvgpr_write_b32 a126, 0
v_accvgpr_write_b32 a127, 0
v_accvgpr_write_b32 a128, 0
v_accvgpr_write_b32 a129, 0
v_accvgpr_write_b32 a130, 0
v_accvgpr_write_b32 a131, 0
v_accvgpr_write_b32 a132, 0
v_accvgpr_write_b32 a133, 0
v_accvgpr_write_b32 a134, 0
v_accvgpr_write_b32 a135, 0
v_accvgpr_write_b32 a136, 0
v_accvgpr_write_b32 a137, 0
v_accvgpr_write_b32 a138, 0
v_accvgpr_write_b32 a139, 0
v_accvgpr_write_b32 a140, 0
v_accvgpr_write_b32 a141, 0
v_accvgpr_write_b32 a142, 0
v_accvgpr_write_b32 a143, 0
v_accvgpr_write_b32 a144, 0
v_accvgpr_write_b32 a145, 0
v_accvgpr_write_b32 a146, 0
v_accvgpr_write_b32 a147, 0
v_accvgpr_write_b32 a148, 0
v_accvgpr_write_b32 a149, 0
v_accvgpr_write_b32 a150, 0
v_accvgpr_write_b32 a151, 0
v_accvgpr_write_b32 a152, 0
v_accvgpr_write_b32 a153, 0
v_accvgpr_write_b32 a154, 0
v_accvgpr_write_b32 a155, 0
v_accvgpr_write_b32 a156, 0
v_accvgpr_write_b32 a157, 0
v_accvgpr_write_b32 a158, 0
v_accvgpr_write_b32 a159, 0
v_accvgpr_write_b32 a160, 0
v_accvgpr_write_b32 a161, 0
v_accvgpr_write_b32 a162, 0
v_accvgpr_write_b32 a163, 0
v_accvgpr_write_b32 a164, 0
v_accvgpr_write_b32 a165, 0
v_accvgpr_write_b32 a166, 0
v_accvgpr_write_b32 a167, 0
v_accvgpr_write_b32 a168, 0
v_accvgpr_write_b32 a169, 0
v_accvgpr_write_b32 a170, 0
v_accvgpr_write_b32 a171, 0
v_accvgpr_write_b32 a172, 0
v_accvgpr_write_b32 a173, 0
v_accvgpr_write_b32 a174, 0
v_accvgpr_write_b32 a175, 0
v_accvgpr_write_b32 a176, 0
v_accvgpr_write_b32 a177, 0
v_accvgpr_write_b32 a178, 0
v_accvgpr_write_b32 a179, 0
v_accvgpr_write_b32 a180, 0
v_accvgpr_write_b32 a181, 0
v_accvgpr_write_b32 a182, 0
v_accvgpr_write_b32 a183, 0
v_accvgpr_write_b32 a184, 0
v_accvgpr_write_b32 a185, 0
v_accvgpr_write_b32 a186, 0
v_accvgpr_write_b32 a187, 0
v_accvgpr_write_b32 a188, 0
v_accvgpr_write_b32 a189, 0
v_accvgpr_write_b32 a190, 0
v_accvgpr_write_b32 a191, 0
v_bfe_u32 v1, v0, 2, 2
v_lshrrev_b32 v2, 5, v0
v_lshl_add_u32 v2, v2, 3, v1
v_mul_u32_u24 v2, 256, v2
v_bfe_u32 v3, v0, 4, 1
v_lshl_add_u32 v2, v3, 5, v2
v_and_b32 v3, 3, v0
v_lshl_add_u32 v2, v3, 3, v2
v_add_u32 v2, s42, v2
v_xor_b32 v3, 0, v1
v_lshl_add_u32 v11, v3, 6, v2
v_xor_b32 v3, 1, v1
v_lshl_add_u32 v12, v3, 6, v2
v_xor_b32 v3, 2, v1
v_lshl_add_u32 v13, v3, 6, v2
v_xor_b32 v3, 3, v1
v_lshl_add_u32 v14, v3, 6, v2
v_bfe_u32 v1, v0, 2, 2
v_lshrrev_b32 v2, 5, v0
v_lshl_add_u32 v2, v2, 3, v1
v_mul_u32_u24 v2, 192, v2
v_bfe_u32 v3, v0, 4, 1
v_lshl_add_u32 v2, v3, 5, v2
v_and_b32 v3, 3, v0
v_lshl_add_u32 v2, v3, 3, v2
v_add_u32 v2, s42, v2
v_mov_b32 v15, v2
s_waitcnt vmcnt(28)
ds_read_b64_tr_b16 v[32:33], v11 offset:0
ds_read_b64_tr_b16 v[34:35], v11 offset:1024
ds_read_b64_tr_b16 v[36:37], v12 offset:0
ds_read_b64_tr_b16 v[38:39], v12 offset:1024
ds_read_b64_tr_b16 v[40:41], v13 offset:0
ds_read_b64_tr_b16 v[42:43], v13 offset:1024
ds_read_b64_tr_b16 v[44:45], v14 offset:0
ds_read_b64_tr_b16 v[46:47], v14 offset:1024
ds_read_b64_tr_b16 v[48:49], v15 offset:4096
ds_read_b64_tr_b16 v[50:51], v15 offset:4864
ds_read_b64_tr_b16 v[52:53], v15 offset:4160
ds_read_b64_tr_b16 v[54:55], v15 offset:4928
ds_read_b64_tr_b16 v[56:57], v15 offset:4224
ds_read_b64_tr_b16 v[58:59], v15 offset:4992
s_mov_b32 s4, 2
gl_32:
s_waitcnt lgkmcnt(0)
s_waitcnt vmcnt(21)
v_mfma_f32_32x32x16_bf16 a[0:15], v[32:35], v[48:51], a[0:15]
ds_read_b64_tr_b16 v[60:61], v11 offset:7168
ds_read_b64_tr_b16 v[62:63], v11 offset:8192
v_mfma_f32_32x32x16_bf16 a[16:31], v[32:35], v[52:55], a[16:31]
ds_read_b64_tr_b16 v[64:65], v12 offset:7168
ds_read_b64_tr_b16 v[66:67], v12 offset:8192
v_mfma_f32_32x32x16_bf16 a[32:47], v[32:35], v[56:59], a[32:47]
ds_read_b64_tr_b16 v[68:69], v13 offset:7168
ds_read_b64_tr_b16 v[70:71], v13 offset:8192
v_mfma_f32_32x32x16_bf16 a[48:63], v[36:39], v[48:51], a[48:63]
ds_read_b64_tr_b16 v[72:73], v14 offset:7168
ds_read_b64_tr_b16 v[74:75], v14 offset:8192
v_mfma_f32_32x32x16_bf16 a[64:79], v[36:39], v[52:55], a[64:79]
ds_read_b64_tr_b16 v[76:77], v15 offset:11264
ds_read_b64_tr_b16 v[78:79], v15 offset:12032
v_mfma_f32_32x32x16_bf16 a[80:95], v[36:39], v[56:59], a[80:95]
ds_read_b64_tr_b16 v[80:81], v15 offset:11328
ds_read_b64_tr_b16 v[82:83], v15 offset:12096
v_mfma_f32_32x32x16_bf16 a[96:111], v[40:43], v[48:51], a[96:111]
ds_read_b64_tr_b16 v[84:85], v15 offset:11392
ds_read_b64_tr_b16 v[86:87], v15 offset:12160
v_mfma_f32_32x32x16_bf16 a[112:127], v[40:43], v[52:55], a[112:127]
s_add_u32 m0, s42, 0
s_nop 0
buffer_load_dwordx4 v4, s[8:11], s43 offen offset:0 lds
buffer_load_dwordx4 v5, s[8:11], s43 offen offset:1024 lds
v_mfma_f32_32x32x16_bf16 a[128:143], v[40:43], v[56:59], a[128:143]
buffer_load_dwordx4 v6, s[8:11], s43 offen offset:2048 lds
buffer_load_dwordx4 v7, s[8:11], s43 offen offset:3072 lds
v_mfma_f32_32x32x16_bf16 a[144:159], v[44:47], v[48:51], a[144:159]
s_add_u32 m0, s42, 4096
s_nop 0
buffer_load_dwordx4 v8, s[12:15], s44 offen offset:0 lds
v_mfma_f32_32x32x16_bf16 a[160:175], v[44:47], v[52:55], a[160:175]
buffer_load_dwordx4 v9, s[12:15], s44 offen offset:1024 lds
buffer_load_dwordx4 v10, s[12:15], s44 offen offset:2048 lds
v_mfma_f32_32x32x16_bf16 a[176:191], v[44:47], v[56:59], a[176:191]
s_add_u32 s43, s43, 589824
s_add_u32 s44, s44, 12288
s_waitcnt lgkmcnt(0)
s_waitcnt vmcnt(21)
v_mfma_f32_32x32x16_bf16 a[0:15], v[60:63], v[76:79], a[0:15]
ds_read_b64_tr_b16 v[32:33], v11 offset:14336
ds_read_b64_tr_b16 v[34:35], v11 offset:15360
v_mfma_f32_32x32x16_bf16 a[16:31], v[60:63], v[80:83], a[16:31]
ds_read_b64_tr_b16 v[36:37], v12 offset:14336
ds_read_b64_tr_b16 v[38:39], v12 offset:15360
v_mfma_f32_32x32x16_bf16 a[32:47], v[60:63], v[84:87], a[32:47]
ds_read_b64_tr_b16 v[40:41], v13 offset:14336
ds_read_b64_tr_b16 v[42:43], v13 offset:15360
v_mfma_f32_32x32x16_bf16 a[48:63], v[64:67], v[76:79], a[48:63]
ds_read_b64_tr_b16 v[44:45], v14 offset:14336
ds_read_b64_tr_b16 v[46:47], v14 offset:15360
v_mfma_f32_32x32x16_bf16 a[64:79], v[64:67], v[80:83], a[64:79]
ds_read_b64_tr_b16 v[48:49], v15 offset:18432
ds_read_b64_tr_b16 v[50:51], v15 offset:19200
v_mfma_f32_32x32x16_bf16 a[80:95], v[64:67], v[84:87], a[80:95]
ds_read_b64_tr_b16 v[52:53], v15 offset:18496
ds_read_b64_tr_b16 v[54:55], v15 offset:19264
v_mfma_f32_32x32x16_bf16 a[96:111], v[68:71], v[76:79], a[96:111]
ds_read_b64_tr_b16 v[56:57], v15 offset:18560
ds_read_b64_tr_b16 v[58:59], v15 offset:19328
v_mfma_f32_32x32x16_bf16 a[112:127], v[68:71], v[80:83], a[112:127]
s_add_u32 m0, s42, 7168
s_nop 0
buffer_load_dwordx4 v4, s[8:11], s43 offen offset:0 lds
buffer_load_dwordx4 v5, s[8:11], s43 offen offset:1024 lds
v_mfma_f32_32x32x16_bf16 a[128:143], v[68:71], v[84:87], a[128:143]
buffer_load_dwordx4 v6, s[8:11], s43 offen offset:2048 lds
buffer_load_dwordx4 v7, s[8:11], s43 offen offset:3072 lds
v_mfma_f32_32x32x16_bf16 a[144:159], v[72:75], v[76:79], a[144:159]
s_add_u32 m0, s42, 11264
s_nop 0
buffer_load_dwordx4 v8, s[12:15], s44 offen offset:0 lds
v_mfma_f32_32x32x16_bf16 a[160:175], v[72:75], v[80:83], a[160:175]
buffer_load_dwordx4 v9, s[12:15], s44 offen offset:1024 lds
buffer_load_dwordx4 v10, s[12:15], s44 offen offset:2048 lds
v_mfma_f32_32x32x16_bf16 a[176:191], v[72:75], v[84:87], a[176:191]
s_add_u32 s43, s43, 589824
s_add_u32 s44, s44, 12288
s_waitcnt lgkmcnt(0)
s_waitcnt vmcnt(21)
v_mfma_f32_32x32x16_bf16 a[0:15], v[32:35], v[48:51], a[0:15]
ds_read_b64_tr_b16 v[60:61], v11 offset:21504
ds_read_b64_tr_b16 v[62:63], v11 offset:22528
v_mfma_f32_32x32x16_bf16 a[16:31], v[32:35], v[52:55], a[16:31]
ds_read_b64_tr_b16 v[64:65], v12 offset:21504
ds_read_b64_tr_b16 v[66:67], v12 offset:22528
v_mfma_f32_32x32x16_bf16 a[32:47], v[32:35], v[56:59], a[32:47]
ds_read_b64_tr_b16 v[68:69], v13 offset:21504
ds_read_b64_tr_b16 v[70:71], v13 offset:22528
v_mfma_f32_32x32x16_bf16 a[48:63], v[36:39], v[48:51], a[48:63]
ds_read_b64_tr_b16 v[72:73], v14 offset:21504
ds_read_b64_tr_b16 v[74:75], v14 offset:22528
v_mfma_f32_32x32x16_bf16 a[64:79], v[36:39], v[52:55], a[64:79]
ds_read_b64_tr_b16 v[76:77], v15 offset:25600
ds_read_b64_tr_b16 v[78:79], v15 offset:26368
v_mfma_f32_32x32x16_bf16 a[80:95], v[36:39], v[56:59], a[80:95]
ds_read_b64_tr_b16 v[80:81], v15 offset:25664
ds_read_b64_tr_b16 v[82:83], v15 offset:26432
v_mfma_f32_32x32x16_bf16 a[96:111], v[40:43], v[48:51], a[96:111]
ds_read_b64_tr_b16 v[84:85], v15 offset:25728
ds_read_b64_tr_b16 v[86:87], v15 offset:26496
v_mfma_f32_32x32x16_bf16 a[112:127], v[40:43], v[52:55], a[112:127]
s_add_u32 m0, s42, 14336
s_nop 0
buffer_load_dwordx4 v4, s[8:11], s43 offen offset:0 lds
buffer_load_dwordx4 v5, s[8:11], s43 offen offset:1024 lds
v_mfma_f32_32x32x16_bf16 a[128:143], v[40:43], v[56:59], a[128:143]
buffer_load_dwordx4 v6, s[8:11], s43 offen offset:2048 lds
buffer_load_dwordx4 v7, s[8:11], s43 offen offset:3072 lds
v_mfma_f32_32x32x16_bf16 a[144:159], v[44:47], v[48:51], a[144:159]
s_add_u32 m0, s42, 18432
s_nop 0
buffer_load_dwordx4 v8, s[12:15], s44 offen offset:0 lds
v_mfma_f32_32x32x16_bf16 a[160:175], v[44:47], v[52:55], a[160:175]
buffer_load_dwordx4 v9, s[12:15], s44 offen offset:1024 lds
buffer_load_dwordx4 v10, s[12:15], s44 offen offset:2048 lds
v_mfma_f32_32x32x16_bf16 a[176:191], v[44:47], v[56:59], a[176:191]
s_add_u32 s43, s43, 589824
s_add_u32 s44, s44, 12288
s_waitcnt lgkmcnt(0)
s_waitcnt vmcnt(21)
v_mfma_f32_32x32x16_bf16 a[0:15], v[60:63], v[76:79], a[0:15]
ds_read_b64_tr_b16 v[32:33], v11 offset:28672
ds_read_b64_tr_b16 v[34:35], v11 offset:29696
v_mfma_f32_32x32x16_bf16 a[16:31], v[60:63], v[80:83], a[16:31]
ds_read_b64_tr_b16 v[36:37], v12 offset:28672
ds_read_b64_tr_b16 v[38:39], v12 offset:29696
v_mfma_f32_32x32x16_bf16 a[32:47], v[60:63], v[84:87], a[32:47]
ds_read_b64_tr_b16 v[40:41], v13 offset:28672
ds_read_b64_tr_b16 v[42:43], v13 offset:29696
v_mfma_f32_32x32x16_bf16 a[48:63], v[64:67], v[76:79], a[48:63]
ds_read_b64_tr_b16 v[44:45], v14 offset:28672
ds_read_b64_tr_b16 v[46:47], v14 offset:29696
v_mfma_f32_32x32x16_bf16 a[64:79], v[64:67], v[80:83], a[64:79]
ds_read_b64_tr_b16 v[48:49], v15 offset:32768
ds_read_b64_tr_b16 v[50:51], v15 offset:33536
v_mfma_f32_32x32x16_bf16 a[80:95], v[64:67], v[84:87], a[80:95]
ds_read_b64_tr_b16 v[52:53], v15 offset:32832
ds_read_b64_tr_b16 v[54:55], v15 offset:33600
v_mfma_f32_32x32x16_bf16 a[96:111], v[68:71], v[76:79], a[96:111]
ds_read_b64_tr_b16 v[56:57], v15 offset:32896
ds_read_b64_tr_b16 v[58:59], v15 offset:33664
v_mfma_f32_32x32x16_bf16 a[112:127], v[68:71], v[80:83], a[112:127]
s_add_u32 m0, s42, 21504
s_nop 0
buffer_load_dwordx4 v4, s[8:11], s43 offen offset:0 lds
buffer_load_dwordx4 v5, s[8:11], s43 offen offset:1024 lds
v_mfma_f32_32x32x16_bf16 a[128:143], v[68:71], v[84:87], a[128:143]
buffer_load_dwordx4 v6, s[8:11], s43 offen offset:2048 lds
buffer_load_dwordx4 v7, s[8:11], s43 offen offset:3072 lds
v_mfma_f32_32x32x16_bf16 a[144:159], v[72:75], v[76:79], a[144:159]
s_add_u32 m0, s42, 25600
s_nop 0
buffer_load_dwordx4 v8, s[12:15], s44 offen offset:0 lds
v_mfma_f32_32x32x16_bf16 a[160:175], v[72:75], v[80:83], a[160:175]
buffer_load_dwordx4 v9, s[12:15], s44 offen offset:1024 lds
buffer_load_dwordx4 v10, s[12:15], s44 offen offset:2048 lds
v_mfma_f32_32x32x16_bf16 a[176:191], v[72:75], v[84:87], a[176:191]
s_add_u32 s43, s43, 589824
s_add_u32 s44, s44, 12288
s_waitcnt lgkmcnt(0)
s_waitcnt vmcnt(21)
v_mfma_f32_32x32x16_bf16 a[0:15], v[32:35], v[48:51], a[0:15]
ds_read_b64_tr_b16 v[60:61], v11 offset:0
ds_read_b64_tr_b16 v[62:63], v11 offset:1024
v_mfma_f32_32x32x16_bf16 a[16:31], v[32:35], v[52:55], a[16:31]
ds_read_b64_tr_b16 v[64:65], v12 offset:0
ds_read_b64_tr_b16 v[66:67], v12 offset:1024
v_mfma_f32_32x32x16_bf16 a[32:47], v[32:35], v[56:59], a[32:47]
ds_read_b64_tr_b16 v[68:69], v13 offset:0
ds_read_b64_tr_b16 v[70:71], v13 offset:1024
v_mfma_f32_32x32x16_bf16 a[48:63], v[36:39], v[48:51], a[48:63]
ds_read_b64_tr_b16 v[72:73], v14 offset:0
ds_read_b64_tr_b16 v[74:75], v14 offset:1024
v_mfma_f32_32x32x16_bf16 a[64:79], v[36:39], v[52:55], a[64:79]
ds_read_b64_tr_b16 v[76:77], v15 offset:4096
ds_read_b64_tr_b16 v[78:79], v15 offset:4864
v_mfma_f32_32x32x16_bf16 a[80:95], v[36:39], v[56:59], a[80:95]
ds_read_b64_tr_b16 v[80:81], v15 offset:4160
ds_read_b64_tr_b16 v[82:83], v15 offset:4928
v_mfma_f32_32x32x16_bf16 a[96:111], v[40:43], v[48:51], a[96:111]
ds_read_b64_tr_b16 v[84:85], v15 offset:4224
ds_read_b64_tr_b16 v[86:87], v15 offset:4992
v_mfma_f32_32x32x16_bf16 a[112:127], v[40:43], v[52:55], a[112:127]
s_add_u32 m0, s42, 28672
s_nop 0
buffer_load_dwordx4 v4, s[8:11], s43 offen offset:0 lds
buffer_load_dwordx4 v5, s[8:11], s43 offen offset:1024 lds
v_mfma_f32_32x32x16_bf16 a[128:143], v[40:43], v[56:59], a[128:143]
buffer_load_dwordx4 v6, s[8:11], s43 offen offset:2048 lds
buffer_load_dwordx4 v7, s[8:11], s43 offen offset:3072 lds
v_mfma_f32_32x32x16_bf16 a[144:159], v[44:47], v[48:51], a[144:159]
s_add_u32 m0, s42, 32768
s_nop 0
buffer_load_dwordx4 v8, s[12:15], s44 offen offset:0 lds
v_mfma_f32_32x32x16_bf16 a[160:175], v[44:47], v[52:55], a[160:175]
buffer_load_dwordx4 v9, s[12:15], s44 offen offset:1024 lds
buffer_load_dwordx4 v10, s[12:15], s44 offen offset:2048 lds
v_mfma_f32_32x32x16_bf16 a[176:191], v[44:47], v[56:59], a[176:191]
s_add_u32 s43, s43, 589824
s_add_u32 s44, s44, 12288
s_waitcnt lgkmcnt(0)
s_waitcnt vmcnt(21)
v_mfma_f32_32x32x16_bf16 a[0:15], v[60:63], v[76:79], a[0:15]
ds_read_b64_tr_b16 v[32:33], v11 offset:7168
ds_read_b64_tr_b16 v[34:35], v11 offset:8192
v_mfma_f32_32x32x16_bf16 a[16:31], v[60:63], v[80:83], a[16:31]
ds_read_b64_tr_b16 v[36:37], v12 offset:7168
ds_read_b64_tr_b16 v[38:39], v12 offset:8192
v_mfma_f32_32x32x16_bf16 a[32:47], v[60:63], v[84:87], a[32:47]
ds_read_b64_tr_b16 v[40:41], v13 offset:7168
ds_read_b64_tr_b16 v[42:43], v13 offset:8192
v_mfma_f32_32x32x16_bf16 a[48:63], v[64:67], v[76:79], a[48:63]
ds_read_b64_tr_b16 v[44:45], v14 offset:7168
ds_read_b64_tr_b16 v[46:47], v14 offset:8192
v_mfma_f32_32x32x16_bf16 a[64:79], v[64:67], v[80:83], a[64:79]
ds_read_b64_tr_b16 v[48:49], v15 offset:11264
ds_read_b64_tr_b16 v[50:51], v15 offset:12032
v_mfma_f32_32x32x16_bf16 a[80:95], v[64:67], v[84:87], a[80:95]
ds_read_b64_tr_b16 v[52:53], v15 offset:11328
ds_read_b64_tr_b16 v[54:55], v15 offset:12096
v_mfma_f32_32x32x16_bf16 a[96:111], v[68:71], v[76:79], a[96:111]
ds_read_b64_tr_b16 v[56:57], v15 offset:11392
ds_read_b64_tr_b16 v[58:59], v15 offset:12160
v_mfma_f32_32x32x16_bf16 a[112:127], v[68:71], v[80:83], a[112:127]
s_add_u32 m0, s42, 0
s_nop 0
buffer_load_dwordx4 v4, s[8:11], s43 offen offset:0 lds
buffer_load_dwordx4 v5, s[8:11], s43 offen offset:1024 lds
v_mfma_f32_32x32x16_bf16 a[128:143], v[68:71], v[84:87], a[128:143]
buffer_load_dwordx4 v6, s[8:11], s43 offen offset:2048 lds
buffer_load_dwordx4 v7, s[8:11], s43 offen offset:3072 lds
v_mfma_f32_32x32x16_bf16 a[144:159], v[72:75], v[76:79], a[144:159]
s_add_u32 m0, s42, 4096
s_nop 0
buffer_load_dwordx4 v8, s[12:15], s44 offen offset:0 lds
v_mfma_f32_32x32x16_bf16 a[160:175], v[72:75], v[80:83], a[160:175]
buffer_load_dwordx4 v9, s[12:15], s44 offen offset:1024 lds
buffer_load_dwordx4 v10, s[12:15], s44 offen offset:2048 lds
v_mfma_f32_32x32x16_bf16 a[176:191], v[72:75], v[84:87], a[176:191]
s_add_u32 s43, s43, 589824
s_add_u32 s44, s44, 12288
s_waitcnt lgkmcnt(0)
s_waitcnt vmcnt(21)
v_mfma_f32_32x32x16_bf16 a[0:15], v[32:35], v[48:51], a[0:15]
ds_read_b64_tr_b16 v[60:61], v11 offset:14336
ds_read_b64_tr_b16 v[62:63], v11 offset:15360
v_mfma_f32_32x32x16_bf16 a[16:31], v[32:35], v[52:55], a[16:31]
ds_read_b64_tr_b16 v[64:65], v12 offset:14336
ds_read_b64_tr_b16 v[66:67], v12 offset:15360
v_mfma_f32_32x32x16_bf16 a[32:47], v[32:35], v[56:59], a[32:47]
ds_read_b64_tr_b16 v[68:69], v13 offset:14336
ds_read_b64_tr_b16 v[70:71], v13 offset:15360
v_mfma_f32_32x32x16_bf16 a[48:63], v[36:39], v[48:51], a[48:63]
ds_read_b64_tr_b16 v[72:73], v14 offset:14336
ds_read_b64_tr_b16 v[74:75], v14 offset:15360
v_mfma_f32_32x32x16_bf16 a[64:79], v[36:39], v[52:55], a[64:79]
ds_read_b64_tr_b16 v[76:77], v15 offset:18432
ds_read_b64_tr_b16 v[78:79], v15 offset:19200
v_mfma_f32_32x32x16_bf16 a[80:95], v[36:39], v[56:59], a[80:95]
ds_read_b64_tr_b16 v[80:81], v15 offset:18496
ds_read_b64_tr_b16 v[82:83], v15 offset:19264
v_mfma_f32_32x32x16_bf16 a[96:111], v[40:43], v[48:51], a[96:111]
ds_read_b64_tr_b16 v[84:85], v15 offset:18560
ds_read_b64_tr_b16 v[86:87], v15 offset:19328
v_mfma_f32_32x32x16_bf16 a[112:127], v[40:43], v[52:55], a[112:127]
s_add_u32 m0, s42, 7168
s_nop 0
buffer_load_dwordx4 v4, s[8:11], s43 offen offset:0 lds
buffer_load_dwordx4 v5, s[8:11], s43 offen offset:1024 lds
v_mfma_f32_32x32x16_bf16 a[128:143], v[40:43], v[56:59], a[128:143]
buffer_load_dwordx4 v6, s[8:11], s43 offen offset:2048 lds
buffer_load_dwordx4 v7, s[8:11], s43 offen offset:3072 lds
v_mfma_f32_32x32x16_bf16 a[144:159], v[44:47], v[48:51], a[144:159]
s_add_u32 m0, s42, 11264
s_nop 0
buffer_load_dwordx4 v8, s[12:15], s44 offen offset:0 lds
v_mfma_f32_32x32x16_bf16 a[160:175], v[44:47], v[52:55], a[160:175]
buffer_load_dwordx4 v9, s[12:15], s44 offen offset:1024 lds
buffer_load_dwordx4 v10, s[12:15], s44 offen offset:2048 lds
v_mfma_f32_32x32x16_bf16 a[176:191], v[44:47], v[56:59], a[176:191]
s_add_u32 s43, s43, 589824
s_add_u32 s44, s44, 12288
s_waitcnt lgkmcnt(0)
s_waitcnt vmcnt(21)
v_mfma_f32_32x32x16_bf16 a[0:15], v[60:63], v[76:79], a[0:15]
ds_read_b64_tr_b16 v[32:33], v11 offset:21504
ds_read_b64_tr_b16 v[34:35], v11 offset:22528
v_mfma_f32_32x32x16_bf16 a[16:31], v[60:63], v[80:83], a[16:31]
ds_read_b64_tr_b16 v[36:37], v12 offset:21504
ds_read_b64_tr_b16 v[38:39], v12 offset:22528
v_mfma_f32_32x32x16_bf16 a[32:47], v[60:63], v[84:87], a[32:47]
ds_read_b64_tr_b16 v[40:41], v13 offset:21504
ds_read_b64_tr_b16 v[42:43], v13 offset:22528
v_mfma_f32_32x32x16_bf16 a[48:63], v[64:67], v[76:79], a[48:63]
ds_read_b64_tr_b16 v[44:45], v14 offset:21504
ds_read_b64_tr_b16 v[46:47], v14 offset:22528
v_mfma_f32_32x32x16_bf16 a[64:79], v[64:67], v[80:83], a[64:79]
ds_read_b64_tr_b16 v[48:49], v15 offset:25600
ds_read_b64_tr_b16 v[50:51], v15 offset:26368
v_mfma_f32_32x32x16_bf16 a[80:95], v[64:67], v[84:87], a[80:95]
ds_read_b64_tr_b16 v[52:53], v15 offset:25664
ds_read_b64_tr_b16 v[54:55], v15 offset:26432
v_mfma_f32_32x32x16_bf16 a[96:111], v[68:71], v[76:79], a[96:111]
ds_read_b64_tr_b16 v[56:57], v15 offset:25728
ds_read_b64_tr_b16 v[58:59], v15 offset:26496
v_mfma_f32_32x32x16_bf16 a[112:127], v[68:71], v[80:83], a[112:127]
s_add_u32 m0, s42, 14336
s_nop 0
buffer_load_dwordx4 v4, s[8:11], s43 offen offset:0 lds
buffer_load_dwordx4 v5, s[8:11], s43 offen offset:1024 lds
v_mfma_f32_32x32x16_bf16 a[128:143], v[68:71], v[84:87], a[128:143]
buffer_load_dwordx4 v6, s[8:11], s43 offen offset:2048 lds
buffer_load_dwordx4 v7, s[8:11], s43 offen offset:3072 lds
v_mfma_f32_32x32x16_bf16 a[144:159], v[72:75], v[76:79], a[144:159]
s_add_u32 m0, s42, 18432
s_nop 0
buffer_load_dwordx4 v8, s[12:15], s44 offen offset:0 lds
v_mfma_f32_32x32x16_bf16 a[160:175], v[72:75], v[80:83], a[160:175]
buffer_load_dwordx4 v9, s[12:15], s44 offen offset:1024 lds
buffer_load_dwordx4 v10, s[12:15], s44 offen offset:2048 lds
v_mfma_f32_32x32x16_bf16 a[176:191], v[72:75], v[84:87], a[176:191]
s_add_u32 s43, s43, 589824
s_add_u32 s44, s44, 12288
s_waitcnt lgkmcnt(0)
s_waitcnt vmcnt(21)
v_mfma_f32_32x32x16_bf16 a[0:15], v[32:35], v[48:51], a[0:15]
ds_read_b64_tr_b16 v[60:61], v11 offset:28672
ds_read_b64_tr_b16 v[62:63], v11 offset:29696
v_mfma_f32_32x32x16_bf16 a[16:31], v[32:35], v[52:55], a[16:31]
ds_read_b64_tr_b16 v[64:65], v12 offset:28672
ds_read_b64_tr_b16 v[66:67], v12 offset:29696
v_mfma_f32_32x32x16_bf16 a[32:47], v[32:35], v[56:59], a[32:47]
ds_read_b64_tr_b16 v[68:69], v13 offset:28672
ds_read_b64_tr_b16 v[70:71], v13 offset:29696
v_mfma_f32_32x32x16_bf16 a[48:63], v[36:39], v[48:51], a[48:63]
ds_read_b64_tr_b16 v[72:73], v14 offset:28672
ds_read_b64_tr_b16 v[74:75], v14 offset:29696
v_mfma_f32_32x32x16_bf16 a[64:79], v[36:39], v[52:55], a[64:79]
ds_read_b64_tr_b16 v[76:77], v15 offset:32768
ds_read_b64_tr_b16 v[78:79], v15 offset:33536
v_mfma_f32_32x32x16_bf16 a[80:95], v[36:39], v[56:59], a[80:95]
ds_read_b64_tr_b16 v[80:81], v15 offset:32832
ds_read_b64_tr_b16 v[82:83], v15 offset:33600
v_mfma_f32_32x32x16_bf16 a[96:111], v[40:43], v[48:51], a[96:111]
ds_read_b64_tr_b16 v[84:85], v15 offset:32896
ds_read_b64_tr_b16 v[86:87], v15 offset:33664
v_mfma_f32_32x32x16_bf16 a[112:127], v[40:43], v[52:55], a[112:127]
s_add_u32 m0, s42, 21504
s_nop 0
buffer_load_dwordx4 v4, s[8:11], s43 offen offset:0 lds
buffer_load_dwordx4 v5, s[8:11], s43 offen offset:1024 lds
v_mfma_f32_32x32x16_bf16 a[128:143], v[40:43], v[56:59], a[128:143]
buffer_load_dwordx4 v6, s[8:11], s43 offen offset:2048 lds
buffer_load_dwordx4 v7, s[8:11], s43 offen offset:3072 lds
v_mfma_f32_32x32x16_bf16 a[144:159], v[44:47], v[48:51], a[144:159]
s_add_u32 m0, s42, 25600
s_nop 0
buffer_load_dwordx4 v8, s[12:15], s44 offen offset:0 lds
v_mfma_f32_32x32x16_bf16 a[160:175], v[44:47], v[52:55], a[160:175]
buffer_load_dwordx4 v9, s[12:15], s44 offen offset:1024 lds
buffer_load_dwordx4 v10, s[12:15], s44 offen offset:2048 lds
v_mfma_f32_32x32x16_bf16 a[176:191], v[44:47], v[56:59], a[176:191]
s_add_u32 s43, s43, 589824
s_add_u32 s44, s44, 12288
s_waitcnt lgkmcnt(0)
s_waitcnt vmcnt(21)
v_mfma_f32_32x32x16_bf16 a[0:15], v[60:63], v[76:79], a[0:15]
ds_read_b64_tr_b16 v[32:33], v11 offset:0
ds_read_b64_tr_b16 v[34:35], v11 offset:1024
v_mfma_f32_32x32x16_bf16 a[16:31], v[60:63], v[80:83], a[16:31]
ds_read_b64_tr_b16 v[36:37], v12 offset:0
ds_read_b64_tr_b16 v[38:39], v12 offset:1024
v_mfma_f32_32x32x16_bf16 a[32:47], v[60:63], v[84:87], a[32:47]
ds_read_b64_tr_b16 v[40:41], v13 offset:0
ds_read_b64_tr_b16 v[42:43], v13 offset:1024
v_mfma_f32_32x32x16_bf16 a[48:63], v[64:67], v[76:79], a[48:63]
ds_read_b64_tr_b16 v[44:45], v14 offset:0
ds_read_b64_tr_b16 v[46:47], v14 offset:1024
v_mfma_f32_32x32x16_bf16 a[64:79], v[64:67], v[80:83], a[64:79]
ds_read_b64_tr_b16 v[48:49], v15 offset:4096
ds_read_b64_tr_b16 v[50:51], v15 offset:4864
v_mfma_f32_32x32x16_bf16 a[80:95], v[64:67], v[84:87], a[80:95]
ds_read_b64_tr_b16 v[52:53], v15 offset:4160
ds_read_b64_tr_b16 v[54:55], v15 offset:4928
v_mfma_f32_32x32x16_bf16 a[96:111], v[68:71], v[76:79], a[96:111]
ds_read_b64_tr_b16 v[56:57], v15 offset:4224
ds_read_b64_tr_b16 v[58:59], v15 offset:4992
v_mfma_f32_32x32x16_bf16 a[112:127], v[68:71], v[80:83], a[112:127]
s_add_u32 m0, s42, 28672
s_nop 0
buffer_load_dwordx4 v4, s[8:11], s43 offen offset:0 lds
buffer_load_dwordx4 v5, s[8:11], s43 offen offset:1024 lds
v_mfma_f32_32x32x16_bf16 a[128:143], v[68:71], v[84:87], a[128:143]
buffer_load_dwordx4 v6, s[8:11], s43 offen offset:2048 lds
buffer_load_dwordx4 v7, s[8:11], s43 offen offset:3072 lds
v_mfma_f32_32x32x16_bf16 a[144:159], v[72:75], v[76:79], a[144:159]
s_add_u32 m0, s42, 32768
s_nop 0
buffer_load_dwordx4 v8, s[12:15], s44 offen offset:0 lds
v_mfma_f32_32x32x16_bf16 a[160:175], v[72:75], v[80:83], a[160:175]
buffer_load_dwordx4 v9, s[12:15], s44 offen offset:1024 lds
buffer_load_dwordx4 v10, s[12:15], s44 offen offset:2048 lds
v_mfma_f32_32x32x16_bf16 a[176:191], v[72:75], v[84:87], a[176:191]
s_add_u32 s43, s43, 589824
s_add_u32 s44, s44, 12288
s_sub_u32 s4, s4, 1
s_cmp_lg_u32 s4, 0
s_cbranch_scc1 gl_32
s_waitcnt lgkmcnt(0)
s_waitcnt vmcnt(21)
v_mfma_f32_32x32x16_bf16 a[0:15], v[32:35], v[48:51], a[0:15]
ds_read_b64_tr_b16 v[60:61], v11 offset:7168
ds_read_b64_tr_b16 v[62:63], v11 offset:8192
v_mfma_f32_32x32x16_bf16 a[16:31], v[32:35], v[52:55], a[16:31]
ds_read_b64_tr_b16 v[64:65], v12 offset:7168
ds_read_b64_tr_b16 v[66:67], v12 offset:8192
v_mfma_f32_32x32x16_bf16 a[32:47], v[32:35], v[56:59], a[32:47]
ds_read_b64_tr_b16 v[68:69], v13 offset:7168
ds_read_b64_tr_b16 v[70:71], v13 offset:8192
v_mfma_f32_32x32x16_bf16 a[48:63], v[36:39], v[48:51], a[48:63]
ds_read_b64_tr_b16 v[72:73], v14 offset:7168
ds_read_b64_tr_b16 v[74:75], v14 offset:8192
v_mfma_f32_32x32x16_bf16 a[64:79], v[36:39], v[52:55], a[64:79]
ds_read_b64_tr_b16 v[76:77], v15 offset:11264
ds_read_b64_tr_b16 v[78:79], v15 offset:12032
v_mfma_f32_32x32x16_bf16 a[80:95], v[36:39], v[56:59], a[80:95]
ds_read_b64_tr_b16 v[80:81], v15 offset:11328
ds_read_b64_tr_b16 v[82:83], v15 offset:12096
v_mfma_f32_32x32x16_bf16 a[96:111], v[40:43], v[48:51], a[96:111]
ds_read_b64_tr_b16 v[84:85], v15 offset:11392
ds_read_b64_tr_b16 v[86:87], v15 offset:12160
v_mfma_f32_32x32x16_bf16 a[112:127], v[40:43], v[52:55], a[112:127]
s_add_u32 m0, s42, 0
s_nop 0
buffer_load_dwordx4 v4, s[8:11], s43 offen offset:0 lds
buffer_load_dwordx4 v5, s[8:11], s43 offen offset:1024 lds
v_mfma_f32_32x32x16_bf16 a[128:143], v[40:43], v[56:59], a[128:143]
buffer_load_dwordx4 v6, s[8:11], s43 offen offset:2048 lds
buffer_load_dwordx4 v7, s[8:11], s43 offen offset:3072 lds
v_mfma_f32_32x32x16_bf16 a[144:159], v[44:47], v[48:51], a[144:159]
s_add_u32 m0, s42, 4096
s_nop 0
buffer_load_dwordx4 v8, s[12:15], s44 offen offset:0 lds
v_mfma_f32_32x32x16_bf16 a[160:175], v[44:47], v[52:55], a[160:175]
buffer_load_dwordx4 v9, s[12:15], s44 offen offset:1024 lds
buffer_load_dwordx4 v10, s[12:15], s44 offen offset:2048 lds
v_mfma_f32_32x32x16_bf16 a[176:191], v[44:47], v[56:59], a[176:191]
s_add_u32 s43, s43, 589824
s_add_u32 s44, s44, 12288
s_waitcnt lgkmcnt(0)
s_waitcnt vmcnt(21)
v_mfma_f32_32x32x16_bf16 a[0:15], v[60:63], v[76:79], a[0:15]
ds_read_b64_tr_b16 v[32:33], v11 offset:14336
ds_read_b64_tr_b16 v[34:35], v11 offset:15360
v_mfma_f32_32x32x16_bf16 a[16:31], v[60:63], v[80:83], a[16:31]
ds_read_b64_tr_b16 v[36:37], v12 offset:14336
ds_read_b64_tr_b16 v[38:39], v12 offset:15360
v_mfma_f32_32x32x16_bf16 a[32:47], v[60:63], v[84:87], a[32:47]
ds_read_b64_tr_b16 v[40:41], v13 offset:14336
ds_read_b64_tr_b16 v[42:43], v13 offset:15360
v_mfma_f32_32x32x16_bf16 a[48:63], v[64:67], v[76:79], a[48:63]
ds_read_b64_tr_b16 v[44:45], v14 offset:14336
ds_read_b64_tr_b16 v[46:47], v14 offset:15360
v_mfma_f32_32x32x16_bf16 a[64:79], v[64:67], v[80:83], a[64:79]
ds_read_b64_tr_b16 v[48:49], v15 offset:18432
ds_read_b64_tr_b16 v[50:51], v15 offset:19200
v_mfma_f32_32x32x16_bf16 a[80:95], v[64:67], v[84:87], a[80:95]
ds_read_b64_tr_b16 v[52:53], v15 offset:18496
ds_read_b64_tr_b16 v[54:55], v15 offset:19264
v_mfma_f32_32x32x16_bf16 a[96:111], v[68:71], v[76:79], a[96:111]
ds_read_b64_tr_b16 v[56:57], v15 offset:18560
ds_read_b64_tr_b16 v[58:59], v15 offset:19328
v_mfma_f32_32x32x16_bf16 a[112:127], v[68:71], v[80:83], a[112:127]
s_add_u32 m0, s42, 7168
s_nop 0
buffer_load_dwordx4 v4, s[8:11], s43 offen offset:0 lds
buffer_load_dwordx4 v5, s[8:11], s43 offen offset:1024 lds
v_mfma_f32_32x32x16_bf16 a[128:143], v[68:71], v[84:87], a[128:143]
buffer_load_dwordx4 v6, s[8:11], s43 offen offset:2048 lds
buffer_load_dwordx4 v7, s[8:11], s43 offen offset:3072 lds
v_mfma_f32_32x32x16_bf16 a[144:159], v[72:75], v[76:79], a[144:159]
s_add_u32 m0, s42, 11264
s_nop 0
buffer_load_dwordx4 v8, s[12:15], s44 offen offset:0 lds
v_mfma_f32_32x32x16_bf16 a[160:175], v[72:75], v[80:83], a[160:175]
buffer_load_dwordx4 v9, s[12:15], s44 offen offset:1024 lds
buffer_load_dwordx4 v10, s[12:15], s44 offen offset:2048 lds
v_mfma_f32_32x32x16_bf16 a[176:191], v[72:75], v[84:87], a[176:191]
s_add_u32 s43, s43, 589824
s_add_u32 s44, s44, 12288
s_waitcnt lgkmcnt(0)
s_waitcnt vmcnt(21)
v_mfma_f32_32x32x16_bf16 a[0:15], v[32:35], v[48:51], a[0:15]
ds_read_b64_tr_b16 v[60:61], v11 offset:21504
ds_read_b64_tr_b16 v[62:63], v11 offset:22528
v_mfma_f32_32x32x16_bf16 a[16:31], v[32:35], v[52:55], a[16:31]
ds_read_b64_tr_b16 v[64:65], v12 offset:21504
ds_read_b64_tr_b16 v[66:67], v12 offset:22528
v_mfma_f32_32x32x16_bf16 a[32:47], v[32:35], v[56:59], a[32:47]
ds_read_b64_tr_b16 v[68:69], v13 offset:21504
ds_read_b64_tr_b16 v[70:71], v13 offset:22528
v_mfma_f32_32x32x16_bf16 a[48:63], v[36:39], v[48:51], a[48:63]
ds_read_b64_tr_b16 v[72:73], v14 offset:21504
ds_read_b64_tr_b16 v[74:75], v14 offset:22528
v_mfma_f32_32x32x16_bf16 a[64:79], v[36:39], v[52:55], a[64:79]
ds_read_b64_tr_b16 v[76:77], v15 offset:25600
ds_read_b64_tr_b16 v[78:79], v15 offset:26368
v_mfma_f32_32x32x16_bf16 a[80:95], v[36:39], v[56:59], a[80:95]
ds_read_b64_tr_b16 v[80:81], v15 offset:25664
ds_read_b64_tr_b16 v[82:83], v15 offset:26432
v_mfma_f32_32x32x16_bf16 a[96:111], v[40:43], v[48:51], a[96:111]
ds_read_b64_tr_b16 v[84:85], v15 offset:25728
ds_read_b64_tr_b16 v[86:87], v15 offset:26496
v_mfma_f32_32x32x16_bf16 a[112:127], v[40:43], v[52:55], a[112:127]
s_add_u32 m0, s42, 14336
s_nop 0
buffer_load_dwordx4 v4, s[8:11], s43 offen offset:0 lds
buffer_load_dwordx4 v5, s[8:11], s43 offen offset:1024 lds
v_mfma_f32_32x32x16_bf16 a[128:143], v[40:43], v[56:59], a[128:143]
buffer_load_dwordx4 v6, s[8:11], s43 offen offset:2048 lds
buffer_load_dwordx4 v7, s[8:11], s43 offen offset:3072 lds
v_mfma_f32_32x32x16_bf16 a[144:159], v[44:47], v[48:51], a[144:159]
s_add_u32 m0, s42, 18432
s_nop 0
buffer_load_dwordx4 v8, s[12:15], s44 offen offset:0 lds
v_mfma_f32_32x32x16_bf16 a[160:175], v[44:47], v[52:55], a[160:175]
buffer_load_dwordx4 v9, s[12:15], s44 offen offset:1024 lds
buffer_load_dwordx4 v10, s[12:15], s44 offen offset:2048 lds
v_mfma_f32_32x32x16_bf16 a[176:191], v[44:47], v[56:59], a[176:191]
s_add_u32 s43, s43, 589824
s_add_u32 s44, s44, 12288
s_waitcnt lgkmcnt(0)
s_waitcnt vmcnt(21)
v_mfma_f32_32x32x16_bf16 a[0:15], v[60:63], v[76:79], a[0:15]
ds_read_b64_tr_b16 v[32:33], v11 offset:28672
ds_read_b64_tr_b16 v[34:35], v11 offset:29696
v_mfma_f32_32x32x16_bf16 a[16:31], v[60:63], v[80:83], a[16:31]
ds_read_b64_tr_b16 v[36:37], v12 offset:28672
ds_read_b64_tr_b16 v[38:39], v12 offset:29696
v_mfma_f32_32x32x16_bf16 a[32:47], v[60:63], v[84:87], a[32:47]
ds_read_b64_tr_b16 v[40:41], v13 offset:28672
ds_read_b64_tr_b16 v[42:43], v13 offset:29696
v_mfma_f32_32x32x16_bf16 a[48:63], v[64:67], v[76:79], a[48:63]
ds_read_b64_tr_b16 v[44:45], v14 offset:28672
ds_read_b64_tr_b16 v[46:47], v14 offset:29696
v_mfma_f32_32x32x16_bf16 a[64:79], v[64:67], v[80:83], a[64:79]
ds_read_b64_tr_b16 v[48:49], v15 offset:32768
ds_read_b64_tr_b16 v[50:51], v15 offset:33536
v_mfma_f32_32x32x16_bf16 a[80:95], v[64:67], v[84:87], a[80:95]
ds_read_b64_tr_b16 v[52:53], v15 offset:32832
ds_read_b64_tr_b16 v[54:55], v15 offset:33600
v_mfma_f32_32x32x16_bf16 a[96:111], v[68:71], v[76:79], a[96:111]
ds_read_b64_tr_b16 v[56:57], v15 offset:32896
ds_read_b64_tr_b16 v[58:59], v15 offset:33664
v_mfma_f32_32x32x16_bf16 a[112:127], v[68:71], v[80:83], a[112:127]
s_add_u32 m0, s42, 21504
s_nop 0
buffer_load_dwordx4 v4, s[8:11], s43 offen offset:0 lds
buffer_load_dwordx4 v5, s[8:11], s43 offen offset:1024 lds
v_mfma_f32_32x32x16_bf16 a[128:143], v[68:71], v[84:87], a[128:143]
buffer_load_dwordx4 v6, s[8:11], s43 offen offset:2048 lds
buffer_load_dwordx4 v7, s[8:11], s43 offen offset:3072 lds
v_mfma_f32_32x32x16_bf16 a[144:159], v[72:75], v[76:79], a[144:159]
s_add_u32 m0, s42, 25600
s_nop 0
buffer_load_dwordx4 v8, s[12:15], s44 offen offset:0 lds
v_mfma_f32_32x32x16_bf16 a[160:175], v[72:75], v[80:83], a[160:175]
buffer_load_dwordx4 v9, s[12:15], s44 offen offset:1024 lds
buffer_load_dwordx4 v10, s[12:15], s44 offen offset:2048 lds
v_mfma_f32_32x32x16_bf16 a[176:191], v[72:75], v[84:87], a[176:191]
s_add_u32 s43, s43, 589824
s_add_u32 s44, s44, 12288
s_waitcnt lgkmcnt(0)
s_waitcnt vmcnt(21)
v_mfma_f32_32x32x16_bf16 a[0:15], v[32:35], v[48:51], a[0:15]
ds_read_b64_tr_b16 v[60:61], v11 offset:0
ds_read_b64_tr_b16 v[62:63], v11 offset:1024
v_mfma_f32_32x32x16_bf16 a[16:31], v[32:35], v[52:55], a[16:31]
ds_read_b64_tr_b16 v[64:65], v12 offset:0
ds_read_b64_tr_b16 v[66:67], v12 offset:1024
v_mfma_f32_32x32x16_bf16 a[32:47], v[32:35], v[56:59], a[32:47]
ds_read_b64_tr_b16 v[68:69], v13 offset:0
ds_read_b64_tr_b16 v[70:71], v13 offset:1024
v_mfma_f32_32x32x16_bf16 a[48:63], v[36:39], v[48:51], a[48:63]
ds_read_b64_tr_b16 v[72:73], v14 offset:0
ds_read_b64_tr_b16 v[74:75], v14 offset:1024
v_mfma_f32_32x32x16_bf16 a[64:79], v[36:39], v[52:55], a[64:79]
ds_read_b64_tr_b16 v[76:77], v15 offset:4096
ds_read_b64_tr_b16 v[78:79], v15 offset:4864
v_mfma_f32_32x32x16_bf16 a[80:95], v[36:39], v[56:59], a[80:95]
ds_read_b64_tr_b16 v[80:81], v15 offset:4160
ds_read_b64_tr_b16 v[82:83], v15 offset:4928
v_mfma_f32_32x32x16_bf16 a[96:111], v[40:43], v[48:51], a[96:111]
ds_read_b64_tr_b16 v[84:85], v15 offset:4224
ds_read_b64_tr_b16 v[86:87], v15 offset:4992
v_mfma_f32_32x32x16_bf16 a[112:127], v[40:43], v[52:55], a[112:127]
s_add_u32 m0, s42, 28672
s_nop 0
buffer_load_dwordx4 v4, s[8:11], s43 offen offset:0 lds
buffer_load_dwordx4 v5, s[8:11], s43 offen offset:1024 lds
v_mfma_f32_32x32x16_bf16 a[128:143], v[40:43], v[56:59], a[128:143]
buffer_load_dwordx4 v6, s[8:11], s43 offen offset:2048 lds
buffer_load_dwordx4 v7, s[8:11], s43 offen offset:3072 lds
v_mfma_f32_32x32x16_bf16 a[144:159], v[44:47], v[48:51], a[144:159]
s_add_u32 m0, s42, 32768
s_nop 0
buffer_load_dwordx4 v8, s[12:15], s44 offen offset:0 lds
v_mfma_f32_32x32x16_bf16 a[160:175], v[44:47], v[52:55], a[160:175]
buffer_load_dwordx4 v9, s[12:15], s44 offen offset:1024 lds
buffer_load_dwordx4 v10, s[12:15], s44 offen offset:2048 lds
v_mfma_f32_32x32x16_bf16 a[176:191], v[44:47], v[56:59], a[176:191]
s_add_u32 s43, s43, 589824
s_add_u32 s44, s44, 12288
s_waitcnt lgkmcnt(0)
s_waitcnt vmcnt(21)
v_mfma_f32_32x32x16_bf16 a[0:15], v[60:63], v[76:79], a[0:15]
ds_read_b64_tr_b16 v[32:33], v11 offset:7168
ds_read_b64_tr_b16 v[34:35], v11 offset:8192
v_mfma_f32_32x32x16_bf16 a[16:31], v[60:63], v[80:83], a[16:31]
ds_read_b64_tr_b16 v[36:37], v12 offset:7168
ds_read_b64_tr_b16 v[38:39], v12 offset:8192
v_mfma_f32_32x32x16_bf16 a[32:47], v[60:63], v[84:87], a[32:47]
ds_read_b64_tr_b16 v[40:41], v13 offset:7168
ds_read_b64_tr_b16 v[42:43], v13 offset:8192
v_mfma_f32_32x32x16_bf16 a[48:63], v[64:67], v[76:79], a[48:63]
ds_read_b64_tr_b16 v[44:45], v14 offset:7168
ds_read_b64_tr_b16 v[46:47], v14 offset:8192
v_mfma_f32_32x32x16_bf16 a[64:79], v[64:67], v[80:83], a[64:79]
ds_read_b64_tr_b16 v[48:49], v15 offset:11264
ds_read_b64_tr_b16 v[50:51], v15 offset:12032
v_mfma_f32_32x32x16_bf16 a[80:95], v[64:67], v[84:87], a[80:95]
ds_read_b64_tr_b16 v[52:53], v15 offset:11328
ds_read_b64_tr_b16 v[54:55], v15 offset:12096
v_mfma_f32_32x32x16_bf16 a[96:111], v[68:71], v[76:79], a[96:111]
ds_read_b64_tr_b16 v[56:57], v15 offset:11392
ds_read_b64_tr_b16 v[58:59], v15 offset:12160
v_mfma_f32_32x32x16_bf16 a[112:127], v[68:71], v[80:83], a[112:127]
s_add_u32 m0, s42, 0
s_nop 0
buffer_load_dwordx4 v4, s[8:11], s43 offen offset:0 lds
buffer_load_dwordx4 v5, s[8:11], s43 offen offset:1024 lds
v_mfma_f32_32x32x16_bf16 a[128:143], v[68:71], v[84:87], a[128:143]
buffer_load_dwordx4 v6, s[8:11], s43 offen offset:2048 lds
buffer_load_dwordx4 v7, s[8:11], s43 offen offset:3072 lds
v_mfma_f32_32x32x16_bf16 a[144:159], v[72:75], v[76:79], a[144:159]
s_add_u32 m0, s42, 4096
s_nop 0
buffer_load_dwordx4 v8, s[12:15], s44 offen offset:0 lds
v_mfma_f32_32x32x16_bf16 a[160:175], v[72:75], v[80:83], a[160:175]
buffer_load_dwordx4 v9, s[12:15], s44 offen offset:1024 lds
buffer_load_dwordx4 v10, s[12:15], s44 offen offset:2048 lds
v_mfma_f32_32x32x16_bf16 a[176:191], v[72:75], v[84:87], a[176:191]
s_add_u32 s43, s43, 589824
s_add_u32 s44, s44, 12288
s_waitcnt lgkmcnt(0)
s_waitcnt vmcnt(21)
v_mfma_f32_32x32x16_bf16 a[0:15], v[32:35], v[48:51], a[0:15]
ds_read_b64_tr_b16 v[60:61], v11 offset:14336
ds_read_b64_tr_b16 v[62:63], v11 offset:15360
v_mfma_f32_32x32x16_bf16 a[16:31], v[32:35], v[52:55], a[16:31]
ds_read_b64_tr_b16 v[64:65], v12 offset:14336
ds_read_b64_tr_b16 v[66:67], v12 offset:15360
v_mfma_f32_32x32x16_bf16 a[32:47], v[32:35], v[56:59], a[32:47]
ds_read_b64_tr_b16 v[68:69], v13 offset:14336
ds_read_b64_tr_b16 v[70:71], v13 offset:15360
v_mfma_f32_32x32x16_bf16 a[48:63], v[36:39], v[48:51], a[48:63]
ds_read_b64_tr_b16 v[72:73], v14 offset:14336
ds_read_b64_tr_b16 v[74:75], v14 offset:15360
v_mfma_f32_32x32x16_bf16 a[64:79], v[36:39], v[52:55], a[64:79]
ds_read_b64_tr_b16 v[76:77], v15 offset:18432
ds_read_b64_tr_b16 v[78:79], v15 offset:19200
v_mfma_f32_32x32x16_bf16 a[80:95], v[36:39], v[56:59], a[80:95]
ds_read_b64_tr_b16 v[80:81], v15 offset:18496
ds_read_b64_tr_b16 v[82:83], v15 offset:19264
v_mfma_f32_32x32x16_bf16 a[96:111], v[40:43], v[48:51], a[96:111]
ds_read_b64_tr_b16 v[84:85], v15 offset:18560
ds_read_b64_tr_b16 v[86:87], v15 offset:19328
v_mfma_f32_32x32x16_bf16 a[112:127], v[40:43], v[52:55], a[112:127]
s_add_u32 m0, s42, 7168
s_nop 0
buffer_load_dwordx4 v4, s[8:11], s43 offen offset:0 lds
buffer_load_dwordx4 v5, s[8:11], s43 offen offset:1024 lds
v_mfma_f32_32x32x16_bf16 a[128:143], v[40:43], v[56:59], a[128:143]
buffer_load_dwordx4 v6, s[8:11], s43 offen offset:2048 lds
buffer_load_dwordx4 v7, s[8:11], s43 offen offset:3072 lds
v_mfma_f32_32x32x16_bf16 a[144:159], v[44:47], v[48:51], a[144:159]
s_add_u32 m0, s42, 11264
s_nop 0
buffer_load_dwordx4 v8, s[12:15], s44 offen offset:0 lds
v_mfma_f32_32x32x16_bf16 a[160:175], v[44:47], v[52:55], a[160:175]
buffer_load_dwordx4 v9, s[12:15], s44 offen offset:1024 lds
buffer_load_dwordx4 v10, s[12:15], s44 offen offset:2048 lds
v_mfma_f32_32x32x16_bf16 a[176:191], v[44:47], v[56:59], a[176:191]
s_add_u32 s43, s43, 589824
s_add_u32 s44, s44, 12288
s_waitcnt lgkmcnt(0)
s_waitcnt vmcnt(21)
v_mfma_f32_32x32x16_bf16 a[0:15], v[60:63], v[76:79], a[0:15]
ds_read_b64_tr_b16 v[32:33], v11 offset:21504
ds_read_b64_tr_b16 v[34:35], v11 offset:22528
v_mfma_f32_32x32x16_bf16 a[16:31], v[60:63], v[80:83], a[16:31]
ds_read_b64_tr_b16 v[36:37], v12 offset:21504
ds_read_b64_tr_b16 v[38:39], v12 offset:22528
v_mfma_f32_32x32x16_bf16 a[32:47], v[60:63], v[84:87], a[32:47]
ds_read_b64_tr_b16 v[40:41], v13 offset:21504
v_mfma_f32_32x32x16_bf16 a[48:63], v[64:67], v[76:79], a[48:63]
ds_read_b64_tr_b16 v[42:43], v13 offset:22528
ds_read_b64_tr_b16 v[44:45], v14 offset:21504
v_mfma_f32_32x32x16_bf16 a[64:79], v[64:67], v[80:83], a[64:79]
ds_read_b64_tr_b16 v[46:47], v14 offset:22528
v_mfma_f32_32x32x16_bf16 a[80:95], v[64:67], v[84:87], a[80:95]
ds_read_b64_tr_b16 v[48:49], v15 offset:25600
ds_read_b64_tr_b16 v[50:51], v15 offset:26368
v_mfma_f32_32x32x16_bf16 a[96:111], v[68:71], v[76:79], a[96:111]
ds_read_b64_tr_b16 v[52:53], v15 offset:25664
v_mfma_f32_32x32x16_bf16 a[112:127], v[68:71], v[80:83], a[112:127]
ds_read_b64_tr_b16 v[54:55], v15 offset:26432
ds_read_b64_tr_b16 v[56:57], v15 offset:25728
v_mfma_f32_32x32x16_bf16 a[128:143], v[68:71], v[84:87], a[128:143]
ds_read_b64_tr_b16 v[58:59], v15 offset:26496
v_mfma_f32_32x32x16_bf16 a[144:159], v[72:75], v[76:79], a[144:159]
v_mfma_f32_32x32x16_bf16 a[160:175], v[72:75], v[80:83], a[160:175]
v_mfma_f32_32x32x16_bf16 a[176:191], v[72:75], v[84:87], a[176:191]
s_waitcnt lgkmcnt(0)
s_waitcnt vmcnt(14)
v_mfma_f32_32x32x16_bf16 a[0:15], v[32:35], v[48:51], a[0:15]
ds_read_b64_tr_b16 v[60:61], v11 offset:28672
ds_read_b64_tr_b16 v[62:63], v11 offset:29696
v_mfma_f32_32x32x16_bf16 a[16:31], v[32:35], v[52:55], a[16:31]
ds_read_b64_tr_b16 v[64:65], v12 offset:28672
ds_read_b64_tr_b16 v[66:67], v12 offset:29696
v_mfma_f32_32x32x16_bf16 a[32:47], v[32:35], v[56:59], a[32:47]
ds_read_b64_tr_b16 v[68:69], v13 offset:28672
v_mfma_f32_32x32x16_bf16 a[48:63], v[36:39], v[48:51], a[48:63]
ds_read_b64_tr_b16 v[70:71], v13 offset:29696
ds_read_b64_tr_b16 v[72:73], v14 offset:28672
v_mfma_f32_32x32x16_bf16 a[64:79], v[36:39], v[52:55], a[64:79]
ds_read_b64_tr_b16 v[74:75], v14 offset:29696
v_mfma_f32_32x32x16_bf16 a[80:95], v[36:39], v[56:59], a[80:95]
ds_read_b64_tr_b16 v[76:77], v15 offset:32768
ds_read_b64_tr_b16 v[78:79], v15 offset:33536
v_mfma_f32_32x32x16_bf16 a[96:111], v[40:43], v[48:51], a[96:111]
ds_read_b64_tr_b16 v[80:81], v15 offset:32832
v_mfma_f32_32x32x16_bf16 a[112:127], v[40:43], v[52:55], a[112:127]
ds_read_b64_tr_b16 v[82:83], v15 offset:33600
ds_read_b64_tr_b16 v[84:85], v15 offset:32896
v_mfma_f32_32x32x16_bf16 a[128:143], v[40:43], v[56:59], a[128:143]
ds_read_b64_tr_b16 v[86:87], v15 offset:33664
v_mfma_f32_32x32x16_bf16 a[144:159], v[44:47], v[48:51], a[144:159]
v_mfma_f32_32x32x16_bf16 a[160:175], v[44:47], v[52:55], a[160:175]
v_mfma_f32_32x32x16_bf16 a[176:191], v[44:47], v[56:59], a[176:191]
s_waitcnt lgkmcnt(0)
s_waitcnt vmcnt(7)
v_mfma_f32_32x32x16_bf16 a[0:15], v[60:63], v[76:79], a[0:15]
ds_read_b64_tr_b16 v[32:33], v11 offset:0
ds_read_b64_tr_b16 v[34:35], v11 offset:1024
v_mfma_f32_32x32x16_bf16 a[16:31], v[60:63], v[80:83], a[16:31]
ds_read_b64_tr_b16 v[36:37], v12 offset:0
ds_read_b64_tr_b16 v[38:39], v12 offset:1024
v_mfma_f32_32x32x16_bf16 a[32:47], v[60:63], v[84:87], a[32:47]
ds_read_b64_tr_b16 v[40:41], v13 offset:0
v_mfma_f32_32x32x16_bf16 a[48:63], v[64:67], v[76:79], a[48:63]
ds_read_b64_tr_b16 v[42:43], v13 offset:1024
ds_read_b64_tr_b16 v[44:45], v14 offset:0
v_mfma_f32_32x32x16_bf16 a[64:79], v[64:67], v[80:83], a[64:79]
ds_read_b64_tr_b16 v[46:47], v14 offset:1024
v_mfma_f32_32x32x16_bf16 a[80:95], v[64:67], v[84:87], a[80:95]
ds_read_b64_tr_b16 v[48:49], v15 offset:4096
ds_read_b64_tr_b16 v[50:51], v15 offset:4864
v_mfma_f32_32x32x16_bf16 a[96:111], v[68:71], v[76:79], a[96:111]
ds_read_b64_tr_b16 v[52:53], v15 offset:4160
v_mfma_f32_32x32x16_bf16 a[112:127], v[68:71], v[80:83], a[112:127]
ds_read_b64_tr_b16 v[54:55], v15 offset:4928
ds_read_b64_tr_b16 v[56:57], v15 offset:4224
v_mfma_f32_32x32x16_bf16 a[128:143], v[68:71], v[84:87], a[128:143]
ds_read_b64_tr_b16 v[58:59], v15 offset:4992
v_mfma_f32_32x32x16_bf16 a[144:159], v[72:75], v[76:79], a[144:159]
v_mfma_f32_32x32x16_bf16 a[160:175], v[72:75], v[80:83], a[160:175]
v_mfma_f32_32x32x16_bf16 a[176:191], v[72:75], v[84:87], a[176:191]
s_waitcnt lgkmcnt(0)
s_waitcnt vmcnt(0)
v_mfma_f32_32x32x16_bf16 a[0:15], v[32:35], v[48:51], a[0:15]
ds_read_b64_tr_b16 v[60:61], v11 offset:7168
ds_read_b64_tr_b16 v[62:63], v11 offset:8192
v_mfma_f32_32x32x16_bf16 a[16:31], v[32:35], v[52:55], a[16:31]
ds_read_b64_tr_b16 v[64:65], v12 offset:7168
ds_read_b64_tr_b16 v[66:67], v12 offset:8192
v_mfma_f32_32x32x16_bf16 a[32:47], v[32:35], v[56:59], a[32:47]
ds_read_b64_tr_b16 v[68:69], v13 offset:7168
v_mfma_f32_32x32x16_bf16 a[48:63], v[36:39], v[48:51], a[48:63]
ds_read_b64_tr_b16 v[70:71], v13 offset:8192
ds_read_b64_tr_b16 v[72:73], v14 offset:7168
v_mfma_f32_32x32x16_bf16 a[64:79], v[36:39], v[52:55], a[64:79]
ds_read_b64_tr_b16 v[74:75], v14 offset:8192
v_mfma_f32_32x32x16_bf16 a[80:95], v[36:39], v[56:59], a[80:95]
ds_read_b64_tr_b16 v[76:77], v15 offset:11264
ds_read_b64_tr_b16 v[78:79], v15 offset:12032
v_mfma_f32_32x32x16_bf16 a[96:111], v[40:43], v[48:51], a[96:111]
ds_read_b64_tr_b16 v[80:81], v15 offset:11328
v_mfma_f32_32x32x16_bf16 a[112:127], v[40:43], v[52:55], a[112:127]
ds_read_b64_tr_b16 v[82:83], v15 offset:12096
ds_read_b64_tr_b16 v[84:85], v15 offset:11392
v_mfma_f32_32x32x16_bf16 a[128:143], v[40:43], v[56:59], a[128:143]
ds_read_b64_tr_b16 v[86:87], v15 offset:12160
v_mfma_f32_32x32x16_bf16 a[144:159], v[44:47], v[48:51], a[144:159]
v_mfma_f32_32x32x16_bf16 a[160:175], v[44:47], v[52:55], a[160:175]
v_mfma_f32_32x32x16_bf16 a[176:191], v[44:47], v[56:59], a[176:191]
s_waitcnt lgkmcnt(0)
v_mfma_f32_32x32x16_bf16 a[0:15], v[60:63], v[76:79], a[0:15]
v_mfma_f32_32x32x16_bf16 a[16:31], v[60:63], v[80:83], a[16:31]
v_mfma_f32_32x32x16_bf16 a[32:47], v[60:63], v[84:87], a[32:47]
v_mfma_f32_32x32x16_bf16 a[48:63], v[64:67], v[76:79], a[48:63]
v_mfma_f32_32x32x16_bf16 a[64:79], v[64:67], v[80:83], a[64:79]
v_mfma_f32_32x32x16_bf16 a[80:95], v[64:67], v[84:87], a[80:95]
v_mfma_f32_32x32x16_bf16 a[96:111], v[68:71], v[76:79], a[96:111]
v_mfma_f32_32x32x16_bf16 a[112:127], v[68:71], v[80:83], a[112:127]
v_mfma_f32_32x32x16_bf16 a[128:143], v[68:71], v[84:87], a[128:143]
v_mfma_f32_32x32x16_bf16 a[144:159], v[72:75], v[76:79], a[144:159]
v_mfma_f32_32x32x16_bf16 a[160:175], v[72:75], v[80:83], a[160:175]
v_mfma_f32_32x32x16_bf16 a[176:191], v[72:75], v[84:87], a[176:191]
s_nop 7
s_nop 7
s_lshl_b32 s6, s36, 8
s_lshl_b32 s5, s3, 6
s_add_u32 s6, s6, s5
v_lshrrev_b32 v3, 5, v0
v_lshlrev_b32 v3, 3, v3
buffer_load_dwordx2 v[8:9], v3, s[16:19], s6 offen offset:0
buffer_load_dwordx2 v[10:11], v3, s[16:19], s6 offen offset:16
buffer_load_dwordx2 v[12:13], v3, s[16:19], s6 offen offset:32
buffer_load_dwordx2 v[14:15], v3, s[16:19], s6 offen offset:48
v_lshlrev_b32 v1, 4, v0
s_mul_i32 s5, s3, 36864
v_add_u32 v2, s5, v1
s_mov_b32 s7, 0xc0135761
s_mul_i32 s5, s37, 884736
s_lshl_b32 s6, s36, 13
s_add_u32 s5, s5, s6
s_lshl_b32 s6, s3, 11
s_add_u32 s5, s5, s6
v_add_u32 v4, 65536, v1
v_add_u32 v5, 131072, v1
s_barrier
s_cmp_eq_u32 s3, 0
s_cbranch_scc0 w1_e1
ds_write_b128 v1, a[48:51] offset:61440
ds_write_b128 v1, a[52:55] offset:62464
ds_write_b128 v1, a[56:59] offset:63488
ds_write_b128 v1, a[60:63] offset:64512
ds_write_b128 v4, a[64:67] offset:0
ds_write_b128 v4, a[68:71] offset:1024
ds_write_b128 v4, a[72:75] offset:2048
ds_write_b128 v4, a[76:79] offset:3072
ds_write_b128 v4, a[80:83] offset:4096
ds_write_b128 v4, a[84:87] offset:5120
ds_write_b128 v4, a[88:91] offset:6144
ds_write_b128 v4, a[92:95] offset:7168
ds_write_b128 v4, a[96:99] offset:20480
ds_write_b128 v4, a[100:103] offset:21504
ds_write_b128 v4, a[104:107] offset:22528
ds_write_b128 v4, a[108:111] offset:23552
ds_write_b128 v4, a[112:115] offset:24576
ds_write_b128 v4, a[116:119] offset:25600
ds_write_b128 v4, a[120:123] offset:26624
ds_write_b128 v4, a[124:127] offset:27648
ds_write_b128 v4, a[128:131] offset:28672
ds_write_b128 v4, a[132:135] offset:29696
ds_write_b128 v4, a[136:139] offset:30720
ds_write_b128 v4, a[140:143] offset:31744
ds_write_b128 v4, a[144:147] offset:45056
ds_write_b128 v4, a[148:151] offset:46080
ds_write_b128 v4, a[152:155] offset:47104
ds_write_b128 v4, a[156:159] offset:48128
ds_write_b128 v4, a[160:163] offset:49152
ds_write_b128 v4, a[164:167] offset:50176
ds_write_b128 v4, a[168:171] offset:51200
ds_write_b128 v4, a[172:175] offset:52224
ds_write_b128 v4, a[176:179] offset:53248
ds_write_b128 v4, a[180:183] offset:54272
ds_write_b128 v4, a[184:187] offset:55296
ds_write_b128 v4, a[188:191] offset:56320
v_accvgpr_read_b32 v32, a0
v_accvgpr_read_b32 v33, a1
v_accvgpr_read_b32 v34, a2
v_accvgpr_read_b32 v35, a3
v_accvgpr_read_b32 v36, a4
v_accvgpr_read_b32 v37, a5
v_accvgpr_read_b32 v38, a6
v_accvgpr_read_b32 v39, a7
v_accvgpr_read_b32 v40, a8
v_accvgpr_read_b32 v41, a9
v_accvgpr_read_b32 v42, a10
v_accvgpr_read_b32 v43, a11
v_accvgpr_read_b32 v44, a12
v_accvgpr_read_b32 v45, a13
v_accvgpr_read_b32 v46, a14
v_accvgpr_read_b32 v47, a15
v_accvgpr_read_b32 v48, a16
v_accvgpr_read_b32 v49, a17
v_accvgpr_read_b32 v50, a18
v_accvgpr_read_b32 v51, a19
v_accvgpr_read_b32 v52, a20
v_accvgpr_read_b32 v53, a21
v_accvgpr_read_b32 v54, a22
v_accvgpr_read_b32 v55, a23
v_accvgpr_read_b32 v56, a24
v_accvgpr_read_b32 v57, a25
v_accvgpr_read_b32 v58, a26
v_accvgpr_read_b32 v59, a27
v_accvgpr_read_b32 v60, a28
v_accvgpr_read_b32 v61, a29
v_accvgpr_read_b32 v62, a30
v_accvgpr_read_b32 v63, a31
v_accvgpr_read_b32 v64, a32
v_accvgpr_read_b32 v65, a33
v_accvgpr_read_b32 v66, a34
v_accvgpr_read_b32 v67, a35
v_accvgpr_read_b32 v68, a36
v_accvgpr_read_b32 v69, a37
v_accvgpr_read_b32 v70, a38
v_accvgpr_read_b32 v71, a39
v_accvgpr_read_b32 v72, a40
v_accvgpr_read_b32 v73, a41
v_accvgpr_read_b32 v74, a42
v_accvgpr_read_b32 v75, a43
v_accvgpr_read_b32 v76, a44
v_accvgpr_read_b32 v77, a45
v_accvgpr_read_b32 v78, a46
v_accvgpr_read_b32 v79, a47
s_branch w1_e
w1_e1:
s_cmp_eq_u32 s3, 1
s_cbranch_scc0 w1_e2
ds_write_b128 v1, a[0:3] offset:0
ds_write_b128 v1, a[4:7] offset:1024
ds_write_b128 v1, a[8:11] offset:2048
ds_write_b128 v1, a[12:15] offset:3072
ds_write_b128 v1, a[16:19] offset:4096
ds_write_b128 v1, a[20:23] offset:5120
ds_write_b128 v1, a[24:27] offset:6144
ds_write_b128 v1, a[28:31] offset:7168
ds_write_b128 v1, a[32:35] offset:8192
ds_write_b128 v1, a[36:39] offset:9216
ds_write_b128 v1, a[40:43] offset:10240
ds_write_b128 v1, a[44:47] offset:11264
ds_write_b128 v4, a[96:99] offset:32768
ds_write_b128 v4, a[100:103] offset:33792
ds_write_b128 v4, a[104:107] offset:34816
ds_write_b128 v4, a[108:111] offset:35840
ds_write_b128 v4, a[112:115] offset:36864
ds_write_b128 v4, a[116:119] offset:37888
ds_write_b128 v4, a[120:123] offset:38912
ds_write_b128 v4, a[124:127] offset:39936
ds_write_b128 v4, a[128:131] offset:40960
ds_write_b128 v4, a[132:135] offset:41984
ds_write_b128 v4, a[136:139] offset:43008
ds_write_b128 v4, a[140:143] offset:44032
ds_write_b128 v4, a[144:147] offset:57344
ds_write_b128 v4, a[148:151] offset:58368
ds_write_b128 v4, a[152:155] offset:59392
ds_write_b128 v4, a[156:159] offset:60416
ds_write_b128 v4, a[160:163] offset:61440
ds_write_b128 v4, a[164:167] offset:62464
ds_write_b128 v4, a[168:171] offset:63488
ds_write_b128 v4, a[172:175] offset:64512
ds_write_b128 v5, a[176:179] offset:0
ds_write_b128 v5, a[180:183] offset:1024
ds_write_b128 v5, a[184:187] offset:2048
ds_write_b128 v5, a[188:191] offset:3072
v_accvgpr_read_b32 v32, a48
v_accvgpr_read_b32 v33, a49
v_accvgpr_read_b32 v34, a50
v_accvgpr_read_b32 v35, a51
v_accvgpr_read_b32 v36, a52
v_accvgpr_read_b32 v37, a53
v_accvgpr_read_b32 v38, a54
v_accvgpr_read_b32 v39, a55
v_accvgpr_read_b32 v40, a56
v_accvgpr_read_b32 v41, a57
v_accvgpr_read_b32 v42, a58
v_accvgpr_read_b32 v43, a59
v_accvgpr_read_b32 v44, a60
v_accvgpr_read_b32 v45, a61
v_accvgpr_read_b32 v46, a62
v_accvgpr_read_b32 v47, a63
v_accvgpr_read_b32 v48, a64
v_accvgpr_read_b32 v49, a65
v_accvgpr_read_b32 v50, a66
v_accvgpr_read_b32 v51, a67
v_accvgpr_read_b32 v52, a68
v_accvgpr_read_b32 v53, a69
v_accvgpr_read_b32 v54, a70
v_accvgpr_read_b32 v55, a71
v_accvgpr_read_b32 v56, a72
v_accvgpr_read_b32 v57, a73
v_accvgpr_read_b32 v58, a74
v_accvgpr_read_b32 v59, a75
v_accvgpr_read_b32 v60, a76
v_accvgpr_read_b32 v61, a77
v_accvgpr_read_b32 v62, a78
v_accvgpr_read_b32 v63, a79
v_accvgpr_read_b32 v64, a80
v_accvgpr_read_b32 v65, a81
v_accvgpr_read_b32 v66, a82
v_accvgpr_read_b32 v67, a83
v_accvgpr_read_b32 v68, a84
v_accvgpr_read_b32 v69, a85
v_accvgpr_read_b32 v70, a86
v_accvgpr_read_b32 v71, a87
v_accvgpr_read_b32 v72, a88
v_accvgpr_read_b32 v73, a89
v_accvgpr_read_b32 v74, a90
v_accvgpr_read_b32 v75, a91
v_accvgpr_read_b32 v76, a92
v_accvgpr_read_b32 v77, a93
v_accvgpr_read_b32 v78, a94
v_accvgpr_read_b32 v79, a95
s_branch w1_e
w1_e2:
s_cmp_eq_u32 s3, 2
s_cbranch_scc0 w1_e3
ds_write_b128 v1, a[0:3] offset:12288
ds_write_b128 v1, a[4:7] offset:13312
ds_write_b128 v1, a[8:11] offset:14336
ds_write_b128 v1, a[12:15] offset:15360
ds_write_b128 v1, a[16:19] offset:16384
ds_write_b128 v1, a[20:23] offset:17408
ds_write_b128 v1, a[24:27] offset:18432
ds_write_b128 v1, a[28:31] offset:19456
ds_write_b128 v1, a[32:35] offset:20480
ds_write_b128 v1, a[36:39] offset:21504
ds_write_b128 v1, a[40:43] offset:22528
ds_write_b128 v1, a[44:47] offset:23552
ds_write_b128 v1, a[48:51] offset:36864
ds_write_b128 v1, a[52:55] offset:37888
ds_write_b128 v1, a[56:59] offset:38912
ds_write_b128 v1, a[60:63] offset:39936
ds_write_b128 v1, a[64:67] offset:40960
ds_write_b128 v1, a[68:71] offset:41984
ds_write_b128 v1, a[72:75] offset:43008
ds_write_b128 v1, a[76:79] offset:44032
ds_write_b128 v1, a[80:83] offset:45056
ds_write_b128 v1, a[84:87] offset:46080
ds_write_b128 v1, a[88:91] offset:47104
ds_write_b128 v1, a[92:95] offset:48128
ds_write_b128 v5, a[144:147] offset:4096
ds_write_b128 v5, a[148:151] offset:5120
ds_write_b128 v5, a[152:155] offset:6144
ds_write_b128 v5, a[156:159] offset:7168
ds_write_b128 v5, a[160:163] offset:8192
ds_write_b128 v5, a[164:167] offset:9216
ds_write_b128 v5, a[168:171] offset:10240
ds_write_b128 v5, a[172:175] offset:11264
ds_write_b128 v5, a[176:179] offset:12288
ds_write_b128 v5, a[180:183] offset:13312
ds_write_b128 v5, a[184:187] offset:14336
ds_write_b128 v5, a[188:191] offset:15360
v_accvgpr_read_b32 v32, a96
v_accvgpr_read_b32 v33, a97
v_accvgpr_read_b32 v34, a98
v_accvgpr_read_b32 v35, a99
v_accvgpr_read_b32 v36, a100
v_accvgpr_read_b32 v37, a101
v_accvgpr_read_b32 v38, a102
v_accvgpr_read_b32 v39, a103
v_accvgpr_read_b32 v40, a104
v_accvgpr_read_b32 v41, a105
v_accvgpr_read_b32 v42, a106
v_accvgpr_read_b32 v43, a107
v_accvgpr_read_b32 v44, a108
v_accvgpr_read_b32 v45, a109
v_accvgpr_read_b32 v46, a110
v_accvgpr_read_b32 v47, a111
v_accvgpr_read_b32 v48, a112
v_accvgpr_read_b32 v49, a113
v_accvgpr_read_b32 v50, a114
v_accvgpr_read_b32 v51, a115
v_accvgpr_read_b32 v52, a116
v_accvgpr_read_b32 v53, a117
v_accvgpr_read_b32 v54, a118
v_accvgpr_read_b32 v55, a119
v_accvgpr_read_b32 v56, a120
v_accvgpr_read_b32 v57, a121
v_accvgpr_read_b32 v58, a122
v_accvgpr_read_b32 v59, a123
v_accvgpr_read_b32 v60, a124
v_accvgpr_read_b32 v61, a125
v_accvgpr_read_b32 v62, a126
v_accvgpr_read_b32 v63, a127
v_accvgpr_read_b32 v64, a128
v_accvgpr_read_b32 v65, a129
v_accvgpr_read_b32 v66, a130
v_accvgpr_read_b32 v67, a131
v_accvgpr_read_b32 v68, a132
v_accvgpr_read_b32 v69, a133
v_accvgpr_read_b32 v70, a134
v_accvgpr_read_b32 v71, a135
v_accvgpr_read_b32 v72, a136
v_accvgpr_read_b32 v73, a137
v_accvgpr_read_b32 v74, a138
v_accvgpr_read_b32 v75, a139
v_accvgpr_read_b32 v76, a140
v_accvgpr_read_b32 v77, a141
v_accvgpr_read_b32 v78, a142
v_accvgpr_read_b32 v79, a143
s_branch w1_e
w1_e3:
ds_write_b128 v1, a[0:3] offset:24576
ds_write_b128 v1, a[4:7] offset:25600
ds_write_b128 v1, a[8:11] offset:26624
ds_write_b128 v1, a[12:15] offset:27648
ds_write_b128 v1, a[16:19] offset:28672
ds_write_b128 v1, a[20:23] offset:29696
ds_write_b128 v1, a[24:27] offset:30720
ds_write_b128 v1, a[28:31] offset:31744
ds_write_b128 v1, a[32:35] offset:32768
ds_write_b128 v1, a[36:39] offset:33792
ds_write_b128 v1, a[40:43] offset:34816
ds_write_b128 v1, a[44:47] offset:35840
ds_write_b128 v1, a[48:51] offset:49152
ds_write_b128 v1, a[52:55] offset:50176
ds_write_b128 v1, a[56:59] offset:51200
ds_write_b128 v1, a[60:63] offset:52224
ds_write_b128 v1, a[64:67] offset:53248
ds_write_b128 v1, a[68:71] offset:54272
ds_write_b128 v1, a[72:75] offset:55296
ds_write_b128 v1, a[76:79] offset:56320
ds_write_b128 v1, a[80:83] offset:57344
ds_write_b128 v1, a[84:87] offset:58368
ds_write_b128 v1, a[88:91] offset:59392
ds_write_b128 v1, a[92:95] offset:60416
ds_write_b128 v4, a[96:99] offset:8192
ds_write_b128 v4, a[100:103] offset:9216
ds_write_b128 v4, a[104:107] offset:10240
ds_write_b128 v4, a[108:111] offset:11264
ds_write_b128 v4, a[112:115] offset:12288
ds_write_b128 v4, a[116:119] offset:13312
ds_write_b128 v4, a[120:123] offset:14336
ds_write_b128 v4, a[124:127] offset:15360
ds_write_b128 v4, a[128:131] offset:16384
ds_write_b128 v4, a[132:135] offset:17408
ds_write_b128 v4, a[136:139] offset:18432
ds_write_b128 v4, a[140:143] offset:19456
v_accvgpr_read_b32 v32, a144
v_accvgpr_read_b32 v33, a145
v_accvgpr_read_b32 v34, a146
v_accvgpr_read_b32 v35, a147
v_accvgpr_read_b32 v36, a148
v_accvgpr_read_b32 v37, a149
v_accvgpr_read_b32 v38, a150
v_accvgpr_read_b32 v39, a151
v_accvgpr_read_b32 v40, a152
v_accvgpr_read_b32 v41, a153
v_accvgpr_read_b32 v42, a154
v_accvgpr_read_b32 v43, a155
v_accvgpr_read_b32 v44, a156
v_accvgpr_read_b32 v45, a157
v_accvgpr_read_b32 v46, a158
v_accvgpr_read_b32 v47, a159
v_accvgpr_read_b32 v48, a160
v_accvgpr_read_b32 v49, a161
v_accvgpr_read_b32 v50, a162
v_accvgpr_read_b32 v51, a163
v_accvgpr_read_b32 v52, a164
v_accvgpr_read_b32 v53, a165
v_accvgpr_read_b32 v54, a166
v_accvgpr_read_b32 v55, a167
v_accvgpr_read_b32 v56, a168
v_accvgpr_read_b32 v57, a169
v_accvgpr_read_b32 v58, a170
v_accvgpr_read_b32 v59, a171
v_accvgpr_read_b32 v60, a172
v_accvgpr_read_b32 v61, a173
v_accvgpr_read_b32 v62, a174
v_accvgpr_read_b32 v63, a175
v_accvgpr_read_b32 v64, a176
v_accvgpr_read_b32 v65, a177
v_accvgpr_read_b32 v66, a178
v_accvgpr_read_b32 v67, a179
v_accvgpr_read_b32 v68, a180
v_accvgpr_read_b32 v69, a181
v_accvgpr_read_b32 v70, a182
v_accvgpr_read_b32 v71, a183
v_accvgpr_read_b32 v72, a184
v_accvgpr_read_b32 v73, a185
v_accvgpr_read_b32 v74, a186
v_accvgpr_read_b32 v75, a187
v_accvgpr_read_b32 v76, a188
v_accvgpr_read_b32 v77, a189
v_accvgpr_read_b32 v78, a190
v_accvgpr_read_b32 v79, a191
w1_e:
s_waitcnt vmcnt(0) lgkmcnt(0)
s_barrier
ds_read_b128 v[80:83], v2 offset:0
ds_read_b128 v[84:87], v2 offset:1024
ds_read_b128 v[88:91], v2 offset:12288
ds_read_b128 v[92:95], v2 offset:13312
ds_read_b128 v[96:99], v2 offset:24576
ds_read_b128 v[100:103], v2 offset:25600
v_lshlrev_b32 v16, 16, v8
v_and_b32 v17, 0xffff0000, v8
v_lshlrev_b32 v18, 16, v9
v_and_b32 v19, 0xffff0000, v9
v_lshlrev_b32 v20, 16, v10
v_and_b32 v21, 0xffff0000, v10
v_lshlrev_b32 v22, 16, v11
v_and_b32 v23, 0xffff0000, v11
v_lshlrev_b32 v24, 16, v12
v_and_b32 v25, 0xffff0000, v12
v_lshlrev_b32 v26, 16, v13
v_and_b32 v27, 0xffff0000, v13
v_lshlrev_b32 v28, 16, v14
v_and_b32 v29, 0xffff0000, v14
v_lshlrev_b32 v30, 16, v15
v_and_b32 v31, 0xffff0000, v15
ds_read_b128 v[104:107], v2 offset:2048
ds_read_b128 v[108:111], v2 offset:3072
ds_read_b128 v[112:115], v2 offset:14336
ds_read_b128 v[116:119], v2 offset:15360
ds_read_b128 v[120:123], v2 offset:26624
ds_read_b128 v[124:127], v2 offset:27648
ds_read_b128 v[128:131], v2 offset:4096
ds_read_b128 v[132:135], v2 offset:5120
ds_read_b128 v[136:139], v2 offset:16384
ds_read_b128 v[140:143], v2 offset:17408
ds_read_b128 v[144:147], v2 offset:28672
ds_read_b128 v[148:151], v2 offset:29696
ds_read_b128 v[152:155], v2 offset:6144
ds_read_b128 v[156:159], v2 offset:7168
ds_read_b128 v[160:163], v2 offset:18432
ds_read_b128 v[164:167], v2 offset:19456
ds_read_b128 v[168:171], v2 offset:30720
ds_read_b128 v[172:175], v2 offset:31744
ds_read_b128 v[176:179], v2 offset:8192
ds_read_b128 v[180:183], v2 offset:9216
ds_read_b128 v[184:187], v2 offset:20480
ds_read_b128 v[188:191], v2 offset:21504
ds_read_b128 v[192:195], v2 offset:32768
ds_read_b128 v[196:199], v2 offset:33792
ds_read_b128 v[200:203], v2 offset:10240
ds_read_b128 v[204:207], v2 offset:11264
ds_read_b128 v[208:211], v2 offset:22528
ds_read_b128 v[212:215], v2 offset:23552
ds_read_b128 v[216:219], v2 offset:34816
ds_read_b128 v[220:223], v2 offset:35840
s_waitcnt lgkmcnt(15)
v_add_f32 v32, v32, v80
v_add_f32 v88, v88, v96
v_add_f32 v33, v33, v81
v_add_f32 v89, v89, v97
v_add_f32 v34, v34, v82
v_add_f32 v90, v90, v98
v_add_f32 v35, v35, v83
v_add_f32 v91, v91, v99
v_add_f32 v36, v36, v84
v_add_f32 v92, v92, v100
v_add_f32 v37, v37, v85
v_add_f32 v93, v93, v101
v_add_f32 v38, v38, v86
v_add_f32 v94, v94, v102
v_add_f32 v39, v39, v87
v_add_f32 v95, v95, v103
v_add_f32 v32, v32, v88
v_add_f32 v33, v33, v89
v_add_f32 v34, v34, v90
v_add_f32 v35, v35, v91
v_add_f32 v36, v36, v92
v_add_f32 v37, v37, v93
v_add_f32 v38, v38, v94
v_add_f32 v39, v39, v95
v_cvt_pk_bf16_f32 v80, v32, v33
v_cvt_pk_bf16_f32 v81, v34, v35
v_cvt_pk_bf16_f32 v82, v36, v37
v_cvt_pk_bf16_f32 v83, v38, v39
v_lshlrev_b32 v32, 16, v80
v_and_b32 v33, 0xffff0000, v80
v_lshlrev_b32 v34, 16, v81
v_and_b32 v35, 0xffff0000, v81
v_lshlrev_b32 v36, 16, v82
v_and_b32 v37, 0xffff0000, v82
v_lshlrev_b32 v38, 16, v83
v_and_b32 v39, 0xffff0000, v83
v_add_f32 v32, v32, v16
v_add_f32 v33, v33, v17
v_add_f32 v34, v34, v18
v_add_f32 v35, v35, v19
v_add_f32 v36, v36, v20
v_add_f32 v37, v37, v21
v_add_f32 v38, v38, v22
v_add_f32 v39, v39, v23
v_mul_f32 v80, v32, v32
v_mul_f32 v81, v33, v33
v_mul_f32 v82, v34, v34
v_mul_f32 v83, v35, v35
v_mul_f32 v84, v36, v36
v_mul_f32 v85, v37, v37
v_mul_f32 v86, v38, v38
v_mul_f32 v87, v39, v39
v_mul_f32 v80, 0xbdd2d3e8, v80
v_mul_f32 v81, 0xbdd2d3e8, v81
v_mul_f32 v82, 0xbdd2d3e8, v82
v_mul_f32 v83, 0xbdd2d3e8, v83
v_mul_f32 v84, 0xbdd2d3e8, v84
v_mul_f32 v85, 0xbdd2d3e8, v85
v_mul_f32 v86, 0xbdd2d3e8, v86
v_mul_f32 v87, 0xbdd2d3e8, v87
v_add_f32 v80, s7, v80
v_add_f32 v81, s7, v81
v_add_f32 v82, s7, v82
v_add_f32 v83, s7, v83
v_add_f32 v84, s7, v84
v_add_f32 v85, s7, v85
v_add_f32 v86, s7, v86
v_add_f32 v87, s7, v87
v_mul_f32 v80, v80, v32
v_mul_f32 v81, v81, v33
v_mul_f32 v82, v82, v34
v_mul_f32 v83, v83, v35
v_mul_f32 v84, v84, v36
v_mul_f32 v85, v85, v37
v_mul_f32 v86, v86, v38
v_mul_f32 v87, v87, v39
v_exp_f32 v80, v80
v_exp_f32 v81, v81
v_exp_f32 v82, v82
v_exp_f32 v83, v83
v_exp_f32 v84, v84
v_exp_f32 v85, v85
v_exp_f32 v86, v86
v_exp_f32 v87, v87
v_add_f32 v80, 1.0, v80
v_add_f32 v81, 1.0, v81
v_add_f32 v82, 1.0, v82
v_add_f32 v83, 1.0, v83
v_add_f32 v84, 1.0, v84
v_add_f32 v85, 1.0, v85
v_add_f32 v86, 1.0, v86
v_add_f32 v87, 1.0, v87
v_rcp_f32 v80, v80
v_rcp_f32 v81, v81
v_rcp_f32 v82, v82
v_rcp_f32 v83, v83
v_rcp_f32 v84, v84
v_rcp_f32 v85, v85
v_rcp_f32 v86, v86
v_rcp_f32 v87, v87
v_mul_f32 v32, v32, v80
v_mul_f32 v33, v33, v81
v_mul_f32 v34, v34, v82
v_mul_f32 v35, v35, v83
v_mul_f32 v36, v36, v84
v_mul_f32 v37, v37, v85
v_mul_f32 v38, v38, v86
v_mul_f32 v39, v39, v87
v_cvt_pk_bf16_f32 v80, v32, v33
v_cvt_pk_bf16_f32 v81, v34, v35
v_cvt_pk_bf16_f32 v82, v36, v37
v_cvt_pk_bf16_f32 v83, v38, v39
buffer_store_dwordx4 v[80:83], v1, s[20:23], s5 offen offset:0 sc0 sc1
s_waitcnt lgkmcnt(15)
v_add_f32 v40, v40, v104
v_add_f32 v112, v112, v120
v_add_f32 v41, v41, v105
v_add_f32 v113, v113, v121
v_add_f32 v42, v42, v106
v_add_f32 v114, v114, v122
v_add_f32 v43, v43, v107
v_add_f32 v115, v115, v123
v_add_f32 v44, v44, v108
v_add_f32 v116, v116, v124
v_add_f32 v45, v45, v109
v_add_f32 v117, v117, v125
v_add_f32 v46, v46, v110
v_add_f32 v118, v118, v126
v_add_f32 v47, v47, v111
v_add_f32 v119, v119, v127
v_add_f32 v40, v40, v112
v_add_f32 v41, v41, v113
v_add_f32 v42, v42, v114
v_add_f32 v43, v43, v115
v_add_f32 v44, v44, v116
v_add_f32 v45, v45, v117
v_add_f32 v46, v46, v118
v_add_f32 v47, v47, v119
v_cvt_pk_bf16_f32 v104, v40, v41
v_cvt_pk_bf16_f32 v105, v42, v43
v_cvt_pk_bf16_f32 v106, v44, v45
v_cvt_pk_bf16_f32 v107, v46, v47
v_lshlrev_b32 v40, 16, v104
v_and_b32 v41, 0xffff0000, v104
v_lshlrev_b32 v42, 16, v105
v_and_b32 v43, 0xffff0000, v105
v_lshlrev_b32 v44, 16, v106
v_and_b32 v45, 0xffff0000, v106
v_lshlrev_b32 v46, 16, v107
v_and_b32 v47, 0xffff0000, v107
v_add_f32 v40, v40, v24
v_add_f32 v41, v41, v25
v_add_f32 v42, v42, v26
v_add_f32 v43, v43, v27
v_add_f32 v44, v44, v28
v_add_f32 v45, v45, v29
v_add_f32 v46, v46, v30
v_add_f32 v47, v47, v31
v_mul_f32 v104, v40, v40
v_mul_f32 v105, v41, v41
v_mul_f32 v106, v42, v42
v_mul_f32 v107, v43, v43
v_mul_f32 v108, v44, v44
v_mul_f32 v109, v45, v45
v_mul_f32 v110, v46, v46
v_mul_f32 v111, v47, v47
v_mul_f32 v104, 0xbdd2d3e8, v104
v_mul_f32 v105, 0xbdd2d3e8, v105
v_mul_f32 v106, 0xbdd2d3e8, v106
v_mul_f32 v107, 0xbdd2d3e8, v107
v_mul_f32 v108, 0xbdd2d3e8, v108
v_mul_f32 v109, 0xbdd2d3e8, v109
v_mul_f32 v110, 0xbdd2d3e8, v110
v_mul_f32 v111, 0xbdd2d3e8, v111
v_add_f32 v104, s7, v104
v_add_f32 v105, s7, v105
v_add_f32 v106, s7, v106
v_add_f32 v107, s7, v107
v_add_f32 v108, s7, v108
v_add_f32 v109, s7, v109
v_add_f32 v110, s7, v110
v_add_f32 v111, s7, v111
v_mul_f32 v104, v104, v40
v_mul_f32 v105, v105, v41
v_mul_f32 v106, v106, v42
v_mul_f32 v107, v107, v43
v_mul_f32 v108, v108, v44
v_mul_f32 v109, v109, v45
v_mul_f32 v110, v110, v46
v_mul_f32 v111, v111, v47
v_exp_f32 v104, v104
v_exp_f32 v105, v105
v_exp_f32 v106, v106
v_exp_f32 v107, v107
v_exp_f32 v108, v108
v_exp_f32 v109, v109
v_exp_f32 v110, v110
v_exp_f32 v111, v111
v_add_f32 v104, 1.0, v104
v_add_f32 v105, 1.0, v105
v_add_f32 v106, 1.0, v106
v_add_f32 v107, 1.0, v107
v_add_f32 v108, 1.0, v108
v_add_f32 v109, 1.0, v109
v_add_f32 v110, 1.0, v110
v_add_f32 v111, 1.0, v111
v_rcp_f32 v104, v104
v_rcp_f32 v105, v105
v_rcp_f32 v106, v106
v_rcp_f32 v107, v107
v_rcp_f32 v108, v108
v_rcp_f32 v109, v109
v_rcp_f32 v110, v110
v_rcp_f32 v111, v111
v_mul_f32 v40, v40, v104
v_mul_f32 v41, v41, v105
v_mul_f32 v42, v42, v106
v_mul_f32 v43, v43, v107
v_mul_f32 v44, v44, v108
v_mul_f32 v45, v45, v109
v_mul_f32 v46, v46, v110
v_mul_f32 v47, v47, v111
v_cvt_pk_bf16_f32 v104, v40, v41
v_cvt_pk_bf16_f32 v105, v42, v43
v_cvt_pk_bf16_f32 v106, v44, v45
v_cvt_pk_bf16_f32 v107, v46, v47
buffer_store_dwordx4 v[104:107], v1, s[20:23], s5 offen offset:1024 sc0 sc1
s_add_u32 s5, s5, 294912
s_waitcnt lgkmcnt(15)
v_add_f32 v48, v48, v128
v_add_f32 v136, v136, v144
v_add_f32 v49, v49, v129
v_add_f32 v137, v137, v145
v_add_f32 v50, v50, v130
v_add_f32 v138, v138, v146
v_add_f32 v51, v51, v131
v_add_f32 v139, v139, v147
v_add_f32 v52, v52, v132
v_add_f32 v140, v140, v148
v_add_f32 v53, v53, v133
v_add_f32 v141, v141, v149
v_add_f32 v54, v54, v134
v_add_f32 v142, v142, v150
v_add_f32 v55, v55, v135
v_add_f32 v143, v143, v151
v_add_f32 v48, v48, v136
v_add_f32 v49, v49, v137
v_add_f32 v50, v50, v138
v_add_f32 v51, v51, v139
v_add_f32 v52, v52, v140
v_add_f32 v53, v53, v141
v_add_f32 v54, v54, v142
v_add_f32 v55, v55, v143
v_cvt_pk_bf16_f32 v128, v48, v49
v_cvt_pk_bf16_f32 v129, v50, v51
v_cvt_pk_bf16_f32 v130, v52, v53
v_cvt_pk_bf16_f32 v131, v54, v55
v_lshlrev_b32 v48, 16, v128
v_and_b32 v49, 0xffff0000, v128
v_lshlrev_b32 v50, 16, v129
v_and_b32 v51, 0xffff0000, v129
v_lshlrev_b32 v52, 16, v130
v_and_b32 v53, 0xffff0000, v130
v_lshlrev_b32 v54, 16, v131
v_and_b32 v55, 0xffff0000, v131
v_add_f32 v48, v48, v16
v_add_f32 v49, v49, v17
v_add_f32 v50, v50, v18
v_add_f32 v51, v51, v19
v_add_f32 v52, v52, v20
v_add_f32 v53, v53, v21
v_add_f32 v54, v54, v22
v_add_f32 v55, v55, v23
v_mul_f32 v128, v48, v48
v_mul_f32 v129, v49, v49
v_mul_f32 v130, v50, v50
v_mul_f32 v131, v51, v51
v_mul_f32 v132, v52, v52
v_mul_f32 v133, v53, v53
v_mul_f32 v134, v54, v54
v_mul_f32 v135, v55, v55
v_mul_f32 v128, 0xbdd2d3e8, v128
v_mul_f32 v129, 0xbdd2d3e8, v129
v_mul_f32 v130, 0xbdd2d3e8, v130
v_mul_f32 v131, 0xbdd2d3e8, v131
v_mul_f32 v132, 0xbdd2d3e8, v132
v_mul_f32 v133, 0xbdd2d3e8, v133
v_mul_f32 v134, 0xbdd2d3e8, v134
v_mul_f32 v135, 0xbdd2d3e8, v135
v_add_f32 v128, s7, v128
v_add_f32 v129, s7, v129
v_add_f32 v130, s7, v130
v_add_f32 v131, s7, v131
v_add_f32 v132, s7, v132
v_add_f32 v133, s7, v133
v_add_f32 v134, s7, v134
v_add_f32 v135, s7, v135
v_mul_f32 v128, v128, v48
v_mul_f32 v129, v129, v49
v_mul_f32 v130, v130, v50
v_mul_f32 v131, v131, v51
v_mul_f32 v132, v132, v52
v_mul_f32 v133, v133, v53
v_mul_f32 v134, v134, v54
v_mul_f32 v135, v135, v55
v_exp_f32 v128, v128
v_exp_f32 v129, v129
v_exp_f32 v130, v130
v_exp_f32 v131, v131
v_exp_f32 v132, v132
v_exp_f32 v133, v133
v_exp_f32 v134, v134
v_exp_f32 v135, v135
v_add_f32 v128, 1.0, v128
v_add_f32 v129, 1.0, v129
v_add_f32 v130, 1.0, v130
v_add_f32 v131, 1.0, v131
v_add_f32 v132, 1.0, v132
v_add_f32 v133, 1.0, v133
v_add_f32 v134, 1.0, v134
v_add_f32 v135, 1.0, v135
v_rcp_f32 v128, v128
v_rcp_f32 v129, v129
v_rcp_f32 v130, v130
v_rcp_f32 v131, v131
v_rcp_f32 v132, v132
v_rcp_f32 v133, v133
v_rcp_f32 v134, v134
v_rcp_f32 v135, v135
v_mul_f32 v48, v48, v128
v_mul_f32 v49, v49, v129
v_mul_f32 v50, v50, v130
v_mul_f32 v51, v51, v131
v_mul_f32 v52, v52, v132
v_mul_f32 v53, v53, v133
v_mul_f32 v54, v54, v134
v_mul_f32 v55, v55, v135
v_cvt_pk_bf16_f32 v128, v48, v49
v_cvt_pk_bf16_f32 v129, v50, v51
v_cvt_pk_bf16_f32 v130, v52, v53
v_cvt_pk_bf16_f32 v131, v54, v55
buffer_store_dwordx4 v[128:131], v1, s[20:23], s5 offen offset:0 sc0 sc1
s_waitcnt lgkmcnt(12)
v_add_f32 v56, v56, v152
v_add_f32 v160, v160, v168
v_add_f32 v57, v57, v153
v_add_f32 v161, v161, v169
v_add_f32 v58, v58, v154
v_add_f32 v162, v162, v170
v_add_f32 v59, v59, v155
v_add_f32 v163, v163, v171
v_add_f32 v60, v60, v156
v_add_f32 v164, v164, v172
v_add_f32 v61, v61, v157
v_add_f32 v165, v165, v173
v_add_f32 v62, v62, v158
v_add_f32 v166, v166, v174
v_add_f32 v63, v63, v159
v_add_f32 v167, v167, v175
v_add_f32 v56, v56, v160
v_add_f32 v57, v57, v161
v_add_f32 v58, v58, v162
v_add_f32 v59, v59, v163
v_add_f32 v60, v60, v164
v_add_f32 v61, v61, v165
v_add_f32 v62, v62, v166
v_add_f32 v63, v63, v167
v_cvt_pk_bf16_f32 v152, v56, v57
v_cvt_pk_bf16_f32 v153, v58, v59
v_cvt_pk_bf16_f32 v154, v60, v61
v_cvt_pk_bf16_f32 v155, v62, v63
v_lshlrev_b32 v56, 16, v152
v_and_b32 v57, 0xffff0000, v152
v_lshlrev_b32 v58, 16, v153
v_and_b32 v59, 0xffff0000, v153
v_lshlrev_b32 v60, 16, v154
v_and_b32 v61, 0xffff0000, v154
v_lshlrev_b32 v62, 16, v155
v_and_b32 v63, 0xffff0000, v155
v_add_f32 v56, v56, v24
v_add_f32 v57, v57, v25
v_add_f32 v58, v58, v26
v_add_f32 v59, v59, v27
v_add_f32 v60, v60, v28
v_add_f32 v61, v61, v29
v_add_f32 v62, v62, v30
v_add_f32 v63, v63, v31
v_mul_f32 v152, v56, v56
v_mul_f32 v153, v57, v57
v_mul_f32 v154, v58, v58
v_mul_f32 v155, v59, v59
v_mul_f32 v156, v60, v60
v_mul_f32 v157, v61, v61
v_mul_f32 v158, v62, v62
v_mul_f32 v159, v63, v63
v_mul_f32 v152, 0xbdd2d3e8, v152
v_mul_f32 v153, 0xbdd2d3e8, v153
v_mul_f32 v154, 0xbdd2d3e8, v154
v_mul_f32 v155, 0xbdd2d3e8, v155
v_mul_f32 v156, 0xbdd2d3e8, v156
v_mul_f32 v157, 0xbdd2d3e8, v157
v_mul_f32 v158, 0xbdd2d3e8, v158
v_mul_f32 v159, 0xbdd2d3e8, v159
v_add_f32 v152, s7, v152
v_add_f32 v153, s7, v153
v_add_f32 v154, s7, v154
v_add_f32 v155, s7, v155
v_add_f32 v156, s7, v156
v_add_f32 v157, s7, v157
v_add_f32 v158, s7, v158
v_add_f32 v159, s7, v159
v_mul_f32 v152, v152, v56
v_mul_f32 v153, v153, v57
v_mul_f32 v154, v154, v58
v_mul_f32 v155, v155, v59
v_mul_f32 v156, v156, v60
v_mul_f32 v157, v157, v61
v_mul_f32 v158, v158, v62
v_mul_f32 v159, v159, v63
v_exp_f32 v152, v152
v_exp_f32 v153, v153
v_exp_f32 v154, v154
v_exp_f32 v155, v155
v_exp_f32 v156, v156
v_exp_f32 v157, v157
v_exp_f32 v158, v158
v_exp_f32 v159, v159
v_add_f32 v152, 1.0, v152
v_add_f32 v153, 1.0, v153
v_add_f32 v154, 1.0, v154
v_add_f32 v155, 1.0, v155
v_add_f32 v156, 1.0, v156
v_add_f32 v157, 1.0, v157
v_add_f32 v158, 1.0, v158
v_add_f32 v159, 1.0, v159
v_rcp_f32 v152, v152
v_rcp_f32 v153, v153
v_rcp_f32 v154, v154
v_rcp_f32 v155, v155
v_rcp_f32 v156, v156
v_rcp_f32 v157, v157
v_rcp_f32 v158, v158
v_rcp_f32 v159, v159
v_mul_f32 v56, v56, v152
v_mul_f32 v57, v57, v153
v_mul_f32 v58, v58, v154
v_mul_f32 v59, v59, v155
v_mul_f32 v60, v60, v156
v_mul_f32 v61, v61, v157
v_mul_f32 v62, v62, v158
v_mul_f32 v63, v63, v159
v_cvt_pk_bf16_f32 v152, v56, v57
v_cvt_pk_bf16_f32 v153, v58, v59
v_cvt_pk_bf16_f32 v154, v60, v61
v_cvt_pk_bf16_f32 v155, v62, v63
buffer_store_dwordx4 v[152:155], v1, s[20:23], s5 offen offset:1024 sc0 sc1
s_add_u32 s5, s5, 294912
s_waitcnt lgkmcnt(6)
v_add_f32 v64, v64, v176
v_add_f32 v184, v184, v192
v_add_f32 v65, v65, v177
v_add_f32 v185, v185, v193
v_add_f32 v66, v66, v178
v_add_f32 v186, v186, v194
v_add_f32 v67, v67, v179
v_add_f32 v187, v187, v195
v_add_f32 v68, v68, v180
v_add_f32 v188, v188, v196
v_add_f32 v69, v69, v181
v_add_f32 v189, v189, v197
v_add_f32 v70, v70, v182
v_add_f32 v190, v190, v198
v_add_f32 v71, v71, v183
v_add_f32 v191, v191, v199
v_add_f32 v64, v64, v184
v_add_f32 v65, v65, v185
v_add_f32 v66, v66, v186
v_add_f32 v67, v67, v187
v_add_f32 v68, v68, v188
v_add_f32 v69, v69, v189
v_add_f32 v70, v70, v190
v_add_f32 v71, v71, v191
v_cvt_pk_bf16_f32 v176, v64, v65
v_cvt_pk_bf16_f32 v177, v66, v67
v_cvt_pk_bf16_f32 v178, v68, v69
v_cvt_pk_bf16_f32 v179, v70, v71
v_lshlrev_b32 v64, 16, v176
v_and_b32 v65, 0xffff0000, v176
v_lshlrev_b32 v66, 16, v177
v_and_b32 v67, 0xffff0000, v177
v_lshlrev_b32 v68, 16, v178
v_and_b32 v69, 0xffff0000, v178
v_lshlrev_b32 v70, 16, v179
v_and_b32 v71, 0xffff0000, v179
v_add_f32 v64, v64, v16
v_add_f32 v65, v65, v17
v_add_f32 v66, v66, v18
v_add_f32 v67, v67, v19
v_add_f32 v68, v68, v20
v_add_f32 v69, v69, v21
v_add_f32 v70, v70, v22
v_add_f32 v71, v71, v23
v_mul_f32 v176, v64, v64
v_mul_f32 v177, v65, v65
v_mul_f32 v178, v66, v66
v_mul_f32 v179, v67, v67
v_mul_f32 v180, v68, v68
v_mul_f32 v181, v69, v69
v_mul_f32 v182, v70, v70
v_mul_f32 v183, v71, v71
v_mul_f32 v176, 0xbdd2d3e8, v176
v_mul_f32 v177, 0xbdd2d3e8, v177
v_mul_f32 v178, 0xbdd2d3e8, v178
v_mul_f32 v179, 0xbdd2d3e8, v179
v_mul_f32 v180, 0xbdd2d3e8, v180
v_mul_f32 v181, 0xbdd2d3e8, v181
v_mul_f32 v182, 0xbdd2d3e8, v182
v_mul_f32 v183, 0xbdd2d3e8, v183
v_add_f32 v176, s7, v176
v_add_f32 v177, s7, v177
v_add_f32 v178, s7, v178
v_add_f32 v179, s7, v179
v_add_f32 v180, s7, v180
v_add_f32 v181, s7, v181
v_add_f32 v182, s7, v182
v_add_f32 v183, s7, v183
v_mul_f32 v176, v176, v64
v_mul_f32 v177, v177, v65
v_mul_f32 v178, v178, v66
v_mul_f32 v179, v179, v67
v_mul_f32 v180, v180, v68
v_mul_f32 v181, v181, v69
v_mul_f32 v182, v182, v70
v_mul_f32 v183, v183, v71
v_exp_f32 v176, v176
v_exp_f32 v177, v177
v_exp_f32 v178, v178
v_exp_f32 v179, v179
v_exp_f32 v180, v180
v_exp_f32 v181, v181
v_exp_f32 v182, v182
v_exp_f32 v183, v183
v_add_f32 v176, 1.0, v176
v_add_f32 v177, 1.0, v177
v_add_f32 v178, 1.0, v178
v_add_f32 v179, 1.0, v179
v_add_f32 v180, 1.0, v180
v_add_f32 v181, 1.0, v181
v_add_f32 v182, 1.0, v182
v_add_f32 v183, 1.0, v183
v_rcp_f32 v176, v176
v_rcp_f32 v177, v177
v_rcp_f32 v178, v178
v_rcp_f32 v179, v179
v_rcp_f32 v180, v180
v_rcp_f32 v181, v181
v_rcp_f32 v182, v182
v_rcp_f32 v183, v183
v_mul_f32 v64, v64, v176
v_mul_f32 v65, v65, v177
v_mul_f32 v66, v66, v178
v_mul_f32 v67, v67, v179
v_mul_f32 v68, v68, v180
v_mul_f32 v69, v69, v181
v_mul_f32 v70, v70, v182
v_mul_f32 v71, v71, v183
v_cvt_pk_bf16_f32 v176, v64, v65
v_cvt_pk_bf16_f32 v177, v66, v67
v_cvt_pk_bf16_f32 v178, v68, v69
v_cvt_pk_bf16_f32 v179, v70, v71
buffer_store_dwordx4 v[176:179], v1, s[20:23], s5 offen offset:0 sc0 sc1
s_waitcnt lgkmcnt(0)
v_add_f32 v72, v72, v200
v_add_f32 v208, v208, v216
v_add_f32 v73, v73, v201
v_add_f32 v209, v209, v217
v_add_f32 v74, v74, v202
v_add_f32 v210, v210, v218
v_add_f32 v75, v75, v203
v_add_f32 v211, v211, v219
v_add_f32 v76, v76, v204
v_add_f32 v212, v212, v220
v_add_f32 v77, v77, v205
v_add_f32 v213, v213, v221
v_add_f32 v78, v78, v206
v_add_f32 v214, v214, v222
v_add_f32 v79, v79, v207
v_add_f32 v215, v215, v223
v_add_f32 v72, v72, v208
v_add_f32 v73, v73, v209
v_add_f32 v74, v74, v210
v_add_f32 v75, v75, v211
v_add_f32 v76, v76, v212
v_add_f32 v77, v77, v213
v_add_f32 v78, v78, v214
v_add_f32 v79, v79, v215
v_cvt_pk_bf16_f32 v200, v72, v73
v_cvt_pk_bf16_f32 v201, v74, v75
v_cvt_pk_bf16_f32 v202, v76, v77
v_cvt_pk_bf16_f32 v203, v78, v79
v_lshlrev_b32 v72, 16, v200
v_and_b32 v73, 0xffff0000, v200
v_lshlrev_b32 v74, 16, v201
v_and_b32 v75, 0xffff0000, v201
v_lshlrev_b32 v76, 16, v202
v_and_b32 v77, 0xffff0000, v202
v_lshlrev_b32 v78, 16, v203
v_and_b32 v79, 0xffff0000, v203
v_add_f32 v72, v72, v24
v_add_f32 v73, v73, v25
v_add_f32 v74, v74, v26
v_add_f32 v75, v75, v27
v_add_f32 v76, v76, v28
v_add_f32 v77, v77, v29
v_add_f32 v78, v78, v30
v_add_f32 v79, v79, v31
v_mul_f32 v200, v72, v72
v_mul_f32 v201, v73, v73
v_mul_f32 v202, v74, v74
v_mul_f32 v203, v75, v75
v_mul_f32 v204, v76, v76
v_mul_f32 v205, v77, v77
v_mul_f32 v206, v78, v78
v_mul_f32 v207, v79, v79
v_mul_f32 v200, 0xbdd2d3e8, v200
v_mul_f32 v201, 0xbdd2d3e8, v201
v_mul_f32 v202, 0xbdd2d3e8, v202
v_mul_f32 v203, 0xbdd2d3e8, v203
v_mul_f32 v204, 0xbdd2d3e8, v204
v_mul_f32 v205, 0xbdd2d3e8, v205
v_mul_f32 v206, 0xbdd2d3e8, v206
v_mul_f32 v207, 0xbdd2d3e8, v207
v_add_f32 v200, s7, v200
v_add_f32 v201, s7, v201
v_add_f32 v202, s7, v202
v_add_f32 v203, s7, v203
v_add_f32 v204, s7, v204
v_add_f32 v205, s7, v205
v_add_f32 v206, s7, v206
v_add_f32 v207, s7, v207
v_mul_f32 v200, v200, v72
v_mul_f32 v201, v201, v73
v_mul_f32 v202, v202, v74
v_mul_f32 v203, v203, v75
v_mul_f32 v204, v204, v76
v_mul_f32 v205, v205, v77
v_mul_f32 v206, v206, v78
v_mul_f32 v207, v207, v79
v_exp_f32 v200, v200
v_exp_f32 v201, v201
v_exp_f32 v202, v202
v_exp_f32 v203, v203
v_exp_f32 v204, v204
v_exp_f32 v205, v205
v_exp_f32 v206, v206
v_exp_f32 v207, v207
v_add_f32 v200, 1.0, v200
v_add_f32 v201, 1.0, v201
v_add_f32 v202, 1.0, v202
v_add_f32 v203, 1.0, v203
v_add_f32 v204, 1.0, v204
v_add_f32 v205, 1.0, v205
v_add_f32 v206, 1.0, v206
v_add_f32 v207, 1.0, v207
v_rcp_f32 v200, v200
v_rcp_f32 v201, v201
v_rcp_f32 v202, v202
v_rcp_f32 v203, v203
v_rcp_f32 v204, v204
v_rcp_f32 v205, v205
v_rcp_f32 v206, v206
v_rcp_f32 v207, v207
v_mul_f32 v72, v72, v200
v_mul_f32 v73, v73, v201
v_mul_f32 v74, v74, v202
v_mul_f32 v75, v75, v203
v_mul_f32 v76, v76, v204
v_mul_f32 v77, v77, v205
v_mul_f32 v78, v78, v206
v_mul_f32 v79, v79, v207
v_cvt_pk_bf16_f32 v200, v72, v73
v_cvt_pk_bf16_f32 v201, v74, v75
v_cvt_pk_bf16_f32 v202, v76, v77
v_cvt_pk_bf16_f32 v203, v78, v79
buffer_store_dwordx4 v[200:203], v1, s[20:23], s5 offen offset:1024 sc0 sc1
s_add_u32 s5, s5, 294912
s_endpgm
.section .rodata,"a"
.p2align 6
.amdhsa_kernel w1_kernel
  .amdhsa_next_free_vgpr 448
  .amdhsa_next_free_sgpr 96
  .amdhsa_accum_offset 256
  .amdhsa_group_segment_fixed_size 0
  .amdhsa_kernarg_size 112
  .amdhsa_user_sgpr_count 2
  .amdhsa_user_sgpr_kernarg_segment_ptr 1
  .amdhsa_system_sgpr_workgroup_id_x 1
.end_amdhsa_kernel
.text
.globl w2_kernel
.p2align 8
.type w2_kernel,@function
w2_kernel:
s_cmp_ge_u32 s2, 192
s_cbranch_scc0 w2_kernel_go
s_endpgm
w2_kernel_go:
v_lshrrev_b32 v1, 6, v0
v_and_b32 v0, 63, v0
s_nop 0
v_readfirstlane_b32 s3, v1
s_load_dwordx2 s[8:9], s[0:1], 104
s_load_dwordx2 s[12:13], s[0:1], 72
s_load_dwordx2 s[16:17], s[0:1], 104
s_load_dwordx2 s[20:21], s[0:1], 88
s_load_dwordx2 s[24:25], s[0:1], 80
s_and_b32 s5, s2, 7
s_mul_i32 s5, s5, 24
s_lshr_b32 s6, s2, 3
s_add_u32 s5, s5, s6
s_mul_i32 s36, s5, 0xaaab
s_lshr_b32 s36, s36, 18
s_mul_i32 s6, s36, 6
s_sub_u32 s37, s5, s6
s_mul_i32 s43, s37, 884736
s_lshl_b32 s44, s36, 7
s_mul_i32 s45, s3, 6
s_lshl_b32 s46, s45, 10
v_add_u32 v1, 0, v0
v_lshl_add_u32 v1, s45, 6, v1
v_lshrrev_b32 v2, 9, v1
v_and_b32 v1, 511, v1
v_mul_u32_u24 v2, 294912, v2
v_lshl_add_u32 v4, v1, 4, v2
v_add_u32 v1, 64, v0
v_lshl_add_u32 v1, s45, 6, v1
v_lshrrev_b32 v2, 9, v1
v_and_b32 v1, 511, v1
v_mul_u32_u24 v2, 294912, v2
v_lshl_add_u32 v5, v1, 4, v2
v_subrev_u32 v5, 1024, v5
v_add_u32 v1, 128, v0
v_lshl_add_u32 v1, s45, 6, v1
v_lshrrev_b32 v2, 9, v1
v_and_b32 v1, 511, v1
v_mul_u32_u24 v2, 294912, v2
v_lshl_add_u32 v6, v1, 4, v2
v_subrev_u32 v6, 2048, v6
v_add_u32 v1, 192, v0
v_lshl_add_u32 v1, s45, 6, v1
v_lshrrev_b32 v2, 9, v1
v_and_b32 v1, 511, v1
v_mul_u32_u24 v2, 294912, v2
v_lshl_add_u32 v7, v1, 4, v2
v_subrev_u32 v7, 3072, v7
v_add_u32 v1, 256, v0
v_lshl_add_u32 v1, s45, 6, v1
v_lshrrev_b32 v2, 9, v1
v_and_b32 v1, 511, v1
v_mul_u32_u24 v2, 294912, v2
v_lshl_add_u32 v8, v1, 4, v2
v_add_u32 v1, 320, v0
v_lshl_add_u32 v1, s45, 6, v1
v_lshrrev_b32 v2, 9, v1
v_and_b32 v1, 511, v1
v_mul_u32_u24 v2, 294912, v2
v_lshl_add_u32 v9, v1, 4, v2
v_subrev_u32 v9, 1024, v9
s_mul_i32 s47, s3, 4
s_lshl_b32 s48, s47, 10
v_add_u32 v1, 0, v0
v_lshl_add_u32 v1, s47, 6, v1
v_lshrrev_b32 v2, 3, v1
v_and_b32 v1, 7, v1
v_bfe_u32 v3, v2, 1, 1
v_lshlrev_b32 v3, 2, v3
v_xor_b32 v1, v1, v3
v_mul_u32_u24 v2, 4096, v2
v_lshl_add_u32 v10, v1, 4, v2
v_add_u32 v1, 64, v0
v_lshl_add_u32 v1, s47, 6, v1
v_lshrrev_b32 v2, 3, v1
v_and_b32 v1, 7, v1
v_bfe_u32 v3, v2, 1, 1
v_lshlrev_b32 v3, 2, v3
v_xor_b32 v1, v1, v3
v_mul_u32_u24 v2, 4096, v2
v_lshl_add_u32 v11, v1, 4, v2
v_subrev_u32 v11, 1024, v11
v_add_u32 v1, 128, v0
v_lshl_add_u32 v1, s47, 6, v1
v_lshrrev_b32 v2, 3, v1
v_and_b32 v1, 7, v1
v_bfe_u32 v3, v2, 1, 1
v_lshlrev_b32 v3, 2, v3
v_xor_b32 v1, v1, v3
v_mul_u32_u24 v2, 4096, v2
v_lshl_add_u32 v12, v1, 4, v2
v_subrev_u32 v12, 2048, v12
v_add_u32 v1, 192, v0
v_lshl_add_u32 v1, s47, 6, v1
v_lshrrev_b32 v2, 3, v1
v_and_b32 v1, 7, v1
v_bfe_u32 v3, v2, 1, 1
v_lshlrev_b32 v3, 2, v3
v_xor_b32 v1, v1, v3
v_mul_u32_u24 v2, 4096, v2
v_lshl_add_u32 v13, v1, 4, v2
v_subrev_u32 v13, 3072, v13
s_waitcnt lgkmcnt(0)
s_add_u32 s8, s8, 0x3c00000
s_addc_u32 s9, s9, 0
s_mov_b32 s10, 0x510000
s_mov_b32 s11, 0x00020000
s_mov_b32 s14, 0x1200000
s_mov_b32 s15, 0x00020000
s_add_u32 s16, s16, 0x3400000
s_addc_u32 s17, s17, 0
s_mov_b32 s18, 0x240000
s_mov_b32 s19, 0x00020000
s_mov_b32 s22, 0x240000
s_mov_b32 s23, 0x00020000
s_mov_b32 s26, 0x1000
s_mov_b32 s27, 0x00020000
s_add_u32 m0, s46, 0
s_nop 0
buffer_load_dwordx4 v4, s[8:11], s43 offen offset:0 lds
buffer_load_dwordx4 v5, s[8:11], s43 offen offset:1024 lds
buffer_load_dwordx4 v6, s[8:11], s43 offen offset:2048 lds
buffer_load_dwordx4 v7, s[8:11], s43 offen offset:3072 lds
s_add_u32 m0, s46, 4096
s_nop 0
buffer_load_dwordx4 v8, s[8:11], s43 offen offset:0 lds
buffer_load_dwordx4 v9, s[8:11], s43 offen offset:1024 lds
s_add_u32 m0, s48, 24576
s_nop 0
buffer_load_dwordx4 v10, s[12:15], s44 offen offset:0 lds
buffer_load_dwordx4 v11, s[12:15], s44 offen offset:1024 lds
buffer_load_dwordx4 v12, s[12:15], s44 offen offset:2048 lds
buffer_load_dwordx4 v13, s[12:15], s44 offen offset:3072 lds
s_add_u32 s43, s43, 8192
s_add_u32 s44, s44, 524288
s_add_u32 m0, s46, 40960
s_nop 0
buffer_load_dwordx4 v4, s[8:11], s43 offen offset:0 lds
buffer_load_dwordx4 v5, s[8:11], s43 offen offset:1024 lds
buffer_load_dwordx4 v6, s[8:11], s43 offen offset:2048 lds
buffer_load_dwordx4 v7, s[8:11], s43 offen offset:3072 lds
s_add_u32 m0, s46, 45056
s_nop 0
buffer_load_dwordx4 v8, s[8:11], s43 offen offset:0 lds
buffer_load_dwordx4 v9, s[8:11], s43 offen offset:1024 lds
s_add_u32 m0, s48, 65536
s_nop 0
buffer_load_dwordx4 v10, s[12:15], s44 offen offset:0 lds
buffer_load_dwordx4 v11, s[12:15], s44 offen offset:1024 lds
buffer_load_dwordx4 v12, s[12:15], s44 offen offset:2048 lds
buffer_load_dwordx4 v13, s[12:15], s44 offen offset:3072 lds
s_add_u32 s43, s43, 8192
s_add_u32 s44, s44, 524288
s_add_u32 m0, s46, 81920
s_nop 0
buffer_load_dwordx4 v4, s[8:11], s43 offen offset:0 lds
buffer_load_dwordx4 v5, s[8:11], s43 offen offset:1024 lds
buffer_load_dwordx4 v6, s[8:11], s43 offen offset:2048 lds
buffer_load_dwordx4 v7, s[8:11], s43 offen offset:3072 lds
s_add_u32 m0, s46, 86016
s_nop 0
buffer_load_dwordx4 v8, s[8:11], s43 offen offset:0 lds
buffer_load_dwordx4 v9, s[8:11], s43 offen offset:1024 lds
s_add_u32 m0, s48, 106496
s_nop 0
buffer_load_dwordx4 v10, s[12:15], s44 offen offset:0 lds
buffer_load_dwordx4 v11, s[12:15], s44 offen offset:1024 lds
buffer_load_dwordx4 v12, s[12:15], s44 offen offset:2048 lds
buffer_load_dwordx4 v13, s[12:15], s44 offen offset:3072 lds
s_add_u32 s43, s43, 8192
s_add_u32 s44, s44, 524288
s_add_u32 m0, s46, 122880
s_nop 0
buffer_load_dwordx4 v4, s[8:11], s43 offen offset:0 lds
buffer_load_dwordx4 v5, s[8:11], s43 offen offset:1024 lds
buffer_load_dwordx4 v6, s[8:11], s43 offen offset:2048 lds
buffer_load_dwordx4 v7, s[8:11], s43 offen offset:3072 lds
s_add_u32 m0, s46, 126976
s_nop 0
buffer_load_dwordx4 v8, s[8:11], s43 offen offset:0 lds
v_accvgpr_write_b32 a0, 0
v_accvgpr_write_b32 a1, 0
v_accvgpr_write_b32 a2, 0
v_accvgpr_write_b32 a3, 0
v_accvgpr_write_b32 a4, 0
v_accvgpr_write_b32 a5, 0
v_accvgpr_write_b32 a6, 0
v_accvgpr_write_b32 a7, 0
v_accvgpr_write_b32 a8, 0
v_accvgpr_write_b32 a9, 0
v_accvgpr_write_b32 a10, 0
v_accvgpr_write_b32 a11, 0
v_accvgpr_write_b32 a12, 0
v_accvgpr_write_b32 a13, 0
v_accvgpr_write_b32 a14, 0
v_accvgpr_write_b32 a15, 0
v_accvgpr_write_b32 a16, 0
v_accvgpr_write_b32 a17, 0
v_accvgpr_write_b32 a18, 0
v_accvgpr_write_b32 a19, 0
v_accvgpr_write_b32 a20, 0
v_accvgpr_write_b32 a21, 0
v_accvgpr_write_b32 a22, 0
v_accvgpr_write_b32 a23, 0
v_accvgpr_write_b32 a24, 0
v_accvgpr_write_b32 a25, 0
v_accvgpr_write_b32 a26, 0
v_accvgpr_write_b32 a27, 0
v_accvgpr_write_b32 a28, 0
v_accvgpr_write_b32 a29, 0
v_accvgpr_write_b32 a30, 0
v_accvgpr_write_b32 a31, 0
v_accvgpr_write_b32 a32, 0
v_accvgpr_write_b32 a33, 0
v_accvgpr_write_b32 a34, 0
v_accvgpr_write_b32 a35, 0
v_accvgpr_write_b32 a36, 0
v_accvgpr_write_b32 a37, 0
v_accvgpr_write_b32 a38, 0
v_accvgpr_write_b32 a39, 0
v_accvgpr_write_b32 a40, 0
v_accvgpr_write_b32 a41, 0
v_accvgpr_write_b32 a42, 0
v_accvgpr_write_b32 a43, 0
v_accvgpr_write_b32 a44, 0
v_accvgpr_write_b32 a45, 0
v_accvgpr_write_b32 a46, 0
v_accvgpr_write_b32 a47, 0
v_accvgpr_write_b32 a48, 0
v_accvgpr_write_b32 a49, 0
v_accvgpr_write_b32 a50, 0
v_accvgpr_write_b32 a51, 0
v_accvgpr_write_b32 a52, 0
v_accvgpr_write_b32 a53, 0
v_accvgpr_write_b32 a54, 0
v_accvgpr_write_b32 a55, 0
v_accvgpr_write_b32 a56, 0
v_accvgpr_write_b32 a57, 0
v_accvgpr_write_b32 a58, 0
v_accvgpr_write_b32 a59, 0
v_accvgpr_write_b32 a60, 0
v_accvgpr_write_b32 a61, 0
v_accvgpr_write_b32 a62, 0
v_accvgpr_write_b32 a63, 0
v_accvgpr_write_b32 a64, 0
v_accvgpr_write_b32 a65, 0
v_accvgpr_write_b32 a66, 0
v_accvgpr_write_b32 a67, 0
v_accvgpr_write_b32 a68, 0
v_accvgpr_write_b32 a69, 0
v_accvgpr_write_b32 a70, 0
v_accvgpr_write_b32 a71, 0
v_accvgpr_write_b32 a72, 0
v_accvgpr_write_b32 a73, 0
v_accvgpr_write_b32 a74, 0
v_accvgpr_write_b32 a75, 0
v_accvgpr_write_b32 a76, 0
v_accvgpr_write_b32 a77, 0
v_accvgpr_write_b32 a78, 0
v_accvgpr_write_b32 a79, 0
v_accvgpr_write_b32 a80, 0
v_accvgpr_write_b32 a81, 0
v_accvgpr_write_b32 a82, 0
v_accvgpr_write_b32 a83, 0
v_accvgpr_write_b32 a84, 0
v_accvgpr_write_b32 a85, 0
v_accvgpr_write_b32 a86, 0
v_accvgpr_write_b32 a87, 0
v_accvgpr_write_b32 a88, 0
v_accvgpr_write_b32 a89, 0
v_accvgpr_write_b32 a90, 0
v_accvgpr_write_b32 a91, 0
v_accvgpr_write_b32 a92, 0
v_accvgpr_write_b32 a93, 0
v_accvgpr_write_b32 a94, 0
v_accvgpr_write_b32 a95, 0
s_mul_i32 s42, s3, 2048
v_lshlrev_b32 v14, 4, v0
v_add_u32 v14, s42, v14
v_add_u32 v16, 131072, v14
v_add_u32 v15, 65536, v14
s_mul_i32 s42, s3, 4096
v_bfe_u32 v1, v0, 2, 2
v_lshrrev_b32 v2, 5, v0
v_lshl_add_u32 v2, v2, 2, v1
v_mul_u32_u24 v2, 128, v2
v_bfe_u32 v3, v0, 4, 1
v_lshl_add_u32 v2, v3, 5, v2
v_and_b32 v3, 3, v0
v_lshl_add_u32 v2, v3, 3, v2
v_add_u32 v2, s42, v2
v_lshrrev_b32 v1, 1, v1
v_xor_b32 v3, 0, v1
v_lshl_add_u32 v17, v3, 6, v2
v_xor_b32 v3, 1, v1
v_lshl_add_u32 v18, v3, 6, v2
v_add_u32 v21, 131072, v17
v_add_u32 v22, 131072, v18
v_add_u32 v19, 65536, v17
v_add_u32 v20, 65536, v18
s_waitcnt vmcnt(25)
s_barrier
ds_read_b128 v[32:35], v14 offset:0
ds_read_b128 v[36:39], v14 offset:8192
ds_read_b128 v[40:43], v14 offset:16384
ds_read_b64_tr_b16 v[44:45], v17 offset:24576
ds_read_b64_tr_b16 v[46:47], v17 offset:25600
ds_read_b64_tr_b16 v[48:49], v18 offset:24576
ds_read_b64_tr_b16 v[50:51], v18 offset:25600
s_mov_b32 s4, 8
gl_33:
s_waitcnt lgkmcnt(0)
v_mfma_f32_32x32x16_bf16 a[0:15], v[32:35], v[44:47], a[0:15]
ds_read_b128 v[52:55], v14 offset:1024
ds_read_b128 v[56:59], v14 offset:9216
ds_read_b128 v[60:63], v14 offset:17408
v_mfma_f32_32x32x16_bf16 a[16:31], v[32:35], v[48:51], a[16:31]
ds_read_b64_tr_b16 v[64:65], v17 offset:26624
ds_read_b64_tr_b16 v[66:67], v17 offset:27648
v_mfma_f32_32x32x16_bf16 a[32:47], v[36:39], v[44:47], a[32:47]
ds_read_b64_tr_b16 v[68:69], v18 offset:26624
ds_read_b64_tr_b16 v[70:71], v18 offset:27648
v_mfma_f32_32x32x16_bf16 a[48:63], v[36:39], v[48:51], a[48:63]
buffer_load_dwordx4 v9, s[8:11], s43 offen offset:1024 lds
s_add_u32 m0, s48, 147456
s_nop 0
buffer_load_dwordx4 v10, s[12:15], s44 offen offset:0 lds
v_mfma_f32_32x32x16_bf16 a[64:79], v[40:43], v[44:47], a[64:79]
buffer_load_dwordx4 v11, s[12:15], s44 offen offset:1024 lds
buffer_load_dwordx4 v12, s[12:15], s44 offen offset:2048 lds
v_mfma_f32_32x32x16_bf16 a[80:95], v[40:43], v[48:51], a[80:95]
buffer_load_dwordx4 v13, s[12:15], s44 offen offset:3072 lds
s_add_u32 s43, s43, 8192
s_add_u32 s44, s44, 524288
s_waitcnt lgkmcnt(0)
s_waitcnt vmcnt(20)
s_barrier
v_mfma_f32_32x32x16_bf16 a[0:15], v[52:55], v[64:67], a[0:15]
ds_read_b128 v[32:35], v14 offset:40960
ds_read_b128 v[36:39], v14 offset:49152
ds_read_b128 v[40:43], v14 offset:57344
v_mfma_f32_32x32x16_bf16 a[16:31], v[52:55], v[68:71], a[16:31]
ds_read_b64_tr_b16 v[44:45], v19 offset:0
ds_read_b64_tr_b16 v[46:47], v19 offset:1024
v_mfma_f32_32x32x16_bf16 a[32:47], v[56:59], v[64:67], a[32:47]
ds_read_b64_tr_b16 v[48:49], v20 offset:0
ds_read_b64_tr_b16 v[50:51], v20 offset:1024
v_mfma_f32_32x32x16_bf16 a[48:63], v[56:59], v[68:71], a[48:63]
s_add_u32 m0, s46, 0
s_nop 0
buffer_load_dwordx4 v4, s[8:11], s43 offen offset:0 lds
buffer_load_dwordx4 v5, s[8:11], s43 offen offset:1024 lds
v_mfma_f32_32x32x16_bf16 a[64:79], v[60:63], v[64:67], a[64:79]
buffer_load_dwordx4 v6, s[8:11], s43 offen offset:2048 lds
buffer_load_dwordx4 v7, s[8:11], s43 offen offset:3072 lds
v_mfma_f32_32x32x16_bf16 a[80:95], v[60:63], v[68:71], a[80:95]
s_add_u32 m0, s46, 4096
s_nop 0
buffer_load_dwordx4 v8, s[8:11], s43 offen offset:0 lds
s_waitcnt lgkmcnt(0)
v_mfma_f32_32x32x16_bf16 a[0:15], v[32:35], v[44:47], a[0:15]
ds_read_b128 v[52:55], v14 offset:41984
ds_read_b128 v[56:59], v14 offset:50176
ds_read_b128 v[60:63], v14 offset:58368
v_mfma_f32_32x32x16_bf16 a[16:31], v[32:35], v[48:51], a[16:31]
ds_read_b64_tr_b16 v[64:65], v19 offset:2048
ds_read_b64_tr_b16 v[66:67], v19 offset:3072
v_mfma_f32_32x32x16_bf16 a[32:47], v[36:39], v[44:47], a[32:47]
ds_read_b64_tr_b16 v[68:69], v20 offset:2048
ds_read_b64_tr_b16 v[70:71], v20 offset:3072
v_mfma_f32_32x32x16_bf16 a[48:63], v[36:39], v[48:51], a[48:63]
buffer_load_dwordx4 v9, s[8:11], s43 offen offset:1024 lds
s_add_u32 m0, s48, 24576
s_nop 0
buffer_load_dwordx4 v10, s[12:15], s44 offen offset:0 lds
v_mfma_f32_32x32x16_bf16 a[64:79], v[40:43], v[44:47], a[64:79]
buffer_load_dwordx4 v11, s[12:15], s44 offen offset:1024 lds
buffer_load_dwordx4 v12, s[12:15], s44 offen offset:2048 lds
v_mfma_f32_32x32x16_bf16 a[80:95], v[40:43], v[48:51], a[80:95]
buffer_load_dwordx4 v13, s[12:15], s44 offen offset:3072 lds
s_add_u32 s43, s43, 8192
s_add_u32 s44, s44, 524288
s_waitcnt lgkmcnt(0)
s_waitcnt vmcnt(20)
s_barrier
v_mfma_f32_32x32x16_bf16 a[0:15], v[52:55], v[64:67], a[0:15]
ds_read_b128 v[32:35], v15 offset:16384
ds_read_b128 v[36:39], v15 offset:24576
ds_read_b128 v[40:43], v15 offset:32768
v_mfma_f32_32x32x16_bf16 a[16:31], v[52:55], v[68:71], a[16:31]
ds_read_b64_tr_b16 v[44:45], v19 offset:40960
ds_read_b64_tr_b16 v[46:47], v19 offset:41984
v_mfma_f32_32x32x16_bf16 a[32:47], v[56:59], v[64:67], a[32:47]
ds_read_b64_tr_b16 v[48:49], v20 offset:40960
ds_read_b64_tr_b16 v[50:51], v20 offset:41984
v_mfma_f32_32x32x16_bf16 a[48:63], v[56:59], v[68:71], a[48:63]
s_add_u32 m0, s46, 40960
s_nop 0
buffer_load_dwordx4 v4, s[8:11], s43 offen offset:0 lds
buffer_load_dwordx4 v5, s[8:11], s43 offen offset:1024 lds
v_mfma_f32_32x32x16_bf16 a[64:79], v[60:63], v[64:67], a[64:79]
buffer_load_dwordx4 v6, s[8:11], s43 offen offset:2048 lds
buffer_load_dwordx4 v7, s[8:11], s43 offen offset:3072 lds
v_mfma_f32_32x32x16_bf16 a[80:95], v[60:63], v[68:71], a[80:95]
s_add_u32 m0, s46, 45056
s_nop 0
buffer_load_dwordx4 v8, s[8:11], s43 offen offset:0 lds
s_waitcnt lgkmcnt(0)
v_mfma_f32_32x32x16_bf16 a[0:15], v[32:35], v[44:47], a[0:15]
ds_read_b128 v[52:55], v15 offset:17408
ds_read_b128 v[56:59], v15 offset:25600
ds_read_b128 v[60:63], v15 offset:33792
v_mfma_f32_32x32x16_bf16 a[16:31], v[32:35], v[48:51], a[16:31]
ds_read_b64_tr_b16 v[64:65], v19 offset:43008
ds_read_b64_tr_b16 v[66:67], v19 offset:44032
v_mfma_f32_32x32x16_bf16 a[32:47], v[36:39], v[44:47], a[32:47]
ds_read_b64_tr_b16 v[68:69], v20 offset:43008
ds_read_b64_tr_b16 v[70:71], v20 offset:44032
v_mfma_f32_32x32x16_bf16 a[48:63], v[36:39], v[48:51], a[48:63]
buffer_load_dwordx4 v9, s[8:11], s43 offen offset:1024 lds
s_add_u32 m0, s48, 65536
s_nop 0
buffer_load_dwordx4 v10, s[12:15], s44 offen offset:0 lds
v_mfma_f32_32x32x16_bf16 a[64:79], v[40:43], v[44:47], a[64:79]
buffer_load_dwordx4 v11, s[12:15], s44 offen offset:1024 lds
buffer_load_dwordx4 v12, s[12:15], s44 offen offset:2048 lds
v_mfma_f32_32x32x16_bf16 a[80:95], v[40:43], v[48:51], a[80:95]
buffer_load_dwordx4 v13, s[12:15], s44 offen offset:3072 lds
s_add_u32 s43, s43, 8192
s_add_u32 s44, s44, 524288
s_waitcnt lgkmcnt(0)
s_waitcnt vmcnt(20)
s_barrier
v_mfma_f32_32x32x16_bf16 a[0:15], v[52:55], v[64:67], a[0:15]
ds_read_b128 v[32:35], v15 offset:57344
ds_read_b128 v[36:39], v16 offset:0
ds_read_b128 v[40:43], v16 offset:8192
v_mfma_f32_32x32x16_bf16 a[16:31], v[52:55], v[68:71], a[16:31]
ds_read_b64_tr_b16 v[44:45], v21 offset:16384
ds_read_b64_tr_b16 v[46:47], v21 offset:17408
v_mfma_f32_32x32x16_bf16 a[32:47], v[56:59], v[64:67], a[32:47]
ds_read_b64_tr_b16 v[48:49], v22 offset:16384
ds_read_b64_tr_b16 v[50:51], v22 offset:17408
v_mfma_f32_32x32x16_bf16 a[48:63], v[56:59], v[68:71], a[48:63]
s_add_u32 m0, s46, 81920
s_nop 0
buffer_load_dwordx4 v4, s[8:11], s43 offen offset:0 lds
buffer_load_dwordx4 v5, s[8:11], s43 offen offset:1024 lds
v_mfma_f32_32x32x16_bf16 a[64:79], v[60:63], v[64:67], a[64:79]
buffer_load_dwordx4 v6, s[8:11], s43 offen offset:2048 lds
buffer_load_dwordx4 v7, s[8:11], s43 offen offset:3072 lds
v_mfma_f32_32x32x16_bf16 a[80:95], v[60:63], v[68:71], a[80:95]
s_add_u32 m0, s46, 86016
s_nop 0
buffer_load_dwordx4 v8, s[8:11], s43 offen offset:0 lds
s_waitcnt lgkmcnt(0)
v_mfma_f32_32x32x16_bf16 a[0:15], v[32:35], v[44:47], a[0:15]
ds_read_b128 v[52:55], v15 offset:58368
ds_read_b128 v[56:59], v16 offset:1024
ds_read_b128 v[60:63], v16 offset:9216
v_mfma_f32_32x32x16_bf16 a[16:31], v[32:35], v[48:51], a[16:31]
ds_read_b64_tr_b16 v[64:65], v21 offset:18432
ds_read_b64_tr_b16 v[66:67], v21 offset:19456
v_mfma_f32_32x32x16_bf16 a[32:47], v[36:39], v[44:47], a[32:47]
ds_read_b64_tr_b16 v[68:69], v22 offset:18432
ds_read_b64_tr_b16 v[70:71], v22 offset:19456
v_mfma_f32_32x32x16_bf16 a[48:63], v[36:39], v[48:51], a[48:63]
buffer_load_dwordx4 v9, s[8:11], s43 offen offset:1024 lds
s_add_u32 m0, s48, 106496
s_nop 0
buffer_load_dwordx4 v10, s[12:15], s44 offen offset:0 lds
v_mfma_f32_32x32x16_bf16 a[64:79], v[40:43], v[44:47], a[64:79]
buffer_load_dwordx4 v11, s[12:15], s44 offen offset:1024 lds
buffer_load_dwordx4 v12, s[12:15], s44 offen offset:2048 lds
v_mfma_f32_32x32x16_bf16 a[80:95], v[40:43], v[48:51], a[80:95]
buffer_load_dwordx4 v13, s[12:15], s44 offen offset:3072 lds
s_add_u32 s43, s43, 8192
s_add_u32 s44, s44, 524288
s_waitcnt lgkmcnt(0)
s_waitcnt vmcnt(20)
s_barrier
v_mfma_f32_32x32x16_bf16 a[0:15], v[52:55], v[64:67], a[0:15]
ds_read_b128 v[32:35], v14 offset:0
ds_read_b128 v[36:39], v14 offset:8192
ds_read_b128 v[40:43], v14 offset:16384
v_mfma_f32_32x32x16_bf16 a[16:31], v[52:55], v[68:71], a[16:31]
ds_read_b64_tr_b16 v[44:45], v17 offset:24576
ds_read_b64_tr_b16 v[46:47], v17 offset:25600
v_mfma_f32_32x32x16_bf16 a[32:47], v[56:59], v[64:67], a[32:47]
ds_read_b64_tr_b16 v[48:49], v18 offset:24576
ds_read_b64_tr_b16 v[50:51], v18 offset:25600
v_mfma_f32_32x32x16_bf16 a[48:63], v[56:59], v[68:71], a[48:63]
s_add_u32 m0, s46, 122880
s_nop 0
buffer_load_dwordx4 v4, s[8:11], s43 offen offset:0 lds
buffer_load_dwordx4 v5, s[8:11], s43 offen offset:1024 lds
v_mfma_f32_32x32x16_bf16 a[64:79], v[60:63], v[64:67], a[64:79]
buffer_load_dwordx4 v6, s[8:11], s43 offen offset:2048 lds
buffer_load_dwordx4 v7, s[8:11], s43 offen offset:3072 lds
v_mfma_f32_32x32x16_bf16 a[80:95], v[60:63], v[68:71], a[80:95]
s_add_u32 m0, s46, 126976
s_nop 0
buffer_load_dwordx4 v8, s[8:11], s43 offen offset:0 lds
s_sub_u32 s4, s4, 1
s_cmp_lg_u32 s4, 0
s_cbranch_scc1 gl_33
s_waitcnt lgkmcnt(0)
v_mfma_f32_32x32x16_bf16 a[0:15], v[32:35], v[44:47], a[0:15]
ds_read_b128 v[52:55], v14 offset:1024
ds_read_b128 v[56:59], v14 offset:9216
ds_read_b128 v[60:63], v14 offset:17408
v_mfma_f32_32x32x16_bf16 a[16:31], v[32:35], v[48:51], a[16:31]
ds_read_b64_tr_b16 v[64:65], v17 offset:26624
ds_read_b64_tr_b16 v[66:67], v17 offset:27648
v_mfma_f32_32x32x16_bf16 a[32:47], v[36:39], v[44:47], a[32:47]
ds_read_b64_tr_b16 v[68:69], v18 offset:26624
ds_read_b64_tr_b16 v[70:71], v18 offset:27648
v_mfma_f32_32x32x16_bf16 a[48:63], v[36:39], v[48:51], a[48:63]
buffer_load_dwordx4 v9, s[8:11], s43 offen offset:1024 lds
s_add_u32 m0, s48, 147456
s_nop 0
buffer_load_dwordx4 v10, s[12:15], s44 offen offset:0 lds
v_mfma_f32_32x32x16_bf16 a[64:79], v[40:43], v[44:47], a[64:79]
buffer_load_dwordx4 v11, s[12:15], s44 offen offset:1024 lds
buffer_load_dwordx4 v12, s[12:15], s44 offen offset:2048 lds
v_mfma_f32_32x32x16_bf16 a[80:95], v[40:43], v[48:51], a[80:95]
buffer_load_dwordx4 v13, s[12:15], s44 offen offset:3072 lds
s_add_u32 s43, s43, 8192
s_add_u32 s44, s44, 524288
s_waitcnt lgkmcnt(0)
s_waitcnt vmcnt(20)
s_barrier
v_mfma_f32_32x32x16_bf16 a[0:15], v[52:55], v[64:67], a[0:15]
ds_read_b128 v[32:35], v14 offset:40960
ds_read_b128 v[36:39], v14 offset:49152
v_mfma_f32_32x32x16_bf16 a[16:31], v[52:55], v[68:71], a[16:31]
ds_read_b128 v[40:43], v14 offset:57344
ds_read_b64_tr_b16 v[44:45], v19 offset:0
v_mfma_f32_32x32x16_bf16 a[32:47], v[56:59], v[64:67], a[32:47]
ds_read_b64_tr_b16 v[46:47], v19 offset:1024
ds_read_b64_tr_b16 v[48:49], v20 offset:0
v_mfma_f32_32x32x16_bf16 a[48:63], v[56:59], v[68:71], a[48:63]
ds_read_b64_tr_b16 v[50:51], v20 offset:1024
v_mfma_f32_32x32x16_bf16 a[64:79], v[60:63], v[64:67], a[64:79]
v_mfma_f32_32x32x16_bf16 a[80:95], v[60:63], v[68:71], a[80:95]
s_waitcnt lgkmcnt(0)
v_mfma_f32_32x32x16_bf16 a[0:15], v[32:35], v[44:47], a[0:15]
ds_read_b128 v[52:55], v14 offset:41984
ds_read_b128 v[56:59], v14 offset:50176
v_mfma_f32_32x32x16_bf16 a[16:31], v[32:35], v[48:51], a[16:31]
ds_read_b128 v[60:63], v14 offset:58368
ds_read_b64_tr_b16 v[64:65], v19 offset:2048
v_mfma_f32_32x32x16_bf16 a[32:47], v[36:39], v[44:47], a[32:47]
ds_read_b64_tr_b16 v[66:67], v19 offset:3072
ds_read_b64_tr_b16 v[68:69], v20 offset:2048
v_mfma_f32_32x32x16_bf16 a[48:63], v[36:39], v[48:51], a[48:63]
ds_read_b64_tr_b16 v[70:71], v20 offset:3072
v_mfma_f32_32x32x16_bf16 a[64:79], v[40:43], v[44:47], a[64:79]
v_mfma_f32_32x32x16_bf16 a[80:95], v[40:43], v[48:51], a[80:95]
s_waitcnt lgkmcnt(0)
s_waitcnt vmcnt(10)
s_barrier
v_mfma_f32_32x32x16_bf16 a[0:15], v[52:55], v[64:67], a[0:15]
ds_read_b128 v[32:35], v15 offset:16384
ds_read_b128 v[36:39], v15 offset:24576
v_mfma_f32_32x32x16_bf16 a[16:31], v[52:55], v[68:71], a[16:31]
ds_read_b128 v[40:43], v15 offset:32768
ds_read_b64_tr_b16 v[44:45], v19 offset:40960
v_mfma_f32_32x32x16_bf16 a[32:47], v[56:59], v[64:67], a[32:47]
ds_read_b64_tr_b16 v[46:47], v19 offset:41984
ds_read_b64_tr_b16 v[48:49], v20 offset:40960
v_mfma_f32_32x32x16_bf16 a[48:63], v[56:59], v[68:71], a[48:63]
ds_read_b64_tr_b16 v[50:51], v20 offset:41984
v_mfma_f32_32x32x16_bf16 a[64:79], v[60:63], v[64:67], a[64:79]
v_mfma_f32_32x32x16_bf16 a[80:95], v[60:63], v[68:71], a[80:95]
s_waitcnt lgkmcnt(0)
v_mfma_f32_32x32x16_bf16 a[0:15], v[32:35], v[44:47], a[0:15]
ds_read_b128 v[52:55], v15 offset:17408
ds_read_b128 v[56:59], v15 offset:25600
v_mfma_f32_32x32x16_bf16 a[16:31], v[32:35], v[48:51], a[16:31]
ds_read_b128 v[60:63], v15 offset:33792
ds_read_b64_tr_b16 v[64:65], v19 offset:43008
v_mfma_f32_32x32x16_bf16 a[32:47], v[36:39], v[44:47], a[32:47]
ds_read_b64_tr_b16 v[66:67], v19 offset:44032
ds_read_b64_tr_b16 v[68:69], v20 offset:43008
v_mfma_f32_32x32x16_bf16 a[48:63], v[36:39], v[48:51], a[48:63]
ds_read_b64_tr_b16 v[70:71], v20 offset:44032
v_mfma_f32_32x32x16_bf16 a[64:79], v[40:43], v[44:47], a[64:79]
v_mfma_f32_32x32x16_bf16 a[80:95], v[40:43], v[48:51], a[80:95]
s_waitcnt lgkmcnt(0)
s_waitcnt vmcnt(0)
s_barrier
v_mfma_f32_32x32x16_bf16 a[0:15], v[52:55], v[64:67], a[0:15]
ds_read_b128 v[32:35], v15 offset:57344
ds_read_b128 v[36:39], v16 offset:0
v_mfma_f32_32x32x16_bf16 a[16:31], v[52:55], v[68:71], a[16:31]
ds_read_b128 v[40:43], v16 offset:8192
ds_read_b64_tr_b16 v[44:45], v21 offset:16384
v_mfma_f32_32x32x16_bf16 a[32:47], v[56:59], v[64:67], a[32:47]
ds_read_b64_tr_b16 v[46:47], v21 offset:17408
ds_read_b64_tr_b16 v[48:49], v22 offset:16384
v_mfma_f32_32x32x16_bf16 a[48:63], v[56:59], v[68:71], a[48:63]
ds_read_b64_tr_b16 v[50:51], v22 offset:17408
v_mfma_f32_32x32x16_bf16 a[64:79], v[60:63], v[64:67], a[64:79]
v_mfma_f32_32x32x16_bf16 a[80:95], v[60:63], v[68:71], a[80:95]
s_waitcnt lgkmcnt(0)
v_mfma_f32_32x32x16_bf16 a[0:15], v[32:35], v[44:47], a[0:15]
ds_read_b128 v[52:55], v15 offset:58368
ds_read_b128 v[56:59], v16 offset:1024
v_mfma_f32_32x32x16_bf16 a[16:31], v[32:35], v[48:51], a[16:31]
ds_read_b128 v[60:63], v16 offset:9216
ds_read_b64_tr_b16 v[64:65], v21 offset:18432
v_mfma_f32_32x32x16_bf16 a[32:47], v[36:39], v[44:47], a[32:47]
ds_read_b64_tr_b16 v[66:67], v21 offset:19456
ds_read_b64_tr_b16 v[68:69], v22 offset:18432
v_mfma_f32_32x32x16_bf16 a[48:63], v[36:39], v[48:51], a[48:63]
ds_read_b64_tr_b16 v[70:71], v22 offset:19456
v_mfma_f32_32x32x16_bf16 a[64:79], v[40:43], v[44:47], a[64:79]
v_mfma_f32_32x32x16_bf16 a[80:95], v[40:43], v[48:51], a[80:95]
s_waitcnt lgkmcnt(0)
v_mfma_f32_32x32x16_bf16 a[0:15], v[52:55], v[64:67], a[0:15]
v_mfma_f32_32x32x16_bf16 a[16:31], v[52:55], v[68:71], a[16:31]
v_mfma_f32_32x32x16_bf16 a[32:47], v[56:59], v[64:67], a[32:47]
v_mfma_f32_32x32x16_bf16 a[48:63], v[56:59], v[68:71], a[48:63]
v_mfma_f32_32x32x16_bf16 a[64:79], v[60:63], v[64:67], a[64:79]
v_mfma_f32_32x32x16_bf16 a[80:95], v[60:63], v[68:71], a[80:95]
s_nop 7
s_nop 7
v_and_b32 v1, 31, v0
v_mul_u32_u24 v1, 400, v1
v_lshrrev_b32 v2, 5, v0
v_lshl_add_u32 v1, v2, 4, v1
s_mul_i32 s5, s3, 25600
v_add_u32 v1, s5, v1
v_lshl_add_u32 v2, s3, 6, v0
v_add_u32 v3, 0, v2
v_mul_u32_u24 v4, 0x5556, v3
v_lshrrev_b32 v4, 18, v4
v_mul_u32_u24 v8, 12, v4
v_sub_u32 v8, v3, v8
v_mul_u32_u24 v12, 400, v4
v_lshl_add_u32 v12, v8, 5, v12
v_add_u32 v3, 256, v2
v_mul_u32_u24 v5, 0x5556, v3
v_lshrrev_b32 v5, 18, v5
v_mul_u32_u24 v9, 12, v5
v_sub_u32 v9, v3, v9
v_mul_u32_u24 v13, 400, v5
v_lshl_add_u32 v13, v9, 5, v13
v_add_u32 v3, 512, v2
v_mul_u32_u24 v6, 0x5556, v3
v_lshrrev_b32 v6, 18, v6
v_mul_u32_u24 v10, 12, v6
v_sub_u32 v10, v3, v10
v_mul_u32_u24 v14, 400, v6
v_lshl_add_u32 v14, v10, 5, v14
v_add_u32 v15, 51200, v12
v_add_u32 v16, 51200, v13
v_add_u32 v17, 51200, v14
s_mul_i32 s5, s36, 73728
s_mul_i32 s6, s37, 192
s_add_u32 s5, s5, s6
s_lshl_b32 s6, s36, 7
v_mul_u32_u24 v20, 1152, v4
v_lshl_add_u32 v20, v8, 4, v20
buffer_load_dwordx4 v[32:35], v20, s[16:19], s5 offen
v_lshlrev_b32 v3, 1, v4
buffer_load_ushort v24, v3, s[24:27], s6 offen
v_mul_u32_u24 v21, 1152, v5
v_lshl_add_u32 v21, v9, 4, v21
buffer_load_dwordx4 v[36:39], v21, s[16:19], s5 offen
v_lshlrev_b32 v3, 1, v5
buffer_load_ushort v25, v3, s[24:27], s6 offen
v_mul_u32_u24 v22, 1152, v6
v_lshl_add_u32 v22, v10, 4, v22
buffer_load_dwordx4 v[40:43], v22, s[16:19], s5 offen
v_lshlrev_b32 v3, 1, v6
buffer_load_ushort v26, v3, s[24:27], s6 offen
s_barrier
ds_write_b128 v1, a[0:3] offset:0
ds_write_b128 v1, a[4:7] offset:32
ds_write_b128 v1, a[8:11] offset:64
ds_write_b128 v1, a[12:15] offset:96
ds_write_b128 v1, a[16:19] offset:12800
ds_write_b128 v1, a[20:23] offset:12832
ds_write_b128 v1, a[24:27] offset:12864
ds_write_b128 v1, a[28:31] offset:12896
ds_write_b128 v1, a[32:35] offset:128
ds_write_b128 v1, a[36:39] offset:160
ds_write_b128 v1, a[40:43] offset:192
ds_write_b128 v1, a[44:47] offset:224
ds_write_b128 v1, a[48:51] offset:12928
ds_write_b128 v1, a[52:55] offset:12960
ds_write_b128 v1, a[56:59] offset:12992
ds_write_b128 v1, a[60:63] offset:13024
ds_write_b128 v1, a[64:67] offset:256
ds_write_b128 v1, a[68:71] offset:288
ds_write_b128 v1, a[72:75] offset:320
ds_write_b128 v1, a[76:79] offset:352
ds_write_b128 v1, a[80:83] offset:13056
ds_write_b128 v1, a[84:87] offset:13088
ds_write_b128 v1, a[88:91] offset:13120
ds_write_b128 v1, a[92:95] offset:13152
s_waitcnt lgkmcnt(0)
s_barrier
ds_read_b128 v[64:67], v12 offset:0
ds_read_b128 v[68:71], v12 offset:16
ds_read_b128 v[72:75], v12 offset:25600
ds_read_b128 v[76:79], v12 offset:25616
ds_read_b128 v[80:83], v15 offset:0
ds_read_b128 v[84:87], v15 offset:16
ds_read_b128 v[88:91], v15 offset:25600
ds_read_b128 v[92:95], v15 offset:25616
ds_read_b128 v[96:99], v13 offset:0
ds_read_b128 v[100:103], v13 offset:16
ds_read_b128 v[104:107], v13 offset:25600
ds_read_b128 v[108:111], v13 offset:25616
ds_read_b128 v[112:115], v16 offset:0
ds_read_b128 v[116:119], v16 offset:16
ds_read_b128 v[120:123], v16 offset:25600
ds_read_b128 v[124:127], v16 offset:25616
ds_read_b128 v[128:131], v14 offset:0
ds_read_b128 v[132:135], v14 offset:16
ds_read_b128 v[136:139], v14 offset:25600
ds_read_b128 v[140:143], v14 offset:25616
ds_read_b128 v[144:147], v17 offset:0
ds_read_b128 v[148:151], v17 offset:16
ds_read_b128 v[152:155], v17 offset:25600
ds_read_b128 v[156:159], v17 offset:25616
s_waitcnt lgkmcnt(15)
v_add_f32 v64, v64, v72
v_add_f32 v80, v80, v88
v_add_f32 v65, v65, v73
v_add_f32 v81, v81, v89
v_add_f32 v66, v66, v74
v_add_f32 v82, v82, v90
v_add_f32 v67, v67, v75
v_add_f32 v83, v83, v91
v_add_f32 v68, v68, v76
v_add_f32 v84, v84, v92
v_add_f32 v69, v69, v77
v_add_f32 v85, v85, v93
v_add_f32 v70, v70, v78
v_add_f32 v86, v86, v94
v_add_f32 v71, v71, v79
v_add_f32 v87, v87, v95
v_add_f32 v64, v64, v80
v_add_f32 v65, v65, v81
v_add_f32 v66, v66, v82
v_add_f32 v67, v67, v83
v_add_f32 v68, v68, v84
v_add_f32 v69, v69, v85
v_add_f32 v70, v70, v86
v_add_f32 v71, v71, v87
s_waitcnt vmcnt(0)
v_cvt_pk_bf16_f32 v72, v64, v65
v_cvt_pk_bf16_f32 v73, v66, v67
v_cvt_pk_bf16_f32 v74, v68, v69
v_cvt_pk_bf16_f32 v75, v70, v71
v_lshlrev_b32 v64, 16, v72
v_and_b32 v65, 0xffff0000, v72
v_lshlrev_b32 v66, 16, v73
v_and_b32 v67, 0xffff0000, v73
v_lshlrev_b32 v68, 16, v74
v_and_b32 v69, 0xffff0000, v74
v_lshlrev_b32 v70, 16, v75
v_and_b32 v71, 0xffff0000, v75
v_lshlrev_b32 v24, 16, v24
v_add_f32 v64, v64, v24
v_add_f32 v65, v65, v24
v_add_f32 v66, v66, v24
v_add_f32 v67, v67, v24
v_add_f32 v68, v68, v24
v_add_f32 v69, v69, v24
v_add_f32 v70, v70, v24
v_add_f32 v71, v71, v24
v_cvt_pk_bf16_f32 v72, v64, v65
v_cvt_pk_bf16_f32 v73, v66, v67
v_cvt_pk_bf16_f32 v74, v68, v69
v_cvt_pk_bf16_f32 v75, v70, v71
v_lshlrev_b32 v64, 16, v72
v_and_b32 v65, 0xffff0000, v72
v_lshlrev_b32 v66, 16, v73
v_and_b32 v67, 0xffff0000, v73
v_lshlrev_b32 v68, 16, v74
v_and_b32 v69, 0xffff0000, v74
v_lshlrev_b32 v70, 16, v75
v_and_b32 v71, 0xffff0000, v75
v_lshlrev_b32 v80, 16, v32
v_and_b32 v81, 0xffff0000, v32
v_lshlrev_b32 v82, 16, v33
v_and_b32 v83, 0xffff0000, v33
v_lshlrev_b32 v84, 16, v34
v_and_b32 v85, 0xffff0000, v34
v_lshlrev_b32 v86, 16, v35
v_and_b32 v87, 0xffff0000, v35
v_add_f32 v64, v64, v80
v_add_f32 v65, v65, v81
v_add_f32 v66, v66, v82
v_add_f32 v67, v67, v83
v_add_f32 v68, v68, v84
v_add_f32 v69, v69, v85
v_add_f32 v70, v70, v86
v_add_f32 v71, v71, v87
v_cvt_pk_bf16_f32 v72, v64, v65
v_cvt_pk_bf16_f32 v73, v66, v67
v_cvt_pk_bf16_f32 v74, v68, v69
v_cvt_pk_bf16_f32 v75, v70, v71
buffer_store_dwordx4 v[72:75], v20, s[20:23], s5 offen sc0 sc1
s_waitcnt lgkmcnt(8)
v_add_f32 v96, v96, v104
v_add_f32 v112, v112, v120
v_add_f32 v97, v97, v105
v_add_f32 v113, v113, v121
v_add_f32 v98, v98, v106
v_add_f32 v114, v114, v122
v_add_f32 v99, v99, v107
v_add_f32 v115, v115, v123
v_add_f32 v100, v100, v108
v_add_f32 v116, v116, v124
v_add_f32 v101, v101, v109
v_add_f32 v117, v117, v125
v_add_f32 v102, v102, v110
v_add_f32 v118, v118, v126
v_add_f32 v103, v103, v111
v_add_f32 v119, v119, v127
v_add_f32 v96, v96, v112
v_add_f32 v97, v97, v113
v_add_f32 v98, v98, v114
v_add_f32 v99, v99, v115
v_add_f32 v100, v100, v116
v_add_f32 v101, v101, v117
v_add_f32 v102, v102, v118
v_add_f32 v103, v103, v119
v_cvt_pk_bf16_f32 v104, v96, v97
v_cvt_pk_bf16_f32 v105, v98, v99
v_cvt_pk_bf16_f32 v106, v100, v101
v_cvt_pk_bf16_f32 v107, v102, v103
v_lshlrev_b32 v96, 16, v104
v_and_b32 v97, 0xffff0000, v104
v_lshlrev_b32 v98, 16, v105
v_and_b32 v99, 0xffff0000, v105
v_lshlrev_b32 v100, 16, v106
v_and_b32 v101, 0xffff0000, v106
v_lshlrev_b32 v102, 16, v107
v_and_b32 v103, 0xffff0000, v107
v_lshlrev_b32 v25, 16, v25
v_add_f32 v96, v96, v25
v_add_f32 v97, v97, v25
v_add_f32 v98, v98, v25
v_add_f32 v99, v99, v25
v_add_f32 v100, v100, v25
v_add_f32 v101, v101, v25
v_add_f32 v102, v102, v25
v_add_f32 v103, v103, v25
v_cvt_pk_bf16_f32 v104, v96, v97
v_cvt_pk_bf16_f32 v105, v98, v99
v_cvt_pk_bf16_f32 v106, v100, v101
v_cvt_pk_bf16_f32 v107, v102, v103
v_lshlrev_b32 v96, 16, v104
v_and_b32 v97, 0xffff0000, v104
v_lshlrev_b32 v98, 16, v105
v_and_b32 v99, 0xffff0000, v105
v_lshlrev_b32 v100, 16, v106
v_and_b32 v101, 0xffff0000, v106
v_lshlrev_b32 v102, 16, v107
v_and_b32 v103, 0xffff0000, v107
v_lshlrev_b32 v112, 16, v36
v_and_b32 v113, 0xffff0000, v36
v_lshlrev_b32 v114, 16, v37
v_and_b32 v115, 0xffff0000, v37
v_lshlrev_b32 v116, 16, v38
v_and_b32 v117, 0xffff0000, v38
v_lshlrev_b32 v118, 16, v39
v_and_b32 v119, 0xffff0000, v39
v_add_f32 v96, v96, v112
v_add_f32 v97, v97, v113
v_add_f32 v98, v98, v114
v_add_f32 v99, v99, v115
v_add_f32 v100, v100, v116
v_add_f32 v101, v101, v117
v_add_f32 v102, v102, v118
v_add_f32 v103, v103, v119
v_cvt_pk_bf16_f32 v104, v96, v97
v_cvt_pk_bf16_f32 v105, v98, v99
v_cvt_pk_bf16_f32 v106, v100, v101
v_cvt_pk_bf16_f32 v107, v102, v103
buffer_store_dwordx4 v[104:107], v21, s[20:23], s5 offen sc0 sc1
s_waitcnt lgkmcnt(0)
v_add_f32 v128, v128, v136
v_add_f32 v144, v144, v152
v_add_f32 v129, v129, v137
v_add_f32 v145, v145, v153
v_add_f32 v130, v130, v138
v_add_f32 v146, v146, v154
v_add_f32 v131, v131, v139
v_add_f32 v147, v147, v155
v_add_f32 v132, v132, v140
v_add_f32 v148, v148, v156
v_add_f32 v133, v133, v141
v_add_f32 v149, v149, v157
v_add_f32 v134, v134, v142
v_add_f32 v150, v150, v158
v_add_f32 v135, v135, v143
v_add_f32 v151, v151, v159
v_add_f32 v128, v128, v144
v_add_f32 v129, v129, v145
v_add_f32 v130, v130, v146
v_add_f32 v131, v131, v147
v_add_f32 v132, v132, v148
v_add_f32 v133, v133, v149
v_add_f32 v134, v134, v150
v_add_f32 v135, v135, v151
v_cvt_pk_bf16_f32 v136, v128, v129
v_cvt_pk_bf16_f32 v137, v130, v131
v_cvt_pk_bf16_f32 v138, v132, v133
v_cvt_pk_bf16_f32 v139, v134, v135
v_lshlrev_b32 v128, 16, v136
v_and_b32 v129, 0xffff0000, v136
v_lshlrev_b32 v130, 16, v137
v_and_b32 v131, 0xffff0000, v137
v_lshlrev_b32 v132, 16, v138
v_and_b32 v133, 0xffff0000, v138
v_lshlrev_b32 v134, 16, v139
v_and_b32 v135, 0xffff0000, v139
v_lshlrev_b32 v26, 16, v26
v_add_f32 v128, v128, v26
v_add_f32 v129, v129, v26
v_add_f32 v130, v130, v26
v_add_f32 v131, v131, v26
v_add_f32 v132, v132, v26
v_add_f32 v133, v133, v26
v_add_f32 v134, v134, v26
v_add_f32 v135, v135, v26
v_cvt_pk_bf16_f32 v136, v128, v129
v_cvt_pk_bf16_f32 v137, v130, v131
v_cvt_pk_bf16_f32 v138, v132, v133
v_cvt_pk_bf16_f32 v139, v134, v135
v_lshlrev_b32 v128, 16, v136
v_and_b32 v129, 0xffff0000, v136
v_lshlrev_b32 v130, 16, v137
v_and_b32 v131, 0xffff0000, v137
v_lshlrev_b32 v132, 16, v138
v_and_b32 v133, 0xffff0000, v138
v_lshlrev_b32 v134, 16, v139
v_and_b32 v135, 0xffff0000, v139
v_lshlrev_b32 v144, 16, v40
v_and_b32 v145, 0xffff0000, v40
v_lshlrev_b32 v146, 16, v41
v_and_b32 v147, 0xffff0000, v41
v_lshlrev_b32 v148, 16, v42
v_and_b32 v149, 0xffff0000, v42
v_lshlrev_b32 v150, 16, v43
v_and_b32 v151, 0xffff0000, v43
v_add_f32 v128, v128, v144
v_add_f32 v129, v129, v145
v_add_f32 v130, v130, v146
v_add_f32 v131, v131, v147
v_add_f32 v132, v132, v148
v_add_f32 v133, v133, v149
v_add_f32 v134, v134, v150
v_add_f32 v135, v135, v151
v_cvt_pk_bf16_f32 v136, v128, v129
v_cvt_pk_bf16_f32 v137, v130, v131
v_cvt_pk_bf16_f32 v138, v132, v133
v_cvt_pk_bf16_f32 v139, v134, v135
buffer_store_dwordx4 v[136:139], v22, s[20:23], s5 offen sc0 sc1
s_endpgm
.section .rodata,"a"
.p2align 6
.amdhsa_kernel w2_kernel
  .amdhsa_next_free_vgpr 352
  .amdhsa_next_free_sgpr 96
  .amdhsa_accum_offset 256
  .amdhsa_group_segment_fixed_size 0
  .amdhsa_kernarg_size 112
  .amdhsa_user_sgpr_count 2
  .amdhsa_user_sgpr_kernarg_segment_ptr 1
  .amdhsa_system_sgpr_workgroup_id_x 1
.end_amdhsa_kernel
```
